```python
import torch

def _softmax(x, axis=-1):
    return torch.softmax(x, dim=axis)

def _gelu(x):
    return torch.nn.functional.gelu(x, approximate='tanh')

def _silu(x):
    return torch.nn.functional.silu(x)

def _sigmoid(x):
    return torch.sigmoid(x)

def _layernorm(x, axis=-1, eps=1e-05):
    m = x.mean(dim=axis, keepdim=True)
    v = x.var(dim=axis, keepdim=True, unbiased=False)
    return (x - m) / torch.sqrt(v + eps)

def _scatter_add(tgt, idx, src, axis=0):
    return tgt.clone().index_add_(axis, idx, src)

def _segment_sum(src, seg, n):
    out = torch.zeros((n,) + src.shape[1:], dtype=src.dtype)
    return out.index_add_(0, seg, src)

def _pad(x, pw):
    flat = tuple((v for pair in reversed(pw) for v in pair))
    return torch.nn.functional.pad(x, flat)
kernel_name = 'recurrent_scan__memory_aug_recurrent_mem_tr__swiglu_ffn__prompt'

def setup_inputs():

    _w = lambda a: (lambda t: t.to(torch.bfloat16) if t.is_floating_point() else t)(torch.as_tensor(a))

    def _A_setup():
        B, S, Dm = (1, 2048, 448)
        H, Dh = (16, 256)
        M, seg = (8, 32)
        seg = min(seg, S)
        S = S // seg * seg
        return {'x': _w((lambda *s: torch.randn(*s, dtype=torch.bfloat16) * 0.05)(B, S, Dm)), 'mem0': _w((lambda *s: torch.randn(*s, dtype=torch.bfloat16) * 0.2)(B, M, Dm)), 'Wq': _w((lambda *s: torch.randn(*s, dtype=torch.bfloat16) * 1.6)(Dm, H, Dh) * Dm ** (-0.5)), 'Wk': _w((lambda *s: torch.randn(*s, dtype=torch.bfloat16) * 1.6)(Dm, H, Dh) * Dm ** (-0.5)), 'Wv': _w((lambda *s: torch.randn(*s, dtype=torch.bfloat16) * 0.2)(Dm, H, Dh) * Dm ** (-0.5)), 'Wo': _w((lambda *s: torch.randn(*s, dtype=torch.bfloat16) * 0.2)(H, Dh, Dm) * (H * Dh) ** (-0.5)), 'seg_len': seg}
    _A_in = _A_setup()

    def _B_setup():
        B, S, D, F = (1, 2048, 448, 1792)
        return {'x': _w((lambda *s: torch.randn(*s, dtype=torch.bfloat16) * 0.05)(B, S, D)), 'w_gate': _w((lambda *s: torch.randn(*s, dtype=torch.bfloat16) * 0.1)(D, F)), 'w_up': _w((lambda *s: torch.randn(*s, dtype=torch.bfloat16) * 0.1)(D, F)), 'w_down': _w((lambda *s: torch.randn(*s, dtype=torch.bfloat16) * 0.1)(F, D))}
    _B_in = _B_setup()
    return {'A_x': _A_in['x'], 'A_mem0': _A_in['mem0'], 'A_Wq': _A_in['Wq'], 'A_Wk': _A_in['Wk'], 'A_Wv': _A_in['Wv'], 'A_Wo': _A_in['Wo'], 'A_seg_len': _A_in['seg_len'], 'B_x': _B_in['x'], 'B_w_gate': _B_in['w_gate'], 'B_w_up': _B_in['w_up'], 'B_w_down': _B_in['w_down']}

def reference(A_x, A_mem0, A_Wq, A_Wk, A_Wv, A_Wo, A_seg_len, B_x, B_w_gate, B_w_up, B_w_down):

    def _A_ref(x, mem0, Wq, Wk, Wv, Wo, seg_len):
        B, S, Dm = x.shape
        H, Dh = (Wq.shape[1], Wq.shape[2])
        M = mem0.shape[1]
        scale = Dh ** (-0.5)
        n_seg = S // seg_len
        L = M + seg_len
        idx = torch.arange(L)
        mask = (idx[:, None] < M) | (idx[:, None] >= idx[None, :])
        mem = mem0
        outs = []
        for s in range(n_seg):
            xs = x[:, s * seg_len:(s + 1) * seg_len, :].clone()
            h = torch.concatenate([mem, xs], axis=1)
            q = torch.einsum('btd,dhe->bhte', h, Wq)
            k = torch.einsum('btd,dhe->bhte', h, Wk)
            v = torch.einsum('btd,dhe->bhte', h, Wv)
            scores = torch.einsum('bhqe,bhke->bhqk', q, k) * scale
            scores = torch.where(mask[None, None], scores, -1000000000.0)
            p = _softmax(scores, axis=-1)
            o = torch.einsum('bhqk,bhke->bhqe', p, v)
            o = torch.einsum('bhte,hed->btd', o, Wo)
            mem = o[:, :M, :].clone()
            outs.append(o[:, M:, :])
        return torch.concatenate(outs, axis=1)

    def _B_ref(x, w_gate, w_up, w_down):
        g = _silu(x @ w_gate)
        u = x @ w_up
        return g * u @ w_down
    x = A_x
    xn = _layernorm(x, axis=-1)
    s = _A_ref(xn, A_mem0, A_Wq, A_Wk, A_Wv, A_Wo, A_seg_len)
    g = _silu(_B_ref(xn, B_w_gate, B_w_up, B_w_down))
    return x + s * g
```

```asm
; @launch grid=(256,1,1) block=(256,1,1) lds=147456
.amdgcn_target "amdgcn-amd-amdhsa--gfx950"
.text
.globl recurrent_scan__memory_aug_recurrent_mem_tr__swiglu_ffn__prompt_kernel
.p2align 8
.type recurrent_scan__memory_aug_recurrent_mem_tr__swiglu_ffn__prompt_kernel,@function
recurrent_scan__memory_aug_recurrent_mem_tr__swiglu_ffn__prompt_kernel:
s_cmp_ge_u32 s2, 256
s_cbranch_scc0 Lstart
s_endpgm
Lstart:
s_load_dwordx4 s[4:7], s[0:1], 96
s_load_dwordx4 s[40:43], s[0:1], 0
s_load_dwordx8 s[44:51], s[0:1], 16
s_getreg_b32 s3, hwreg(HW_REG_XCC_ID)
s_and_b32 s3, s3, 15
v_lshrrev_b32 v1, 6, v0
v_and_b32 v2, 63, v0
v_readfirstlane_b32 s17, v1
s_and_b32 s18, s2, 7
s_lshl_b32 s18, s18, 2
s_lshr_b32 s19, s2, 6
s_add_u32 s18, s18, s19
s_lshr_b32 s20, s18, 1
s_and_b32 s21, s18, 1
s_bfe_u32 s22, s2, 0x10005
s_bfe_u32 s23, s2, 0x20003
v_lshrrev_b32 v3, 3, v2
v_lshrrev_b32 v4, 4, v2
v_and_b32 v5, 7, v2
v_xor_b32 v5, v5, v4
v_lshlrev_b32 v10, 13, v3
v_lshl_add_u32 v10, v5, 4, v10
v_xor_b32 v11, 64, v10
v_and_b32 v5, 15, v2
v_lshrrev_b32 v6, 1, v5
v_xor_b32 v6, v6, v4
v_and_b32 v7, 1, v2
v_mul_u32_u24 v8, 896, v4
v_lshl_add_u32 v12, v7, 4, v8
v_lshl_add_u32 v13, v6, 5, v12
v_xor_b32 v6, 4, v6
v_lshl_add_u32 v14, v6, 5, v12
v_mov_b32 v9, 0x40000000
v_cmp_gt_u32 vcc, 7, v6
s_nop 1
v_cndmask_b32 v14, v9, v14, vcc
v_xor_b32 v6, 4, v6
v_cmp_gt_u32 vcc, 7, v6
s_nop 1
v_cndmask_b32 v13, v9, v13, vcc
s_mul_i32 s32, s22, 224*8192
s_lshl_b32 s33, s20, 9
s_add_u32 s32, s32, s33
s_mul_i32 s34, s23, 112*8192
s_add_u32 s34, s34, s33
s_mul_i32 s35, s20, 256*896
s_mul_i32 s36, s23, 224
s_add_u32 s35, s35, s36
s_and_b32 s37, s17, 1
s_cmp_eq_u32 s37, 0
s_cselect_b64 vcc, -1, 0
v_cndmask_b32 v15, v11, v10, vcc
s_lshr_b32 s37, s17, 1
s_cmp_eq_u32 s37, 0
s_cselect_b64 vcc, -1, 0
v_cndmask_b32 v16, v14, v13, vcc
s_lshl_b32 s37, s17, 16
s_add_u32 s32, s32, s37
s_add_u32 s34, s34, s37
s_mul_i32 s37, s17, 3584
s_add_u32 s35, s35, s37
s_lshl_b32 s38, s17, 10
s_cmp_ge_u32 s17, 2
s_cselect_b32 s39, 0x40000000, 0
s_add_u32 s39, s39, s34
s_waitcnt lgkmcnt(0)
s_mov_b32 s12, s4
s_and_b32 s13, s5, 0xffff
s_mov_b32 s14, 256
s_mov_b32 s15, 0x00020000
s_mov_b32 s8, s6
s_and_b32 s9, s7, 0xffff
s_mov_b32 s10, 268435456
s_mov_b32 s11, 0x00020000
s_cmp_eq_u32 s3, 0
s_cselect_b32 s16, 1, 0
s_cmp_eq_u32 s21, 0
s_cselect_b32 s24, s44, s48
s_cselect_b32 s25, s45, s49
s_cselect_b32 s26, s46, s50
s_cselect_b32 s27, s47, s51
s_mov_b32 s56, s24
s_and_b32 s57, s25, 0xffff
s_mov_b32 s58, 3670016
s_mov_b32 s59, 0x00020000
s_mov_b32 s28, s26
s_and_b32 s29, s27, 0xffff
s_mov_b32 s30, 3670016
s_mov_b32 s31, 0x00020000
s_mov_b32 s60, s40
s_and_b32 s61, s41, 0xffff
s_mov_b32 s62, 1835008
s_mov_b32 s63, 0x00020000
s_mov_b32 s64, s42
s_and_b32 s65, s43, 0xffff
s_mov_b32 s66, 7168
s_mov_b32 s67, 0x00020000
v_mov_b32 v250, 1
v_mov_b32 v251, 1073741824
v_cmp_eq_u32 vcc, 0, v2
s_nop 1
v_cndmask_b32 v251, v251, 0, vcc
s_cmp_eq_u32 s16, 1
s_cbranch_scc0 P0nt
s_cmp_eq_u32 s17, 0
s_cbranch_scc0 P0nt
buffer_atomic_add v250, v251, s[12:15], 0 offen sc0
P0nt:
v_lshlrev_b32 v3, 4, v2
v_mov_b32 v9, 1073741824
v_cmp_gt_u32 vcc, 56, v2
s_lshl_b32 s37, s2, 3
s_lshl_b32 s53, s17, 1
v_cndmask_b32 v4, v9, v3, vcc
v_cndmask_b32 v212, 0, 1.0, vcc
s_add_u32 s37, s37, s53
s_mul_i32 s37, s37, 896
buffer_load_dwordx4 v[204:207], v4, s[60:63], s37 offen
buffer_load_dwordx4 v[208:211], v4, s[60:63], s37 offen offset:896
s_cmp_eq_u32 s2, 2
s_cbranch_scc0 P0z
v_lshlrev_b32 v58, 4, v0
v_mov_b32 v244, 0
v_mov_b32 v245, 0
v_mov_b32 v246, 0
v_mov_b32 v247, 0
s_mov_b32 s37, 54853632
buffer_store_dwordx4 v[244:247], v58, s[8:11], s37 offen sc1
s_add_u32 s37, s37, 4096
buffer_store_dwordx4 v[244:247], v58, s[8:11], s37 offen sc1
s_add_u32 s37, s37, 4096
buffer_store_dwordx4 v[244:247], v58, s[8:11], s37 offen sc1
s_add_u32 s37, s37, 4096
buffer_store_dwordx4 v[244:247], v58, s[8:11], s37 offen sc1
s_add_u32 s37, s37, 4096
buffer_store_dwordx4 v[244:247], v58, s[8:11], s37 offen sc1
s_add_u32 s37, s37, 4096
buffer_store_dwordx4 v[244:247], v58, s[8:11], s37 offen sc1
s_add_u32 s37, s37, 4096
buffer_store_dwordx4 v[244:247], v58, s[8:11], s37 offen sc1
s_add_u32 s37, s37, 4096
buffer_store_dwordx4 v[244:247], v58, s[8:11], s37 offen sc1
s_add_u32 s37, s37, 4096
buffer_store_dwordx4 v[244:247], v58, s[8:11], s37 offen sc1
s_add_u32 s37, s37, 4096
buffer_store_dwordx4 v[244:247], v58, s[8:11], s37 offen sc1
s_add_u32 s37, s37, 4096
buffer_store_dwordx4 v[244:247], v58, s[8:11], s37 offen sc1
s_add_u32 s37, s37, 4096
buffer_store_dwordx4 v[244:247], v58, s[8:11], s37 offen sc1
s_add_u32 s37, s37, 4096
buffer_store_dwordx4 v[244:247], v58, s[8:11], s37 offen sc1
s_add_u32 s37, s37, 4096
P0z:
s_cmp_eq_u32 s2, 0
s_cbranch_scc0 P0m0
v_add_u32 v8, 0, v0
v_lshrrev_b32 v9, 6, v8
v_lshlrev_b32 v9, 5, v9
v_bfe_u32 v10, v8, 4, 2
v_lshlrev_b32 v10, 1, v10
v_bfe_u32 v11, v8, 2, 1
v_add_u32 v10, v10, v11
v_mul_u32_u24 v10, 896, v10
v_add_u32 v9, v9, v10
v_bfe_u32 v10, v8, 3, 1
v_lshl_add_u32 v9, v10, 2, v9
v_and_b32 v10, 3, v8
v_lshl_add_u32 v9, v10, 3, v9
buffer_load_dword v238, v9, s[64:67], 0 offen
v_add_u32 v8, 256, v0
v_lshrrev_b32 v9, 6, v8
v_lshlrev_b32 v9, 5, v9
v_bfe_u32 v10, v8, 4, 2
v_lshlrev_b32 v10, 1, v10
v_bfe_u32 v11, v8, 2, 1
v_add_u32 v10, v10, v11
v_mul_u32_u24 v10, 896, v10
v_add_u32 v9, v9, v10
v_bfe_u32 v10, v8, 3, 1
v_lshl_add_u32 v9, v10, 2, v9
v_and_b32 v10, 3, v8
v_lshl_add_u32 v9, v10, 3, v9
buffer_load_dword v239, v9, s[64:67], 0 offen
v_add_u32 v8, 512, v0
v_lshrrev_b32 v9, 6, v8
v_lshlrev_b32 v9, 5, v9
v_bfe_u32 v10, v8, 4, 2
v_lshlrev_b32 v10, 1, v10
v_bfe_u32 v11, v8, 2, 1
v_add_u32 v10, v10, v11
v_mul_u32_u24 v10, 896, v10
v_add_u32 v9, v9, v10
v_bfe_u32 v10, v8, 3, 1
v_lshl_add_u32 v9, v10, 2, v9
v_and_b32 v10, 3, v8
v_lshl_add_u32 v9, v10, 3, v9
buffer_load_dword v240, v9, s[64:67], 0 offen
v_add_u32 v8, 768, v0
v_lshrrev_b32 v9, 6, v8
v_lshlrev_b32 v9, 5, v9
v_bfe_u32 v10, v8, 4, 2
v_lshlrev_b32 v10, 1, v10
v_bfe_u32 v11, v8, 2, 1
v_add_u32 v10, v10, v11
v_mul_u32_u24 v10, 896, v10
v_add_u32 v9, v9, v10
v_bfe_u32 v10, v8, 3, 1
v_lshl_add_u32 v9, v10, 2, v9
v_and_b32 v10, 3, v8
v_lshl_add_u32 v9, v10, 3, v9
buffer_load_dword v241, v9, s[64:67], 0 offen
v_add_u32 v8, 1024, v0
v_lshrrev_b32 v9, 6, v8
v_lshlrev_b32 v9, 5, v9
v_bfe_u32 v10, v8, 4, 2
v_lshlrev_b32 v10, 1, v10
v_bfe_u32 v11, v8, 2, 1
v_add_u32 v10, v10, v11
v_mul_u32_u24 v10, 896, v10
v_add_u32 v9, v9, v10
v_bfe_u32 v10, v8, 3, 1
v_lshl_add_u32 v9, v10, 2, v9
v_and_b32 v10, 3, v8
v_lshl_add_u32 v9, v10, 3, v9
buffer_load_dword v242, v9, s[64:67], 0 offen
v_add_u32 v8, 1280, v0
v_lshrrev_b32 v9, 6, v8
v_lshlrev_b32 v9, 5, v9
v_bfe_u32 v10, v8, 4, 2
v_lshlrev_b32 v10, 1, v10
v_bfe_u32 v11, v8, 2, 1
v_add_u32 v10, v10, v11
v_mul_u32_u24 v10, 896, v10
v_add_u32 v9, v9, v10
v_bfe_u32 v10, v8, 3, 1
v_lshl_add_u32 v9, v10, 2, v9
v_and_b32 v10, 3, v8
v_lshl_add_u32 v9, v10, 3, v9
buffer_load_dword v243, v9, s[64:67], 0 offen
v_add_u32 v8, 1536, v0
v_lshrrev_b32 v9, 6, v8
v_lshlrev_b32 v9, 5, v9
v_bfe_u32 v10, v8, 4, 2
v_lshlrev_b32 v10, 1, v10
v_bfe_u32 v11, v8, 2, 1
v_add_u32 v10, v10, v11
v_mul_u32_u24 v10, 896, v10
v_add_u32 v9, v9, v10
v_bfe_u32 v10, v8, 3, 1
v_lshl_add_u32 v9, v10, 2, v9
v_and_b32 v10, 3, v8
v_lshl_add_u32 v9, v10, 3, v9
buffer_load_dword v244, v9, s[64:67], 0 offen
P0m0:
s_cmp_eq_u32 s21, 0
s_cbranch_scc0 P0gB
s_add_u32 m0, s38, 0
s_add_u32 s37, s32, 0
buffer_load_dwordx4 v15, s[56:59], s37 offen lds
s_add_u32 m0, s38, 4096
s_add_u32 s37, s32, 262144
buffer_load_dwordx4 v15, s[56:59], s37 offen lds
s_add_u32 m0, s38, 8192
s_add_u32 s37, s32, 524288
buffer_load_dwordx4 v15, s[56:59], s37 offen lds
s_add_u32 m0, s38, 12288
s_add_u32 s37, s32, 786432
buffer_load_dwordx4 v15, s[56:59], s37 offen lds
s_add_u32 m0, s38, 16384
s_add_u32 s37, s32, 1048576
buffer_load_dwordx4 v15, s[56:59], s37 offen lds
s_add_u32 m0, s38, 20480
s_add_u32 s37, s32, 1310720
buffer_load_dwordx4 v15, s[56:59], s37 offen lds
s_add_u32 m0, s38, 24576
s_add_u32 s37, s32, 1572864
buffer_load_dwordx4 v15, s[56:59], s37 offen lds
s_add_u32 m0, s38, 28672
s_add_u32 s37, s34, 0
buffer_load_dwordx4 v15, s[28:31], s37 offen lds
s_add_u32 m0, s38, 32768
s_add_u32 s37, s34, 262144
buffer_load_dwordx4 v15, s[28:31], s37 offen lds
s_add_u32 m0, s38, 36864
s_add_u32 s37, s34, 524288
buffer_load_dwordx4 v15, s[28:31], s37 offen lds
s_add_u32 m0, s38, 40960
s_add_u32 s37, s39, 786432
buffer_load_dwordx4 v15, s[28:31], s37 offen lds
s_add_u32 m0, s38, 45056
s_add_u32 s37, s32, 128
buffer_load_dwordx4 v15, s[56:59], s37 offen lds
s_add_u32 m0, s38, 49152
s_add_u32 s37, s32, 262272
buffer_load_dwordx4 v15, s[56:59], s37 offen lds
s_add_u32 m0, s38, 53248
s_add_u32 s37, s32, 524416
buffer_load_dwordx4 v15, s[56:59], s37 offen lds
s_add_u32 m0, s38, 57344
s_add_u32 s37, s32, 786560
buffer_load_dwordx4 v15, s[56:59], s37 offen lds
s_add_u32 m0, s38, 61440
s_add_u32 s37, s32, 1048704
buffer_load_dwordx4 v15, s[56:59], s37 offen lds
s_add_u32 m0, s38, 65536
s_add_u32 s37, s32, 1310848
buffer_load_dwordx4 v15, s[56:59], s37 offen lds
s_add_u32 m0, s38, 69632
s_add_u32 s37, s32, 1572992
buffer_load_dwordx4 v15, s[56:59], s37 offen lds
s_add_u32 m0, s38, 73728
s_add_u32 s37, s34, 128
buffer_load_dwordx4 v15, s[28:31], s37 offen lds
s_add_u32 m0, s38, 77824
s_add_u32 s37, s34, 262272
buffer_load_dwordx4 v15, s[28:31], s37 offen lds
s_add_u32 m0, s38, 81920
s_add_u32 s37, s34, 524416
buffer_load_dwordx4 v15, s[28:31], s37 offen lds
s_add_u32 m0, s38, 86016
s_add_u32 s37, s39, 786560
buffer_load_dwordx4 v15, s[28:31], s37 offen lds
s_add_u32 m0, s38, 90112
s_add_u32 s37, s32, 256
buffer_load_dwordx4 v15, s[56:59], s37 offen lds
s_add_u32 m0, s38, 94208
s_add_u32 s37, s32, 262400
buffer_load_dwordx4 v15, s[56:59], s37 offen lds
s_add_u32 m0, s38, 98304
s_add_u32 s37, s32, 524544
buffer_load_dwordx4 v15, s[56:59], s37 offen lds
s_add_u32 m0, s38, 102400
s_add_u32 s37, s32, 786688
buffer_load_dwordx4 v15, s[56:59], s37 offen lds
s_add_u32 m0, s38, 106496
s_add_u32 s37, s32, 1048832
buffer_load_dwordx4 v15, s[56:59], s37 offen lds
s_add_u32 m0, s38, 110592
s_add_u32 s37, s32, 1310976
buffer_load_dwordx4 v15, s[56:59], s37 offen lds
s_add_u32 m0, s38, 114688
s_add_u32 s37, s32, 1573120
buffer_load_dwordx4 v15, s[56:59], s37 offen lds
s_add_u32 m0, s38, 118784
s_add_u32 s37, s34, 256
buffer_load_dwordx4 v15, s[28:31], s37 offen lds
s_add_u32 m0, s38, 122880
s_add_u32 s37, s34, 262400
buffer_load_dwordx4 v15, s[28:31], s37 offen lds
s_add_u32 m0, s38, 126976
s_add_u32 s37, s34, 524544
buffer_load_dwordx4 v15, s[28:31], s37 offen lds
s_add_u32 m0, s38, 131072
s_add_u32 s37, s39, 786688
buffer_load_dwordx4 v15, s[28:31], s37 offen lds
s_cmp_ge_u32 s2, 16
s_cbranch_scc1 P0ni_1
v_lshlrev_b32 v58, 4, v0
v_mov_b32 v60, -1
v_mov_b32 v61, -1
v_mov_b32 v62, -1
v_mov_b32 v63, -1
s_lshl_b32 s37, s2, 15
s_add_u32 s37, s37, 53477376
buffer_store_dwordx4 v[60:63], v58, s[8:11], s37 offen sc1
s_add_u32 s37, s37, 4096
buffer_store_dwordx4 v[60:63], v58, s[8:11], s37 offen sc1
s_add_u32 s37, s37, 4096
buffer_store_dwordx4 v[60:63], v58, s[8:11], s37 offen sc1
s_add_u32 s37, s37, 4096
buffer_store_dwordx4 v[60:63], v58, s[8:11], s37 offen sc1
s_add_u32 s37, s37, 4096
buffer_store_dwordx4 v[60:63], v58, s[8:11], s37 offen sc1
s_add_u32 s37, s37, 4096
buffer_store_dwordx4 v[60:63], v58, s[8:11], s37 offen sc1
s_add_u32 s37, s37, 4096
buffer_store_dwordx4 v[60:63], v58, s[8:11], s37 offen sc1
s_add_u32 s37, s37, 4096
buffer_store_dwordx4 v[60:63], v58, s[8:11], s37 offen sc1
s_add_u32 s37, s37, 4096
s_cmp_eq_u32 s2, 1
s_cbranch_scc0 P0i2_2
s_mov_b32 s37, 54534144
buffer_store_dwordx4 v[60:63], v58, s[8:11], s37 offen sc1
s_mov_b32 s37, 54538240
buffer_store_dwordx4 v[60:63], v58, s[8:11], s37 offen sc1
s_mov_b32 s37, 54788096
buffer_store_dwordx4 v[60:63], v58, s[8:11], s37 offen sc1
s_add_u32 s37, s37, 4096
buffer_store_dwordx4 v[60:63], v58, s[8:11], s37 offen sc1
s_add_u32 s37, s37, 4096
buffer_store_dwordx4 v[60:63], v58, s[8:11], s37 offen sc1
s_add_u32 s37, s37, 4096
buffer_store_dwordx4 v[60:63], v58, s[8:11], s37 offen sc1
s_add_u32 s37, s37, 4096
buffer_store_dwordx4 v[60:63], v58, s[8:11], s37 offen sc1
s_add_u32 s37, s37, 4096
buffer_store_dwordx4 v[60:63], v58, s[8:11], s37 offen sc1
s_add_u32 s37, s37, 4096
buffer_store_dwordx4 v[60:63], v58, s[8:11], s37 offen sc1
s_add_u32 s37, s37, 4096
buffer_store_dwordx4 v[60:63], v58, s[8:11], s37 offen sc1
s_add_u32 s37, s37, 4096
P0i2_2:
P0ni_1:
v_lshrrev_b32 v4, 4, v2
v_and_b32 v5, 15, v2
v_lshrrev_b32 v6, 2, v5
v_and_b32 v7, 3, v5
v_lshl_add_u32 v6, v6, 3, v7
s_lshl_b32 s37, s17, 6
v_add_u32 v6, s37, v6
v_bfe_u32 v7, v6, 1, 3
v_xor_b32 v7, v7, v4
v_lshlrev_b32 v20, 7, v6
v_lshl_add_u32 v20, v7, 4, v20
v_xor_b32 v21, 64, v20
v_xor_b32 v22, 32, v20
v_add_u32 v22, 512, v22
v_xor_b32 v23, 64, v22
v_lshrrev_b32 v7, 1, v5
v_xor_b32 v7, v7, v4
v_lshlrev_b32 v24, 7, v5
v_lshl_add_u32 v24, v7, 4, v24
v_add_u32 v24, 28672, v24
v_xor_b32 v25, 64, v24
v_and_b32 v7, 7, v5
v_xor_b32 v7, v7, v4
v_lshlrev_b32 v17, 8, v5
v_lshl_add_u32 v17, v7, 4, v17
v_add_u32 v17, 28672, v17
v_xor_b32 v18, 64, v17
v_bfe_u32 v6, v2, 2, 2
v_lshl_add_u32 v7, v4, 3, v6
v_lshlrev_b32 v26, 8, v7
v_and_b32 v7, 3, v2
v_lshl_add_u32 v26, v7, 3, v26
v_add_u32 v26, 28672, v26
v_and_b32 v7, 1, v4
v_lshl_add_u32 v6, v7, 2, v6
v_xor_b32 v7, 0, v6
v_lshl_add_u32 v27, v7, 5, v26
v_xor_b32 v7, 1, v6
v_lshl_add_u32 v28, v7, 5, v26
v_xor_b32 v7, 2, v6
v_lshl_add_u32 v29, v7, 5, v26
v_xor_b32 v7, 3, v6
v_lshl_add_u32 v30, v7, 5, v26
v_xor_b32 v7, 4, v6
v_lshl_add_u32 v31, v7, 5, v26
v_xor_b32 v7, 5, v6
v_lshl_add_u32 v32, v7, 5, v26
v_xor_b32 v7, 6, v6
v_lshl_add_u32 v33, v7, 5, v26
v_mov_b32 v64, 0
v_mov_b32 v65, 0
v_mov_b32 v66, 0
v_mov_b32 v67, 0
v_mov_b32 v68, 0
v_mov_b32 v69, 0
v_mov_b32 v70, 0
v_mov_b32 v71, 0
v_mov_b32 v72, 0
v_mov_b32 v73, 0
v_mov_b32 v74, 0
v_mov_b32 v75, 0
v_mov_b32 v76, 0
v_mov_b32 v77, 0
v_mov_b32 v78, 0
v_mov_b32 v79, 0
v_mov_b32 v80, 0
v_mov_b32 v81, 0
v_mov_b32 v82, 0
v_mov_b32 v83, 0
v_mov_b32 v84, 0
v_mov_b32 v85, 0
v_mov_b32 v86, 0
v_mov_b32 v87, 0
v_mov_b32 v88, 0
v_mov_b32 v89, 0
v_mov_b32 v90, 0
v_mov_b32 v91, 0
v_mov_b32 v92, 0
v_mov_b32 v93, 0
v_mov_b32 v94, 0
v_mov_b32 v95, 0
v_mov_b32 v96, 0
v_mov_b32 v97, 0
v_mov_b32 v98, 0
v_mov_b32 v99, 0
v_mov_b32 v100, 0
v_mov_b32 v101, 0
v_mov_b32 v102, 0
v_mov_b32 v103, 0
v_mov_b32 v104, 0
v_mov_b32 v105, 0
v_mov_b32 v106, 0
v_mov_b32 v107, 0
v_mov_b32 v108, 0
v_mov_b32 v109, 0
v_mov_b32 v110, 0
v_mov_b32 v111, 0
v_mov_b32 v112, 0
v_mov_b32 v113, 0
v_mov_b32 v114, 0
v_mov_b32 v115, 0
v_mov_b32 v116, 0
v_mov_b32 v117, 0
v_mov_b32 v118, 0
v_mov_b32 v119, 0
v_mov_b32 v120, 0
v_mov_b32 v121, 0
v_mov_b32 v122, 0
v_mov_b32 v123, 0
v_mov_b32 v124, 0
v_mov_b32 v125, 0
v_mov_b32 v126, 0
v_mov_b32 v127, 0
v_mov_b32 v128, 0
v_mov_b32 v129, 0
v_mov_b32 v130, 0
v_mov_b32 v131, 0
v_mov_b32 v132, 0
v_mov_b32 v133, 0
v_mov_b32 v134, 0
v_mov_b32 v135, 0
v_mov_b32 v136, 0
v_mov_b32 v137, 0
v_mov_b32 v138, 0
v_mov_b32 v139, 0
v_mov_b32 v140, 0
v_mov_b32 v141, 0
v_mov_b32 v142, 0
v_mov_b32 v143, 0
v_mov_b32 v144, 0
v_mov_b32 v145, 0
v_mov_b32 v146, 0
v_mov_b32 v147, 0
v_mov_b32 v148, 0
v_mov_b32 v149, 0
v_mov_b32 v150, 0
v_mov_b32 v151, 0
v_mov_b32 v152, 0
v_mov_b32 v153, 0
v_mov_b32 v154, 0
v_mov_b32 v155, 0
v_mov_b32 v156, 0
v_mov_b32 v157, 0
v_mov_b32 v158, 0
v_mov_b32 v159, 0
v_mov_b32 v160, 0
v_mov_b32 v161, 0
v_mov_b32 v162, 0
v_mov_b32 v163, 0
v_mov_b32 v164, 0
v_mov_b32 v165, 0
v_mov_b32 v166, 0
v_mov_b32 v167, 0
v_mov_b32 v168, 0
v_mov_b32 v169, 0
v_mov_b32 v170, 0
v_mov_b32 v171, 0
v_mov_b32 v172, 0
v_mov_b32 v173, 0
v_mov_b32 v174, 0
v_mov_b32 v175, 0
s_mov_b32 s52, 0x3B124925
s_mov_b32 s53, 0x3727C5AC
s_mul_i32 s54, s17, 2080
s_add_u32 s54, s54, 135168
v_lshlrev_b32 v215, 4, v2
v_add_u32 v215, s54, v215
s_waitcnt vmcnt(33)
v_lshlrev_b32 v216, 16, v204
v_and_b32 v217, 0xffff0000, v204
v_lshlrev_b32 v218, 16, v205
v_and_b32 v219, 0xffff0000, v205
v_lshlrev_b32 v220, 16, v206
v_and_b32 v221, 0xffff0000, v206
v_lshlrev_b32 v222, 16, v207
v_and_b32 v223, 0xffff0000, v207
v_lshlrev_b32 v224, 16, v208
v_and_b32 v225, 0xffff0000, v208
v_lshlrev_b32 v226, 16, v209
v_and_b32 v227, 0xffff0000, v209
v_lshlrev_b32 v228, 16, v210
v_and_b32 v229, 0xffff0000, v210
v_lshlrev_b32 v230, 16, v211
v_and_b32 v231, 0xffff0000, v211
v_pk_add_f32 v[232:233], v[216:217], v[218:219]
v_pk_add_f32 v[234:235], v[224:225], v[226:227]
v_pk_add_f32 v[232:233], v[232:233], v[220:221]
v_pk_add_f32 v[234:235], v[234:235], v[228:229]
v_pk_add_f32 v[232:233], v[232:233], v[222:223]
v_pk_add_f32 v[234:235], v[234:235], v[230:231]
v_add_f32 v232, v232, v233
v_add_f32 v234, v234, v235
s_nop 0
v_add_f32_dpp v232, v232, v232 quad_perm:[1,0,3,2] row_mask:0xf bank_mask:0xf
v_add_f32_dpp v234, v234, v234 quad_perm:[1,0,3,2] row_mask:0xf bank_mask:0xf
s_nop 0
v_add_f32_dpp v232, v232, v232 quad_perm:[2,3,0,1] row_mask:0xf bank_mask:0xf
v_add_f32_dpp v234, v234, v234 quad_perm:[2,3,0,1] row_mask:0xf bank_mask:0xf
s_nop 0
v_add_f32_dpp v232, v232, v232 row_half_mirror row_mask:0xf bank_mask:0xf
v_add_f32_dpp v234, v234, v234 row_half_mirror row_mask:0xf bank_mask:0xf
s_nop 0
v_add_f32_dpp v232, v232, v232 row_mirror row_mask:0xf bank_mask:0xf
v_add_f32_dpp v234, v234, v234 row_mirror row_mask:0xf bank_mask:0xf
v_mov_b32 v236, v232
v_mov_b32 v237, v234
s_nop 0
v_permlane16_swap_b32 v236, v232
v_permlane16_swap_b32 v237, v234
v_add_f32 v232, v232, v236
v_add_f32 v234, v234, v237
v_mov_b32 v236, v232
v_mov_b32 v237, v234
s_nop 0
v_permlane32_swap_b32 v236, v232
v_permlane32_swap_b32 v237, v234
v_add_f32 v232, v232, v236
v_add_f32 v234, v234, v237
v_mul_f32 v232, s52, v232
v_mul_f32 v234, s52, v234
v_pk_add_f32 v[216:217], v[216:217], v[232:233] op_sel_hi:[1,0] neg_lo:[0,1] neg_hi:[0,1]
v_pk_add_f32 v[224:225], v[224:225], v[234:235] op_sel_hi:[1,0] neg_lo:[0,1] neg_hi:[0,1]
v_pk_add_f32 v[218:219], v[218:219], v[232:233] op_sel_hi:[1,0] neg_lo:[0,1] neg_hi:[0,1]
v_pk_add_f32 v[226:227], v[226:227], v[234:235] op_sel_hi:[1,0] neg_lo:[0,1] neg_hi:[0,1]
v_pk_add_f32 v[220:221], v[220:221], v[232:233] op_sel_hi:[1,0] neg_lo:[0,1] neg_hi:[0,1]
v_pk_add_f32 v[228:229], v[228:229], v[234:235] op_sel_hi:[1,0] neg_lo:[0,1] neg_hi:[0,1]
v_pk_add_f32 v[222:223], v[222:223], v[232:233] op_sel_hi:[1,0] neg_lo:[0,1] neg_hi:[0,1]
v_pk_add_f32 v[230:231], v[230:231], v[234:235] op_sel_hi:[1,0] neg_lo:[0,1] neg_hi:[0,1]
v_pk_mul_f32 v[232:233], v[216:217], v[216:217]
v_pk_mul_f32 v[234:235], v[224:225], v[224:225]
v_pk_fma_f32 v[232:233], v[218:219], v[218:219], v[232:233]
v_pk_fma_f32 v[234:235], v[226:227], v[226:227], v[234:235]
v_pk_fma_f32 v[232:233], v[220:221], v[220:221], v[232:233]
v_pk_fma_f32 v[234:235], v[228:229], v[228:229], v[234:235]
v_pk_fma_f32 v[232:233], v[222:223], v[222:223], v[232:233]
v_pk_fma_f32 v[234:235], v[230:231], v[230:231], v[234:235]
v_add_f32 v232, v232, v233
v_add_f32 v234, v234, v235
v_mul_f32 v232, v232, v212
v_mul_f32 v234, v234, v212
s_nop 0
v_add_f32_dpp v232, v232, v232 quad_perm:[1,0,3,2] row_mask:0xf bank_mask:0xf
v_add_f32_dpp v234, v234, v234 quad_perm:[1,0,3,2] row_mask:0xf bank_mask:0xf
s_nop 0
v_add_f32_dpp v232, v232, v232 quad_perm:[2,3,0,1] row_mask:0xf bank_mask:0xf
v_add_f32_dpp v234, v234, v234 quad_perm:[2,3,0,1] row_mask:0xf bank_mask:0xf
s_nop 0
v_add_f32_dpp v232, v232, v232 row_half_mirror row_mask:0xf bank_mask:0xf
v_add_f32_dpp v234, v234, v234 row_half_mirror row_mask:0xf bank_mask:0xf
s_nop 0
v_add_f32_dpp v232, v232, v232 row_mirror row_mask:0xf bank_mask:0xf
v_add_f32_dpp v234, v234, v234 row_mirror row_mask:0xf bank_mask:0xf
v_mov_b32 v236, v232
v_mov_b32 v237, v234
s_nop 0
v_permlane16_swap_b32 v236, v232
v_permlane16_swap_b32 v237, v234
v_add_f32 v232, v232, v236
v_add_f32 v234, v234, v237
v_mov_b32 v236, v232
v_mov_b32 v237, v234
s_nop 0
v_permlane32_swap_b32 v236, v232
v_permlane32_swap_b32 v237, v234
v_add_f32 v232, v232, v236
v_add_f32 v234, v234, v237
v_mov_b32 v236, s53
v_fmac_f32 v236, s52, v232
v_mov_b32 v237, s53
v_fmac_f32 v237, s52, v234
v_rsq_f32 v232, v236
v_rsq_f32 v234, v237
s_nop 0
v_pk_mul_f32 v[216:217], v[216:217], v[232:233] op_sel_hi:[1,0]
v_pk_mul_f32 v[224:225], v[224:225], v[234:235] op_sel_hi:[1,0]
v_pk_mul_f32 v[218:219], v[218:219], v[232:233] op_sel_hi:[1,0]
v_pk_mul_f32 v[226:227], v[226:227], v[234:235] op_sel_hi:[1,0]
v_pk_mul_f32 v[220:221], v[220:221], v[232:233] op_sel_hi:[1,0]
v_pk_mul_f32 v[228:229], v[228:229], v[234:235] op_sel_hi:[1,0]
v_pk_mul_f32 v[222:223], v[222:223], v[232:233] op_sel_hi:[1,0]
v_pk_mul_f32 v[230:231], v[230:231], v[234:235] op_sel_hi:[1,0]
v_cvt_pk_bf16_f32 v204, v216, v217
v_cvt_pk_bf16_f32 v205, v218, v219
v_cvt_pk_bf16_f32 v206, v220, v221
v_cvt_pk_bf16_f32 v207, v222, v223
ds_write_b128 v215, v[204:207] offset:0
v_cvt_pk_bf16_f32 v208, v224, v225
v_cvt_pk_bf16_f32 v209, v226, v227
v_cvt_pk_bf16_f32 v210, v228, v229
v_cvt_pk_bf16_f32 v211, v230, v231
ds_write_b128 v215, v[208:211] offset:1040
s_waitcnt vmcnt(22) lgkmcnt(0)
s_barrier
s_cmp_eq_u32 s2, 2
s_cbranch_scc0 P0ic_3
s_cmp_eq_u32 s17, 0
s_cbranch_scc0 P0ic_3
v_mov_b32 v4, 1
v_mov_b32 v5, 1073741824
v_cmp_eq_u32 vcc, 0, v2
s_nop 1
v_cndmask_b32 v5, v5, 0, vcc
buffer_atomic_add v4, v5, s[12:15], 0 offen offset:8
P0ic_3:
s_cmp_eq_u32 s2, 0
s_cbranch_scc0 P0ms_4
s_waitcnt vmcnt(0)
s_mov_b32 s37, 54525952
v_lshlrev_b32 v59, 2, v0
buffer_store_dword v238, v59, s[8:11], s37 offen sc1
s_add_u32 s37, s37, 4293918720
buffer_store_dword v238, v59, s[8:11], s37 offen sc1
s_add_u32 s37, s37, 1049600
buffer_store_dword v239, v59, s[8:11], s37 offen sc1
s_add_u32 s37, s37, 4293918720
buffer_store_dword v239, v59, s[8:11], s37 offen sc1
s_add_u32 s37, s37, 1049600
buffer_store_dword v240, v59, s[8:11], s37 offen sc1
s_add_u32 s37, s37, 4293918720
buffer_store_dword v240, v59, s[8:11], s37 offen sc1
s_add_u32 s37, s37, 1049600
buffer_store_dword v241, v59, s[8:11], s37 offen sc1
s_add_u32 s37, s37, 4293918720
buffer_store_dword v241, v59, s[8:11], s37 offen sc1
s_add_u32 s37, s37, 1049600
buffer_store_dword v242, v59, s[8:11], s37 offen sc1
s_add_u32 s37, s37, 4293918720
buffer_store_dword v242, v59, s[8:11], s37 offen sc1
s_add_u32 s37, s37, 1049600
buffer_store_dword v243, v59, s[8:11], s37 offen sc1
s_add_u32 s37, s37, 4293918720
buffer_store_dword v243, v59, s[8:11], s37 offen sc1
s_add_u32 s37, s37, 1049600
buffer_store_dword v244, v59, s[8:11], s37 offen sc1
s_add_u32 s37, s37, 4293918720
buffer_store_dword v244, v59, s[8:11], s37 offen sc1
s_add_u32 s37, s37, 1049600
P0ms_4:
s_cmp_eq_u32 s16, 1
s_cbranch_scc0 P0tk_5
s_cmp_eq_u32 s17, 0
s_cbranch_scc0 P0tk_5
v_readfirstlane_b32 s52, v250
v_mov_b32 v252, 147440
v_mov_b32 v248, 1
v_mov_b32 v253, s52
v_mov_b32 v249, 0
ds_write_b32 v252, v253
s_cmp_eq_u32 s52, 31
s_cbranch_scc0 P0tk_5
buffer_atomic_cmpswap v[248:249], v251, s[12:15], 0 offen offset:4
P0tk_5:
v_and_b32 v36, 7, v0
v_lshrrev_b32 v35, 3, v0
v_mul_u32_u24 v37, 1040, v36
v_add_u32 v37, 135168, v37
v_lshl_add_u32 v38, v35, 4, v37
v_lshrrev_b32 v34, 1, v35
v_lshl_add_u32 v39, v34, 5, v37
v_and_b32 v34, 1, v35
v_lshl_add_u32 v39, v34, 2, v39
ds_read_b128 a[0:3], v38
ds_read_b128 a[4:7], v38 offset:512
ds_read2_b32 a[8:9], v39 offset0:0 offset1:2
ds_read2_b32 a[10:11], v39 offset0:4 offset1:6
ds_read2_b32 a[12:13], v39 offset0:128 offset1:130
ds_read2_b32 a[14:15], v39 offset0:132 offset1:134
v_lshlrev_b32 v36, 4, v36
v_lshl_add_u32 v37, v35, 9, v36
v_lshl_add_u32 v38, v35, 8, v36
v_add_u32 v39, 16384, v37
v_add_u32 v56, 8192, v38
v_mov_b32 v34, 1073741824
v_cmp_gt_u32 vcc, 192, v0
s_lshr_b32 s52, s2, 2
s_mul_i32 s52, s52, 28672
v_cndmask_b32 v39, v34, v39, vcc
v_cndmask_b32 v56, v34, v56, vcc
s_and_b32 s53, s2, 3
s_lshl_b32 s54, s53, 7
s_add_u32 s54, s54, s52
s_add_u32 s54, s54, 55574528
s_and_b32 s55, s53, 1
s_lshl_b32 s55, s55, 7
s_add_u32 s52, s52, s55
s_lshr_b32 s53, s53, 1
s_mul_i32 s53, s53, 14336
s_add_u32 s52, s52, s53
s_add_u32 s52, s52, 14680064
s_waitcnt lgkmcnt(0)
buffer_store_dwordx4 a[0:3], v37, s[8:11], s54 offen sc1
buffer_store_dwordx4 a[4:7], v39, s[8:11], s54 offen sc1
buffer_store_dwordx4 a[8:11], v38, s[8:11], s52 offen sc1
buffer_store_dwordx4 a[12:15], v56, s[8:11], s52 offen sc1
ds_read_b128 v[40:43], v20 offset:0
ds_read_b128 v[44:47], v22 offset:0
ds_read_b128 v[48:51], v20 offset:4096
ds_read_b128 v[52:55], v22 offset:4096
ds_read_b128 v[192:195], v17 offset:0
ds_read_b128 v[196:199], v17 offset:128
ds_read_b128 v[200:203], v17 offset:4096
ds_read_b128 v[204:207], v17 offset:4224
ds_read_b128 v[208:211], v17 offset:8192
ds_read_b128 v[212:215], v17 offset:8320
ds_read_b128 v[216:219], v24 offset:12288
s_mov_b32 s55, 0
P0l_6:
s_waitcnt lgkmcnt(0)
v_mfma_f32_16x16x32_bf16 v[64:67], v[40:43], v[192:195], v[64:67]
ds_read_b128 v[176:179], v21 offset:0
v_mfma_f32_16x16x32_bf16 v[68:71], v[44:47], v[192:195], v[68:71]
ds_read_b128 v[180:183], v23 offset:0
v_mfma_f32_16x16x32_bf16 v[72:75], v[48:51], v[192:195], v[72:75]
ds_read_b128 v[184:187], v21 offset:4096
v_mfma_f32_16x16x32_bf16 v[76:79], v[52:55], v[192:195], v[76:79]
ds_read_b128 v[188:191], v23 offset:4096
v_mfma_f32_16x16x32_bf16 v[80:83], v[40:43], v[196:199], v[80:83]
ds_read_b128 v[220:223], v18 offset:0
v_mfma_f32_16x16x32_bf16 v[84:87], v[44:47], v[196:199], v[84:87]
ds_read_b128 v[224:227], v18 offset:128
v_mfma_f32_16x16x32_bf16 v[88:91], v[48:51], v[196:199], v[88:91]
ds_read_b128 v[228:231], v18 offset:4096
v_mfma_f32_16x16x32_bf16 v[92:95], v[52:55], v[196:199], v[92:95]
ds_read_b128 v[232:235], v18 offset:4224
v_mfma_f32_16x16x32_bf16 v[96:99], v[40:43], v[200:203], v[96:99]
ds_read_b128 v[236:239], v18 offset:8192
v_mfma_f32_16x16x32_bf16 v[100:103], v[44:47], v[200:203], v[100:103]
ds_read_b128 v[240:243], v18 offset:8320
v_mfma_f32_16x16x32_bf16 v[104:107], v[48:51], v[200:203], v[104:107]
ds_read_b128 v[244:247], v25 offset:12288
v_mfma_f32_16x16x32_bf16 v[108:111], v[52:55], v[200:203], v[108:111]
v_mfma_f32_16x16x32_bf16 v[112:115], v[40:43], v[204:207], v[112:115]
v_mfma_f32_16x16x32_bf16 v[116:119], v[44:47], v[204:207], v[116:119]
v_mfma_f32_16x16x32_bf16 v[120:123], v[48:51], v[204:207], v[120:123]
v_mfma_f32_16x16x32_bf16 v[124:127], v[52:55], v[204:207], v[124:127]
v_mfma_f32_16x16x32_bf16 v[128:131], v[40:43], v[208:211], v[128:131]
v_mfma_f32_16x16x32_bf16 v[132:135], v[44:47], v[208:211], v[132:135]
v_mfma_f32_16x16x32_bf16 v[136:139], v[48:51], v[208:211], v[136:139]
v_mfma_f32_16x16x32_bf16 v[140:143], v[52:55], v[208:211], v[140:143]
v_mfma_f32_16x16x32_bf16 v[144:147], v[40:43], v[212:215], v[144:147]
v_mfma_f32_16x16x32_bf16 v[148:151], v[44:47], v[212:215], v[148:151]
v_mfma_f32_16x16x32_bf16 v[152:155], v[48:51], v[212:215], v[152:155]
v_mfma_f32_16x16x32_bf16 v[156:159], v[52:55], v[212:215], v[156:159]
v_mfma_f32_16x16x32_bf16 v[160:163], v[40:43], v[216:219], v[160:163]
v_mfma_f32_16x16x32_bf16 v[164:167], v[44:47], v[216:219], v[164:167]
v_mfma_f32_16x16x32_bf16 v[168:171], v[48:51], v[216:219], v[168:171]
v_mfma_f32_16x16x32_bf16 v[172:175], v[52:55], v[216:219], v[172:175]
s_cmp_eq_u32 s55, 3
s_cbranch_scc1 P0sk_10
s_mov_b32 s69, 45056
s_cmp_eq_u32 s55, 1
s_cbranch_scc1 P0w0_8
s_cmp_eq_u32 s55, 2
s_cbranch_scc1 P0w0_8b
s_waitcnt vmcnt(15) lgkmcnt(0)
s_branch P0w1_9
P0w0_8b:
s_mov_b32 s69, 4294877184
s_waitcnt vmcnt(0) lgkmcnt(0)
s_branch P0w1_9
P0w0_8:
s_waitcnt vmcnt(11) lgkmcnt(0)
P0w1_9:
s_barrier
v_add_u32 v20, s69, v20
v_add_u32 v21, s69, v21
v_add_u32 v22, s69, v22
v_add_u32 v23, s69, v23
v_add_u32 v24, s69, v24
v_add_u32 v25, s69, v25
v_add_u32 v17, s69, v17
v_add_u32 v18, s69, v18
s_cmp_lg_u32 s55, 0
s_cbranch_scc1 P0n3_7
s_add_u32 m0, s38, 0
s_add_u32 s37, s32, 384
buffer_load_dwordx4 v15, s[56:59], s37 offen lds
s_add_u32 m0, s38, 4096
s_add_u32 s37, s32, 262528
buffer_load_dwordx4 v15, s[56:59], s37 offen lds
s_add_u32 m0, s38, 8192
s_add_u32 s37, s32, 524672
buffer_load_dwordx4 v15, s[56:59], s37 offen lds
s_add_u32 m0, s38, 12288
s_add_u32 s37, s32, 786816
buffer_load_dwordx4 v15, s[56:59], s37 offen lds
s_add_u32 m0, s38, 16384
s_add_u32 s37, s32, 1048960
buffer_load_dwordx4 v15, s[56:59], s37 offen lds
s_add_u32 m0, s38, 20480
s_add_u32 s37, s32, 1311104
buffer_load_dwordx4 v15, s[56:59], s37 offen lds
s_add_u32 m0, s38, 24576
s_add_u32 s37, s32, 1573248
buffer_load_dwordx4 v15, s[56:59], s37 offen lds
s_add_u32 m0, s38, 28672
s_add_u32 s37, s34, 384
buffer_load_dwordx4 v15, s[28:31], s37 offen lds
s_add_u32 m0, s38, 32768
s_add_u32 s37, s34, 262528
buffer_load_dwordx4 v15, s[28:31], s37 offen lds
s_add_u32 m0, s38, 36864
s_add_u32 s37, s34, 524672
buffer_load_dwordx4 v15, s[28:31], s37 offen lds
s_add_u32 m0, s38, 40960
s_add_u32 s37, s39, 786816
buffer_load_dwordx4 v15, s[28:31], s37 offen lds
s_mov_b32 s55, 0
P0n3_7:
v_mfma_f32_16x16x32_bf16 v[64:67], v[176:179], v[220:223], v[64:67]
ds_read_b128 v[40:43], v20 offset:0
v_mfma_f32_16x16x32_bf16 v[68:71], v[180:183], v[220:223], v[68:71]
ds_read_b128 v[44:47], v22 offset:0
v_mfma_f32_16x16x32_bf16 v[72:75], v[184:187], v[220:223], v[72:75]
ds_read_b128 v[48:51], v20 offset:4096
v_mfma_f32_16x16x32_bf16 v[76:79], v[188:191], v[220:223], v[76:79]
ds_read_b128 v[52:55], v22 offset:4096
v_mfma_f32_16x16x32_bf16 v[80:83], v[176:179], v[224:227], v[80:83]
ds_read_b128 v[192:195], v17 offset:0
v_mfma_f32_16x16x32_bf16 v[84:87], v[180:183], v[224:227], v[84:87]
ds_read_b128 v[196:199], v17 offset:128
v_mfma_f32_16x16x32_bf16 v[88:91], v[184:187], v[224:227], v[88:91]
ds_read_b128 v[200:203], v17 offset:4096
v_mfma_f32_16x16x32_bf16 v[92:95], v[188:191], v[224:227], v[92:95]
ds_read_b128 v[204:207], v17 offset:4224
v_mfma_f32_16x16x32_bf16 v[96:99], v[176:179], v[228:231], v[96:99]
ds_read_b128 v[208:211], v17 offset:8192
v_mfma_f32_16x16x32_bf16 v[100:103], v[180:183], v[228:231], v[100:103]
ds_read_b128 v[212:215], v17 offset:8320
v_mfma_f32_16x16x32_bf16 v[104:107], v[184:187], v[228:231], v[104:107]
ds_read_b128 v[216:219], v24 offset:12288
v_mfma_f32_16x16x32_bf16 v[108:111], v[188:191], v[228:231], v[108:111]
v_mfma_f32_16x16x32_bf16 v[112:115], v[176:179], v[232:235], v[112:115]
v_mfma_f32_16x16x32_bf16 v[116:119], v[180:183], v[232:235], v[116:119]
v_mfma_f32_16x16x32_bf16 v[120:123], v[184:187], v[232:235], v[120:123]
v_mfma_f32_16x16x32_bf16 v[124:127], v[188:191], v[232:235], v[124:127]
v_mfma_f32_16x16x32_bf16 v[128:131], v[176:179], v[236:239], v[128:131]
v_mfma_f32_16x16x32_bf16 v[132:135], v[180:183], v[236:239], v[132:135]
v_mfma_f32_16x16x32_bf16 v[136:139], v[184:187], v[236:239], v[136:139]
v_mfma_f32_16x16x32_bf16 v[140:143], v[188:191], v[236:239], v[140:143]
v_mfma_f32_16x16x32_bf16 v[144:147], v[176:179], v[240:243], v[144:147]
v_mfma_f32_16x16x32_bf16 v[148:151], v[180:183], v[240:243], v[148:151]
v_mfma_f32_16x16x32_bf16 v[152:155], v[184:187], v[240:243], v[152:155]
v_mfma_f32_16x16x32_bf16 v[156:159], v[188:191], v[240:243], v[156:159]
v_mfma_f32_16x16x32_bf16 v[160:163], v[176:179], v[244:247], v[160:163]
v_mfma_f32_16x16x32_bf16 v[164:167], v[180:183], v[244:247], v[164:167]
v_mfma_f32_16x16x32_bf16 v[168:171], v[184:187], v[244:247], v[168:171]
v_mfma_f32_16x16x32_bf16 v[172:175], v[188:191], v[244:247], v[172:175]
s_add_u32 s55, s55, 1
s_branch P0l_6
P0sk_10:
s_waitcnt lgkmcnt(0)
v_mfma_f32_16x16x32_bf16 v[64:67], v[176:179], v[220:223], v[64:67]
v_mfma_f32_16x16x32_bf16 v[68:71], v[180:183], v[220:223], v[68:71]
v_mfma_f32_16x16x32_bf16 v[72:75], v[184:187], v[220:223], v[72:75]
v_mfma_f32_16x16x32_bf16 v[76:79], v[188:191], v[220:223], v[76:79]
v_mfma_f32_16x16x32_bf16 v[80:83], v[176:179], v[224:227], v[80:83]
v_mfma_f32_16x16x32_bf16 v[84:87], v[180:183], v[224:227], v[84:87]
v_mfma_f32_16x16x32_bf16 v[88:91], v[184:187], v[224:227], v[88:91]
v_mfma_f32_16x16x32_bf16 v[92:95], v[188:191], v[224:227], v[92:95]
v_mfma_f32_16x16x32_bf16 v[96:99], v[176:179], v[228:231], v[96:99]
v_mfma_f32_16x16x32_bf16 v[100:103], v[180:183], v[228:231], v[100:103]
v_mfma_f32_16x16x32_bf16 v[104:107], v[184:187], v[228:231], v[104:107]
v_mfma_f32_16x16x32_bf16 v[108:111], v[188:191], v[228:231], v[108:111]
v_mfma_f32_16x16x32_bf16 v[112:115], v[176:179], v[232:235], v[112:115]
v_mfma_f32_16x16x32_bf16 v[116:119], v[180:183], v[232:235], v[116:119]
v_mfma_f32_16x16x32_bf16 v[120:123], v[184:187], v[232:235], v[120:123]
v_mfma_f32_16x16x32_bf16 v[124:127], v[188:191], v[232:235], v[124:127]
v_mfma_f32_16x16x32_bf16 v[128:131], v[176:179], v[236:239], v[128:131]
v_mfma_f32_16x16x32_bf16 v[132:135], v[180:183], v[236:239], v[132:135]
v_mfma_f32_16x16x32_bf16 v[136:139], v[184:187], v[236:239], v[136:139]
v_mfma_f32_16x16x32_bf16 v[140:143], v[188:191], v[236:239], v[140:143]
v_mfma_f32_16x16x32_bf16 v[144:147], v[176:179], v[240:243], v[144:147]
v_mfma_f32_16x16x32_bf16 v[148:151], v[180:183], v[240:243], v[148:151]
v_mfma_f32_16x16x32_bf16 v[152:155], v[184:187], v[240:243], v[152:155]
v_mfma_f32_16x16x32_bf16 v[156:159], v[188:191], v[240:243], v[156:159]
v_mfma_f32_16x16x32_bf16 v[160:163], v[176:179], v[244:247], v[160:163]
v_mfma_f32_16x16x32_bf16 v[164:167], v[180:183], v[244:247], v[164:167]
v_mfma_f32_16x16x32_bf16 v[168:171], v[184:187], v[244:247], v[168:171]
v_mfma_f32_16x16x32_bf16 v[172:175], v[188:191], v[244:247], v[172:175]
s_mov_b32 s39, 1035512379
s_mul_i32 s52, s20, 401408
s_mul_i32 s53, s23, 100352
s_add_u32 s52, s52, s53
s_add_u32 s52, s52, 0
s_mov_b32 s54, 14336
s_branch P0epi
P0gB:
s_add_u32 m0, s38, 0
s_add_u32 s37, s32, 0
buffer_load_dwordx4 v15, s[56:59], s37 offen lds
s_add_u32 m0, s38, 4096
s_add_u32 s37, s32, 262144
buffer_load_dwordx4 v15, s[56:59], s37 offen lds
s_add_u32 m0, s38, 8192
s_add_u32 s37, s32, 524288
buffer_load_dwordx4 v15, s[56:59], s37 offen lds
s_add_u32 m0, s38, 12288
s_add_u32 s37, s32, 786432
buffer_load_dwordx4 v15, s[56:59], s37 offen lds
s_add_u32 m0, s38, 16384
s_add_u32 s37, s32, 1048576
buffer_load_dwordx4 v15, s[56:59], s37 offen lds
s_add_u32 m0, s38, 20480
s_add_u32 s37, s32, 1310720
buffer_load_dwordx4 v15, s[56:59], s37 offen lds
s_add_u32 m0, s38, 24576
s_add_u32 s37, s32, 1572864
buffer_load_dwordx4 v15, s[56:59], s37 offen lds
s_add_u32 m0, s38, 28672
s_add_u32 s37, s35, 0
buffer_load_dwordx4 v16, s[28:31], s37 offen lds
s_add_u32 m0, s38, 32768
s_add_u32 s37, s35, 14336
buffer_load_dwordx4 v16, s[28:31], s37 offen lds
s_add_u32 m0, s38, 36864
s_add_u32 s37, s35, 28672
buffer_load_dwordx4 v16, s[28:31], s37 offen lds
s_add_u32 m0, s38, 40960
s_add_u32 s37, s35, 43008
buffer_load_dwordx4 v16, s[28:31], s37 offen lds
s_add_u32 m0, s38, 45056
s_add_u32 s37, s32, 128
buffer_load_dwordx4 v15, s[56:59], s37 offen lds
s_add_u32 m0, s38, 49152
s_add_u32 s37, s32, 262272
buffer_load_dwordx4 v15, s[56:59], s37 offen lds
s_add_u32 m0, s38, 53248
s_add_u32 s37, s32, 524416
buffer_load_dwordx4 v15, s[56:59], s37 offen lds
s_add_u32 m0, s38, 57344
s_add_u32 s37, s32, 786560
buffer_load_dwordx4 v15, s[56:59], s37 offen lds
s_add_u32 m0, s38, 61440
s_add_u32 s37, s32, 1048704
buffer_load_dwordx4 v15, s[56:59], s37 offen lds
s_add_u32 m0, s38, 65536
s_add_u32 s37, s32, 1310848
buffer_load_dwordx4 v15, s[56:59], s37 offen lds
s_add_u32 m0, s38, 69632
s_add_u32 s37, s32, 1572992
buffer_load_dwordx4 v15, s[56:59], s37 offen lds
s_add_u32 m0, s38, 73728
s_add_u32 s37, s35, 57344
buffer_load_dwordx4 v16, s[28:31], s37 offen lds
s_add_u32 m0, s38, 77824
s_add_u32 s37, s35, 71680
buffer_load_dwordx4 v16, s[28:31], s37 offen lds
s_add_u32 m0, s38, 81920
s_add_u32 s37, s35, 86016
buffer_load_dwordx4 v16, s[28:31], s37 offen lds
s_add_u32 m0, s38, 86016
s_add_u32 s37, s35, 100352
buffer_load_dwordx4 v16, s[28:31], s37 offen lds
s_add_u32 m0, s38, 90112
s_add_u32 s37, s32, 256
buffer_load_dwordx4 v15, s[56:59], s37 offen lds
s_add_u32 m0, s38, 94208
s_add_u32 s37, s32, 262400
buffer_load_dwordx4 v15, s[56:59], s37 offen lds
s_add_u32 m0, s38, 98304
s_add_u32 s37, s32, 524544
buffer_load_dwordx4 v15, s[56:59], s37 offen lds
s_add_u32 m0, s38, 102400
s_add_u32 s37, s32, 786688
buffer_load_dwordx4 v15, s[56:59], s37 offen lds
s_add_u32 m0, s38, 106496
s_add_u32 s37, s32, 1048832
buffer_load_dwordx4 v15, s[56:59], s37 offen lds
s_add_u32 m0, s38, 110592
s_add_u32 s37, s32, 1310976
buffer_load_dwordx4 v15, s[56:59], s37 offen lds
s_add_u32 m0, s38, 114688
s_add_u32 s37, s32, 1573120
buffer_load_dwordx4 v15, s[56:59], s37 offen lds
s_add_u32 m0, s38, 118784
s_add_u32 s37, s35, 114688
buffer_load_dwordx4 v16, s[28:31], s37 offen lds
s_add_u32 m0, s38, 122880
s_add_u32 s37, s35, 129024
buffer_load_dwordx4 v16, s[28:31], s37 offen lds
s_add_u32 m0, s38, 126976
s_add_u32 s37, s35, 143360
buffer_load_dwordx4 v16, s[28:31], s37 offen lds
s_add_u32 m0, s38, 131072
s_add_u32 s37, s35, 157696
buffer_load_dwordx4 v16, s[28:31], s37 offen lds
s_cmp_ge_u32 s2, 16
s_cbranch_scc1 P0ni_11
v_lshlrev_b32 v58, 4, v0
v_mov_b32 v60, -1
v_mov_b32 v61, -1
v_mov_b32 v62, -1
v_mov_b32 v63, -1
s_lshl_b32 s37, s2, 15
s_add_u32 s37, s37, 53477376
buffer_store_dwordx4 v[60:63], v58, s[8:11], s37 offen sc1
s_add_u32 s37, s37, 4096
buffer_store_dwordx4 v[60:63], v58, s[8:11], s37 offen sc1
s_add_u32 s37, s37, 4096
buffer_store_dwordx4 v[60:63], v58, s[8:11], s37 offen sc1
s_add_u32 s37, s37, 4096
buffer_store_dwordx4 v[60:63], v58, s[8:11], s37 offen sc1
s_add_u32 s37, s37, 4096
buffer_store_dwordx4 v[60:63], v58, s[8:11], s37 offen sc1
s_add_u32 s37, s37, 4096
buffer_store_dwordx4 v[60:63], v58, s[8:11], s37 offen sc1
s_add_u32 s37, s37, 4096
buffer_store_dwordx4 v[60:63], v58, s[8:11], s37 offen sc1
s_add_u32 s37, s37, 4096
buffer_store_dwordx4 v[60:63], v58, s[8:11], s37 offen sc1
s_add_u32 s37, s37, 4096
s_cmp_eq_u32 s2, 1
s_cbranch_scc0 P0i2_12
s_mov_b32 s37, 54534144
buffer_store_dwordx4 v[60:63], v58, s[8:11], s37 offen sc1
s_mov_b32 s37, 54538240
buffer_store_dwordx4 v[60:63], v58, s[8:11], s37 offen sc1
s_mov_b32 s37, 54788096
buffer_store_dwordx4 v[60:63], v58, s[8:11], s37 offen sc1
s_add_u32 s37, s37, 4096
buffer_store_dwordx4 v[60:63], v58, s[8:11], s37 offen sc1
s_add_u32 s37, s37, 4096
buffer_store_dwordx4 v[60:63], v58, s[8:11], s37 offen sc1
s_add_u32 s37, s37, 4096
buffer_store_dwordx4 v[60:63], v58, s[8:11], s37 offen sc1
s_add_u32 s37, s37, 4096
buffer_store_dwordx4 v[60:63], v58, s[8:11], s37 offen sc1
s_add_u32 s37, s37, 4096
buffer_store_dwordx4 v[60:63], v58, s[8:11], s37 offen sc1
s_add_u32 s37, s37, 4096
buffer_store_dwordx4 v[60:63], v58, s[8:11], s37 offen sc1
s_add_u32 s37, s37, 4096
buffer_store_dwordx4 v[60:63], v58, s[8:11], s37 offen sc1
s_add_u32 s37, s37, 4096
P0i2_12:
P0ni_11:
v_lshrrev_b32 v4, 4, v2
v_and_b32 v5, 15, v2
v_lshrrev_b32 v6, 2, v5
v_and_b32 v7, 3, v5
v_lshl_add_u32 v6, v6, 3, v7
s_lshl_b32 s37, s17, 6
v_add_u32 v6, s37, v6
v_bfe_u32 v7, v6, 1, 3
v_xor_b32 v7, v7, v4
v_lshlrev_b32 v20, 7, v6
v_lshl_add_u32 v20, v7, 4, v20
v_xor_b32 v21, 64, v20
v_xor_b32 v22, 32, v20
v_add_u32 v22, 512, v22
v_xor_b32 v23, 64, v22
v_lshrrev_b32 v7, 1, v5
v_xor_b32 v7, v7, v4
v_lshlrev_b32 v24, 7, v5
v_lshl_add_u32 v24, v7, 4, v24
v_add_u32 v24, 28672, v24
v_xor_b32 v25, 64, v24
v_and_b32 v7, 7, v5
v_xor_b32 v7, v7, v4
v_lshlrev_b32 v17, 8, v5
v_lshl_add_u32 v17, v7, 4, v17
v_add_u32 v17, 28672, v17
v_xor_b32 v18, 64, v17
v_bfe_u32 v6, v2, 2, 2
v_lshl_add_u32 v7, v4, 3, v6
v_lshlrev_b32 v26, 8, v7
v_and_b32 v7, 3, v2
v_lshl_add_u32 v26, v7, 3, v26
v_add_u32 v26, 28672, v26
v_and_b32 v7, 1, v4
v_lshl_add_u32 v6, v7, 2, v6
v_xor_b32 v7, 0, v6
v_lshl_add_u32 v27, v7, 5, v26
v_xor_b32 v7, 1, v6
v_lshl_add_u32 v28, v7, 5, v26
v_xor_b32 v7, 2, v6
v_lshl_add_u32 v29, v7, 5, v26
v_xor_b32 v7, 3, v6
v_lshl_add_u32 v30, v7, 5, v26
v_xor_b32 v7, 4, v6
v_lshl_add_u32 v31, v7, 5, v26
v_xor_b32 v7, 5, v6
v_lshl_add_u32 v32, v7, 5, v26
v_xor_b32 v7, 6, v6
v_lshl_add_u32 v33, v7, 5, v26
v_mov_b32 v64, 0
v_mov_b32 v65, 0
v_mov_b32 v66, 0
v_mov_b32 v67, 0
v_mov_b32 v68, 0
v_mov_b32 v69, 0
v_mov_b32 v70, 0
v_mov_b32 v71, 0
v_mov_b32 v72, 0
v_mov_b32 v73, 0
v_mov_b32 v74, 0
v_mov_b32 v75, 0
v_mov_b32 v76, 0
v_mov_b32 v77, 0
v_mov_b32 v78, 0
v_mov_b32 v79, 0
v_mov_b32 v80, 0
v_mov_b32 v81, 0
v_mov_b32 v82, 0
v_mov_b32 v83, 0
v_mov_b32 v84, 0
v_mov_b32 v85, 0
v_mov_b32 v86, 0
v_mov_b32 v87, 0
v_mov_b32 v88, 0
v_mov_b32 v89, 0
v_mov_b32 v90, 0
v_mov_b32 v91, 0
v_mov_b32 v92, 0
v_mov_b32 v93, 0
v_mov_b32 v94, 0
v_mov_b32 v95, 0
v_mov_b32 v96, 0
v_mov_b32 v97, 0
v_mov_b32 v98, 0
v_mov_b32 v99, 0
v_mov_b32 v100, 0
v_mov_b32 v101, 0
v_mov_b32 v102, 0
v_mov_b32 v103, 0
v_mov_b32 v104, 0
v_mov_b32 v105, 0
v_mov_b32 v106, 0
v_mov_b32 v107, 0
v_mov_b32 v108, 0
v_mov_b32 v109, 0
v_mov_b32 v110, 0
v_mov_b32 v111, 0
v_mov_b32 v112, 0
v_mov_b32 v113, 0
v_mov_b32 v114, 0
v_mov_b32 v115, 0
v_mov_b32 v116, 0
v_mov_b32 v117, 0
v_mov_b32 v118, 0
v_mov_b32 v119, 0
v_mov_b32 v120, 0
v_mov_b32 v121, 0
v_mov_b32 v122, 0
v_mov_b32 v123, 0
v_mov_b32 v124, 0
v_mov_b32 v125, 0
v_mov_b32 v126, 0
v_mov_b32 v127, 0
v_mov_b32 v128, 0
v_mov_b32 v129, 0
v_mov_b32 v130, 0
v_mov_b32 v131, 0
v_mov_b32 v132, 0
v_mov_b32 v133, 0
v_mov_b32 v134, 0
v_mov_b32 v135, 0
v_mov_b32 v136, 0
v_mov_b32 v137, 0
v_mov_b32 v138, 0
v_mov_b32 v139, 0
v_mov_b32 v140, 0
v_mov_b32 v141, 0
v_mov_b32 v142, 0
v_mov_b32 v143, 0
v_mov_b32 v144, 0
v_mov_b32 v145, 0
v_mov_b32 v146, 0
v_mov_b32 v147, 0
v_mov_b32 v148, 0
v_mov_b32 v149, 0
v_mov_b32 v150, 0
v_mov_b32 v151, 0
v_mov_b32 v152, 0
v_mov_b32 v153, 0
v_mov_b32 v154, 0
v_mov_b32 v155, 0
v_mov_b32 v156, 0
v_mov_b32 v157, 0
v_mov_b32 v158, 0
v_mov_b32 v159, 0
v_mov_b32 v160, 0
v_mov_b32 v161, 0
v_mov_b32 v162, 0
v_mov_b32 v163, 0
v_mov_b32 v164, 0
v_mov_b32 v165, 0
v_mov_b32 v166, 0
v_mov_b32 v167, 0
v_mov_b32 v168, 0
v_mov_b32 v169, 0
v_mov_b32 v170, 0
v_mov_b32 v171, 0
v_mov_b32 v172, 0
v_mov_b32 v173, 0
v_mov_b32 v174, 0
v_mov_b32 v175, 0
s_mov_b32 s52, 0x3B124925
s_mov_b32 s53, 0x3727C5AC
s_mul_i32 s54, s17, 2080
s_add_u32 s54, s54, 135168
v_lshlrev_b32 v215, 4, v2
v_add_u32 v215, s54, v215
s_waitcnt vmcnt(33)
v_lshlrev_b32 v216, 16, v204
v_and_b32 v217, 0xffff0000, v204
v_lshlrev_b32 v218, 16, v205
v_and_b32 v219, 0xffff0000, v205
v_lshlrev_b32 v220, 16, v206
v_and_b32 v221, 0xffff0000, v206
v_lshlrev_b32 v222, 16, v207
v_and_b32 v223, 0xffff0000, v207
v_lshlrev_b32 v224, 16, v208
v_and_b32 v225, 0xffff0000, v208
v_lshlrev_b32 v226, 16, v209
v_and_b32 v227, 0xffff0000, v209
v_lshlrev_b32 v228, 16, v210
v_and_b32 v229, 0xffff0000, v210
v_lshlrev_b32 v230, 16, v211
v_and_b32 v231, 0xffff0000, v211
v_pk_add_f32 v[232:233], v[216:217], v[218:219]
v_pk_add_f32 v[234:235], v[224:225], v[226:227]
v_pk_add_f32 v[232:233], v[232:233], v[220:221]
v_pk_add_f32 v[234:235], v[234:235], v[228:229]
v_pk_add_f32 v[232:233], v[232:233], v[222:223]
v_pk_add_f32 v[234:235], v[234:235], v[230:231]
v_add_f32 v232, v232, v233
v_add_f32 v234, v234, v235
s_nop 0
v_add_f32_dpp v232, v232, v232 quad_perm:[1,0,3,2] row_mask:0xf bank_mask:0xf
v_add_f32_dpp v234, v234, v234 quad_perm:[1,0,3,2] row_mask:0xf bank_mask:0xf
s_nop 0
v_add_f32_dpp v232, v232, v232 quad_perm:[2,3,0,1] row_mask:0xf bank_mask:0xf
v_add_f32_dpp v234, v234, v234 quad_perm:[2,3,0,1] row_mask:0xf bank_mask:0xf
s_nop 0
v_add_f32_dpp v232, v232, v232 row_half_mirror row_mask:0xf bank_mask:0xf
v_add_f32_dpp v234, v234, v234 row_half_mirror row_mask:0xf bank_mask:0xf
s_nop 0
v_add_f32_dpp v232, v232, v232 row_mirror row_mask:0xf bank_mask:0xf
v_add_f32_dpp v234, v234, v234 row_mirror row_mask:0xf bank_mask:0xf
v_mov_b32 v236, v232
v_mov_b32 v237, v234
s_nop 0
v_permlane16_swap_b32 v236, v232
v_permlane16_swap_b32 v237, v234
v_add_f32 v232, v232, v236
v_add_f32 v234, v234, v237
v_mov_b32 v236, v232
v_mov_b32 v237, v234
s_nop 0
v_permlane32_swap_b32 v236, v232
v_permlane32_swap_b32 v237, v234
v_add_f32 v232, v232, v236
v_add_f32 v234, v234, v237
v_mul_f32 v232, s52, v232
v_mul_f32 v234, s52, v234
v_pk_add_f32 v[216:217], v[216:217], v[232:233] op_sel_hi:[1,0] neg_lo:[0,1] neg_hi:[0,1]
v_pk_add_f32 v[224:225], v[224:225], v[234:235] op_sel_hi:[1,0] neg_lo:[0,1] neg_hi:[0,1]
v_pk_add_f32 v[218:219], v[218:219], v[232:233] op_sel_hi:[1,0] neg_lo:[0,1] neg_hi:[0,1]
v_pk_add_f32 v[226:227], v[226:227], v[234:235] op_sel_hi:[1,0] neg_lo:[0,1] neg_hi:[0,1]
v_pk_add_f32 v[220:221], v[220:221], v[232:233] op_sel_hi:[1,0] neg_lo:[0,1] neg_hi:[0,1]
v_pk_add_f32 v[228:229], v[228:229], v[234:235] op_sel_hi:[1,0] neg_lo:[0,1] neg_hi:[0,1]
v_pk_add_f32 v[222:223], v[222:223], v[232:233] op_sel_hi:[1,0] neg_lo:[0,1] neg_hi:[0,1]
v_pk_add_f32 v[230:231], v[230:231], v[234:235] op_sel_hi:[1,0] neg_lo:[0,1] neg_hi:[0,1]
v_pk_mul_f32 v[232:233], v[216:217], v[216:217]
v_pk_mul_f32 v[234:235], v[224:225], v[224:225]
v_pk_fma_f32 v[232:233], v[218:219], v[218:219], v[232:233]
v_pk_fma_f32 v[234:235], v[226:227], v[226:227], v[234:235]
v_pk_fma_f32 v[232:233], v[220:221], v[220:221], v[232:233]
v_pk_fma_f32 v[234:235], v[228:229], v[228:229], v[234:235]
v_pk_fma_f32 v[232:233], v[222:223], v[222:223], v[232:233]
v_pk_fma_f32 v[234:235], v[230:231], v[230:231], v[234:235]
v_add_f32 v232, v232, v233
v_add_f32 v234, v234, v235
v_mul_f32 v232, v232, v212
v_mul_f32 v234, v234, v212
s_nop 0
v_add_f32_dpp v232, v232, v232 quad_perm:[1,0,3,2] row_mask:0xf bank_mask:0xf
v_add_f32_dpp v234, v234, v234 quad_perm:[1,0,3,2] row_mask:0xf bank_mask:0xf
s_nop 0
v_add_f32_dpp v232, v232, v232 quad_perm:[2,3,0,1] row_mask:0xf bank_mask:0xf
v_add_f32_dpp v234, v234, v234 quad_perm:[2,3,0,1] row_mask:0xf bank_mask:0xf
s_nop 0
v_add_f32_dpp v232, v232, v232 row_half_mirror row_mask:0xf bank_mask:0xf
v_add_f32_dpp v234, v234, v234 row_half_mirror row_mask:0xf bank_mask:0xf
s_nop 0
v_add_f32_dpp v232, v232, v232 row_mirror row_mask:0xf bank_mask:0xf
v_add_f32_dpp v234, v234, v234 row_mirror row_mask:0xf bank_mask:0xf
v_mov_b32 v236, v232
v_mov_b32 v237, v234
s_nop 0
v_permlane16_swap_b32 v236, v232
v_permlane16_swap_b32 v237, v234
v_add_f32 v232, v232, v236
v_add_f32 v234, v234, v237
v_mov_b32 v236, v232
v_mov_b32 v237, v234
s_nop 0
v_permlane32_swap_b32 v236, v232
v_permlane32_swap_b32 v237, v234
v_add_f32 v232, v232, v236
v_add_f32 v234, v234, v237
v_mov_b32 v236, s53
v_fmac_f32 v236, s52, v232
v_mov_b32 v237, s53
v_fmac_f32 v237, s52, v234
v_rsq_f32 v232, v236
v_rsq_f32 v234, v237
s_nop 0
v_pk_mul_f32 v[216:217], v[216:217], v[232:233] op_sel_hi:[1,0]
v_pk_mul_f32 v[224:225], v[224:225], v[234:235] op_sel_hi:[1,0]
v_pk_mul_f32 v[218:219], v[218:219], v[232:233] op_sel_hi:[1,0]
v_pk_mul_f32 v[226:227], v[226:227], v[234:235] op_sel_hi:[1,0]
v_pk_mul_f32 v[220:221], v[220:221], v[232:233] op_sel_hi:[1,0]
v_pk_mul_f32 v[228:229], v[228:229], v[234:235] op_sel_hi:[1,0]
v_pk_mul_f32 v[222:223], v[222:223], v[232:233] op_sel_hi:[1,0]
v_pk_mul_f32 v[230:231], v[230:231], v[234:235] op_sel_hi:[1,0]
v_cvt_pk_bf16_f32 v204, v216, v217
v_cvt_pk_bf16_f32 v205, v218, v219
v_cvt_pk_bf16_f32 v206, v220, v221
v_cvt_pk_bf16_f32 v207, v222, v223
ds_write_b128 v215, v[204:207] offset:0
v_cvt_pk_bf16_f32 v208, v224, v225
v_cvt_pk_bf16_f32 v209, v226, v227
v_cvt_pk_bf16_f32 v210, v228, v229
v_cvt_pk_bf16_f32 v211, v230, v231
ds_write_b128 v215, v[208:211] offset:1040
s_waitcnt vmcnt(22) lgkmcnt(0)
s_barrier
s_cmp_eq_u32 s2, 2
s_cbranch_scc0 P0ic_13
s_cmp_eq_u32 s17, 0
s_cbranch_scc0 P0ic_13
v_mov_b32 v4, 1
v_mov_b32 v5, 1073741824
v_cmp_eq_u32 vcc, 0, v2
s_nop 1
v_cndmask_b32 v5, v5, 0, vcc
buffer_atomic_add v4, v5, s[12:15], 0 offen offset:8
P0ic_13:
s_cmp_eq_u32 s2, 0
s_cbranch_scc0 P0ms_14
s_waitcnt vmcnt(0)
s_mov_b32 s37, 54525952
v_lshlrev_b32 v59, 2, v0
buffer_store_dword v238, v59, s[8:11], s37 offen sc1
s_add_u32 s37, s37, 4293918720
buffer_store_dword v238, v59, s[8:11], s37 offen sc1
s_add_u32 s37, s37, 1049600
buffer_store_dword v239, v59, s[8:11], s37 offen sc1
s_add_u32 s37, s37, 4293918720
buffer_store_dword v239, v59, s[8:11], s37 offen sc1
s_add_u32 s37, s37, 1049600
buffer_store_dword v240, v59, s[8:11], s37 offen sc1
s_add_u32 s37, s37, 4293918720
buffer_store_dword v240, v59, s[8:11], s37 offen sc1
s_add_u32 s37, s37, 1049600
buffer_store_dword v241, v59, s[8:11], s37 offen sc1
s_add_u32 s37, s37, 4293918720
buffer_store_dword v241, v59, s[8:11], s37 offen sc1
s_add_u32 s37, s37, 1049600
buffer_store_dword v242, v59, s[8:11], s37 offen sc1
s_add_u32 s37, s37, 4293918720
buffer_store_dword v242, v59, s[8:11], s37 offen sc1
s_add_u32 s37, s37, 1049600
buffer_store_dword v243, v59, s[8:11], s37 offen sc1
s_add_u32 s37, s37, 4293918720
buffer_store_dword v243, v59, s[8:11], s37 offen sc1
s_add_u32 s37, s37, 1049600
buffer_store_dword v244, v59, s[8:11], s37 offen sc1
s_add_u32 s37, s37, 4293918720
buffer_store_dword v244, v59, s[8:11], s37 offen sc1
s_add_u32 s37, s37, 1049600
P0ms_14:
s_cmp_eq_u32 s16, 1
s_cbranch_scc0 P0tk_15
s_cmp_eq_u32 s17, 0
s_cbranch_scc0 P0tk_15
v_readfirstlane_b32 s52, v250
v_mov_b32 v252, 147440
v_mov_b32 v248, 1
v_mov_b32 v253, s52
v_mov_b32 v249, 0
ds_write_b32 v252, v253
s_cmp_eq_u32 s52, 31
s_cbranch_scc0 P0tk_15
buffer_atomic_cmpswap v[248:249], v251, s[12:15], 0 offen offset:4
P0tk_15:
v_and_b32 v36, 7, v0
v_lshrrev_b32 v35, 3, v0
v_mul_u32_u24 v37, 1040, v36
v_add_u32 v37, 135168, v37
v_lshl_add_u32 v38, v35, 4, v37
v_lshrrev_b32 v34, 1, v35
v_lshl_add_u32 v39, v34, 5, v37
v_and_b32 v34, 1, v35
v_lshl_add_u32 v39, v34, 2, v39
ds_read_b128 a[0:3], v38
ds_read_b128 a[4:7], v38 offset:512
ds_read2_b32 a[8:9], v39 offset0:0 offset1:2
ds_read2_b32 a[10:11], v39 offset0:4 offset1:6
ds_read2_b32 a[12:13], v39 offset0:128 offset1:130
ds_read2_b32 a[14:15], v39 offset0:132 offset1:134
v_lshlrev_b32 v36, 4, v36
v_lshl_add_u32 v37, v35, 9, v36
v_lshl_add_u32 v38, v35, 8, v36
v_add_u32 v39, 16384, v37
v_add_u32 v56, 8192, v38
v_mov_b32 v34, 1073741824
v_cmp_gt_u32 vcc, 192, v0
s_lshr_b32 s52, s2, 2
s_mul_i32 s52, s52, 28672
v_cndmask_b32 v39, v34, v39, vcc
v_cndmask_b32 v56, v34, v56, vcc
s_and_b32 s53, s2, 3
s_lshl_b32 s54, s53, 7
s_add_u32 s54, s54, s52
s_add_u32 s54, s54, 55574528
s_and_b32 s55, s53, 1
s_lshl_b32 s55, s55, 7
s_add_u32 s52, s52, s55
s_lshr_b32 s53, s53, 1
s_mul_i32 s53, s53, 14336
s_add_u32 s52, s52, s53
s_add_u32 s52, s52, 14680064
s_waitcnt lgkmcnt(0)
buffer_store_dwordx4 a[0:3], v37, s[8:11], s54 offen sc1
buffer_store_dwordx4 a[4:7], v39, s[8:11], s54 offen sc1
buffer_store_dwordx4 a[8:11], v38, s[8:11], s52 offen sc1
buffer_store_dwordx4 a[12:15], v56, s[8:11], s52 offen sc1
ds_read_b128 v[40:43], v20 offset:0
ds_read_b128 v[44:47], v22 offset:0
ds_read_b128 v[48:51], v20 offset:4096
ds_read_b128 v[52:55], v22 offset:4096
ds_read_b64_tr_b16 v[192:193], v27 offset:0
ds_read_b64_tr_b16 v[194:195], v27 offset:1024
ds_read_b64_tr_b16 v[196:197], v28 offset:0
ds_read_b64_tr_b16 v[198:199], v28 offset:1024
ds_read_b64_tr_b16 v[200:201], v29 offset:0
ds_read_b64_tr_b16 v[202:203], v29 offset:1024
ds_read_b64_tr_b16 v[204:205], v30 offset:0
ds_read_b64_tr_b16 v[206:207], v30 offset:1024
ds_read_b64_tr_b16 v[208:209], v31 offset:0
ds_read_b64_tr_b16 v[210:211], v31 offset:1024
ds_read_b64_tr_b16 v[212:213], v32 offset:0
ds_read_b64_tr_b16 v[214:215], v32 offset:1024
ds_read_b64_tr_b16 v[216:217], v33 offset:0
ds_read_b64_tr_b16 v[218:219], v33 offset:1024
s_mov_b32 s55, 0
P0l_16:
s_waitcnt lgkmcnt(0)
v_mfma_f32_16x16x32_bf16 v[64:67], v[40:43], v[192:195], v[64:67]
ds_read_b128 v[176:179], v21 offset:0
v_mfma_f32_16x16x32_bf16 v[68:71], v[44:47], v[192:195], v[68:71]
ds_read_b128 v[180:183], v23 offset:0
v_mfma_f32_16x16x32_bf16 v[72:75], v[48:51], v[192:195], v[72:75]
ds_read_b128 v[184:187], v21 offset:4096
v_mfma_f32_16x16x32_bf16 v[76:79], v[52:55], v[192:195], v[76:79]
ds_read_b128 v[188:191], v23 offset:4096
v_mfma_f32_16x16x32_bf16 v[80:83], v[40:43], v[196:199], v[80:83]
ds_read_b64_tr_b16 v[220:221], v27 offset:8192
v_mfma_f32_16x16x32_bf16 v[84:87], v[44:47], v[196:199], v[84:87]
ds_read_b64_tr_b16 v[222:223], v27 offset:9216
v_mfma_f32_16x16x32_bf16 v[88:91], v[48:51], v[196:199], v[88:91]
ds_read_b64_tr_b16 v[224:225], v28 offset:8192
v_mfma_f32_16x16x32_bf16 v[92:95], v[52:55], v[196:199], v[92:95]
ds_read_b64_tr_b16 v[226:227], v28 offset:9216
v_mfma_f32_16x16x32_bf16 v[96:99], v[40:43], v[200:203], v[96:99]
ds_read_b64_tr_b16 v[228:229], v29 offset:8192
v_mfma_f32_16x16x32_bf16 v[100:103], v[44:47], v[200:203], v[100:103]
ds_read_b64_tr_b16 v[230:231], v29 offset:9216
v_mfma_f32_16x16x32_bf16 v[104:107], v[48:51], v[200:203], v[104:107]
ds_read_b64_tr_b16 v[232:233], v30 offset:8192
v_mfma_f32_16x16x32_bf16 v[108:111], v[52:55], v[200:203], v[108:111]
ds_read_b64_tr_b16 v[234:235], v30 offset:9216
v_mfma_f32_16x16x32_bf16 v[112:115], v[40:43], v[204:207], v[112:115]
ds_read_b64_tr_b16 v[236:237], v31 offset:8192
v_mfma_f32_16x16x32_bf16 v[116:119], v[44:47], v[204:207], v[116:119]
ds_read_b64_tr_b16 v[238:239], v31 offset:9216
v_mfma_f32_16x16x32_bf16 v[120:123], v[48:51], v[204:207], v[120:123]
ds_read_b64_tr_b16 v[240:241], v32 offset:8192
v_mfma_f32_16x16x32_bf16 v[124:127], v[52:55], v[204:207], v[124:127]
ds_read_b64_tr_b16 v[242:243], v32 offset:9216
v_mfma_f32_16x16x32_bf16 v[128:131], v[40:43], v[208:211], v[128:131]
ds_read_b64_tr_b16 v[244:245], v33 offset:8192
v_mfma_f32_16x16x32_bf16 v[132:135], v[44:47], v[208:211], v[132:135]
ds_read_b64_tr_b16 v[246:247], v33 offset:9216
v_mfma_f32_16x16x32_bf16 v[136:139], v[48:51], v[208:211], v[136:139]
v_mfma_f32_16x16x32_bf16 v[140:143], v[52:55], v[208:211], v[140:143]
v_mfma_f32_16x16x32_bf16 v[144:147], v[40:43], v[212:215], v[144:147]
v_mfma_f32_16x16x32_bf16 v[148:151], v[44:47], v[212:215], v[148:151]
v_mfma_f32_16x16x32_bf16 v[152:155], v[48:51], v[212:215], v[152:155]
v_mfma_f32_16x16x32_bf16 v[156:159], v[52:55], v[212:215], v[156:159]
v_mfma_f32_16x16x32_bf16 v[160:163], v[40:43], v[216:219], v[160:163]
v_mfma_f32_16x16x32_bf16 v[164:167], v[44:47], v[216:219], v[164:167]
v_mfma_f32_16x16x32_bf16 v[168:171], v[48:51], v[216:219], v[168:171]
v_mfma_f32_16x16x32_bf16 v[172:175], v[52:55], v[216:219], v[172:175]
s_cmp_eq_u32 s55, 3
s_cbranch_scc1 P0sk_20
s_mov_b32 s69, 45056
s_cmp_eq_u32 s55, 1
s_cbranch_scc1 P0w0_18
s_cmp_eq_u32 s55, 2
s_cbranch_scc1 P0w0_18b
s_waitcnt vmcnt(15) lgkmcnt(0)
s_branch P0w1_19
P0w0_18b:
s_mov_b32 s69, 4294877184
s_waitcnt vmcnt(0) lgkmcnt(0)
s_branch P0w1_19
P0w0_18:
s_waitcnt vmcnt(11) lgkmcnt(0)
P0w1_19:
s_barrier
v_add_u32 v20, s69, v20
v_add_u32 v21, s69, v21
v_add_u32 v22, s69, v22
v_add_u32 v23, s69, v23
v_add_u32 v27, s69, v27
v_add_u32 v28, s69, v28
v_add_u32 v29, s69, v29
v_add_u32 v30, s69, v30
v_add_u32 v31, s69, v31
v_add_u32 v32, s69, v32
v_add_u32 v33, s69, v33
s_cmp_lg_u32 s55, 0
s_cbranch_scc1 P0n3_17
s_add_u32 m0, s38, 0
s_add_u32 s37, s32, 384
buffer_load_dwordx4 v15, s[56:59], s37 offen lds
s_add_u32 m0, s38, 4096
s_add_u32 s37, s32, 262528
buffer_load_dwordx4 v15, s[56:59], s37 offen lds
s_add_u32 m0, s38, 8192
s_add_u32 s37, s32, 524672
buffer_load_dwordx4 v15, s[56:59], s37 offen lds
s_add_u32 m0, s38, 12288
s_add_u32 s37, s32, 786816
buffer_load_dwordx4 v15, s[56:59], s37 offen lds
s_add_u32 m0, s38, 16384
s_add_u32 s37, s32, 1048960
buffer_load_dwordx4 v15, s[56:59], s37 offen lds
s_add_u32 m0, s38, 20480
s_add_u32 s37, s32, 1311104
buffer_load_dwordx4 v15, s[56:59], s37 offen lds
s_add_u32 m0, s38, 24576
s_add_u32 s37, s32, 1573248
buffer_load_dwordx4 v15, s[56:59], s37 offen lds
s_add_u32 m0, s38, 28672
s_add_u32 s37, s35, 172032
buffer_load_dwordx4 v16, s[28:31], s37 offen lds
s_add_u32 m0, s38, 32768
s_add_u32 s37, s35, 186368
buffer_load_dwordx4 v16, s[28:31], s37 offen lds
s_add_u32 m0, s38, 36864
s_add_u32 s37, s35, 200704
buffer_load_dwordx4 v16, s[28:31], s37 offen lds
s_add_u32 m0, s38, 40960
s_add_u32 s37, s35, 215040
buffer_load_dwordx4 v16, s[28:31], s37 offen lds
s_mov_b32 s55, 0
P0n3_17:
v_mfma_f32_16x16x32_bf16 v[64:67], v[176:179], v[220:223], v[64:67]
ds_read_b128 v[40:43], v20 offset:0
v_mfma_f32_16x16x32_bf16 v[68:71], v[180:183], v[220:223], v[68:71]
ds_read_b128 v[44:47], v22 offset:0
v_mfma_f32_16x16x32_bf16 v[72:75], v[184:187], v[220:223], v[72:75]
ds_read_b128 v[48:51], v20 offset:4096
v_mfma_f32_16x16x32_bf16 v[76:79], v[188:191], v[220:223], v[76:79]
ds_read_b128 v[52:55], v22 offset:4096
v_mfma_f32_16x16x32_bf16 v[80:83], v[176:179], v[224:227], v[80:83]
ds_read_b64_tr_b16 v[192:193], v27 offset:0
v_mfma_f32_16x16x32_bf16 v[84:87], v[180:183], v[224:227], v[84:87]
ds_read_b64_tr_b16 v[194:195], v27 offset:1024
v_mfma_f32_16x16x32_bf16 v[88:91], v[184:187], v[224:227], v[88:91]
ds_read_b64_tr_b16 v[196:197], v28 offset:0
v_mfma_f32_16x16x32_bf16 v[92:95], v[188:191], v[224:227], v[92:95]
ds_read_b64_tr_b16 v[198:199], v28 offset:1024
v_mfma_f32_16x16x32_bf16 v[96:99], v[176:179], v[228:231], v[96:99]
ds_read_b64_tr_b16 v[200:201], v29 offset:0
v_mfma_f32_16x16x32_bf16 v[100:103], v[180:183], v[228:231], v[100:103]
ds_read_b64_tr_b16 v[202:203], v29 offset:1024
v_mfma_f32_16x16x32_bf16 v[104:107], v[184:187], v[228:231], v[104:107]
ds_read_b64_tr_b16 v[204:205], v30 offset:0
v_mfma_f32_16x16x32_bf16 v[108:111], v[188:191], v[228:231], v[108:111]
ds_read_b64_tr_b16 v[206:207], v30 offset:1024
v_mfma_f32_16x16x32_bf16 v[112:115], v[176:179], v[232:235], v[112:115]
ds_read_b64_tr_b16 v[208:209], v31 offset:0
v_mfma_f32_16x16x32_bf16 v[116:119], v[180:183], v[232:235], v[116:119]
ds_read_b64_tr_b16 v[210:211], v31 offset:1024
v_mfma_f32_16x16x32_bf16 v[120:123], v[184:187], v[232:235], v[120:123]
ds_read_b64_tr_b16 v[212:213], v32 offset:0
v_mfma_f32_16x16x32_bf16 v[124:127], v[188:191], v[232:235], v[124:127]
ds_read_b64_tr_b16 v[214:215], v32 offset:1024
v_mfma_f32_16x16x32_bf16 v[128:131], v[176:179], v[236:239], v[128:131]
ds_read_b64_tr_b16 v[216:217], v33 offset:0
v_mfma_f32_16x16x32_bf16 v[132:135], v[180:183], v[236:239], v[132:135]
ds_read_b64_tr_b16 v[218:219], v33 offset:1024
v_mfma_f32_16x16x32_bf16 v[136:139], v[184:187], v[236:239], v[136:139]
v_mfma_f32_16x16x32_bf16 v[140:143], v[188:191], v[236:239], v[140:143]
v_mfma_f32_16x16x32_bf16 v[144:147], v[176:179], v[240:243], v[144:147]
v_mfma_f32_16x16x32_bf16 v[148:151], v[180:183], v[240:243], v[148:151]
v_mfma_f32_16x16x32_bf16 v[152:155], v[184:187], v[240:243], v[152:155]
v_mfma_f32_16x16x32_bf16 v[156:159], v[188:191], v[240:243], v[156:159]
v_mfma_f32_16x16x32_bf16 v[160:163], v[176:179], v[244:247], v[160:163]
v_mfma_f32_16x16x32_bf16 v[164:167], v[180:183], v[244:247], v[164:167]
v_mfma_f32_16x16x32_bf16 v[168:171], v[184:187], v[244:247], v[168:171]
v_mfma_f32_16x16x32_bf16 v[172:175], v[188:191], v[244:247], v[172:175]
s_add_u32 s55, s55, 1
s_branch P0l_16
P0sk_20:
s_waitcnt lgkmcnt(0)
v_mfma_f32_16x16x32_bf16 v[64:67], v[176:179], v[220:223], v[64:67]
v_mfma_f32_16x16x32_bf16 v[68:71], v[180:183], v[220:223], v[68:71]
v_mfma_f32_16x16x32_bf16 v[72:75], v[184:187], v[220:223], v[72:75]
v_mfma_f32_16x16x32_bf16 v[76:79], v[188:191], v[220:223], v[76:79]
v_mfma_f32_16x16x32_bf16 v[80:83], v[176:179], v[224:227], v[80:83]
v_mfma_f32_16x16x32_bf16 v[84:87], v[180:183], v[224:227], v[84:87]
v_mfma_f32_16x16x32_bf16 v[88:91], v[184:187], v[224:227], v[88:91]
v_mfma_f32_16x16x32_bf16 v[92:95], v[188:191], v[224:227], v[92:95]
v_mfma_f32_16x16x32_bf16 v[96:99], v[176:179], v[228:231], v[96:99]
v_mfma_f32_16x16x32_bf16 v[100:103], v[180:183], v[228:231], v[100:103]
v_mfma_f32_16x16x32_bf16 v[104:107], v[184:187], v[228:231], v[104:107]
v_mfma_f32_16x16x32_bf16 v[108:111], v[188:191], v[228:231], v[108:111]
v_mfma_f32_16x16x32_bf16 v[112:115], v[176:179], v[232:235], v[112:115]
v_mfma_f32_16x16x32_bf16 v[116:119], v[180:183], v[232:235], v[116:119]
v_mfma_f32_16x16x32_bf16 v[120:123], v[184:187], v[232:235], v[120:123]
v_mfma_f32_16x16x32_bf16 v[124:127], v[188:191], v[232:235], v[124:127]
v_mfma_f32_16x16x32_bf16 v[128:131], v[176:179], v[236:239], v[128:131]
v_mfma_f32_16x16x32_bf16 v[132:135], v[180:183], v[236:239], v[132:135]
v_mfma_f32_16x16x32_bf16 v[136:139], v[184:187], v[236:239], v[136:139]
v_mfma_f32_16x16x32_bf16 v[140:143], v[188:191], v[236:239], v[140:143]
v_mfma_f32_16x16x32_bf16 v[144:147], v[176:179], v[240:243], v[144:147]
v_mfma_f32_16x16x32_bf16 v[148:151], v[180:183], v[240:243], v[148:151]
v_mfma_f32_16x16x32_bf16 v[152:155], v[184:187], v[240:243], v[152:155]
v_mfma_f32_16x16x32_bf16 v[156:159], v[188:191], v[240:243], v[156:159]
v_mfma_f32_16x16x32_bf16 v[160:163], v[176:179], v[244:247], v[160:163]
v_mfma_f32_16x16x32_bf16 v[164:167], v[180:183], v[244:247], v[164:167]
v_mfma_f32_16x16x32_bf16 v[168:171], v[184:187], v[244:247], v[168:171]
v_mfma_f32_16x16x32_bf16 v[172:175], v[188:191], v[244:247], v[172:175]
s_mov_b32 s39, 1.0
s_mul_i32 s52, s20, 14336
s_mul_i32 s53, s23, 1605632
s_add_u32 s52, s52, s53
s_add_u32 s52, s52, 7340032
s_mov_b32 s54, 229376
P0epi:
s_mul_i32 s53, s22, 7168
s_add_u32 s52, s52, s53
s_lshl_b32 s53, s17, 11
s_add_u32 s52, s52, s53
v_lshlrev_b32 v3, 4, v2
v_add_u32 v5, 1024, v3
s_cmp_eq_u32 s17, 3
s_cselect_b32 s53, 1073741824, 0
v_add_u32 v5, s53, v5
v_mov_b32 v6, 0
buffer_load_dword v7, v6, s[12:15], 0 offen offset:8 sc1
s_nop 3
v_pk_mul_f32 v[64:65], v[64:65], s[38:39] op_sel:[0,1] op_sel_hi:[1,1]
v_pk_mul_f32 v[66:67], v[66:67], s[38:39] op_sel:[0,1] op_sel_hi:[1,1]
v_pk_mul_f32 v[68:69], v[68:69], s[38:39] op_sel:[0,1] op_sel_hi:[1,1]
v_pk_mul_f32 v[70:71], v[70:71], s[38:39] op_sel:[0,1] op_sel_hi:[1,1]
v_cvt_pk_bf16_f32 v64, v64, v65
v_cvt_pk_bf16_f32 v65, v66, v67
v_cvt_pk_bf16_f32 v66, v68, v69
v_cvt_pk_bf16_f32 v67, v70, v71
buffer_store_dwordx4 v[64:67], v3, s[8:11], s52 offen sc1
v_pk_mul_f32 v[72:73], v[72:73], s[38:39] op_sel:[0,1] op_sel_hi:[1,1]
v_pk_mul_f32 v[74:75], v[74:75], s[38:39] op_sel:[0,1] op_sel_hi:[1,1]
v_pk_mul_f32 v[76:77], v[76:77], s[38:39] op_sel:[0,1] op_sel_hi:[1,1]
v_pk_mul_f32 v[78:79], v[78:79], s[38:39] op_sel:[0,1] op_sel_hi:[1,1]
v_cvt_pk_bf16_f32 v72, v72, v73
v_cvt_pk_bf16_f32 v73, v74, v75
v_cvt_pk_bf16_f32 v74, v76, v77
v_cvt_pk_bf16_f32 v75, v78, v79
buffer_store_dwordx4 v[72:75], v5, s[8:11], s52 offen sc1
s_add_u32 s52, s52, s54
v_pk_mul_f32 v[80:81], v[80:81], s[38:39] op_sel:[0,1] op_sel_hi:[1,1]
v_pk_mul_f32 v[82:83], v[82:83], s[38:39] op_sel:[0,1] op_sel_hi:[1,1]
v_pk_mul_f32 v[84:85], v[84:85], s[38:39] op_sel:[0,1] op_sel_hi:[1,1]
v_pk_mul_f32 v[86:87], v[86:87], s[38:39] op_sel:[0,1] op_sel_hi:[1,1]
v_cvt_pk_bf16_f32 v80, v80, v81
v_cvt_pk_bf16_f32 v81, v82, v83
v_cvt_pk_bf16_f32 v82, v84, v85
v_cvt_pk_bf16_f32 v83, v86, v87
buffer_store_dwordx4 v[80:83], v3, s[8:11], s52 offen sc1
v_pk_mul_f32 v[88:89], v[88:89], s[38:39] op_sel:[0,1] op_sel_hi:[1,1]
v_pk_mul_f32 v[90:91], v[90:91], s[38:39] op_sel:[0,1] op_sel_hi:[1,1]
v_pk_mul_f32 v[92:93], v[92:93], s[38:39] op_sel:[0,1] op_sel_hi:[1,1]
v_pk_mul_f32 v[94:95], v[94:95], s[38:39] op_sel:[0,1] op_sel_hi:[1,1]
v_cvt_pk_bf16_f32 v88, v88, v89
v_cvt_pk_bf16_f32 v89, v90, v91
v_cvt_pk_bf16_f32 v90, v92, v93
v_cvt_pk_bf16_f32 v91, v94, v95
buffer_store_dwordx4 v[88:91], v5, s[8:11], s52 offen sc1
s_add_u32 s52, s52, s54
v_pk_mul_f32 v[96:97], v[96:97], s[38:39] op_sel:[0,1] op_sel_hi:[1,1]
v_pk_mul_f32 v[98:99], v[98:99], s[38:39] op_sel:[0,1] op_sel_hi:[1,1]
v_pk_mul_f32 v[100:101], v[100:101], s[38:39] op_sel:[0,1] op_sel_hi:[1,1]
v_pk_mul_f32 v[102:103], v[102:103], s[38:39] op_sel:[0,1] op_sel_hi:[1,1]
v_cvt_pk_bf16_f32 v96, v96, v97
v_cvt_pk_bf16_f32 v97, v98, v99
v_cvt_pk_bf16_f32 v98, v100, v101
v_cvt_pk_bf16_f32 v99, v102, v103
buffer_store_dwordx4 v[96:99], v3, s[8:11], s52 offen sc1
v_pk_mul_f32 v[104:105], v[104:105], s[38:39] op_sel:[0,1] op_sel_hi:[1,1]
v_pk_mul_f32 v[106:107], v[106:107], s[38:39] op_sel:[0,1] op_sel_hi:[1,1]
v_pk_mul_f32 v[108:109], v[108:109], s[38:39] op_sel:[0,1] op_sel_hi:[1,1]
v_pk_mul_f32 v[110:111], v[110:111], s[38:39] op_sel:[0,1] op_sel_hi:[1,1]
v_cvt_pk_bf16_f32 v104, v104, v105
v_cvt_pk_bf16_f32 v105, v106, v107
v_cvt_pk_bf16_f32 v106, v108, v109
v_cvt_pk_bf16_f32 v107, v110, v111
buffer_store_dwordx4 v[104:107], v5, s[8:11], s52 offen sc1
s_add_u32 s52, s52, s54
v_pk_mul_f32 v[112:113], v[112:113], s[38:39] op_sel:[0,1] op_sel_hi:[1,1]
v_pk_mul_f32 v[114:115], v[114:115], s[38:39] op_sel:[0,1] op_sel_hi:[1,1]
v_pk_mul_f32 v[116:117], v[116:117], s[38:39] op_sel:[0,1] op_sel_hi:[1,1]
v_pk_mul_f32 v[118:119], v[118:119], s[38:39] op_sel:[0,1] op_sel_hi:[1,1]
v_cvt_pk_bf16_f32 v112, v112, v113
v_cvt_pk_bf16_f32 v113, v114, v115
v_cvt_pk_bf16_f32 v114, v116, v117
v_cvt_pk_bf16_f32 v115, v118, v119
buffer_store_dwordx4 v[112:115], v3, s[8:11], s52 offen sc1
v_pk_mul_f32 v[120:121], v[120:121], s[38:39] op_sel:[0,1] op_sel_hi:[1,1]
v_pk_mul_f32 v[122:123], v[122:123], s[38:39] op_sel:[0,1] op_sel_hi:[1,1]
v_pk_mul_f32 v[124:125], v[124:125], s[38:39] op_sel:[0,1] op_sel_hi:[1,1]
v_pk_mul_f32 v[126:127], v[126:127], s[38:39] op_sel:[0,1] op_sel_hi:[1,1]
v_cvt_pk_bf16_f32 v120, v120, v121
v_cvt_pk_bf16_f32 v121, v122, v123
v_cvt_pk_bf16_f32 v122, v124, v125
v_cvt_pk_bf16_f32 v123, v126, v127
buffer_store_dwordx4 v[120:123], v5, s[8:11], s52 offen sc1
s_add_u32 s52, s52, s54
v_pk_mul_f32 v[128:129], v[128:129], s[38:39] op_sel:[0,1] op_sel_hi:[1,1]
v_pk_mul_f32 v[130:131], v[130:131], s[38:39] op_sel:[0,1] op_sel_hi:[1,1]
v_pk_mul_f32 v[132:133], v[132:133], s[38:39] op_sel:[0,1] op_sel_hi:[1,1]
v_pk_mul_f32 v[134:135], v[134:135], s[38:39] op_sel:[0,1] op_sel_hi:[1,1]
v_cvt_pk_bf16_f32 v128, v128, v129
v_cvt_pk_bf16_f32 v129, v130, v131
v_cvt_pk_bf16_f32 v130, v132, v133
v_cvt_pk_bf16_f32 v131, v134, v135
buffer_store_dwordx4 v[128:131], v3, s[8:11], s52 offen sc1
v_pk_mul_f32 v[136:137], v[136:137], s[38:39] op_sel:[0,1] op_sel_hi:[1,1]
v_pk_mul_f32 v[138:139], v[138:139], s[38:39] op_sel:[0,1] op_sel_hi:[1,1]
v_pk_mul_f32 v[140:141], v[140:141], s[38:39] op_sel:[0,1] op_sel_hi:[1,1]
v_pk_mul_f32 v[142:143], v[142:143], s[38:39] op_sel:[0,1] op_sel_hi:[1,1]
v_cvt_pk_bf16_f32 v136, v136, v137
v_cvt_pk_bf16_f32 v137, v138, v139
v_cvt_pk_bf16_f32 v138, v140, v141
v_cvt_pk_bf16_f32 v139, v142, v143
buffer_store_dwordx4 v[136:139], v5, s[8:11], s52 offen sc1
s_add_u32 s52, s52, s54
v_pk_mul_f32 v[144:145], v[144:145], s[38:39] op_sel:[0,1] op_sel_hi:[1,1]
v_pk_mul_f32 v[146:147], v[146:147], s[38:39] op_sel:[0,1] op_sel_hi:[1,1]
v_pk_mul_f32 v[148:149], v[148:149], s[38:39] op_sel:[0,1] op_sel_hi:[1,1]
v_pk_mul_f32 v[150:151], v[150:151], s[38:39] op_sel:[0,1] op_sel_hi:[1,1]
v_cvt_pk_bf16_f32 v144, v144, v145
v_cvt_pk_bf16_f32 v145, v146, v147
v_cvt_pk_bf16_f32 v146, v148, v149
v_cvt_pk_bf16_f32 v147, v150, v151
buffer_store_dwordx4 v[144:147], v3, s[8:11], s52 offen sc1
v_pk_mul_f32 v[152:153], v[152:153], s[38:39] op_sel:[0,1] op_sel_hi:[1,1]
v_pk_mul_f32 v[154:155], v[154:155], s[38:39] op_sel:[0,1] op_sel_hi:[1,1]
v_pk_mul_f32 v[156:157], v[156:157], s[38:39] op_sel:[0,1] op_sel_hi:[1,1]
v_pk_mul_f32 v[158:159], v[158:159], s[38:39] op_sel:[0,1] op_sel_hi:[1,1]
v_cvt_pk_bf16_f32 v152, v152, v153
v_cvt_pk_bf16_f32 v153, v154, v155
v_cvt_pk_bf16_f32 v154, v156, v157
v_cvt_pk_bf16_f32 v155, v158, v159
buffer_store_dwordx4 v[152:155], v5, s[8:11], s52 offen sc1
s_add_u32 s52, s52, s54
v_pk_mul_f32 v[160:161], v[160:161], s[38:39] op_sel:[0,1] op_sel_hi:[1,1]
v_pk_mul_f32 v[162:163], v[162:163], s[38:39] op_sel:[0,1] op_sel_hi:[1,1]
v_pk_mul_f32 v[164:165], v[164:165], s[38:39] op_sel:[0,1] op_sel_hi:[1,1]
v_pk_mul_f32 v[166:167], v[166:167], s[38:39] op_sel:[0,1] op_sel_hi:[1,1]
v_cvt_pk_bf16_f32 v160, v160, v161
v_cvt_pk_bf16_f32 v161, v162, v163
v_cvt_pk_bf16_f32 v162, v164, v165
v_cvt_pk_bf16_f32 v163, v166, v167
buffer_store_dwordx4 v[160:163], v3, s[8:11], s52 offen sc1
v_pk_mul_f32 v[168:169], v[168:169], s[38:39] op_sel:[0,1] op_sel_hi:[1,1]
v_pk_mul_f32 v[170:171], v[170:171], s[38:39] op_sel:[0,1] op_sel_hi:[1,1]
v_pk_mul_f32 v[172:173], v[172:173], s[38:39] op_sel:[0,1] op_sel_hi:[1,1]
v_pk_mul_f32 v[174:175], v[174:175], s[38:39] op_sel:[0,1] op_sel_hi:[1,1]
v_cvt_pk_bf16_f32 v168, v168, v169
v_cvt_pk_bf16_f32 v169, v170, v171
v_cvt_pk_bf16_f32 v170, v172, v173
v_cvt_pk_bf16_f32 v171, v174, v175
buffer_store_dwordx4 v[168:171], v5, s[8:11], s52 offen sc1
s_add_u32 s52, s52, s54
s_waitcnt vmcnt(0)
s_mov_b32 s40, 0x100000
P0iw:
v_cmp_gt_u32 vcc, 1, v7
s_cbranch_vccz P0iok
buffer_load_dword v7, v6, s[12:15], 0 offen offset:8 sc1
s_waitcnt vmcnt(0)
s_sub_u32 s40, s40, 1
s_cbranch_scc0 P0iw
P0iok:
s_barrier
s_cmp_eq_u32 s17, 0
s_cbranch_scc0 P0done
s_lshl_b32 s52, s18, 7
s_add_u32 s52, s52, 54861824
s_lshr_b32 s53, s2, 4
s_lshl_b32 s53, s53, 7
s_add_u32 s53, s53, 54865920
v_mov_b32 v4, 1
v_mov_b32 v5, 1073741824
v_cmp_eq_u32 vcc, 0, v2
s_nop 1
v_cndmask_b32 v5, v5, 0, vcc
buffer_atomic_add v4, v5, s[8:11], s52 offen offset:0
buffer_atomic_add v4, v5, s[8:11], s53 offen
s_lshl_b32 s52, s18, 5
s_bfe_u32 s53, s2, 0x30003
s_lshl_b32 s53, s53, 2
s_add_u32 s52, s52, s53
s_add_u32 s52, s52, 54878208
buffer_store_dword v4, v5, s[8:11], s52 offen sc1
P0done:
s_cmp_eq_u32 s16, 1
s_mov_b32 s16, 99
s_cbranch_scc0 P0x
v_mov_b32 v252, 147440
ds_read_b32 v253, v252
s_waitcnt lgkmcnt(0)
v_readfirstlane_b32 s16, v253
s_barrier
P0x:
s_cmp_lt_u32 s16, 32
s_cbranch_scc1 Lteam
s_cmp_lt_u32 s16, 99
s_cbranch_scc1 Lbulk
s_mov_b32 s40, 20000
v_mov_b32 v40, 0
Lmw_21:
buffer_load_dword v42, v40, s[12:15], 0 offen offset:4 sc1
s_waitcnt vmcnt(0)
v_readfirstlane_b32 s41, v42
s_cmp_lg_u32 s41, 0
s_cbranch_scc1 Lmg_22
s_sleep 1
s_sub_u32 s40, s40, 1
s_cbranch_scc0 Lmw_21
v_mov_b32 v42, 2
v_mov_b32 v43, 0
buffer_atomic_cmpswap v[42:43], v40, s[12:15], 0 offen offset:4
s_waitcnt vmcnt(0)
s_mov_b32 s40, 20000
s_branch Lmw_21
Lmg_22:
s_cmp_eq_u32 s41, 1
s_cbranch_scc1 Lbulk
v_mov_b32 v1, 1
v_mov_b32 v2, 0
v_mov_b32 v3, 147440
v_cmp_eq_u32 vcc, 0, v0
s_and_saveexec_b64 s[36:37], vcc
s_cbranch_execz Lskipb
buffer_atomic_add v1, v2, s[12:15], 0 offen offset:0 sc0
s_waitcnt vmcnt(0)
ds_write_b32 v3, v1
s_waitcnt lgkmcnt(0)
Lskipb:
s_mov_b64 exec, s[36:37]
s_barrier
ds_read_b32 v1, v3
s_waitcnt lgkmcnt(0)
v_readfirstlane_b32 s16, v1
s_barrier
s_cmp_lt_u32 s16, 32
s_cbranch_scc1 Lteam
Lbulk:
v_lshrrev_b32 v1, 6, v0
s_nop 0
v_readfirstlane_b32 s17, v1
v_and_b32 v1, 63, v0
v_lshlrev_b32 v2, 4, v1
v_mov_b32 v25, 0
s_mov_b32 s19, 0x20000
s_load_dwordx4 s[56:59], s[0:1], 64
s_load_dwordx2 s[60:61], s[0:1], 80
s_load_dwordx2 s[72:73], s[0:1], 0
s_load_dwordx2 s[74:75], s[0:1], 88
s_waitcnt lgkmcnt(0)
s_mov_b32 s64, s72
s_and_b32 s65, s73, 0xffff
s_mov_b32 s66, 1835008
s_mov_b32 s67, 0x00020000
s_mov_b32 s68, s74
s_and_b32 s69, s75, 0xffff
s_mov_b32 s70, 1835008
s_mov_b32 s71, 0x00020000
s_mov_b32 s40, s56
s_and_b32 s41, s57, 0xffff
s_mov_b32 s42, 1605632
s_mov_b32 s43, 0x00020000
s_mov_b32 s44, s58
s_and_b32 s45, s59, 0xffff
s_mov_b32 s46, 1605632
s_mov_b32 s47, 0x00020000
s_mov_b32 s48, s60
s_and_b32 s49, s61, 0xffff
s_mov_b32 s50, 1605632
s_mov_b32 s51, 0x00020000
s_add_u32 s31, s3, 6
s_cmp_ge_u32 s31, 7
s_cselect_b32 s26, 7, 0
s_sub_u32 s31, s31, s26
s_cmp_ge_u32 s31, 7
s_cselect_b32 s31, 0, s31
s_mov_b32 s32, 0
Lnext_23:
s_cmp_lg_u32 s17, 0
s_cbranch_scc1 Lq_29
v_mov_b32 v27, 1073741824
v_cmp_eq_u32 vcc, 0, v1
s_nop 1
v_cndmask_b32 v27, v27, v25, vcc
s_cmp_lg_u32 s32, 0
s_cbranch_scc1 Lglob_30
Lvq_31:
s_lshl_b32 s26, s31, 7
s_add_u32 s26, s26, 54857984
v_mov_b32 v26, 1
buffer_atomic_add v26, v27, s[8:11], s26 offen sc0
s_getpc_b64 s[34:35]
Lvpc:
s_mul_i32 s27, s31, 248
s_add_u32 s34, s34, Lvtab-Lvpc
s_addc_u32 s35, s35, 0
s_waitcnt vmcnt(0)
v_readfirstlane_b32 s20, v26
s_cmp_ge_u32 s20, 62
s_cbranch_scc1 Lvn_32
s_lshl_b32 s20, s20, 2
s_add_u32 s27, s27, s20
s_load_dword s20, s[34:35], s27
s_waitcnt lgkmcnt(0)
s_cmp_eq_u32 s20, 0xffff
s_cbranch_scc0 Lgot_33
Lvn_32:
v_lshlrev_b32 v28, 7, v1
s_mov_b32 s26, 54857984
v_min_u32 v28, 768, v28
buffer_load_dword v26, v28, s[8:11], s26 offen sc1
s_waitcnt vmcnt(0)
v_cmp_gt_u32 vcc, 62, v26
s_nop 3
s_and_b32 s26, vcc_lo, 0x7f
s_ff1_i32_b32 s31, s26
s_cbranch_scc1 Lvq_31
s_mov_b32 s32, 1
Lglob_30:
s_mov_b32 s26, 54857728
v_mov_b32 v26, 1
buffer_atomic_add v26, v27, s[8:11], s26 offen sc0
s_waitcnt vmcnt(0)
Lglob_302:
v_readfirstlane_b32 s20, v26
s_add_u32 s20, s20, 384
s_cmp_ge_u32 s20, 928
s_cselect_b32 s20, 0xfffe, s20
Lgot_33:
v_mov_b32 v28, 131072
v_mov_b32 v26, s20
ds_write_b32 v28, v26
s_waitcnt lgkmcnt(0)
Lq_29:
s_barrier
v_mov_b32 v28, 131072
ds_read_b32 v26, v28
s_waitcnt lgkmcnt(0)
v_readfirstlane_b32 s20, v26
s_barrier
s_cmp_ge_u32 s20, 65534
s_cbranch_scc1 Lend2
s_cmp_lt_u32 s20, 256
s_cbranch_scc0 Ld_34
s_sub_u32 s26, s20, 0
s_lshr_b32 s21, s26, 4
s_add_u32 s21, s21, 0
s_and_b32 s22, s26, 15
s_lshl_b32 s23, s21, 2
s_add_u32 s23, s23, s17
s_branch LiV_24
Ld_34:
s_cmp_lt_u32 s20, 384
s_cbranch_scc0 Ld_35
s_sub_u32 s26, s20, 256
s_lshr_b32 s21, s26, 3
s_add_u32 s21, s21, 0
s_and_b32 s22, s26, 7
s_lshl_b32 s23, s21, 2
s_add_u32 s23, s23, s17
s_branch LiF1_25
Ld_35:
s_cmp_lt_u32 s20, 448
s_cbranch_scc0 Ld_36
s_sub_u32 s26, s20, 384
s_lshr_b32 s21, s26, 4
s_add_u32 s21, s21, 0
s_and_b32 s22, s26, 15
s_lshl_b32 s23, s21, 2
s_add_u32 s23, s23, s17
s_branch LiS_27
Ld_36:
s_cmp_lt_u32 s20, 480
s_cbranch_scc0 Ld_37
s_sub_u32 s26, s20, 448
s_lshr_b32 s21, s26, 1
s_add_u32 s21, s21, 0
s_and_b32 s22, s26, 1
s_lshl_b32 s23, s21, 2
s_add_u32 s23, s23, s17
s_branch LiF2_26
Ld_37:
s_cmp_lt_u32 s20, 672
s_cbranch_scc0 Ld_38
s_sub_u32 s26, s20, 480
s_lshr_b32 s21, s26, 4
s_add_u32 s21, s21, 4
s_and_b32 s22, s26, 15
s_lshl_b32 s23, s21, 2
s_add_u32 s23, s23, s17
s_branch LiS_27
Ld_38:
s_cmp_lt_u32 s20, 928
s_cbranch_scc0 Ld_39
s_sub_u32 s26, s20, 672
s_lshr_b32 s21, s26, 2
s_add_u32 s21, s21, 0
s_and_b32 s22, s26, 3
s_lshl_b32 s23, s21, 2
s_add_u32 s23, s23, s17
s_branch LiO_28
Ld_39:
s_sub_u32 s26, s20, 928
s_lshr_b32 s21, s26, 5
s_add_u32 s21, s21, 0
s_and_b32 s22, s26, 31
s_lshl_b32 s23, s21, 2
s_add_u32 s23, s23, s17
s_branch LiVH_40
Lvtab:
.long 928, 929, 930, 931, 956, 957, 960, 961, 962, 963, 32, 33, 48, 49, 63, 64, 65, 256, 263, 264, 272, 280, 288, 296, 304, 312, 319, 320, 328, 336, 344, 352, 360, 368, 375, 376, 80, 81, 96, 97, 112, 113, 126, 128, 129, 144, 145, 160, 161, 175, 176, 177, 192, 193, 208, 209, 224, 225, 238, 240, 241, 65535
.long 932, 933, 934, 935, 958, 959, 964, 965, 966, 967, 34, 35, 50, 51, 66, 67, 78, 257, 265, 271, 273, 281, 289, 297, 305, 313, 321, 327, 329, 337, 345, 353, 361, 369, 377, 383, 82, 83, 98, 99, 114, 115, 127, 130, 131, 146, 147, 162, 163, 178, 179, 190, 194, 195, 210, 211, 226, 227, 239, 242, 243, 65535
.long 936, 937, 938, 939, 968, 969, 970, 971, 988, 989, 36, 37, 52, 53, 68, 69, 79, 258, 266, 274, 279, 282, 290, 298, 306, 314, 322, 330, 335, 338, 346, 354, 362, 370, 378, 84, 85, 100, 101, 116, 117, 132, 133, 142, 148, 149, 164, 165, 180, 181, 191, 196, 197, 212, 213, 228, 229, 244, 245, 254, 65535, 65535
.long 940, 941, 942, 943, 972, 973, 974, 975, 990, 991, 38, 39, 54, 55, 70, 71, 259, 267, 275, 283, 287, 291, 299, 307, 315, 323, 331, 339, 343, 347, 355, 363, 371, 379, 86, 87, 94, 102, 103, 118, 119, 134, 135, 143, 150, 151, 166, 167, 182, 183, 198, 199, 206, 214, 215, 230, 231, 246, 247, 255, 65535, 65535
.long 944, 945, 946, 947, 976, 977, 978, 979, 40, 41, 46, 56, 57, 72, 73, 260, 268, 276, 284, 292, 295, 300, 308, 316, 324, 332, 340, 348, 351, 356, 364, 372, 380, 88, 89, 95, 104, 105, 120, 121, 136, 137, 152, 153, 158, 168, 169, 184, 185, 200, 201, 207, 216, 217, 232, 233, 248, 249, 65535, 65535, 65535, 65535
.long 948, 949, 950, 951, 980, 981, 982, 983, 42, 43, 47, 58, 59, 74, 75, 261, 269, 277, 285, 293, 301, 303, 309, 317, 325, 333, 341, 349, 357, 359, 365, 373, 381, 90, 91, 106, 107, 110, 122, 123, 138, 139, 154, 155, 159, 170, 171, 186, 187, 202, 203, 218, 219, 222, 234, 235, 250, 251, 65535, 65535, 65535, 65535
.long 952, 953, 954, 955, 984, 985, 986, 987, 44, 45, 60, 61, 62, 76, 77, 262, 270, 278, 286, 294, 302, 310, 311, 318, 326, 334, 342, 350, 358, 366, 367, 374, 382, 92, 93, 108, 109, 111, 124, 125, 140, 141, 156, 157, 172, 173, 174, 188, 189, 204, 205, 220, 221, 223, 236, 237, 252, 253, 65535, 65535, 65535, 65535
.p2align 6
LiO_28:
s_lshr_b32 s26, s21, 2
s_lshl_b32 s26, s26, 7
s_add_u32 s27, s26, 54859776
s_add_u32 s28, s26, 54870016
s_add_u32 s26, s26, 54853632
v_mov_b32 v230, 1
v_mov_b32 v231, 1073741824
v_cmp_eq_u32 vcc, 0, v0
s_mov_b32 s33, 54857728
s_cmp_lg_u32 s17, 0
v_cndmask_b32 v231, v231, v25, vcc
s_cbranch_scc1 Lonq_41
buffer_atomic_add v230, v231, s[8:11], s33 offen sc0
Lonq_41:
s_cmp_lg_u32 s17, 0
s_cbranch_scc1 Lwo_43
Lwm_42:
buffer_load_dword v26, v25, s[8:11], s26 offen sc1
buffer_load_dword v27, v25, s[8:11], s27 offen sc1
buffer_load_dword v28, v25, s[8:11], s28 offen sc1
s_waitcnt vmcnt(0)
v_cmp_gt_u32 vcc, 32, v26
v_cmp_gt_u32 s[62:63], 2, v27
s_nop 3
s_or_b64 vcc, vcc, s[62:63]
v_cmp_gt_u32 s[62:63], 16, v28
s_nop 3
s_or_b64 vcc, vcc, s[62:63]
s_cbranch_scc0 Lwo_43
s_sleep 32
s_sub_u32 s19, s19, 1
s_cbranch_scc0 Lwm_42
s_mov_b32 s19, 0
Lwo_43:
s_barrier
s_mul_i32 s33, s21, 28
s_mul_i32 s34, s22, 7
s_add_u32 s33, s33, s34
s_lshl_b32 s34, s33, 14
s_lshl_b32 s35, s17, 12
s_add_u32 s34, s34, s35
s_add_u32 s34, s34, 16777216
s_lshl_b32 s35, s33, 12
s_lshl_b32 s36, s17, 10
s_add_u32 s35, s35, s36
s_add_u32 s35, s35, 46137344
buffer_load_dwordx4 v[72:75], v2, s[8:11], s34 offen offset:0 sc1
buffer_load_dwordx4 v[76:79], v2, s[8:11], s34 offen offset:1024 sc1
buffer_load_dwordx4 v[80:83], v2, s[8:11], s34 offen offset:2048 sc1
buffer_load_dwordx4 v[84:87], v2, s[8:11], s34 offen offset:3072 sc1
s_add_u32 s34, s34, 16384
buffer_load_dwordx4 v[92:95], v2, s[8:11], s34 offen offset:0 sc1
buffer_load_dwordx4 v[96:99], v2, s[8:11], s34 offen offset:1024 sc1
buffer_load_dwordx4 v[100:103], v2, s[8:11], s34 offen offset:2048 sc1
buffer_load_dwordx4 v[104:107], v2, s[8:11], s34 offen offset:3072 sc1
s_add_u32 s34, s34, 16384
buffer_load_dwordx4 v[112:115], v2, s[8:11], s34 offen offset:0 sc1
buffer_load_dwordx4 v[116:119], v2, s[8:11], s34 offen offset:1024 sc1
buffer_load_dwordx4 v[120:123], v2, s[8:11], s34 offen offset:2048 sc1
buffer_load_dwordx4 v[124:127], v2, s[8:11], s34 offen offset:3072 sc1
s_add_u32 s34, s34, 16384
buffer_load_dwordx4 v[132:135], v2, s[8:11], s34 offen offset:0 sc1
buffer_load_dwordx4 v[136:139], v2, s[8:11], s34 offen offset:1024 sc1
buffer_load_dwordx4 v[140:143], v2, s[8:11], s34 offen offset:2048 sc1
buffer_load_dwordx4 v[144:147], v2, s[8:11], s34 offen offset:3072 sc1
s_add_u32 s34, s34, 16384
buffer_load_dwordx4 v[152:155], v2, s[8:11], s34 offen offset:0 sc1
buffer_load_dwordx4 v[156:159], v2, s[8:11], s34 offen offset:1024 sc1
buffer_load_dwordx4 v[160:163], v2, s[8:11], s34 offen offset:2048 sc1
buffer_load_dwordx4 v[164:167], v2, s[8:11], s34 offen offset:3072 sc1
s_add_u32 s34, s34, 16384
buffer_load_dwordx4 v[172:175], v2, s[8:11], s34 offen offset:0 sc1
buffer_load_dwordx4 v[176:179], v2, s[8:11], s34 offen offset:1024 sc1
buffer_load_dwordx4 v[180:183], v2, s[8:11], s34 offen offset:2048 sc1
buffer_load_dwordx4 v[184:187], v2, s[8:11], s34 offen offset:3072 sc1
s_add_u32 s34, s34, 16384
buffer_load_dwordx4 v[192:195], v2, s[8:11], s34 offen offset:0 sc1
buffer_load_dwordx4 v[196:199], v2, s[8:11], s34 offen offset:1024 sc1
buffer_load_dwordx4 v[200:203], v2, s[8:11], s34 offen offset:2048 sc1
buffer_load_dwordx4 v[204:207], v2, s[8:11], s34 offen offset:3072 sc1
s_add_u32 s34, s34, 16384
v_and_b32 v247, 15, v1
v_lshrrev_b32 v246, 4, v1
s_and_b32 s36, s17, 1
s_lshl_b32 s36, s36, 4
v_add_u32 v244, s36, v247
v_mul_u32_u24 v244, 896, v244
v_lshl_add_u32 v244, v246, 3, v244
s_lshr_b32 s36, s17, 1
s_lshl_b32 s36, s36, 5
v_add_u32 v244, s36, v244
s_cmp_ge_u32 s17, 2
s_cselect_b32 s36, 1073741824, 0
v_add_u32 v245, s36, v244
s_mul_i32 s37, s21, 28672
s_mul_i32 s38, s22, 224
s_add_u32 s37, s37, s38
s_add_u32 s38, s37, 65011712
v_lshlrev_b32 v250, 2, v246
v_lshl_add_u32 v251, v247, 4, v250
s_mul_i32 s39, s17, 14336
v_add_u32 v246, s39, v2
s_lshl_b32 s39, s17, 10
v_add_u32 v247, s39, v2
buffer_load_dwordx2 v[212:213], v244, s[64:67], s37 offen offset:0
buffer_load_dwordx2 v[214:215], v244, s[8:11], s38 offen offset:0 sc1
buffer_load_dwordx2 v[216:217], v244, s[64:67], s37 offen offset:64
buffer_load_dwordx2 v[218:219], v244, s[8:11], s38 offen offset:64 sc1
buffer_load_dwordx2 v[220:221], v244, s[64:67], s37 offen offset:128
buffer_load_dwordx2 v[222:223], v244, s[8:11], s38 offen offset:128 sc1
buffer_load_dwordx2 v[224:225], v245, s[64:67], s37 offen offset:192
buffer_load_dwordx2 v[226:227], v245, s[8:11], s38 offen offset:192 sc1
s_cmp_lg_u32 s17, 0
s_cbranch_scc1 Lwo_45
s_mov_b32 s39, 54857856
Lwf_46:
buffer_load_dword v26, v25, s[8:11], s39 offen sc1
s_waitcnt vmcnt(0)
v_readfirstlane_b32 s33, v26
s_cmp_gt_u32 s33, s21
s_cbranch_scc1 Lwg_47
s_sub_u32 s19, s19, 1
s_cbranch_scc1 Lwg_47
s_sleep 6
s_add_u32 s33, s33, 2
s_cmp_gt_u32 s33, s21
s_cbranch_scc1 Lwf_46
s_sleep 127
s_branch Lwf_46
Lwg_47:
s_max_i32 s19, s19, 0
Lwo_45:
s_barrier
s_lshl_b32 s33, s21, 15
s_lshl_b32 s34, s17, 12
s_add_u32 s33, s33, s34
s_add_u32 s33, s33, 67108864
s_add_u32 s34, s33, 16384
s_lshl_b32 s36, s21, 13
s_lshl_b32 s39, s17, 11
s_add_u32 s36, s36, s39
s_add_u32 s36, s36, 69206016
s_mov_b32 s26, 54858880
v_and_b32 v249, 3, v1
v_lshlrev_b32 v249, 9, v249
v_min_u32 v248, 6, v1
v_lshlrev_b32 v248, 12, v248
s_cmp_ge_u32 s21, 62
s_cselect_b32 s28, 0, s21
s_cselect_b32 s60, 0, 1073741824
v_add_u32 v248, s60, v248
Loh_48:
buffer_load_dword v250, v249, s[8:11], s36 offen sc1
buffer_load_dword v252, v25, s[8:11], s26 offen sc1
buffer_load_dword v253, v248, s[8:11], s35 offen sc1
s_waitcnt vmcnt(0)
v_max_u32 v250, v250, v253
v_cmp_ge_u32 s[62:63], s28, v252
v_cmp_eq_u32 vcc, -1, v250
s_nop 3
s_or_b64 vcc, vcc, s[62:63]
s_cbranch_scc0 Lop_49

s_sub_u32 s19, s19, 1
s_cbranch_scc0 Loh_48
s_mov_b32 s19, 0
Lop_49:
buffer_load_dwordx4 v[32:35], v2, s[8:11], s33 offen offset:0 sc1
buffer_load_dwordx4 v[52:55], v2, s[8:11], s34 offen offset:0 sc1
buffer_load_dwordx4 v[36:39], v2, s[8:11], s33 offen offset:1024 sc1
buffer_load_dwordx4 v[56:59], v2, s[8:11], s34 offen offset:1024 sc1
buffer_load_dwordx4 v[40:43], v2, s[8:11], s33 offen offset:2048 sc1
buffer_load_dwordx4 v[60:63], v2, s[8:11], s34 offen offset:2048 sc1
buffer_load_dwordx4 v[44:47], v2, s[8:11], s33 offen offset:3072 sc1
buffer_load_dwordx4 v[64:67], v2, s[8:11], s34 offen offset:3072 sc1
buffer_load_dword v48, v251, s[8:11], s36 offen offset:0 sc1
buffer_load_dword v49, v251, s[8:11], s36 offen offset:512 sc1
buffer_load_dword v50, v251, s[8:11], s36 offen offset:1024 sc1
buffer_load_dword v51, v251, s[8:11], s36 offen offset:1536 sc1
buffer_load_dword v68, v251, s[8:11], s36 offen offset:256 sc1
buffer_load_dword v69, v251, s[8:11], s36 offen offset:768 sc1
buffer_load_dword v70, v251, s[8:11], s36 offen offset:1280 sc1
buffer_load_dword v71, v251, s[8:11], s36 offen offset:1792 sc1
s_mov_b32 s39, s35
buffer_load_dwordx4 v[88:91], v2, s[8:11], s39 offen sc1
s_add_u32 s39, s39, 4096
buffer_load_dwordx4 v[108:111], v2, s[8:11], s39 offen sc1
s_add_u32 s39, s39, 4096
buffer_load_dwordx4 v[128:131], v2, s[8:11], s39 offen sc1
s_add_u32 s39, s39, 4096
buffer_load_dwordx4 v[148:151], v2, s[8:11], s39 offen sc1
s_add_u32 s39, s39, 4096
buffer_load_dwordx4 v[168:171], v2, s[8:11], s39 offen sc1
s_add_u32 s39, s39, 4096
buffer_load_dwordx4 v[188:191], v2, s[8:11], s39 offen sc1
s_add_u32 s39, s39, 4096
buffer_load_dwordx4 v[208:211], v2, s[8:11], s39 offen sc1
s_add_u32 s39, s39, 4096
s_waitcnt vmcnt(21)
v_mfma_f32_16x16x32_bf16 a[0:3], v[72:75], v[32:35], 0
v_mfma_f32_16x16x32_bf16 a[4:7], v[72:75], v[52:55], 0
v_mfma_f32_16x16x32_bf16 a[8:11], v[92:95], v[32:35], 0
v_mfma_f32_16x16x32_bf16 a[12:15], v[92:95], v[52:55], 0
v_mfma_f32_16x16x32_bf16 a[16:19], v[112:115], v[32:35], 0
v_mfma_f32_16x16x32_bf16 a[20:23], v[112:115], v[52:55], 0
v_mfma_f32_16x16x32_bf16 a[24:27], v[132:135], v[32:35], 0
v_mfma_f32_16x16x32_bf16 a[28:31], v[132:135], v[52:55], 0
v_mfma_f32_16x16x32_bf16 a[32:35], v[152:155], v[32:35], 0
v_mfma_f32_16x16x32_bf16 a[36:39], v[152:155], v[52:55], 0
v_mfma_f32_16x16x32_bf16 a[40:43], v[172:175], v[32:35], 0
v_mfma_f32_16x16x32_bf16 a[44:47], v[172:175], v[52:55], 0
v_mfma_f32_16x16x32_bf16 a[48:51], v[192:195], v[32:35], 0
v_mfma_f32_16x16x32_bf16 a[52:55], v[192:195], v[52:55], 0
s_waitcnt vmcnt(19)
v_mfma_f32_16x16x32_bf16 a[0:3], v[76:79], v[36:39], a[0:3]
v_mfma_f32_16x16x32_bf16 a[4:7], v[76:79], v[56:59], a[4:7]
v_mfma_f32_16x16x32_bf16 a[8:11], v[96:99], v[36:39], a[8:11]
v_mfma_f32_16x16x32_bf16 a[12:15], v[96:99], v[56:59], a[12:15]
v_mfma_f32_16x16x32_bf16 a[16:19], v[116:119], v[36:39], a[16:19]
v_mfma_f32_16x16x32_bf16 a[20:23], v[116:119], v[56:59], a[20:23]
v_mfma_f32_16x16x32_bf16 a[24:27], v[136:139], v[36:39], a[24:27]
v_mfma_f32_16x16x32_bf16 a[28:31], v[136:139], v[56:59], a[28:31]
v_mfma_f32_16x16x32_bf16 a[32:35], v[156:159], v[36:39], a[32:35]
v_mfma_f32_16x16x32_bf16 a[36:39], v[156:159], v[56:59], a[36:39]
v_mfma_f32_16x16x32_bf16 a[40:43], v[176:179], v[36:39], a[40:43]
v_mfma_f32_16x16x32_bf16 a[44:47], v[176:179], v[56:59], a[44:47]
v_mfma_f32_16x16x32_bf16 a[48:51], v[196:199], v[36:39], a[48:51]
v_mfma_f32_16x16x32_bf16 a[52:55], v[196:199], v[56:59], a[52:55]
s_waitcnt vmcnt(17)
v_mfma_f32_16x16x32_bf16 a[0:3], v[80:83], v[40:43], a[0:3]
v_mfma_f32_16x16x32_bf16 a[4:7], v[80:83], v[60:63], a[4:7]
v_mfma_f32_16x16x32_bf16 a[8:11], v[100:103], v[40:43], a[8:11]
v_mfma_f32_16x16x32_bf16 a[12:15], v[100:103], v[60:63], a[12:15]
v_mfma_f32_16x16x32_bf16 a[16:19], v[120:123], v[40:43], a[16:19]
v_mfma_f32_16x16x32_bf16 a[20:23], v[120:123], v[60:63], a[20:23]
v_mfma_f32_16x16x32_bf16 a[24:27], v[140:143], v[40:43], a[24:27]
v_mfma_f32_16x16x32_bf16 a[28:31], v[140:143], v[60:63], a[28:31]
v_mfma_f32_16x16x32_bf16 a[32:35], v[160:163], v[40:43], a[32:35]
v_mfma_f32_16x16x32_bf16 a[36:39], v[160:163], v[60:63], a[36:39]
v_mfma_f32_16x16x32_bf16 a[40:43], v[180:183], v[40:43], a[40:43]
v_mfma_f32_16x16x32_bf16 a[44:47], v[180:183], v[60:63], a[44:47]
v_mfma_f32_16x16x32_bf16 a[48:51], v[200:203], v[40:43], a[48:51]
v_mfma_f32_16x16x32_bf16 a[52:55], v[200:203], v[60:63], a[52:55]
s_waitcnt vmcnt(15)
v_mfma_f32_16x16x32_bf16 a[0:3], v[84:87], v[44:47], a[0:3]
v_mfma_f32_16x16x32_bf16 a[4:7], v[84:87], v[64:67], a[4:7]
v_mfma_f32_16x16x32_bf16 a[8:11], v[104:107], v[44:47], a[8:11]
v_mfma_f32_16x16x32_bf16 a[12:15], v[104:107], v[64:67], a[12:15]
v_mfma_f32_16x16x32_bf16 a[16:19], v[124:127], v[44:47], a[16:19]
v_mfma_f32_16x16x32_bf16 a[20:23], v[124:127], v[64:67], a[20:23]
v_mfma_f32_16x16x32_bf16 a[24:27], v[144:147], v[44:47], a[24:27]
v_mfma_f32_16x16x32_bf16 a[28:31], v[144:147], v[64:67], a[28:31]
v_mfma_f32_16x16x32_bf16 a[32:35], v[164:167], v[44:47], a[32:35]
v_mfma_f32_16x16x32_bf16 a[36:39], v[164:167], v[64:67], a[36:39]
v_mfma_f32_16x16x32_bf16 a[40:43], v[184:187], v[44:47], a[40:43]
v_mfma_f32_16x16x32_bf16 a[44:47], v[184:187], v[64:67], a[44:47]
v_mfma_f32_16x16x32_bf16 a[48:51], v[204:207], v[44:47], a[48:51]
v_mfma_f32_16x16x32_bf16 a[52:55], v[204:207], v[64:67], a[52:55]
s_waitcnt vmcnt(6)
v_mfma_f32_16x16x32_bf16 a[0:3], v[88:91], v[48:51], a[0:3]
v_mfma_f32_16x16x32_bf16 a[4:7], v[88:91], v[68:71], a[4:7]
s_waitcnt vmcnt(5)
v_mfma_f32_16x16x32_bf16 a[8:11], v[108:111], v[48:51], a[8:11]
v_mfma_f32_16x16x32_bf16 a[12:15], v[108:111], v[68:71], a[12:15]
s_waitcnt vmcnt(4)
v_mfma_f32_16x16x32_bf16 a[16:19], v[128:131], v[48:51], a[16:19]
v_mfma_f32_16x16x32_bf16 a[20:23], v[128:131], v[68:71], a[20:23]
s_waitcnt vmcnt(3)
v_mfma_f32_16x16x32_bf16 a[24:27], v[148:151], v[48:51], a[24:27]
v_mfma_f32_16x16x32_bf16 a[28:31], v[148:151], v[68:71], a[28:31]
s_waitcnt vmcnt(2)
v_mfma_f32_16x16x32_bf16 a[32:35], v[168:171], v[48:51], a[32:35]
v_mfma_f32_16x16x32_bf16 a[36:39], v[168:171], v[68:71], a[36:39]
s_waitcnt vmcnt(1)
v_mfma_f32_16x16x32_bf16 a[40:43], v[188:191], v[48:51], a[40:43]
v_mfma_f32_16x16x32_bf16 a[44:47], v[188:191], v[68:71], a[44:47]
s_waitcnt vmcnt(0)
v_mfma_f32_16x16x32_bf16 a[48:51], v[208:211], v[48:51], a[48:51]
v_mfma_f32_16x16x32_bf16 a[52:55], v[208:211], v[68:71], a[52:55]
v_accvgpr_read_b32 v228, a0
v_accvgpr_read_b32 v229, a4
v_max3_u32 v250, v88, v108, v128
v_max3_u32 v250, v250, v148, v168
v_max3_u32 v250, v250, v188, v208
v_cmp_u_f32 vcc, v228, v229
v_cmp_eq_u32 s[62:63], -1, v250
s_nop 3
s_or_b64 vcc, vcc, s[62:63]
s_cbranch_scc0 Look_50
s_sleep 1
s_sub_u32 s19, s19, 1
s_cbranch_scc0 Lop_49
s_mov_b32 s19, 0
Look_50:
ds_write_b128 v246, a[0:3] offset:0
ds_write_b128 v246, a[4:7] offset:1024
ds_write_b128 v246, a[8:11] offset:2048
ds_write_b128 v246, a[12:15] offset:3072
ds_write_b128 v246, a[16:19] offset:4096
ds_write_b128 v246, a[20:23] offset:5120
ds_write_b128 v246, a[24:27] offset:6144
ds_write_b128 v246, a[28:31] offset:7168
ds_write_b128 v246, a[32:35] offset:8192
ds_write_b128 v246, a[36:39] offset:9216
ds_write_b128 v246, a[40:43] offset:10240
ds_write_b128 v246, a[44:47] offset:11264
ds_write_b128 v246, a[48:51] offset:12288
ds_write_b128 v246, a[52:55] offset:13312
s_waitcnt lgkmcnt(0)
s_barrier
ds_read_b128 v[32:35], v247 offset:0
ds_read_b128 v[36:39], v247 offset:14336
ds_read_b128 v[40:43], v247 offset:28672
ds_read_b128 v[44:47], v247 offset:43008
ds_read_b128 v[48:51], v247 offset:4096
ds_read_b128 v[52:55], v247 offset:18432
ds_read_b128 v[56:59], v247 offset:32768
ds_read_b128 v[60:63], v247 offset:47104
ds_read_b128 v[64:67], v247 offset:8192
ds_read_b128 v[68:71], v247 offset:22528
ds_read_b128 v[72:75], v247 offset:36864
ds_read_b128 v[76:79], v247 offset:51200
ds_read_b128 v[80:83], v247 offset:12288
ds_read_b128 v[84:87], v247 offset:26624
ds_read_b128 v[88:91], v247 offset:40960
ds_read_b128 v[92:95], v247 offset:55296
s_waitcnt lgkmcnt(12)
v_pk_add_f32 v[32:33], v[32:33], v[36:37]
v_pk_add_f32 v[34:35], v[34:35], v[38:39]
v_pk_add_f32 v[40:41], v[40:41], v[44:45]
v_pk_add_f32 v[42:43], v[42:43], v[46:47]
v_pk_add_f32 v[32:33], v[32:33], v[40:41]
v_pk_add_f32 v[34:35], v[34:35], v[42:43]
v_lshlrev_b32 v36, 16, v212
v_and_b32 v37, 0xffff0000, v212
v_lshlrev_b32 v38, 16, v213
v_and_b32 v39, 0xffff0000, v213
v_lshlrev_b32 v40, 16, v214
v_and_b32 v41, 0xffff0000, v214
v_lshlrev_b32 v42, 16, v215
v_and_b32 v43, 0xffff0000, v215
v_pk_fma_f32 v[32:33], v[32:33], v[40:41], v[36:37]
v_pk_fma_f32 v[34:35], v[34:35], v[42:43], v[38:39]
v_cvt_pk_bf16_f32 v32, v32, v33
v_cvt_pk_bf16_f32 v33, v34, v35
buffer_store_dwordx2 v[32:33], v244, s[68:71], s37 offen offset:0 nt
s_waitcnt lgkmcnt(8)
v_pk_add_f32 v[48:49], v[48:49], v[52:53]
v_pk_add_f32 v[50:51], v[50:51], v[54:55]
v_pk_add_f32 v[56:57], v[56:57], v[60:61]
v_pk_add_f32 v[58:59], v[58:59], v[62:63]
v_pk_add_f32 v[48:49], v[48:49], v[56:57]
v_pk_add_f32 v[50:51], v[50:51], v[58:59]
v_lshlrev_b32 v52, 16, v216
v_and_b32 v53, 0xffff0000, v216
v_lshlrev_b32 v54, 16, v217
v_and_b32 v55, 0xffff0000, v217
v_lshlrev_b32 v56, 16, v218
v_and_b32 v57, 0xffff0000, v218
v_lshlrev_b32 v58, 16, v219
v_and_b32 v59, 0xffff0000, v219
v_pk_fma_f32 v[48:49], v[48:49], v[56:57], v[52:53]
v_pk_fma_f32 v[50:51], v[50:51], v[58:59], v[54:55]
v_cvt_pk_bf16_f32 v48, v48, v49
v_cvt_pk_bf16_f32 v49, v50, v51
buffer_store_dwordx2 v[48:49], v244, s[68:71], s37 offen offset:64 nt
s_waitcnt lgkmcnt(4)
v_pk_add_f32 v[64:65], v[64:65], v[68:69]
v_pk_add_f32 v[66:67], v[66:67], v[70:71]
v_pk_add_f32 v[72:73], v[72:73], v[76:77]
v_pk_add_f32 v[74:75], v[74:75], v[78:79]
v_pk_add_f32 v[64:65], v[64:65], v[72:73]
v_pk_add_f32 v[66:67], v[66:67], v[74:75]
v_lshlrev_b32 v68, 16, v220
v_and_b32 v69, 0xffff0000, v220
v_lshlrev_b32 v70, 16, v221
v_and_b32 v71, 0xffff0000, v221
v_lshlrev_b32 v72, 16, v222
v_and_b32 v73, 0xffff0000, v222
v_lshlrev_b32 v74, 16, v223
v_and_b32 v75, 0xffff0000, v223
v_pk_fma_f32 v[64:65], v[64:65], v[72:73], v[68:69]
v_pk_fma_f32 v[66:67], v[66:67], v[74:75], v[70:71]
v_cvt_pk_bf16_f32 v64, v64, v65
v_cvt_pk_bf16_f32 v65, v66, v67
buffer_store_dwordx2 v[64:65], v244, s[68:71], s37 offen offset:128 nt
s_waitcnt lgkmcnt(0)
v_pk_add_f32 v[80:81], v[80:81], v[84:85]
v_pk_add_f32 v[82:83], v[82:83], v[86:87]
v_pk_add_f32 v[88:89], v[88:89], v[92:93]
v_pk_add_f32 v[90:91], v[90:91], v[94:95]
v_pk_add_f32 v[80:81], v[80:81], v[88:89]
v_pk_add_f32 v[82:83], v[82:83], v[90:91]
v_lshlrev_b32 v84, 16, v224
v_and_b32 v85, 0xffff0000, v224
v_lshlrev_b32 v86, 16, v225
v_and_b32 v87, 0xffff0000, v225
v_lshlrev_b32 v88, 16, v226
v_and_b32 v89, 0xffff0000, v226
v_lshlrev_b32 v90, 16, v227
v_and_b32 v91, 0xffff0000, v227
v_pk_fma_f32 v[80:81], v[80:81], v[88:89], v[84:85]
v_pk_fma_f32 v[82:83], v[82:83], v[90:91], v[86:87]
v_cvt_pk_bf16_f32 v80, v80, v81
v_cvt_pk_bf16_f32 v81, v82, v83
buffer_store_dwordx2 v[80:81], v245, s[68:71], s37 offen offset:192 nt
s_barrier
s_cmp_lg_u32 s17, 0
s_cbranch_scc1 Lq_29
v_mov_b32 v26, v230
s_branch Lglob_302
.p2align 6
LiVH_40:
v_bfe_u32 v26, v1, 4, 1
s_mov_b32 s26, 229376
v_mul_lo_u32 v26, v26, s26
v_lshrrev_b32 v27, 5, v1
v_lshl_add_u32 v26, v27, 8, v26
v_and_b32 v27, 15, v1
v_lshl_add_u32 v3, v27, 4, v26
v_add_u32 v5, 0, v2
v_add_u32 v6, 28672, v2
v_add_u32 v7, 57344, v2
v_add_u32 v8, 86016, v2
s_mul_i32 s25, s17, 7168
s_and_b32 s33, s22, 1
s_lshr_b32 s22, s22, 1
s_mul_i32 s24, s33, 3211264
s_lshl_b32 s26, s17, 9
s_add_u32 s24, s24, s26
s_mul_i32 s26, s22, 14336
s_add_u32 s24, s24, s26
s_add_u32 s24, s24, 7340032
s_mul_i32 s29, s23, 28672
s_add_u32 s29, s29, 55574528
s_lshl_b32 s27, s21, 7
s_add_u32 s27, s27, 54865920
s_lshl_b32 s28, s22, 8
s_add_u32 s28, s28, 54861952
s_cmp_lg_u32 s17, 0
s_cbranch_scc1 Lwo_52
Lwm_51:
buffer_load_dword v26, v25, s[8:11], s27 offen sc1
buffer_load_dword v27, v25, s[8:11], s28 offen sc1
s_waitcnt vmcnt(0)
v_cmp_gt_u32 vcc, 16, v26
v_cmp_gt_u32 s[62:63], 8, v27
s_nop 3
s_or_b64 vcc, vcc, s[62:63]
s_cbranch_scc0 Lwo_52
s_sleep 2
s_sub_u32 s19, s19, 1
s_cbranch_scc0 Lwm_51
s_mov_b32 s19, 0
Lwo_52:
s_barrier
s_add_u32 m0, s25, 0
s_add_u32 s26, s24, 0
buffer_load_dwordx4 v3, s[8:11], s26 offen sc1 lds
s_add_u32 m0, s25, 1024
s_add_u32 s26, s24, 458752
buffer_load_dwordx4 v3, s[8:11], s26 offen sc1 lds
s_add_u32 m0, s25, 2048
s_add_u32 s26, s24, 917504
buffer_load_dwordx4 v3, s[8:11], s26 offen sc1 lds
s_add_u32 m0, s25, 3072
s_add_u32 s26, s24, 1376256
buffer_load_dwordx4 v3, s[8:11], s26 offen sc1 lds
s_add_u32 m0, s25, 4096
s_add_u32 s26, s24, 1835008
buffer_load_dwordx4 v3, s[8:11], s26 offen sc1 lds
s_add_u32 m0, s25, 5120
s_add_u32 s26, s24, 2293760
buffer_load_dwordx4 v3, s[8:11], s26 offen sc1 lds
s_add_u32 m0, s25, 6144
s_add_u32 s26, s24, 2752512
buffer_load_dwordx4 v3, s[8:11], s26 offen sc1 lds
s_add_u32 s24, s24, 2048
buffer_load_dwordx4 v[128:131], v2, s[8:11], s29 offen offset:0 sc1
buffer_load_dwordx4 v[132:135], v2, s[8:11], s29 offen offset:1024 sc1
buffer_load_dwordx4 v[136:139], v2, s[8:11], s29 offen offset:2048 sc1
buffer_load_dwordx4 v[140:143], v2, s[8:11], s29 offen offset:3072 sc1
s_add_u32 s29, s29, 4096
buffer_load_dwordx4 v[144:147], v2, s[8:11], s29 offen offset:0 sc1
buffer_load_dwordx4 v[148:151], v2, s[8:11], s29 offen offset:1024 sc1
buffer_load_dwordx4 v[152:155], v2, s[8:11], s29 offen offset:2048 sc1
buffer_load_dwordx4 v[156:159], v2, s[8:11], s29 offen offset:3072 sc1
s_add_u32 s29, s29, 4096
buffer_load_dwordx4 v[160:163], v2, s[8:11], s29 offen offset:0 sc1
buffer_load_dwordx4 v[164:167], v2, s[8:11], s29 offen offset:1024 sc1
buffer_load_dwordx4 v[168:171], v2, s[8:11], s29 offen offset:2048 sc1
buffer_load_dwordx4 v[172:175], v2, s[8:11], s29 offen offset:3072 sc1
s_add_u32 s29, s29, 4096
buffer_load_dwordx4 v[176:179], v2, s[8:11], s29 offen offset:0 sc1
buffer_load_dwordx4 v[180:183], v2, s[8:11], s29 offen offset:1024 sc1
buffer_load_dwordx4 v[184:187], v2, s[8:11], s29 offen offset:2048 sc1
buffer_load_dwordx4 v[188:191], v2, s[8:11], s29 offen offset:3072 sc1
s_add_u32 s29, s29, 4096
buffer_load_dwordx4 v[192:195], v2, s[8:11], s29 offen offset:0 sc1
buffer_load_dwordx4 v[196:199], v2, s[8:11], s29 offen offset:1024 sc1
buffer_load_dwordx4 v[200:203], v2, s[8:11], s29 offen offset:2048 sc1
buffer_load_dwordx4 v[204:207], v2, s[8:11], s29 offen offset:3072 sc1
s_add_u32 s29, s29, 4096
buffer_load_dwordx4 v[208:211], v2, s[8:11], s29 offen offset:0 sc1
buffer_load_dwordx4 v[212:215], v2, s[8:11], s29 offen offset:1024 sc1
buffer_load_dwordx4 v[216:219], v2, s[8:11], s29 offen offset:2048 sc1
buffer_load_dwordx4 v[220:223], v2, s[8:11], s29 offen offset:3072 sc1
s_add_u32 s29, s29, 4096
buffer_load_dwordx4 v[224:227], v2, s[8:11], s29 offen offset:0 sc1
buffer_load_dwordx4 v[228:231], v2, s[8:11], s29 offen offset:1024 sc1
buffer_load_dwordx4 v[232:235], v2, s[8:11], s29 offen offset:2048 sc1
buffer_load_dwordx4 v[236:239], v2, s[8:11], s29 offen offset:3072 sc1
s_add_u32 m0, s25, 28672
s_add_u32 s26, s24, 0
buffer_load_dwordx4 v3, s[8:11], s26 offen sc1 lds
s_add_u32 m0, s25, 29696
s_add_u32 s26, s24, 458752
buffer_load_dwordx4 v3, s[8:11], s26 offen sc1 lds
s_add_u32 m0, s25, 30720
s_add_u32 s26, s24, 917504
buffer_load_dwordx4 v3, s[8:11], s26 offen sc1 lds
s_add_u32 m0, s25, 31744
s_add_u32 s26, s24, 1376256
buffer_load_dwordx4 v3, s[8:11], s26 offen sc1 lds
s_add_u32 m0, s25, 32768
s_add_u32 s26, s24, 1835008
buffer_load_dwordx4 v3, s[8:11], s26 offen sc1 lds
s_add_u32 m0, s25, 33792
s_add_u32 s26, s24, 2293760
buffer_load_dwordx4 v3, s[8:11], s26 offen sc1 lds
s_add_u32 m0, s25, 34816
s_add_u32 s26, s24, 2752512
buffer_load_dwordx4 v3, s[8:11], s26 offen sc1 lds
s_add_u32 s24, s24, 2048
s_add_u32 m0, s25, 57344
s_add_u32 s26, s24, 0
buffer_load_dwordx4 v3, s[8:11], s26 offen sc1 lds
s_add_u32 m0, s25, 58368
s_add_u32 s26, s24, 458752
buffer_load_dwordx4 v3, s[8:11], s26 offen sc1 lds
s_add_u32 m0, s25, 59392
s_add_u32 s26, s24, 917504
buffer_load_dwordx4 v3, s[8:11], s26 offen sc1 lds
s_add_u32 m0, s25, 60416
s_add_u32 s26, s24, 1376256
buffer_load_dwordx4 v3, s[8:11], s26 offen sc1 lds
s_add_u32 m0, s25, 61440
s_add_u32 s26, s24, 1835008
buffer_load_dwordx4 v3, s[8:11], s26 offen sc1 lds
s_add_u32 m0, s25, 62464
s_add_u32 s26, s24, 2293760
buffer_load_dwordx4 v3, s[8:11], s26 offen sc1 lds
s_add_u32 m0, s25, 63488
s_add_u32 s26, s24, 2752512
buffer_load_dwordx4 v3, s[8:11], s26 offen sc1 lds
s_add_u32 s24, s24, 2048
s_waitcnt vmcnt(14)
s_barrier
ds_read_b128 v[64:67], v5 offset:0
ds_read_b128 v[68:71], v5 offset:1024
ds_read_b128 v[72:75], v5 offset:2048
ds_read_b128 v[76:79], v5 offset:3072
ds_read_b128 v[80:83], v5 offset:4096
ds_read_b128 v[84:87], v5 offset:5120
ds_read_b128 v[88:91], v5 offset:6144
ds_read_b128 v[92:95], v5 offset:7168
s_waitcnt lgkmcnt(7)
v_mfma_f32_32x32x16_bf16 a[0:15], v[128:131], v[64:67], 0
ds_read_b128 v[96:99], v5 offset:8192
s_waitcnt lgkmcnt(7)
v_mfma_f32_32x32x16_bf16 a[16:31], v[128:131], v[68:71], 0
ds_read_b128 v[100:103], v5 offset:9216
s_waitcnt lgkmcnt(7)
v_mfma_f32_32x32x16_bf16 a[32:47], v[128:131], v[72:75], 0
ds_read_b128 v[104:107], v5 offset:10240
s_waitcnt lgkmcnt(7)
v_mfma_f32_32x32x16_bf16 a[48:63], v[128:131], v[76:79], 0
ds_read_b128 v[108:111], v5 offset:11264
s_waitcnt lgkmcnt(7)
v_mfma_f32_32x32x16_bf16 a[64:79], v[128:131], v[80:83], 0
ds_read_b128 v[112:115], v5 offset:12288
s_waitcnt lgkmcnt(7)
v_mfma_f32_32x32x16_bf16 a[80:95], v[128:131], v[84:87], 0
ds_read_b128 v[116:119], v5 offset:13312
s_waitcnt lgkmcnt(7)
v_mfma_f32_32x32x16_bf16 a[96:111], v[128:131], v[88:91], 0
ds_read_b128 v[120:123], v5 offset:14336
s_waitcnt lgkmcnt(7)
v_mfma_f32_32x32x16_bf16 a[0:15], v[132:135], v[92:95], a[0:15]
ds_read_b128 v[124:127], v5 offset:15360
s_waitcnt lgkmcnt(7)
v_mfma_f32_32x32x16_bf16 a[16:31], v[132:135], v[96:99], a[16:31]
ds_read_b128 v[64:67], v5 offset:16384
s_waitcnt lgkmcnt(7)
v_mfma_f32_32x32x16_bf16 a[32:47], v[132:135], v[100:103], a[32:47]
ds_read_b128 v[68:71], v5 offset:17408
s_waitcnt lgkmcnt(7)
v_mfma_f32_32x32x16_bf16 a[48:63], v[132:135], v[104:107], a[48:63]
ds_read_b128 v[72:75], v5 offset:18432
s_waitcnt lgkmcnt(7)
v_mfma_f32_32x32x16_bf16 a[64:79], v[132:135], v[108:111], a[64:79]
ds_read_b128 v[76:79], v5 offset:19456
s_waitcnt lgkmcnt(7)
v_mfma_f32_32x32x16_bf16 a[80:95], v[132:135], v[112:115], a[80:95]
ds_read_b128 v[80:83], v5 offset:20480
s_waitcnt lgkmcnt(7)
v_mfma_f32_32x32x16_bf16 a[96:111], v[132:135], v[116:119], a[96:111]
ds_read_b128 v[84:87], v5 offset:21504
s_waitcnt lgkmcnt(7)
v_mfma_f32_32x32x16_bf16 a[0:15], v[136:139], v[120:123], a[0:15]
ds_read_b128 v[88:91], v5 offset:22528
s_waitcnt lgkmcnt(7)
v_mfma_f32_32x32x16_bf16 a[16:31], v[136:139], v[124:127], a[16:31]
ds_read_b128 v[92:95], v5 offset:23552
s_waitcnt lgkmcnt(7)
v_mfma_f32_32x32x16_bf16 a[32:47], v[136:139], v[64:67], a[32:47]
ds_read_b128 v[96:99], v5 offset:24576
s_waitcnt lgkmcnt(7)
v_mfma_f32_32x32x16_bf16 a[48:63], v[136:139], v[68:71], a[48:63]
ds_read_b128 v[100:103], v5 offset:25600
s_waitcnt lgkmcnt(7)
v_mfma_f32_32x32x16_bf16 a[64:79], v[136:139], v[72:75], a[64:79]
ds_read_b128 v[104:107], v5 offset:26624
s_waitcnt lgkmcnt(7)
v_mfma_f32_32x32x16_bf16 a[80:95], v[136:139], v[76:79], a[80:95]
s_waitcnt vmcnt(7)
s_barrier
ds_read_b128 v[108:111], v5 offset:27648
s_waitcnt lgkmcnt(7)
v_mfma_f32_32x32x16_bf16 a[96:111], v[136:139], v[80:83], a[96:111]
ds_read_b128 v[112:115], v6 offset:0
s_waitcnt lgkmcnt(7)
v_mfma_f32_32x32x16_bf16 a[0:15], v[140:143], v[84:87], a[0:15]
ds_read_b128 v[116:119], v6 offset:1024
s_add_u32 m0, s25, 86016
s_add_u32 s26, s24, 0
buffer_load_dwordx4 v3, s[8:11], s26 offen sc1 lds
s_waitcnt lgkmcnt(7)
v_mfma_f32_32x32x16_bf16 a[16:31], v[140:143], v[88:91], a[16:31]
ds_read_b128 v[120:123], v6 offset:2048
s_waitcnt lgkmcnt(7)
v_mfma_f32_32x32x16_bf16 a[32:47], v[140:143], v[92:95], a[32:47]
ds_read_b128 v[124:127], v6 offset:3072
s_waitcnt lgkmcnt(7)
v_mfma_f32_32x32x16_bf16 a[48:63], v[140:143], v[96:99], a[48:63]
ds_read_b128 v[64:67], v6 offset:4096
s_add_u32 m0, s25, 87040
s_add_u32 s26, s24, 458752
buffer_load_dwordx4 v3, s[8:11], s26 offen sc1 lds
s_waitcnt lgkmcnt(7)
v_mfma_f32_32x32x16_bf16 a[64:79], v[140:143], v[100:103], a[64:79]
ds_read_b128 v[68:71], v6 offset:5120
s_waitcnt lgkmcnt(7)
v_mfma_f32_32x32x16_bf16 a[80:95], v[140:143], v[104:107], a[80:95]
ds_read_b128 v[72:75], v6 offset:6144
s_waitcnt lgkmcnt(7)
v_mfma_f32_32x32x16_bf16 a[96:111], v[140:143], v[108:111], a[96:111]
ds_read_b128 v[76:79], v6 offset:7168
s_add_u32 m0, s25, 88064
s_add_u32 s26, s24, 917504
buffer_load_dwordx4 v3, s[8:11], s26 offen sc1 lds
s_waitcnt lgkmcnt(7)
v_mfma_f32_32x32x16_bf16 a[0:15], v[144:147], v[112:115], a[0:15]
ds_read_b128 v[80:83], v6 offset:8192
s_waitcnt lgkmcnt(7)
v_mfma_f32_32x32x16_bf16 a[16:31], v[144:147], v[116:119], a[16:31]
ds_read_b128 v[84:87], v6 offset:9216
s_waitcnt lgkmcnt(7)
v_mfma_f32_32x32x16_bf16 a[32:47], v[144:147], v[120:123], a[32:47]
ds_read_b128 v[88:91], v6 offset:10240
s_add_u32 m0, s25, 89088
s_add_u32 s26, s24, 1376256
buffer_load_dwordx4 v3, s[8:11], s26 offen sc1 lds
s_waitcnt lgkmcnt(7)
v_mfma_f32_32x32x16_bf16 a[48:63], v[144:147], v[124:127], a[48:63]
ds_read_b128 v[92:95], v6 offset:11264
s_waitcnt lgkmcnt(7)
v_mfma_f32_32x32x16_bf16 a[64:79], v[144:147], v[64:67], a[64:79]
ds_read_b128 v[96:99], v6 offset:12288
s_waitcnt lgkmcnt(7)
v_mfma_f32_32x32x16_bf16 a[80:95], v[144:147], v[68:71], a[80:95]
ds_read_b128 v[100:103], v6 offset:13312
s_add_u32 m0, s25, 90112
s_add_u32 s26, s24, 1835008
buffer_load_dwordx4 v3, s[8:11], s26 offen sc1 lds
s_waitcnt lgkmcnt(7)
v_mfma_f32_32x32x16_bf16 a[96:111], v[144:147], v[72:75], a[96:111]
ds_read_b128 v[104:107], v6 offset:14336
s_waitcnt lgkmcnt(7)
v_mfma_f32_32x32x16_bf16 a[0:15], v[148:151], v[76:79], a[0:15]
ds_read_b128 v[108:111], v6 offset:15360
s_waitcnt lgkmcnt(7)
v_mfma_f32_32x32x16_bf16 a[16:31], v[148:151], v[80:83], a[16:31]
ds_read_b128 v[112:115], v6 offset:16384
s_add_u32 m0, s25, 91136
s_add_u32 s26, s24, 2293760
buffer_load_dwordx4 v3, s[8:11], s26 offen sc1 lds
s_waitcnt lgkmcnt(7)
v_mfma_f32_32x32x16_bf16 a[32:47], v[148:151], v[84:87], a[32:47]
ds_read_b128 v[116:119], v6 offset:17408
s_waitcnt lgkmcnt(7)
v_mfma_f32_32x32x16_bf16 a[48:63], v[148:151], v[88:91], a[48:63]
ds_read_b128 v[120:123], v6 offset:18432
s_waitcnt lgkmcnt(7)
v_mfma_f32_32x32x16_bf16 a[64:79], v[148:151], v[92:95], a[64:79]
ds_read_b128 v[124:127], v6 offset:19456
s_add_u32 m0, s25, 92160
s_add_u32 s26, s24, 2752512
buffer_load_dwordx4 v3, s[8:11], s26 offen sc1 lds
s_add_u32 s24, s24, 2048
s_waitcnt lgkmcnt(7)
v_mfma_f32_32x32x16_bf16 a[80:95], v[148:151], v[96:99], a[80:95]
ds_read_b128 v[64:67], v6 offset:20480
s_waitcnt lgkmcnt(7)
v_mfma_f32_32x32x16_bf16 a[96:111], v[148:151], v[100:103], a[96:111]
ds_read_b128 v[68:71], v6 offset:21504
s_waitcnt lgkmcnt(7)
v_mfma_f32_32x32x16_bf16 a[0:15], v[152:155], v[104:107], a[0:15]
ds_read_b128 v[72:75], v6 offset:22528
s_waitcnt lgkmcnt(7)
v_mfma_f32_32x32x16_bf16 a[16:31], v[152:155], v[108:111], a[16:31]
ds_read_b128 v[76:79], v6 offset:23552
s_waitcnt lgkmcnt(7)
v_mfma_f32_32x32x16_bf16 a[32:47], v[152:155], v[112:115], a[32:47]
ds_read_b128 v[80:83], v6 offset:24576
s_waitcnt lgkmcnt(7)
v_mfma_f32_32x32x16_bf16 a[48:63], v[152:155], v[116:119], a[48:63]
ds_read_b128 v[84:87], v6 offset:25600
s_waitcnt lgkmcnt(7)
v_mfma_f32_32x32x16_bf16 a[64:79], v[152:155], v[120:123], a[64:79]
ds_read_b128 v[88:91], v6 offset:26624
s_waitcnt lgkmcnt(7)
v_mfma_f32_32x32x16_bf16 a[80:95], v[152:155], v[124:127], a[80:95]
s_waitcnt vmcnt(7)
s_barrier
ds_read_b128 v[92:95], v6 offset:27648
s_waitcnt lgkmcnt(7)
v_mfma_f32_32x32x16_bf16 a[96:111], v[152:155], v[64:67], a[96:111]
ds_read_b128 v[96:99], v7 offset:0
s_add_u32 m0, s25, 0
s_add_u32 s26, s24, 0
buffer_load_dwordx4 v3, s[8:11], s26 offen sc1 lds
s_waitcnt lgkmcnt(7)
v_mfma_f32_32x32x16_bf16 a[0:15], v[156:159], v[68:71], a[0:15]
ds_read_b128 v[100:103], v7 offset:1024
s_waitcnt lgkmcnt(7)
v_mfma_f32_32x32x16_bf16 a[16:31], v[156:159], v[72:75], a[16:31]
ds_read_b128 v[104:107], v7 offset:2048
s_waitcnt lgkmcnt(7)
v_mfma_f32_32x32x16_bf16 a[32:47], v[156:159], v[76:79], a[32:47]
ds_read_b128 v[108:111], v7 offset:3072
s_add_u32 m0, s25, 1024
s_add_u32 s26, s24, 458752
buffer_load_dwordx4 v3, s[8:11], s26 offen sc1 lds
s_waitcnt lgkmcnt(7)
v_mfma_f32_32x32x16_bf16 a[48:63], v[156:159], v[80:83], a[48:63]
ds_read_b128 v[112:115], v7 offset:4096
s_waitcnt lgkmcnt(7)
v_mfma_f32_32x32x16_bf16 a[64:79], v[156:159], v[84:87], a[64:79]
ds_read_b128 v[116:119], v7 offset:5120
s_waitcnt lgkmcnt(7)
v_mfma_f32_32x32x16_bf16 a[80:95], v[156:159], v[88:91], a[80:95]
ds_read_b128 v[120:123], v7 offset:6144
s_add_u32 m0, s25, 2048
s_add_u32 s26, s24, 917504
buffer_load_dwordx4 v3, s[8:11], s26 offen sc1 lds
s_waitcnt lgkmcnt(7)
v_mfma_f32_32x32x16_bf16 a[96:111], v[156:159], v[92:95], a[96:111]
ds_read_b128 v[124:127], v7 offset:7168
s_waitcnt lgkmcnt(7)
v_mfma_f32_32x32x16_bf16 a[0:15], v[160:163], v[96:99], a[0:15]
ds_read_b128 v[64:67], v7 offset:8192
s_waitcnt lgkmcnt(7)
v_mfma_f32_32x32x16_bf16 a[16:31], v[160:163], v[100:103], a[16:31]
ds_read_b128 v[68:71], v7 offset:9216
s_add_u32 m0, s25, 3072
s_add_u32 s26, s24, 1376256
buffer_load_dwordx4 v3, s[8:11], s26 offen sc1 lds
s_waitcnt lgkmcnt(7)
v_mfma_f32_32x32x16_bf16 a[32:47], v[160:163], v[104:107], a[32:47]
ds_read_b128 v[72:75], v7 offset:10240
s_waitcnt lgkmcnt(7)
v_mfma_f32_32x32x16_bf16 a[48:63], v[160:163], v[108:111], a[48:63]
ds_read_b128 v[76:79], v7 offset:11264
s_waitcnt lgkmcnt(7)
v_mfma_f32_32x32x16_bf16 a[64:79], v[160:163], v[112:115], a[64:79]
ds_read_b128 v[80:83], v7 offset:12288
s_add_u32 m0, s25, 4096
s_add_u32 s26, s24, 1835008
buffer_load_dwordx4 v3, s[8:11], s26 offen sc1 lds
s_waitcnt lgkmcnt(7)
v_mfma_f32_32x32x16_bf16 a[80:95], v[160:163], v[116:119], a[80:95]
ds_read_b128 v[84:87], v7 offset:13312
s_waitcnt lgkmcnt(7)
v_mfma_f32_32x32x16_bf16 a[96:111], v[160:163], v[120:123], a[96:111]
ds_read_b128 v[88:91], v7 offset:14336
s_waitcnt lgkmcnt(7)
v_mfma_f32_32x32x16_bf16 a[0:15], v[164:167], v[124:127], a[0:15]
ds_read_b128 v[92:95], v7 offset:15360
s_add_u32 m0, s25, 5120
s_add_u32 s26, s24, 2293760
buffer_load_dwordx4 v3, s[8:11], s26 offen sc1 lds
s_waitcnt lgkmcnt(7)
v_mfma_f32_32x32x16_bf16 a[16:31], v[164:167], v[64:67], a[16:31]
ds_read_b128 v[96:99], v7 offset:16384
s_waitcnt lgkmcnt(7)
v_mfma_f32_32x32x16_bf16 a[32:47], v[164:167], v[68:71], a[32:47]
ds_read_b128 v[100:103], v7 offset:17408
s_waitcnt lgkmcnt(7)
v_mfma_f32_32x32x16_bf16 a[48:63], v[164:167], v[72:75], a[48:63]
ds_read_b128 v[104:107], v7 offset:18432
s_add_u32 m0, s25, 6144
s_add_u32 s26, s24, 2752512
buffer_load_dwordx4 v3, s[8:11], s26 offen sc1 lds
s_add_u32 s24, s24, 2048
s_waitcnt lgkmcnt(7)
v_mfma_f32_32x32x16_bf16 a[64:79], v[164:167], v[76:79], a[64:79]
ds_read_b128 v[108:111], v7 offset:19456
s_waitcnt lgkmcnt(7)
v_mfma_f32_32x32x16_bf16 a[80:95], v[164:167], v[80:83], a[80:95]
ds_read_b128 v[112:115], v7 offset:20480
s_waitcnt lgkmcnt(7)
v_mfma_f32_32x32x16_bf16 a[96:111], v[164:167], v[84:87], a[96:111]
ds_read_b128 v[116:119], v7 offset:21504
s_waitcnt lgkmcnt(7)
v_mfma_f32_32x32x16_bf16 a[0:15], v[168:171], v[88:91], a[0:15]
ds_read_b128 v[120:123], v7 offset:22528
s_waitcnt lgkmcnt(7)
v_mfma_f32_32x32x16_bf16 a[16:31], v[168:171], v[92:95], a[16:31]
ds_read_b128 v[124:127], v7 offset:23552
s_waitcnt lgkmcnt(7)
v_mfma_f32_32x32x16_bf16 a[32:47], v[168:171], v[96:99], a[32:47]
ds_read_b128 v[64:67], v7 offset:24576
s_waitcnt lgkmcnt(7)
v_mfma_f32_32x32x16_bf16 a[48:63], v[168:171], v[100:103], a[48:63]
ds_read_b128 v[68:71], v7 offset:25600
s_waitcnt lgkmcnt(7)
v_mfma_f32_32x32x16_bf16 a[64:79], v[168:171], v[104:107], a[64:79]
ds_read_b128 v[72:75], v7 offset:26624
s_waitcnt lgkmcnt(7)
v_mfma_f32_32x32x16_bf16 a[80:95], v[168:171], v[108:111], a[80:95]
s_waitcnt vmcnt(7)
s_barrier
ds_read_b128 v[76:79], v7 offset:27648
s_add_u32 m0, s25, 28672
s_add_u32 s26, s24, 0
buffer_load_dwordx4 v3, s[8:11], s26 offen sc1 lds
s_waitcnt lgkmcnt(7)
v_mfma_f32_32x32x16_bf16 a[96:111], v[168:171], v[112:115], a[96:111]
ds_read_b128 v[80:83], v8 offset:0
s_waitcnt lgkmcnt(7)
v_mfma_f32_32x32x16_bf16 a[0:15], v[172:175], v[116:119], a[0:15]
ds_read_b128 v[84:87], v8 offset:1024
s_waitcnt lgkmcnt(7)
v_mfma_f32_32x32x16_bf16 a[16:31], v[172:175], v[120:123], a[16:31]
ds_read_b128 v[88:91], v8 offset:2048
s_add_u32 m0, s25, 29696
s_add_u32 s26, s24, 458752
buffer_load_dwordx4 v3, s[8:11], s26 offen sc1 lds
s_waitcnt lgkmcnt(7)
v_mfma_f32_32x32x16_bf16 a[32:47], v[172:175], v[124:127], a[32:47]
ds_read_b128 v[92:95], v8 offset:3072
s_waitcnt lgkmcnt(7)
v_mfma_f32_32x32x16_bf16 a[48:63], v[172:175], v[64:67], a[48:63]
ds_read_b128 v[96:99], v8 offset:4096
s_waitcnt lgkmcnt(7)
v_mfma_f32_32x32x16_bf16 a[64:79], v[172:175], v[68:71], a[64:79]
ds_read_b128 v[100:103], v8 offset:5120
s_add_u32 m0, s25, 30720
s_add_u32 s26, s24, 917504
buffer_load_dwordx4 v3, s[8:11], s26 offen sc1 lds
s_waitcnt lgkmcnt(7)
v_mfma_f32_32x32x16_bf16 a[80:95], v[172:175], v[72:75], a[80:95]
ds_read_b128 v[104:107], v8 offset:6144
s_waitcnt lgkmcnt(7)
v_mfma_f32_32x32x16_bf16 a[96:111], v[172:175], v[76:79], a[96:111]
ds_read_b128 v[108:111], v8 offset:7168
s_waitcnt lgkmcnt(7)
v_mfma_f32_32x32x16_bf16 a[0:15], v[176:179], v[80:83], a[0:15]
ds_read_b128 v[112:115], v8 offset:8192
s_add_u32 m0, s25, 31744
s_add_u32 s26, s24, 1376256
buffer_load_dwordx4 v3, s[8:11], s26 offen sc1 lds
s_waitcnt lgkmcnt(7)
v_mfma_f32_32x32x16_bf16 a[16:31], v[176:179], v[84:87], a[16:31]
ds_read_b128 v[116:119], v8 offset:9216
s_waitcnt lgkmcnt(7)
v_mfma_f32_32x32x16_bf16 a[32:47], v[176:179], v[88:91], a[32:47]
ds_read_b128 v[120:123], v8 offset:10240
s_waitcnt lgkmcnt(7)
v_mfma_f32_32x32x16_bf16 a[48:63], v[176:179], v[92:95], a[48:63]
ds_read_b128 v[124:127], v8 offset:11264
s_add_u32 m0, s25, 32768
s_add_u32 s26, s24, 1835008
buffer_load_dwordx4 v3, s[8:11], s26 offen sc1 lds
s_waitcnt lgkmcnt(7)
v_mfma_f32_32x32x16_bf16 a[64:79], v[176:179], v[96:99], a[64:79]
ds_read_b128 v[64:67], v8 offset:12288
s_waitcnt lgkmcnt(7)
v_mfma_f32_32x32x16_bf16 a[80:95], v[176:179], v[100:103], a[80:95]
ds_read_b128 v[68:71], v8 offset:13312
s_waitcnt lgkmcnt(7)
v_mfma_f32_32x32x16_bf16 a[96:111], v[176:179], v[104:107], a[96:111]
ds_read_b128 v[72:75], v8 offset:14336
s_add_u32 m0, s25, 33792
s_add_u32 s26, s24, 2293760
buffer_load_dwordx4 v3, s[8:11], s26 offen sc1 lds
s_waitcnt lgkmcnt(7)
v_mfma_f32_32x32x16_bf16 a[0:15], v[180:183], v[108:111], a[0:15]
ds_read_b128 v[76:79], v8 offset:15360
s_waitcnt lgkmcnt(7)
v_mfma_f32_32x32x16_bf16 a[16:31], v[180:183], v[112:115], a[16:31]
ds_read_b128 v[80:83], v8 offset:16384
s_waitcnt lgkmcnt(7)
v_mfma_f32_32x32x16_bf16 a[32:47], v[180:183], v[116:119], a[32:47]
ds_read_b128 v[84:87], v8 offset:17408
s_add_u32 m0, s25, 34816
s_add_u32 s26, s24, 2752512
buffer_load_dwordx4 v3, s[8:11], s26 offen sc1 lds
s_add_u32 s24, s24, 2048
s_waitcnt lgkmcnt(7)
v_mfma_f32_32x32x16_bf16 a[48:63], v[180:183], v[120:123], a[48:63]
ds_read_b128 v[88:91], v8 offset:18432
s_waitcnt lgkmcnt(7)
v_mfma_f32_32x32x16_bf16 a[64:79], v[180:183], v[124:127], a[64:79]
ds_read_b128 v[92:95], v8 offset:19456
s_waitcnt lgkmcnt(7)
v_mfma_f32_32x32x16_bf16 a[80:95], v[180:183], v[64:67], a[80:95]
ds_read_b128 v[96:99], v8 offset:20480
s_waitcnt lgkmcnt(7)
v_mfma_f32_32x32x16_bf16 a[96:111], v[180:183], v[68:71], a[96:111]
ds_read_b128 v[100:103], v8 offset:21504
s_waitcnt lgkmcnt(7)
v_mfma_f32_32x32x16_bf16 a[0:15], v[184:187], v[72:75], a[0:15]
ds_read_b128 v[104:107], v8 offset:22528
s_waitcnt lgkmcnt(7)
v_mfma_f32_32x32x16_bf16 a[16:31], v[184:187], v[76:79], a[16:31]
ds_read_b128 v[108:111], v8 offset:23552
s_waitcnt lgkmcnt(7)
v_mfma_f32_32x32x16_bf16 a[32:47], v[184:187], v[80:83], a[32:47]
ds_read_b128 v[112:115], v8 offset:24576
s_waitcnt lgkmcnt(7)
v_mfma_f32_32x32x16_bf16 a[48:63], v[184:187], v[84:87], a[48:63]
ds_read_b128 v[116:119], v8 offset:25600
s_waitcnt lgkmcnt(7)
v_mfma_f32_32x32x16_bf16 a[64:79], v[184:187], v[88:91], a[64:79]
ds_read_b128 v[120:123], v8 offset:26624
s_waitcnt lgkmcnt(7)
v_mfma_f32_32x32x16_bf16 a[80:95], v[184:187], v[92:95], a[80:95]
s_waitcnt vmcnt(7)
s_barrier
ds_read_b128 v[124:127], v8 offset:27648
s_waitcnt lgkmcnt(7)
v_mfma_f32_32x32x16_bf16 a[96:111], v[184:187], v[96:99], a[96:111]
ds_read_b128 v[64:67], v5 offset:0
s_waitcnt lgkmcnt(7)
v_mfma_f32_32x32x16_bf16 a[0:15], v[188:191], v[100:103], a[0:15]
ds_read_b128 v[68:71], v5 offset:1024
s_add_u32 m0, s25, 57344
s_add_u32 s26, s24, 0
buffer_load_dwordx4 v3, s[8:11], s26 offen sc1 lds
s_waitcnt lgkmcnt(7)
v_mfma_f32_32x32x16_bf16 a[16:31], v[188:191], v[104:107], a[16:31]
ds_read_b128 v[72:75], v5 offset:2048
s_waitcnt lgkmcnt(7)
v_mfma_f32_32x32x16_bf16 a[32:47], v[188:191], v[108:111], a[32:47]
ds_read_b128 v[76:79], v5 offset:3072
s_waitcnt lgkmcnt(7)
v_mfma_f32_32x32x16_bf16 a[48:63], v[188:191], v[112:115], a[48:63]
ds_read_b128 v[80:83], v5 offset:4096
s_add_u32 m0, s25, 58368
s_add_u32 s26, s24, 458752
buffer_load_dwordx4 v3, s[8:11], s26 offen sc1 lds
s_waitcnt lgkmcnt(7)
v_mfma_f32_32x32x16_bf16 a[64:79], v[188:191], v[116:119], a[64:79]
ds_read_b128 v[84:87], v5 offset:5120
s_waitcnt lgkmcnt(7)
v_mfma_f32_32x32x16_bf16 a[80:95], v[188:191], v[120:123], a[80:95]
ds_read_b128 v[88:91], v5 offset:6144
s_waitcnt lgkmcnt(7)
v_mfma_f32_32x32x16_bf16 a[96:111], v[188:191], v[124:127], a[96:111]
ds_read_b128 v[92:95], v5 offset:7168
s_add_u32 m0, s25, 59392
s_add_u32 s26, s24, 917504
buffer_load_dwordx4 v3, s[8:11], s26 offen sc1 lds
s_waitcnt lgkmcnt(7)
v_mfma_f32_32x32x16_bf16 a[0:15], v[192:195], v[64:67], a[0:15]
ds_read_b128 v[96:99], v5 offset:8192
s_waitcnt lgkmcnt(7)
v_mfma_f32_32x32x16_bf16 a[16:31], v[192:195], v[68:71], a[16:31]
ds_read_b128 v[100:103], v5 offset:9216
s_waitcnt lgkmcnt(7)
v_mfma_f32_32x32x16_bf16 a[32:47], v[192:195], v[72:75], a[32:47]
ds_read_b128 v[104:107], v5 offset:10240
s_add_u32 m0, s25, 60416
s_add_u32 s26, s24, 1376256
buffer_load_dwordx4 v3, s[8:11], s26 offen sc1 lds
s_waitcnt lgkmcnt(7)
v_mfma_f32_32x32x16_bf16 a[48:63], v[192:195], v[76:79], a[48:63]
ds_read_b128 v[108:111], v5 offset:11264
s_waitcnt lgkmcnt(7)
v_mfma_f32_32x32x16_bf16 a[64:79], v[192:195], v[80:83], a[64:79]
ds_read_b128 v[112:115], v5 offset:12288
s_waitcnt lgkmcnt(7)
v_mfma_f32_32x32x16_bf16 a[80:95], v[192:195], v[84:87], a[80:95]
ds_read_b128 v[116:119], v5 offset:13312
s_add_u32 m0, s25, 61440
s_add_u32 s26, s24, 1835008
buffer_load_dwordx4 v3, s[8:11], s26 offen sc1 lds
s_waitcnt lgkmcnt(7)
v_mfma_f32_32x32x16_bf16 a[96:111], v[192:195], v[88:91], a[96:111]
ds_read_b128 v[120:123], v5 offset:14336
s_waitcnt lgkmcnt(7)
v_mfma_f32_32x32x16_bf16 a[0:15], v[196:199], v[92:95], a[0:15]
ds_read_b128 v[124:127], v5 offset:15360
s_waitcnt lgkmcnt(7)
v_mfma_f32_32x32x16_bf16 a[16:31], v[196:199], v[96:99], a[16:31]
ds_read_b128 v[64:67], v5 offset:16384
s_add_u32 m0, s25, 62464
s_add_u32 s26, s24, 2293760
buffer_load_dwordx4 v3, s[8:11], s26 offen sc1 lds
s_waitcnt lgkmcnt(7)
v_mfma_f32_32x32x16_bf16 a[32:47], v[196:199], v[100:103], a[32:47]
ds_read_b128 v[68:71], v5 offset:17408
s_waitcnt lgkmcnt(7)
v_mfma_f32_32x32x16_bf16 a[48:63], v[196:199], v[104:107], a[48:63]
ds_read_b128 v[72:75], v5 offset:18432
s_waitcnt lgkmcnt(7)
v_mfma_f32_32x32x16_bf16 a[64:79], v[196:199], v[108:111], a[64:79]
ds_read_b128 v[76:79], v5 offset:19456
s_add_u32 m0, s25, 63488
s_add_u32 s26, s24, 2752512
buffer_load_dwordx4 v3, s[8:11], s26 offen sc1 lds
s_add_u32 s24, s24, 2048
s_waitcnt lgkmcnt(7)
v_mfma_f32_32x32x16_bf16 a[80:95], v[196:199], v[112:115], a[80:95]
ds_read_b128 v[80:83], v5 offset:20480
s_waitcnt lgkmcnt(7)
v_mfma_f32_32x32x16_bf16 a[96:111], v[196:199], v[116:119], a[96:111]
ds_read_b128 v[84:87], v5 offset:21504
s_waitcnt lgkmcnt(7)
v_mfma_f32_32x32x16_bf16 a[0:15], v[200:203], v[120:123], a[0:15]
ds_read_b128 v[88:91], v5 offset:22528
s_waitcnt lgkmcnt(7)
v_mfma_f32_32x32x16_bf16 a[16:31], v[200:203], v[124:127], a[16:31]
ds_read_b128 v[92:95], v5 offset:23552
s_waitcnt lgkmcnt(7)
v_mfma_f32_32x32x16_bf16 a[32:47], v[200:203], v[64:67], a[32:47]
ds_read_b128 v[96:99], v5 offset:24576
s_waitcnt lgkmcnt(7)
v_mfma_f32_32x32x16_bf16 a[48:63], v[200:203], v[68:71], a[48:63]
ds_read_b128 v[100:103], v5 offset:25600
s_waitcnt lgkmcnt(7)
v_mfma_f32_32x32x16_bf16 a[64:79], v[200:203], v[72:75], a[64:79]
ds_read_b128 v[104:107], v5 offset:26624
s_waitcnt lgkmcnt(7)
v_mfma_f32_32x32x16_bf16 a[80:95], v[200:203], v[76:79], a[80:95]
s_waitcnt vmcnt(7)
s_barrier
ds_read_b128 v[108:111], v5 offset:27648
s_waitcnt lgkmcnt(7)
v_mfma_f32_32x32x16_bf16 a[96:111], v[200:203], v[80:83], a[96:111]
ds_read_b128 v[112:115], v6 offset:0
s_waitcnt lgkmcnt(7)
v_mfma_f32_32x32x16_bf16 a[0:15], v[204:207], v[84:87], a[0:15]
ds_read_b128 v[116:119], v6 offset:1024
s_waitcnt lgkmcnt(7)
v_mfma_f32_32x32x16_bf16 a[16:31], v[204:207], v[88:91], a[16:31]
ds_read_b128 v[120:123], v6 offset:2048
s_waitcnt lgkmcnt(7)
v_mfma_f32_32x32x16_bf16 a[32:47], v[204:207], v[92:95], a[32:47]
ds_read_b128 v[124:127], v6 offset:3072
s_waitcnt lgkmcnt(7)
v_mfma_f32_32x32x16_bf16 a[48:63], v[204:207], v[96:99], a[48:63]
ds_read_b128 v[64:67], v6 offset:4096
s_waitcnt lgkmcnt(7)
v_mfma_f32_32x32x16_bf16 a[64:79], v[204:207], v[100:103], a[64:79]
ds_read_b128 v[68:71], v6 offset:5120
s_waitcnt lgkmcnt(7)
v_mfma_f32_32x32x16_bf16 a[80:95], v[204:207], v[104:107], a[80:95]
ds_read_b128 v[72:75], v6 offset:6144
s_waitcnt lgkmcnt(7)
v_mfma_f32_32x32x16_bf16 a[96:111], v[204:207], v[108:111], a[96:111]
ds_read_b128 v[76:79], v6 offset:7168
s_waitcnt lgkmcnt(7)
v_mfma_f32_32x32x16_bf16 a[0:15], v[208:211], v[112:115], a[0:15]
ds_read_b128 v[80:83], v6 offset:8192
s_waitcnt lgkmcnt(7)
v_mfma_f32_32x32x16_bf16 a[16:31], v[208:211], v[116:119], a[16:31]
ds_read_b128 v[84:87], v6 offset:9216
s_waitcnt lgkmcnt(7)
v_mfma_f32_32x32x16_bf16 a[32:47], v[208:211], v[120:123], a[32:47]
ds_read_b128 v[88:91], v6 offset:10240
s_waitcnt lgkmcnt(7)
v_mfma_f32_32x32x16_bf16 a[48:63], v[208:211], v[124:127], a[48:63]
ds_read_b128 v[92:95], v6 offset:11264
s_waitcnt lgkmcnt(7)
v_mfma_f32_32x32x16_bf16 a[64:79], v[208:211], v[64:67], a[64:79]
ds_read_b128 v[96:99], v6 offset:12288
s_waitcnt lgkmcnt(7)
v_mfma_f32_32x32x16_bf16 a[80:95], v[208:211], v[68:71], a[80:95]
ds_read_b128 v[100:103], v6 offset:13312
s_waitcnt lgkmcnt(7)
v_mfma_f32_32x32x16_bf16 a[96:111], v[208:211], v[72:75], a[96:111]
ds_read_b128 v[104:107], v6 offset:14336
s_waitcnt lgkmcnt(7)
v_mfma_f32_32x32x16_bf16 a[0:15], v[212:215], v[76:79], a[0:15]
ds_read_b128 v[108:111], v6 offset:15360
s_waitcnt lgkmcnt(7)
v_mfma_f32_32x32x16_bf16 a[16:31], v[212:215], v[80:83], a[16:31]
ds_read_b128 v[112:115], v6 offset:16384
s_waitcnt lgkmcnt(7)
v_mfma_f32_32x32x16_bf16 a[32:47], v[212:215], v[84:87], a[32:47]
ds_read_b128 v[116:119], v6 offset:17408
s_waitcnt lgkmcnt(7)
v_mfma_f32_32x32x16_bf16 a[48:63], v[212:215], v[88:91], a[48:63]
ds_read_b128 v[120:123], v6 offset:18432
s_waitcnt lgkmcnt(7)
v_mfma_f32_32x32x16_bf16 a[64:79], v[212:215], v[92:95], a[64:79]
ds_read_b128 v[124:127], v6 offset:19456
s_waitcnt lgkmcnt(7)
v_mfma_f32_32x32x16_bf16 a[80:95], v[212:215], v[96:99], a[80:95]
ds_read_b128 v[64:67], v6 offset:20480
s_waitcnt lgkmcnt(7)
v_mfma_f32_32x32x16_bf16 a[96:111], v[212:215], v[100:103], a[96:111]
ds_read_b128 v[68:71], v6 offset:21504
s_waitcnt lgkmcnt(7)
v_mfma_f32_32x32x16_bf16 a[0:15], v[216:219], v[104:107], a[0:15]
ds_read_b128 v[72:75], v6 offset:22528
s_waitcnt lgkmcnt(7)
v_mfma_f32_32x32x16_bf16 a[16:31], v[216:219], v[108:111], a[16:31]
ds_read_b128 v[76:79], v6 offset:23552
s_waitcnt lgkmcnt(7)
v_mfma_f32_32x32x16_bf16 a[32:47], v[216:219], v[112:115], a[32:47]
ds_read_b128 v[80:83], v6 offset:24576
s_waitcnt lgkmcnt(7)
v_mfma_f32_32x32x16_bf16 a[48:63], v[216:219], v[116:119], a[48:63]
ds_read_b128 v[84:87], v6 offset:25600
s_waitcnt lgkmcnt(7)
v_mfma_f32_32x32x16_bf16 a[64:79], v[216:219], v[120:123], a[64:79]
ds_read_b128 v[88:91], v6 offset:26624
s_waitcnt lgkmcnt(7)
v_mfma_f32_32x32x16_bf16 a[80:95], v[216:219], v[124:127], a[80:95]
s_waitcnt vmcnt(0)
s_barrier
ds_read_b128 v[92:95], v6 offset:27648
s_waitcnt lgkmcnt(7)
v_mfma_f32_32x32x16_bf16 a[96:111], v[216:219], v[64:67], a[96:111]
ds_read_b128 v[96:99], v7 offset:0
s_waitcnt lgkmcnt(7)
v_mfma_f32_32x32x16_bf16 a[0:15], v[220:223], v[68:71], a[0:15]
ds_read_b128 v[100:103], v7 offset:1024
s_waitcnt lgkmcnt(7)
v_mfma_f32_32x32x16_bf16 a[16:31], v[220:223], v[72:75], a[16:31]
ds_read_b128 v[104:107], v7 offset:2048
s_waitcnt lgkmcnt(7)
v_mfma_f32_32x32x16_bf16 a[32:47], v[220:223], v[76:79], a[32:47]
ds_read_b128 v[108:111], v7 offset:3072
s_waitcnt lgkmcnt(7)
v_mfma_f32_32x32x16_bf16 a[48:63], v[220:223], v[80:83], a[48:63]
ds_read_b128 v[112:115], v7 offset:4096
s_waitcnt lgkmcnt(7)
v_mfma_f32_32x32x16_bf16 a[64:79], v[220:223], v[84:87], a[64:79]
ds_read_b128 v[116:119], v7 offset:5120
s_waitcnt lgkmcnt(7)
v_mfma_f32_32x32x16_bf16 a[80:95], v[220:223], v[88:91], a[80:95]
ds_read_b128 v[120:123], v7 offset:6144
s_waitcnt lgkmcnt(7)
v_mfma_f32_32x32x16_bf16 a[96:111], v[220:223], v[92:95], a[96:111]
ds_read_b128 v[124:127], v7 offset:7168
s_waitcnt lgkmcnt(7)
v_mfma_f32_32x32x16_bf16 a[0:15], v[224:227], v[96:99], a[0:15]
ds_read_b128 v[64:67], v7 offset:8192
s_waitcnt lgkmcnt(7)
v_mfma_f32_32x32x16_bf16 a[16:31], v[224:227], v[100:103], a[16:31]
ds_read_b128 v[68:71], v7 offset:9216
s_waitcnt lgkmcnt(7)
v_mfma_f32_32x32x16_bf16 a[32:47], v[224:227], v[104:107], a[32:47]
ds_read_b128 v[72:75], v7 offset:10240
s_waitcnt lgkmcnt(7)
v_mfma_f32_32x32x16_bf16 a[48:63], v[224:227], v[108:111], a[48:63]
ds_read_b128 v[76:79], v7 offset:11264
s_waitcnt lgkmcnt(7)
v_mfma_f32_32x32x16_bf16 a[64:79], v[224:227], v[112:115], a[64:79]
ds_read_b128 v[80:83], v7 offset:12288
s_waitcnt lgkmcnt(7)
v_mfma_f32_32x32x16_bf16 a[80:95], v[224:227], v[116:119], a[80:95]
ds_read_b128 v[84:87], v7 offset:13312
s_waitcnt lgkmcnt(7)
v_mfma_f32_32x32x16_bf16 a[96:111], v[224:227], v[120:123], a[96:111]
ds_read_b128 v[88:91], v7 offset:14336
s_waitcnt lgkmcnt(7)
v_mfma_f32_32x32x16_bf16 a[0:15], v[228:231], v[124:127], a[0:15]
ds_read_b128 v[92:95], v7 offset:15360
s_waitcnt lgkmcnt(7)
v_mfma_f32_32x32x16_bf16 a[16:31], v[228:231], v[64:67], a[16:31]
ds_read_b128 v[96:99], v7 offset:16384
s_waitcnt lgkmcnt(7)
v_mfma_f32_32x32x16_bf16 a[32:47], v[228:231], v[68:71], a[32:47]
ds_read_b128 v[100:103], v7 offset:17408
s_waitcnt lgkmcnt(7)
v_mfma_f32_32x32x16_bf16 a[48:63], v[228:231], v[72:75], a[48:63]
ds_read_b128 v[104:107], v7 offset:18432
s_waitcnt lgkmcnt(7)
v_mfma_f32_32x32x16_bf16 a[64:79], v[228:231], v[76:79], a[64:79]
ds_read_b128 v[108:111], v7 offset:19456
s_waitcnt lgkmcnt(7)
v_mfma_f32_32x32x16_bf16 a[80:95], v[228:231], v[80:83], a[80:95]
ds_read_b128 v[112:115], v7 offset:20480
s_waitcnt lgkmcnt(7)
v_mfma_f32_32x32x16_bf16 a[96:111], v[228:231], v[84:87], a[96:111]
ds_read_b128 v[116:119], v7 offset:21504
s_waitcnt lgkmcnt(7)
v_mfma_f32_32x32x16_bf16 a[0:15], v[232:235], v[88:91], a[0:15]
ds_read_b128 v[120:123], v7 offset:22528
s_waitcnt lgkmcnt(7)
v_mfma_f32_32x32x16_bf16 a[16:31], v[232:235], v[92:95], a[16:31]
ds_read_b128 v[124:127], v7 offset:23552
s_waitcnt lgkmcnt(7)
v_mfma_f32_32x32x16_bf16 a[32:47], v[232:235], v[96:99], a[32:47]
ds_read_b128 v[64:67], v7 offset:24576
s_waitcnt lgkmcnt(7)
v_mfma_f32_32x32x16_bf16 a[48:63], v[232:235], v[100:103], a[48:63]
ds_read_b128 v[68:71], v7 offset:25600
s_waitcnt lgkmcnt(7)
v_mfma_f32_32x32x16_bf16 a[64:79], v[232:235], v[104:107], a[64:79]
ds_read_b128 v[72:75], v7 offset:26624
s_waitcnt lgkmcnt(7)
v_mfma_f32_32x32x16_bf16 a[80:95], v[232:235], v[108:111], a[80:95]
ds_read_b128 v[76:79], v7 offset:27648
s_waitcnt lgkmcnt(7)
v_mfma_f32_32x32x16_bf16 a[96:111], v[232:235], v[112:115], a[96:111]
s_waitcnt lgkmcnt(6)
v_mfma_f32_32x32x16_bf16 a[0:15], v[236:239], v[116:119], a[0:15]
s_waitcnt lgkmcnt(5)
v_mfma_f32_32x32x16_bf16 a[16:31], v[236:239], v[120:123], a[16:31]
s_waitcnt lgkmcnt(4)
v_mfma_f32_32x32x16_bf16 a[32:47], v[236:239], v[124:127], a[32:47]
s_waitcnt lgkmcnt(3)
v_mfma_f32_32x32x16_bf16 a[48:63], v[236:239], v[64:67], a[48:63]
s_waitcnt lgkmcnt(2)
v_mfma_f32_32x32x16_bf16 a[64:79], v[236:239], v[68:71], a[64:79]
s_waitcnt lgkmcnt(1)
v_mfma_f32_32x32x16_bf16 a[80:95], v[236:239], v[72:75], a[80:95]
s_waitcnt lgkmcnt(0)
v_mfma_f32_32x32x16_bf16 a[96:111], v[236:239], v[76:79], a[96:111]
s_nop 15
v_bfe_u32 v26, v1, 4, 1
v_lshlrev_b32 v26, 14, v26
v_lshrrev_b32 v27, 5, v1
v_lshl_add_u32 v26, v27, 8, v26
v_and_b32 v27, 15, v1
v_lshl_add_u32 v26, v27, 4, v26
s_mul_i32 s26, s23, 458752
s_lshl_b32 s27, s22, 10
s_add_u32 s26, s26, s27
s_add_u32 s26, s26, 16777216
s_mul_i32 s33, s33, 229376
s_add_u32 s26, s26, s33
v_accvgpr_read_b32 v32, a0
v_accvgpr_read_b32 v33, a1
v_accvgpr_read_b32 v34, a2
v_accvgpr_read_b32 v35, a3
v_accvgpr_read_b32 v36, a4
v_accvgpr_read_b32 v37, a5
v_accvgpr_read_b32 v38, a6
v_accvgpr_read_b32 v39, a7
v_accvgpr_read_b32 v40, a8
v_accvgpr_read_b32 v41, a9
v_accvgpr_read_b32 v42, a10
v_accvgpr_read_b32 v43, a11
v_accvgpr_read_b32 v44, a12
v_accvgpr_read_b32 v45, a13
v_accvgpr_read_b32 v46, a14
v_accvgpr_read_b32 v47, a15
v_cvt_pk_bf16_f32 v32, v32, v33
v_cvt_pk_bf16_f32 v33, v34, v35
v_cvt_pk_bf16_f32 v34, v36, v37
v_cvt_pk_bf16_f32 v35, v38, v39
v_cvt_pk_bf16_f32 v36, v40, v41
v_cvt_pk_bf16_f32 v37, v42, v43
v_cvt_pk_bf16_f32 v38, v44, v45
v_cvt_pk_bf16_f32 v39, v46, v47
buffer_store_dwordx4 v[32:35], v26, s[8:11], s26 offen sc1
buffer_store_dwordx4 v[36:39], v26, s[8:11], s26 offen offset:512 sc1
s_add_u32 s26, s26, 32768
v_accvgpr_read_b32 v48, a16
v_accvgpr_read_b32 v49, a17
v_accvgpr_read_b32 v50, a18
v_accvgpr_read_b32 v51, a19
v_accvgpr_read_b32 v52, a20
v_accvgpr_read_b32 v53, a21
v_accvgpr_read_b32 v54, a22
v_accvgpr_read_b32 v55, a23
v_accvgpr_read_b32 v56, a24
v_accvgpr_read_b32 v57, a25
v_accvgpr_read_b32 v58, a26
v_accvgpr_read_b32 v59, a27
v_accvgpr_read_b32 v60, a28
v_accvgpr_read_b32 v61, a29
v_accvgpr_read_b32 v62, a30
v_accvgpr_read_b32 v63, a31
v_cvt_pk_bf16_f32 v48, v48, v49
v_cvt_pk_bf16_f32 v49, v50, v51
v_cvt_pk_bf16_f32 v50, v52, v53
v_cvt_pk_bf16_f32 v51, v54, v55
v_cvt_pk_bf16_f32 v52, v56, v57
v_cvt_pk_bf16_f32 v53, v58, v59
v_cvt_pk_bf16_f32 v54, v60, v61
v_cvt_pk_bf16_f32 v55, v62, v63
buffer_store_dwordx4 v[48:51], v26, s[8:11], s26 offen sc1
buffer_store_dwordx4 v[52:55], v26, s[8:11], s26 offen offset:512 sc1
s_add_u32 s26, s26, 32768
v_accvgpr_read_b32 v32, a32
v_accvgpr_read_b32 v33, a33
v_accvgpr_read_b32 v34, a34
v_accvgpr_read_b32 v35, a35
v_accvgpr_read_b32 v36, a36
v_accvgpr_read_b32 v37, a37
v_accvgpr_read_b32 v38, a38
v_accvgpr_read_b32 v39, a39
v_accvgpr_read_b32 v40, a40
v_accvgpr_read_b32 v41, a41
v_accvgpr_read_b32 v42, a42
v_accvgpr_read_b32 v43, a43
v_accvgpr_read_b32 v44, a44
v_accvgpr_read_b32 v45, a45
v_accvgpr_read_b32 v46, a46
v_accvgpr_read_b32 v47, a47
v_cvt_pk_bf16_f32 v32, v32, v33
v_cvt_pk_bf16_f32 v33, v34, v35
v_cvt_pk_bf16_f32 v34, v36, v37
v_cvt_pk_bf16_f32 v35, v38, v39
v_cvt_pk_bf16_f32 v36, v40, v41
v_cvt_pk_bf16_f32 v37, v42, v43
v_cvt_pk_bf16_f32 v38, v44, v45
v_cvt_pk_bf16_f32 v39, v46, v47
buffer_store_dwordx4 v[32:35], v26, s[8:11], s26 offen sc1
buffer_store_dwordx4 v[36:39], v26, s[8:11], s26 offen offset:512 sc1
s_add_u32 s26, s26, 32768
v_accvgpr_read_b32 v48, a48
v_accvgpr_read_b32 v49, a49
v_accvgpr_read_b32 v50, a50
v_accvgpr_read_b32 v51, a51
v_accvgpr_read_b32 v52, a52
v_accvgpr_read_b32 v53, a53
v_accvgpr_read_b32 v54, a54
v_accvgpr_read_b32 v55, a55
v_accvgpr_read_b32 v56, a56
v_accvgpr_read_b32 v57, a57
v_accvgpr_read_b32 v58, a58
v_accvgpr_read_b32 v59, a59
v_accvgpr_read_b32 v60, a60
v_accvgpr_read_b32 v61, a61
v_accvgpr_read_b32 v62, a62
v_accvgpr_read_b32 v63, a63
v_cvt_pk_bf16_f32 v48, v48, v49
v_cvt_pk_bf16_f32 v49, v50, v51
v_cvt_pk_bf16_f32 v50, v52, v53
v_cvt_pk_bf16_f32 v51, v54, v55
v_cvt_pk_bf16_f32 v52, v56, v57
v_cvt_pk_bf16_f32 v53, v58, v59
v_cvt_pk_bf16_f32 v54, v60, v61
v_cvt_pk_bf16_f32 v55, v62, v63
buffer_store_dwordx4 v[48:51], v26, s[8:11], s26 offen sc1
buffer_store_dwordx4 v[52:55], v26, s[8:11], s26 offen offset:512 sc1
s_add_u32 s26, s26, 32768
v_accvgpr_read_b32 v32, a64
v_accvgpr_read_b32 v33, a65
v_accvgpr_read_b32 v34, a66
v_accvgpr_read_b32 v35, a67
v_accvgpr_read_b32 v36, a68
v_accvgpr_read_b32 v37, a69
v_accvgpr_read_b32 v38, a70
v_accvgpr_read_b32 v39, a71
v_accvgpr_read_b32 v40, a72
v_accvgpr_read_b32 v41, a73
v_accvgpr_read_b32 v42, a74
v_accvgpr_read_b32 v43, a75
v_accvgpr_read_b32 v44, a76
v_accvgpr_read_b32 v45, a77
v_accvgpr_read_b32 v46, a78
v_accvgpr_read_b32 v47, a79
v_cvt_pk_bf16_f32 v32, v32, v33
v_cvt_pk_bf16_f32 v33, v34, v35
v_cvt_pk_bf16_f32 v34, v36, v37
v_cvt_pk_bf16_f32 v35, v38, v39
v_cvt_pk_bf16_f32 v36, v40, v41
v_cvt_pk_bf16_f32 v37, v42, v43
v_cvt_pk_bf16_f32 v38, v44, v45
v_cvt_pk_bf16_f32 v39, v46, v47
buffer_store_dwordx4 v[32:35], v26, s[8:11], s26 offen sc1
buffer_store_dwordx4 v[36:39], v26, s[8:11], s26 offen offset:512 sc1
s_add_u32 s26, s26, 32768
v_accvgpr_read_b32 v48, a80
v_accvgpr_read_b32 v49, a81
v_accvgpr_read_b32 v50, a82
v_accvgpr_read_b32 v51, a83
v_accvgpr_read_b32 v52, a84
v_accvgpr_read_b32 v53, a85
v_accvgpr_read_b32 v54, a86
v_accvgpr_read_b32 v55, a87
v_accvgpr_read_b32 v56, a88
v_accvgpr_read_b32 v57, a89
v_accvgpr_read_b32 v58, a90
v_accvgpr_read_b32 v59, a91
v_accvgpr_read_b32 v60, a92
v_accvgpr_read_b32 v61, a93
v_accvgpr_read_b32 v62, a94
v_accvgpr_read_b32 v63, a95
v_cvt_pk_bf16_f32 v48, v48, v49
v_cvt_pk_bf16_f32 v49, v50, v51
v_cvt_pk_bf16_f32 v50, v52, v53
v_cvt_pk_bf16_f32 v51, v54, v55
v_cvt_pk_bf16_f32 v52, v56, v57
v_cvt_pk_bf16_f32 v53, v58, v59
v_cvt_pk_bf16_f32 v54, v60, v61
v_cvt_pk_bf16_f32 v55, v62, v63
buffer_store_dwordx4 v[48:51], v26, s[8:11], s26 offen sc1
buffer_store_dwordx4 v[52:55], v26, s[8:11], s26 offen offset:512 sc1
s_add_u32 s26, s26, 32768
v_accvgpr_read_b32 v32, a96
v_accvgpr_read_b32 v33, a97
v_accvgpr_read_b32 v34, a98
v_accvgpr_read_b32 v35, a99
v_accvgpr_read_b32 v36, a100
v_accvgpr_read_b32 v37, a101
v_accvgpr_read_b32 v38, a102
v_accvgpr_read_b32 v39, a103
v_accvgpr_read_b32 v40, a104
v_accvgpr_read_b32 v41, a105
v_accvgpr_read_b32 v42, a106
v_accvgpr_read_b32 v43, a107
v_accvgpr_read_b32 v44, a108
v_accvgpr_read_b32 v45, a109
v_accvgpr_read_b32 v46, a110
v_accvgpr_read_b32 v47, a111
v_cvt_pk_bf16_f32 v32, v32, v33
v_cvt_pk_bf16_f32 v33, v34, v35
v_cvt_pk_bf16_f32 v34, v36, v37
v_cvt_pk_bf16_f32 v35, v38, v39
v_cvt_pk_bf16_f32 v36, v40, v41
v_cvt_pk_bf16_f32 v37, v42, v43
v_cvt_pk_bf16_f32 v38, v44, v45
v_cvt_pk_bf16_f32 v39, v46, v47
buffer_store_dwordx4 v[32:35], v26, s[8:11], s26 offen sc1
buffer_store_dwordx4 v[36:39], v26, s[8:11], s26 offen offset:512 sc1
s_add_u32 s26, s26, 32768
s_waitcnt vmcnt(0)
s_barrier
s_cmp_lg_u32 s17, 0
s_cbranch_scc1 Lsig_54
s_lshl_b32 s26, s21, 7
s_add_u32 s26, s26, 54853632
v_mov_b32 v26, 1
v_mov_b32 v27, 1073741824
v_cmp_eq_u32 vcc, 0, v1
s_nop 1
v_cndmask_b32 v27, v27, v25, vcc
buffer_atomic_add v26, v27, s[8:11], s26 offen
Lsig_54:
s_branch Lnext_23
.p2align 6
LiV_24:
v_bfe_u32 v26, v1, 4, 1
s_mov_b32 s26, 229376
v_mul_lo_u32 v26, v26, s26
v_lshrrev_b32 v27, 5, v1
v_lshl_add_u32 v26, v27, 8, v26
v_and_b32 v27, 15, v1
v_lshl_add_u32 v3, v27, 4, v26
v_add_u32 v5, 0, v2
v_add_u32 v6, 28672, v2
v_add_u32 v7, 57344, v2
v_add_u32 v8, 86016, v2
s_mul_i32 s25, s17, 7168
s_and_b32 s26, s17, 1
s_mul_i32 s24, s26, 3211264
s_lshr_b32 s26, s17, 1
s_lshl_b32 s26, s26, 9
s_add_u32 s24, s24, s26
s_mul_i32 s26, s22, 14336
s_add_u32 s24, s24, s26
s_add_u32 s24, s24, 7340032
s_mul_i32 s29, s23, 28672
s_add_u32 s29, s29, 55574528
s_lshl_b32 s27, s21, 7
s_add_u32 s27, s27, 54865920
s_lshl_b32 s28, s22, 8
s_add_u32 s28, s28, 54861952
s_cmp_lg_u32 s17, 0
s_cbranch_scc1 Lwo_56
Lwm_55:
buffer_load_dword v26, v25, s[8:11], s27 offen sc1
buffer_load_dword v27, v25, s[8:11], s28 offen sc1
s_waitcnt vmcnt(0)
v_cmp_gt_u32 vcc, 16, v26
v_cmp_gt_u32 s[62:63], 8, v27
s_nop 3
s_or_b64 vcc, vcc, s[62:63]
s_cbranch_scc0 Lwo_56
s_sleep 2
s_sub_u32 s19, s19, 1
s_cbranch_scc0 Lwm_55
s_mov_b32 s19, 0
Lwo_56:
s_barrier
s_add_u32 m0, s25, 0
s_add_u32 s26, s24, 0
buffer_load_dwordx4 v3, s[8:11], s26 offen sc1 lds
s_add_u32 m0, s25, 1024
s_add_u32 s26, s24, 458752
buffer_load_dwordx4 v3, s[8:11], s26 offen sc1 lds
s_add_u32 m0, s25, 2048
s_add_u32 s26, s24, 917504
buffer_load_dwordx4 v3, s[8:11], s26 offen sc1 lds
s_add_u32 m0, s25, 3072
s_add_u32 s26, s24, 1376256
buffer_load_dwordx4 v3, s[8:11], s26 offen sc1 lds
s_add_u32 m0, s25, 4096
s_add_u32 s26, s24, 1835008
buffer_load_dwordx4 v3, s[8:11], s26 offen sc1 lds
s_add_u32 m0, s25, 5120
s_add_u32 s26, s24, 2293760
buffer_load_dwordx4 v3, s[8:11], s26 offen sc1 lds
s_add_u32 m0, s25, 6144
s_add_u32 s26, s24, 2752512
buffer_load_dwordx4 v3, s[8:11], s26 offen sc1 lds
s_add_u32 s24, s24, 1024
buffer_load_dwordx4 v[128:131], v2, s[8:11], s29 offen offset:0 sc1
buffer_load_dwordx4 v[132:135], v2, s[8:11], s29 offen offset:1024 sc1
buffer_load_dwordx4 v[136:139], v2, s[8:11], s29 offen offset:2048 sc1
buffer_load_dwordx4 v[140:143], v2, s[8:11], s29 offen offset:3072 sc1
s_add_u32 s29, s29, 4096
buffer_load_dwordx4 v[144:147], v2, s[8:11], s29 offen offset:0 sc1
buffer_load_dwordx4 v[148:151], v2, s[8:11], s29 offen offset:1024 sc1
buffer_load_dwordx4 v[152:155], v2, s[8:11], s29 offen offset:2048 sc1
buffer_load_dwordx4 v[156:159], v2, s[8:11], s29 offen offset:3072 sc1
s_add_u32 s29, s29, 4096
buffer_load_dwordx4 v[160:163], v2, s[8:11], s29 offen offset:0 sc1
buffer_load_dwordx4 v[164:167], v2, s[8:11], s29 offen offset:1024 sc1
buffer_load_dwordx4 v[168:171], v2, s[8:11], s29 offen offset:2048 sc1
buffer_load_dwordx4 v[172:175], v2, s[8:11], s29 offen offset:3072 sc1
s_add_u32 s29, s29, 4096
buffer_load_dwordx4 v[176:179], v2, s[8:11], s29 offen offset:0 sc1
buffer_load_dwordx4 v[180:183], v2, s[8:11], s29 offen offset:1024 sc1
buffer_load_dwordx4 v[184:187], v2, s[8:11], s29 offen offset:2048 sc1
buffer_load_dwordx4 v[188:191], v2, s[8:11], s29 offen offset:3072 sc1
s_add_u32 s29, s29, 4096
buffer_load_dwordx4 v[192:195], v2, s[8:11], s29 offen offset:0 sc1
buffer_load_dwordx4 v[196:199], v2, s[8:11], s29 offen offset:1024 sc1
buffer_load_dwordx4 v[200:203], v2, s[8:11], s29 offen offset:2048 sc1
buffer_load_dwordx4 v[204:207], v2, s[8:11], s29 offen offset:3072 sc1
s_add_u32 s29, s29, 4096
buffer_load_dwordx4 v[208:211], v2, s[8:11], s29 offen offset:0 sc1
buffer_load_dwordx4 v[212:215], v2, s[8:11], s29 offen offset:1024 sc1
buffer_load_dwordx4 v[216:219], v2, s[8:11], s29 offen offset:2048 sc1
buffer_load_dwordx4 v[220:223], v2, s[8:11], s29 offen offset:3072 sc1
s_add_u32 s29, s29, 4096
buffer_load_dwordx4 v[224:227], v2, s[8:11], s29 offen offset:0 sc1
buffer_load_dwordx4 v[228:231], v2, s[8:11], s29 offen offset:1024 sc1
buffer_load_dwordx4 v[232:235], v2, s[8:11], s29 offen offset:2048 sc1
buffer_load_dwordx4 v[236:239], v2, s[8:11], s29 offen offset:3072 sc1
s_add_u32 m0, s25, 28672
s_add_u32 s26, s24, 0
buffer_load_dwordx4 v3, s[8:11], s26 offen sc1 lds
s_add_u32 m0, s25, 29696
s_add_u32 s26, s24, 458752
buffer_load_dwordx4 v3, s[8:11], s26 offen sc1 lds
s_add_u32 m0, s25, 30720
s_add_u32 s26, s24, 917504
buffer_load_dwordx4 v3, s[8:11], s26 offen sc1 lds
s_add_u32 m0, s25, 31744
s_add_u32 s26, s24, 1376256
buffer_load_dwordx4 v3, s[8:11], s26 offen sc1 lds
s_add_u32 m0, s25, 32768
s_add_u32 s26, s24, 1835008
buffer_load_dwordx4 v3, s[8:11], s26 offen sc1 lds
s_add_u32 m0, s25, 33792
s_add_u32 s26, s24, 2293760
buffer_load_dwordx4 v3, s[8:11], s26 offen sc1 lds
s_add_u32 m0, s25, 34816
s_add_u32 s26, s24, 2752512
buffer_load_dwordx4 v3, s[8:11], s26 offen sc1 lds
s_add_u32 s24, s24, 1024
s_add_u32 m0, s25, 57344
s_add_u32 s26, s24, 0
buffer_load_dwordx4 v3, s[8:11], s26 offen sc1 lds
s_add_u32 m0, s25, 58368
s_add_u32 s26, s24, 458752
buffer_load_dwordx4 v3, s[8:11], s26 offen sc1 lds
s_add_u32 m0, s25, 59392
s_add_u32 s26, s24, 917504
buffer_load_dwordx4 v3, s[8:11], s26 offen sc1 lds
s_add_u32 m0, s25, 60416
s_add_u32 s26, s24, 1376256
buffer_load_dwordx4 v3, s[8:11], s26 offen sc1 lds
s_add_u32 m0, s25, 61440
s_add_u32 s26, s24, 1835008
buffer_load_dwordx4 v3, s[8:11], s26 offen sc1 lds
s_add_u32 m0, s25, 62464
s_add_u32 s26, s24, 2293760
buffer_load_dwordx4 v3, s[8:11], s26 offen sc1 lds
s_add_u32 m0, s25, 63488
s_add_u32 s26, s24, 2752512
buffer_load_dwordx4 v3, s[8:11], s26 offen sc1 lds
s_add_u32 s24, s24, 1024
s_waitcnt vmcnt(14)
s_barrier
ds_read_b128 v[64:67], v5 offset:0
ds_read_b128 v[68:71], v5 offset:1024
ds_read_b128 v[72:75], v5 offset:2048
ds_read_b128 v[76:79], v5 offset:3072
ds_read_b128 v[80:83], v5 offset:4096
ds_read_b128 v[84:87], v5 offset:5120
ds_read_b128 v[88:91], v5 offset:6144
ds_read_b128 v[92:95], v5 offset:7168
s_waitcnt lgkmcnt(7)
v_mfma_f32_32x32x16_bf16 a[0:15], v[128:131], v[64:67], 0
ds_read_b128 v[96:99], v5 offset:8192
s_waitcnt lgkmcnt(7)
v_mfma_f32_32x32x16_bf16 a[16:31], v[128:131], v[68:71], 0
ds_read_b128 v[100:103], v5 offset:9216
s_waitcnt lgkmcnt(7)
v_mfma_f32_32x32x16_bf16 a[32:47], v[128:131], v[72:75], 0
ds_read_b128 v[104:107], v5 offset:10240
s_waitcnt lgkmcnt(7)
v_mfma_f32_32x32x16_bf16 a[48:63], v[128:131], v[76:79], 0
ds_read_b128 v[108:111], v5 offset:11264
s_waitcnt lgkmcnt(7)
v_mfma_f32_32x32x16_bf16 a[64:79], v[128:131], v[80:83], 0
ds_read_b128 v[112:115], v5 offset:12288
s_waitcnt lgkmcnt(7)
v_mfma_f32_32x32x16_bf16 a[80:95], v[128:131], v[84:87], 0
ds_read_b128 v[116:119], v5 offset:13312
s_waitcnt lgkmcnt(7)
v_mfma_f32_32x32x16_bf16 a[96:111], v[128:131], v[88:91], 0
ds_read_b128 v[120:123], v5 offset:14336
s_waitcnt lgkmcnt(7)
v_mfma_f32_32x32x16_bf16 a[112:127], v[128:131], v[92:95], 0
ds_read_b128 v[124:127], v5 offset:15360
s_waitcnt lgkmcnt(7)
v_mfma_f32_32x32x16_bf16 a[128:143], v[128:131], v[96:99], 0
ds_read_b128 v[64:67], v5 offset:16384
s_waitcnt lgkmcnt(7)
v_mfma_f32_32x32x16_bf16 a[144:159], v[128:131], v[100:103], 0
ds_read_b128 v[68:71], v5 offset:17408
s_waitcnt lgkmcnt(7)
v_mfma_f32_32x32x16_bf16 a[160:175], v[128:131], v[104:107], 0
ds_read_b128 v[72:75], v5 offset:18432
s_waitcnt lgkmcnt(7)
v_mfma_f32_32x32x16_bf16 a[176:191], v[128:131], v[108:111], 0
ds_read_b128 v[76:79], v5 offset:19456
s_waitcnt lgkmcnt(7)
v_mfma_f32_32x32x16_bf16 a[192:207], v[128:131], v[112:115], 0
ds_read_b128 v[80:83], v5 offset:20480
s_waitcnt lgkmcnt(7)
v_mfma_f32_32x32x16_bf16 a[208:223], v[128:131], v[116:119], 0
ds_read_b128 v[84:87], v5 offset:21504
s_waitcnt lgkmcnt(7)
v_mfma_f32_32x32x16_bf16 a[0:15], v[132:135], v[120:123], a[0:15]
ds_read_b128 v[88:91], v5 offset:22528
s_waitcnt lgkmcnt(7)
v_mfma_f32_32x32x16_bf16 a[16:31], v[132:135], v[124:127], a[16:31]
ds_read_b128 v[92:95], v5 offset:23552
s_waitcnt lgkmcnt(7)
v_mfma_f32_32x32x16_bf16 a[32:47], v[132:135], v[64:67], a[32:47]
ds_read_b128 v[96:99], v5 offset:24576
s_waitcnt lgkmcnt(7)
v_mfma_f32_32x32x16_bf16 a[48:63], v[132:135], v[68:71], a[48:63]
ds_read_b128 v[100:103], v5 offset:25600
s_waitcnt lgkmcnt(7)
v_mfma_f32_32x32x16_bf16 a[64:79], v[132:135], v[72:75], a[64:79]
ds_read_b128 v[104:107], v5 offset:26624
s_waitcnt lgkmcnt(7)
v_mfma_f32_32x32x16_bf16 a[80:95], v[132:135], v[76:79], a[80:95]
s_waitcnt vmcnt(7)
s_barrier
ds_read_b128 v[108:111], v5 offset:27648
s_waitcnt lgkmcnt(7)
v_mfma_f32_32x32x16_bf16 a[96:111], v[132:135], v[80:83], a[96:111]
ds_read_b128 v[112:115], v6 offset:0
s_waitcnt lgkmcnt(7)
v_mfma_f32_32x32x16_bf16 a[112:127], v[132:135], v[84:87], a[112:127]
ds_read_b128 v[116:119], v6 offset:1024
s_add_u32 m0, s25, 86016
s_add_u32 s26, s24, 0
buffer_load_dwordx4 v3, s[8:11], s26 offen sc1 lds
s_waitcnt lgkmcnt(7)
v_mfma_f32_32x32x16_bf16 a[128:143], v[132:135], v[88:91], a[128:143]
ds_read_b128 v[120:123], v6 offset:2048
s_waitcnt lgkmcnt(7)
v_mfma_f32_32x32x16_bf16 a[144:159], v[132:135], v[92:95], a[144:159]
ds_read_b128 v[124:127], v6 offset:3072
s_waitcnt lgkmcnt(7)
v_mfma_f32_32x32x16_bf16 a[160:175], v[132:135], v[96:99], a[160:175]
ds_read_b128 v[64:67], v6 offset:4096
s_add_u32 m0, s25, 87040
s_add_u32 s26, s24, 458752
buffer_load_dwordx4 v3, s[8:11], s26 offen sc1 lds
s_waitcnt lgkmcnt(7)
v_mfma_f32_32x32x16_bf16 a[176:191], v[132:135], v[100:103], a[176:191]
ds_read_b128 v[68:71], v6 offset:5120
s_waitcnt lgkmcnt(7)
v_mfma_f32_32x32x16_bf16 a[192:207], v[132:135], v[104:107], a[192:207]
ds_read_b128 v[72:75], v6 offset:6144
s_waitcnt lgkmcnt(7)
v_mfma_f32_32x32x16_bf16 a[208:223], v[132:135], v[108:111], a[208:223]
ds_read_b128 v[76:79], v6 offset:7168
s_add_u32 m0, s25, 88064
s_add_u32 s26, s24, 917504
buffer_load_dwordx4 v3, s[8:11], s26 offen sc1 lds
s_waitcnt lgkmcnt(7)
v_mfma_f32_32x32x16_bf16 a[0:15], v[136:139], v[112:115], a[0:15]
ds_read_b128 v[80:83], v6 offset:8192
s_waitcnt lgkmcnt(7)
v_mfma_f32_32x32x16_bf16 a[16:31], v[136:139], v[116:119], a[16:31]
ds_read_b128 v[84:87], v6 offset:9216
s_waitcnt lgkmcnt(7)
v_mfma_f32_32x32x16_bf16 a[32:47], v[136:139], v[120:123], a[32:47]
ds_read_b128 v[88:91], v6 offset:10240
s_add_u32 m0, s25, 89088
s_add_u32 s26, s24, 1376256
buffer_load_dwordx4 v3, s[8:11], s26 offen sc1 lds
s_waitcnt lgkmcnt(7)
v_mfma_f32_32x32x16_bf16 a[48:63], v[136:139], v[124:127], a[48:63]
ds_read_b128 v[92:95], v6 offset:11264
s_waitcnt lgkmcnt(7)
v_mfma_f32_32x32x16_bf16 a[64:79], v[136:139], v[64:67], a[64:79]
ds_read_b128 v[96:99], v6 offset:12288
s_waitcnt lgkmcnt(7)
v_mfma_f32_32x32x16_bf16 a[80:95], v[136:139], v[68:71], a[80:95]
ds_read_b128 v[100:103], v6 offset:13312
s_add_u32 m0, s25, 90112
s_add_u32 s26, s24, 1835008
buffer_load_dwordx4 v3, s[8:11], s26 offen sc1 lds
s_waitcnt lgkmcnt(7)
v_mfma_f32_32x32x16_bf16 a[96:111], v[136:139], v[72:75], a[96:111]
ds_read_b128 v[104:107], v6 offset:14336
s_waitcnt lgkmcnt(7)
v_mfma_f32_32x32x16_bf16 a[112:127], v[136:139], v[76:79], a[112:127]
ds_read_b128 v[108:111], v6 offset:15360
s_waitcnt lgkmcnt(7)
v_mfma_f32_32x32x16_bf16 a[128:143], v[136:139], v[80:83], a[128:143]
ds_read_b128 v[112:115], v6 offset:16384
s_add_u32 m0, s25, 91136
s_add_u32 s26, s24, 2293760
buffer_load_dwordx4 v3, s[8:11], s26 offen sc1 lds
s_waitcnt lgkmcnt(7)
v_mfma_f32_32x32x16_bf16 a[144:159], v[136:139], v[84:87], a[144:159]
ds_read_b128 v[116:119], v6 offset:17408
s_waitcnt lgkmcnt(7)
v_mfma_f32_32x32x16_bf16 a[160:175], v[136:139], v[88:91], a[160:175]
ds_read_b128 v[120:123], v6 offset:18432
s_waitcnt lgkmcnt(7)
v_mfma_f32_32x32x16_bf16 a[176:191], v[136:139], v[92:95], a[176:191]
ds_read_b128 v[124:127], v6 offset:19456
s_add_u32 m0, s25, 92160
s_add_u32 s26, s24, 2752512
buffer_load_dwordx4 v3, s[8:11], s26 offen sc1 lds
s_add_u32 s24, s24, 1024
s_waitcnt lgkmcnt(7)
v_mfma_f32_32x32x16_bf16 a[192:207], v[136:139], v[96:99], a[192:207]
ds_read_b128 v[64:67], v6 offset:20480
s_waitcnt lgkmcnt(7)
v_mfma_f32_32x32x16_bf16 a[208:223], v[136:139], v[100:103], a[208:223]
ds_read_b128 v[68:71], v6 offset:21504
s_waitcnt lgkmcnt(7)
v_mfma_f32_32x32x16_bf16 a[0:15], v[140:143], v[104:107], a[0:15]
ds_read_b128 v[72:75], v6 offset:22528
s_waitcnt lgkmcnt(7)
v_mfma_f32_32x32x16_bf16 a[16:31], v[140:143], v[108:111], a[16:31]
ds_read_b128 v[76:79], v6 offset:23552
s_waitcnt lgkmcnt(7)
v_mfma_f32_32x32x16_bf16 a[32:47], v[140:143], v[112:115], a[32:47]
ds_read_b128 v[80:83], v6 offset:24576
s_waitcnt lgkmcnt(7)
v_mfma_f32_32x32x16_bf16 a[48:63], v[140:143], v[116:119], a[48:63]
ds_read_b128 v[84:87], v6 offset:25600
s_waitcnt lgkmcnt(7)
v_mfma_f32_32x32x16_bf16 a[64:79], v[140:143], v[120:123], a[64:79]
ds_read_b128 v[88:91], v6 offset:26624
s_waitcnt lgkmcnt(7)
v_mfma_f32_32x32x16_bf16 a[80:95], v[140:143], v[124:127], a[80:95]
s_waitcnt vmcnt(7)
s_barrier
ds_read_b128 v[92:95], v6 offset:27648
s_waitcnt lgkmcnt(7)
v_mfma_f32_32x32x16_bf16 a[96:111], v[140:143], v[64:67], a[96:111]
ds_read_b128 v[96:99], v7 offset:0
s_add_u32 m0, s25, 0
s_add_u32 s26, s24, 0
buffer_load_dwordx4 v3, s[8:11], s26 offen sc1 lds
s_waitcnt lgkmcnt(7)
v_mfma_f32_32x32x16_bf16 a[112:127], v[140:143], v[68:71], a[112:127]
ds_read_b128 v[100:103], v7 offset:1024
s_waitcnt lgkmcnt(7)
v_mfma_f32_32x32x16_bf16 a[128:143], v[140:143], v[72:75], a[128:143]
ds_read_b128 v[104:107], v7 offset:2048
s_waitcnt lgkmcnt(7)
v_mfma_f32_32x32x16_bf16 a[144:159], v[140:143], v[76:79], a[144:159]
ds_read_b128 v[108:111], v7 offset:3072
s_add_u32 m0, s25, 1024
s_add_u32 s26, s24, 458752
buffer_load_dwordx4 v3, s[8:11], s26 offen sc1 lds
s_waitcnt lgkmcnt(7)
v_mfma_f32_32x32x16_bf16 a[160:175], v[140:143], v[80:83], a[160:175]
ds_read_b128 v[112:115], v7 offset:4096
s_waitcnt lgkmcnt(7)
v_mfma_f32_32x32x16_bf16 a[176:191], v[140:143], v[84:87], a[176:191]
ds_read_b128 v[116:119], v7 offset:5120
s_waitcnt lgkmcnt(7)
v_mfma_f32_32x32x16_bf16 a[192:207], v[140:143], v[88:91], a[192:207]
ds_read_b128 v[120:123], v7 offset:6144
s_add_u32 m0, s25, 2048
s_add_u32 s26, s24, 917504
buffer_load_dwordx4 v3, s[8:11], s26 offen sc1 lds
s_waitcnt lgkmcnt(7)
v_mfma_f32_32x32x16_bf16 a[208:223], v[140:143], v[92:95], a[208:223]
ds_read_b128 v[124:127], v7 offset:7168
s_waitcnt lgkmcnt(7)
v_mfma_f32_32x32x16_bf16 a[0:15], v[144:147], v[96:99], a[0:15]
ds_read_b128 v[64:67], v7 offset:8192
s_waitcnt lgkmcnt(7)
v_mfma_f32_32x32x16_bf16 a[16:31], v[144:147], v[100:103], a[16:31]
ds_read_b128 v[68:71], v7 offset:9216
s_add_u32 m0, s25, 3072
s_add_u32 s26, s24, 1376256
buffer_load_dwordx4 v3, s[8:11], s26 offen sc1 lds
s_waitcnt lgkmcnt(7)
v_mfma_f32_32x32x16_bf16 a[32:47], v[144:147], v[104:107], a[32:47]
ds_read_b128 v[72:75], v7 offset:10240
s_waitcnt lgkmcnt(7)
v_mfma_f32_32x32x16_bf16 a[48:63], v[144:147], v[108:111], a[48:63]
ds_read_b128 v[76:79], v7 offset:11264
s_waitcnt lgkmcnt(7)
v_mfma_f32_32x32x16_bf16 a[64:79], v[144:147], v[112:115], a[64:79]
ds_read_b128 v[80:83], v7 offset:12288
s_add_u32 m0, s25, 4096
s_add_u32 s26, s24, 1835008
buffer_load_dwordx4 v3, s[8:11], s26 offen sc1 lds
s_waitcnt lgkmcnt(7)
v_mfma_f32_32x32x16_bf16 a[80:95], v[144:147], v[116:119], a[80:95]
ds_read_b128 v[84:87], v7 offset:13312
s_waitcnt lgkmcnt(7)
v_mfma_f32_32x32x16_bf16 a[96:111], v[144:147], v[120:123], a[96:111]
ds_read_b128 v[88:91], v7 offset:14336
s_waitcnt lgkmcnt(7)
v_mfma_f32_32x32x16_bf16 a[112:127], v[144:147], v[124:127], a[112:127]
ds_read_b128 v[92:95], v7 offset:15360
s_add_u32 m0, s25, 5120
s_add_u32 s26, s24, 2293760
buffer_load_dwordx4 v3, s[8:11], s26 offen sc1 lds
s_waitcnt lgkmcnt(7)
v_mfma_f32_32x32x16_bf16 a[128:143], v[144:147], v[64:67], a[128:143]
ds_read_b128 v[96:99], v7 offset:16384
s_waitcnt lgkmcnt(7)
v_mfma_f32_32x32x16_bf16 a[144:159], v[144:147], v[68:71], a[144:159]
ds_read_b128 v[100:103], v7 offset:17408
s_waitcnt lgkmcnt(7)
v_mfma_f32_32x32x16_bf16 a[160:175], v[144:147], v[72:75], a[160:175]
ds_read_b128 v[104:107], v7 offset:18432
s_add_u32 m0, s25, 6144
s_add_u32 s26, s24, 2752512
buffer_load_dwordx4 v3, s[8:11], s26 offen sc1 lds
s_add_u32 s24, s24, 1024
s_waitcnt lgkmcnt(7)
v_mfma_f32_32x32x16_bf16 a[176:191], v[144:147], v[76:79], a[176:191]
ds_read_b128 v[108:111], v7 offset:19456
s_waitcnt lgkmcnt(7)
v_mfma_f32_32x32x16_bf16 a[192:207], v[144:147], v[80:83], a[192:207]
ds_read_b128 v[112:115], v7 offset:20480
s_waitcnt lgkmcnt(7)
v_mfma_f32_32x32x16_bf16 a[208:223], v[144:147], v[84:87], a[208:223]
ds_read_b128 v[116:119], v7 offset:21504
s_waitcnt lgkmcnt(7)
v_mfma_f32_32x32x16_bf16 a[0:15], v[148:151], v[88:91], a[0:15]
ds_read_b128 v[120:123], v7 offset:22528
s_waitcnt lgkmcnt(7)
v_mfma_f32_32x32x16_bf16 a[16:31], v[148:151], v[92:95], a[16:31]
ds_read_b128 v[124:127], v7 offset:23552
s_waitcnt lgkmcnt(7)
v_mfma_f32_32x32x16_bf16 a[32:47], v[148:151], v[96:99], a[32:47]
ds_read_b128 v[64:67], v7 offset:24576
s_waitcnt lgkmcnt(7)
v_mfma_f32_32x32x16_bf16 a[48:63], v[148:151], v[100:103], a[48:63]
ds_read_b128 v[68:71], v7 offset:25600
s_waitcnt lgkmcnt(7)
v_mfma_f32_32x32x16_bf16 a[64:79], v[148:151], v[104:107], a[64:79]
ds_read_b128 v[72:75], v7 offset:26624
s_waitcnt lgkmcnt(7)
v_mfma_f32_32x32x16_bf16 a[80:95], v[148:151], v[108:111], a[80:95]
s_waitcnt vmcnt(7)
s_barrier
ds_read_b128 v[76:79], v7 offset:27648
s_add_u32 m0, s25, 28672
s_add_u32 s26, s24, 0
buffer_load_dwordx4 v3, s[8:11], s26 offen sc1 lds
s_waitcnt lgkmcnt(7)
v_mfma_f32_32x32x16_bf16 a[96:111], v[148:151], v[112:115], a[96:111]
ds_read_b128 v[80:83], v8 offset:0
s_waitcnt lgkmcnt(7)
v_mfma_f32_32x32x16_bf16 a[112:127], v[148:151], v[116:119], a[112:127]
ds_read_b128 v[84:87], v8 offset:1024
s_waitcnt lgkmcnt(7)
v_mfma_f32_32x32x16_bf16 a[128:143], v[148:151], v[120:123], a[128:143]
ds_read_b128 v[88:91], v8 offset:2048
s_add_u32 m0, s25, 29696
s_add_u32 s26, s24, 458752
buffer_load_dwordx4 v3, s[8:11], s26 offen sc1 lds
s_waitcnt lgkmcnt(7)
v_mfma_f32_32x32x16_bf16 a[144:159], v[148:151], v[124:127], a[144:159]
ds_read_b128 v[92:95], v8 offset:3072
s_waitcnt lgkmcnt(7)
v_mfma_f32_32x32x16_bf16 a[160:175], v[148:151], v[64:67], a[160:175]
ds_read_b128 v[96:99], v8 offset:4096
s_waitcnt lgkmcnt(7)
v_mfma_f32_32x32x16_bf16 a[176:191], v[148:151], v[68:71], a[176:191]
ds_read_b128 v[100:103], v8 offset:5120
s_add_u32 m0, s25, 30720
s_add_u32 s26, s24, 917504
buffer_load_dwordx4 v3, s[8:11], s26 offen sc1 lds
s_waitcnt lgkmcnt(7)
v_mfma_f32_32x32x16_bf16 a[192:207], v[148:151], v[72:75], a[192:207]
ds_read_b128 v[104:107], v8 offset:6144
s_waitcnt lgkmcnt(7)
v_mfma_f32_32x32x16_bf16 a[208:223], v[148:151], v[76:79], a[208:223]
ds_read_b128 v[108:111], v8 offset:7168
s_waitcnt lgkmcnt(7)
v_mfma_f32_32x32x16_bf16 a[0:15], v[152:155], v[80:83], a[0:15]
ds_read_b128 v[112:115], v8 offset:8192
s_add_u32 m0, s25, 31744
s_add_u32 s26, s24, 1376256
buffer_load_dwordx4 v3, s[8:11], s26 offen sc1 lds
s_waitcnt lgkmcnt(7)
v_mfma_f32_32x32x16_bf16 a[16:31], v[152:155], v[84:87], a[16:31]
ds_read_b128 v[116:119], v8 offset:9216
s_waitcnt lgkmcnt(7)
v_mfma_f32_32x32x16_bf16 a[32:47], v[152:155], v[88:91], a[32:47]
ds_read_b128 v[120:123], v8 offset:10240
s_waitcnt lgkmcnt(7)
v_mfma_f32_32x32x16_bf16 a[48:63], v[152:155], v[92:95], a[48:63]
ds_read_b128 v[124:127], v8 offset:11264
s_add_u32 m0, s25, 32768
s_add_u32 s26, s24, 1835008
buffer_load_dwordx4 v3, s[8:11], s26 offen sc1 lds
s_waitcnt lgkmcnt(7)
v_mfma_f32_32x32x16_bf16 a[64:79], v[152:155], v[96:99], a[64:79]
ds_read_b128 v[64:67], v8 offset:12288
s_waitcnt lgkmcnt(7)
v_mfma_f32_32x32x16_bf16 a[80:95], v[152:155], v[100:103], a[80:95]
ds_read_b128 v[68:71], v8 offset:13312
s_waitcnt lgkmcnt(7)
v_mfma_f32_32x32x16_bf16 a[96:111], v[152:155], v[104:107], a[96:111]
ds_read_b128 v[72:75], v8 offset:14336
s_add_u32 m0, s25, 33792
s_add_u32 s26, s24, 2293760
buffer_load_dwordx4 v3, s[8:11], s26 offen sc1 lds
s_waitcnt lgkmcnt(7)
v_mfma_f32_32x32x16_bf16 a[112:127], v[152:155], v[108:111], a[112:127]
ds_read_b128 v[76:79], v8 offset:15360
s_waitcnt lgkmcnt(7)
v_mfma_f32_32x32x16_bf16 a[128:143], v[152:155], v[112:115], a[128:143]
ds_read_b128 v[80:83], v8 offset:16384
s_waitcnt lgkmcnt(7)
v_mfma_f32_32x32x16_bf16 a[144:159], v[152:155], v[116:119], a[144:159]
ds_read_b128 v[84:87], v8 offset:17408
s_add_u32 m0, s25, 34816
s_add_u32 s26, s24, 2752512
buffer_load_dwordx4 v3, s[8:11], s26 offen sc1 lds
s_add_u32 s24, s24, 1024
s_waitcnt lgkmcnt(7)
v_mfma_f32_32x32x16_bf16 a[160:175], v[152:155], v[120:123], a[160:175]
ds_read_b128 v[88:91], v8 offset:18432
s_waitcnt lgkmcnt(7)
v_mfma_f32_32x32x16_bf16 a[176:191], v[152:155], v[124:127], a[176:191]
ds_read_b128 v[92:95], v8 offset:19456
s_waitcnt lgkmcnt(7)
v_mfma_f32_32x32x16_bf16 a[192:207], v[152:155], v[64:67], a[192:207]
ds_read_b128 v[96:99], v8 offset:20480
s_waitcnt lgkmcnt(7)
v_mfma_f32_32x32x16_bf16 a[208:223], v[152:155], v[68:71], a[208:223]
ds_read_b128 v[100:103], v8 offset:21504
s_waitcnt lgkmcnt(7)
v_mfma_f32_32x32x16_bf16 a[0:15], v[156:159], v[72:75], a[0:15]
ds_read_b128 v[104:107], v8 offset:22528
s_waitcnt lgkmcnt(7)
v_mfma_f32_32x32x16_bf16 a[16:31], v[156:159], v[76:79], a[16:31]
ds_read_b128 v[108:111], v8 offset:23552
s_waitcnt lgkmcnt(7)
v_mfma_f32_32x32x16_bf16 a[32:47], v[156:159], v[80:83], a[32:47]
ds_read_b128 v[112:115], v8 offset:24576
s_waitcnt lgkmcnt(7)
v_mfma_f32_32x32x16_bf16 a[48:63], v[156:159], v[84:87], a[48:63]
ds_read_b128 v[116:119], v8 offset:25600
s_waitcnt lgkmcnt(7)
v_mfma_f32_32x32x16_bf16 a[64:79], v[156:159], v[88:91], a[64:79]
ds_read_b128 v[120:123], v8 offset:26624
s_waitcnt lgkmcnt(7)
v_mfma_f32_32x32x16_bf16 a[80:95], v[156:159], v[92:95], a[80:95]
s_waitcnt vmcnt(7)
s_barrier
ds_read_b128 v[124:127], v8 offset:27648
s_waitcnt lgkmcnt(7)
v_mfma_f32_32x32x16_bf16 a[96:111], v[156:159], v[96:99], a[96:111]
ds_read_b128 v[64:67], v5 offset:0
s_waitcnt lgkmcnt(7)
v_mfma_f32_32x32x16_bf16 a[112:127], v[156:159], v[100:103], a[112:127]
ds_read_b128 v[68:71], v5 offset:1024
s_add_u32 m0, s25, 57344
s_add_u32 s26, s24, 0
buffer_load_dwordx4 v3, s[8:11], s26 offen sc1 lds
s_waitcnt lgkmcnt(7)
v_mfma_f32_32x32x16_bf16 a[128:143], v[156:159], v[104:107], a[128:143]
ds_read_b128 v[72:75], v5 offset:2048
s_waitcnt lgkmcnt(7)
v_mfma_f32_32x32x16_bf16 a[144:159], v[156:159], v[108:111], a[144:159]
ds_read_b128 v[76:79], v5 offset:3072
s_waitcnt lgkmcnt(7)
v_mfma_f32_32x32x16_bf16 a[160:175], v[156:159], v[112:115], a[160:175]
ds_read_b128 v[80:83], v5 offset:4096
s_add_u32 m0, s25, 58368
s_add_u32 s26, s24, 458752
buffer_load_dwordx4 v3, s[8:11], s26 offen sc1 lds
s_waitcnt lgkmcnt(7)
v_mfma_f32_32x32x16_bf16 a[176:191], v[156:159], v[116:119], a[176:191]
ds_read_b128 v[84:87], v5 offset:5120
s_waitcnt lgkmcnt(7)
v_mfma_f32_32x32x16_bf16 a[192:207], v[156:159], v[120:123], a[192:207]
ds_read_b128 v[88:91], v5 offset:6144
s_waitcnt lgkmcnt(7)
v_mfma_f32_32x32x16_bf16 a[208:223], v[156:159], v[124:127], a[208:223]
ds_read_b128 v[92:95], v5 offset:7168
s_add_u32 m0, s25, 59392
s_add_u32 s26, s24, 917504
buffer_load_dwordx4 v3, s[8:11], s26 offen sc1 lds
s_waitcnt lgkmcnt(7)
v_mfma_f32_32x32x16_bf16 a[0:15], v[160:163], v[64:67], a[0:15]
ds_read_b128 v[96:99], v5 offset:8192
s_waitcnt lgkmcnt(7)
v_mfma_f32_32x32x16_bf16 a[16:31], v[160:163], v[68:71], a[16:31]
ds_read_b128 v[100:103], v5 offset:9216
s_waitcnt lgkmcnt(7)
v_mfma_f32_32x32x16_bf16 a[32:47], v[160:163], v[72:75], a[32:47]
ds_read_b128 v[104:107], v5 offset:10240
s_add_u32 m0, s25, 60416
s_add_u32 s26, s24, 1376256
buffer_load_dwordx4 v3, s[8:11], s26 offen sc1 lds
s_waitcnt lgkmcnt(7)
v_mfma_f32_32x32x16_bf16 a[48:63], v[160:163], v[76:79], a[48:63]
ds_read_b128 v[108:111], v5 offset:11264
s_waitcnt lgkmcnt(7)
v_mfma_f32_32x32x16_bf16 a[64:79], v[160:163], v[80:83], a[64:79]
ds_read_b128 v[112:115], v5 offset:12288
s_waitcnt lgkmcnt(7)
v_mfma_f32_32x32x16_bf16 a[80:95], v[160:163], v[84:87], a[80:95]
ds_read_b128 v[116:119], v5 offset:13312
s_add_u32 m0, s25, 61440
s_add_u32 s26, s24, 1835008
buffer_load_dwordx4 v3, s[8:11], s26 offen sc1 lds
s_waitcnt lgkmcnt(7)
v_mfma_f32_32x32x16_bf16 a[96:111], v[160:163], v[88:91], a[96:111]
ds_read_b128 v[120:123], v5 offset:14336
s_waitcnt lgkmcnt(7)
v_mfma_f32_32x32x16_bf16 a[112:127], v[160:163], v[92:95], a[112:127]
ds_read_b128 v[124:127], v5 offset:15360
s_waitcnt lgkmcnt(7)
v_mfma_f32_32x32x16_bf16 a[128:143], v[160:163], v[96:99], a[128:143]
ds_read_b128 v[64:67], v5 offset:16384
s_add_u32 m0, s25, 62464
s_add_u32 s26, s24, 2293760
buffer_load_dwordx4 v3, s[8:11], s26 offen sc1 lds
s_waitcnt lgkmcnt(7)
v_mfma_f32_32x32x16_bf16 a[144:159], v[160:163], v[100:103], a[144:159]
ds_read_b128 v[68:71], v5 offset:17408
s_waitcnt lgkmcnt(7)
v_mfma_f32_32x32x16_bf16 a[160:175], v[160:163], v[104:107], a[160:175]
ds_read_b128 v[72:75], v5 offset:18432
s_waitcnt lgkmcnt(7)
v_mfma_f32_32x32x16_bf16 a[176:191], v[160:163], v[108:111], a[176:191]
ds_read_b128 v[76:79], v5 offset:19456
s_add_u32 m0, s25, 63488
s_add_u32 s26, s24, 2752512
buffer_load_dwordx4 v3, s[8:11], s26 offen sc1 lds
s_add_u32 s24, s24, 1024
s_waitcnt lgkmcnt(7)
v_mfma_f32_32x32x16_bf16 a[192:207], v[160:163], v[112:115], a[192:207]
ds_read_b128 v[80:83], v5 offset:20480
s_waitcnt lgkmcnt(7)
v_mfma_f32_32x32x16_bf16 a[208:223], v[160:163], v[116:119], a[208:223]
ds_read_b128 v[84:87], v5 offset:21504
s_waitcnt lgkmcnt(7)
v_mfma_f32_32x32x16_bf16 a[0:15], v[164:167], v[120:123], a[0:15]
ds_read_b128 v[88:91], v5 offset:22528
s_waitcnt lgkmcnt(7)
v_mfma_f32_32x32x16_bf16 a[16:31], v[164:167], v[124:127], a[16:31]
ds_read_b128 v[92:95], v5 offset:23552
s_waitcnt lgkmcnt(7)
v_mfma_f32_32x32x16_bf16 a[32:47], v[164:167], v[64:67], a[32:47]
ds_read_b128 v[96:99], v5 offset:24576
s_waitcnt lgkmcnt(7)
v_mfma_f32_32x32x16_bf16 a[48:63], v[164:167], v[68:71], a[48:63]
ds_read_b128 v[100:103], v5 offset:25600
s_waitcnt lgkmcnt(7)
v_mfma_f32_32x32x16_bf16 a[64:79], v[164:167], v[72:75], a[64:79]
ds_read_b128 v[104:107], v5 offset:26624
s_waitcnt lgkmcnt(7)
v_mfma_f32_32x32x16_bf16 a[80:95], v[164:167], v[76:79], a[80:95]
s_waitcnt vmcnt(7)
s_barrier
ds_read_b128 v[108:111], v5 offset:27648
s_waitcnt lgkmcnt(7)
v_mfma_f32_32x32x16_bf16 a[96:111], v[164:167], v[80:83], a[96:111]
ds_read_b128 v[112:115], v6 offset:0
s_add_u32 m0, s25, 86016
s_add_u32 s26, s24, 0
buffer_load_dwordx4 v3, s[8:11], s26 offen sc1 lds
s_waitcnt lgkmcnt(7)
v_mfma_f32_32x32x16_bf16 a[112:127], v[164:167], v[84:87], a[112:127]
ds_read_b128 v[116:119], v6 offset:1024
s_waitcnt lgkmcnt(7)
v_mfma_f32_32x32x16_bf16 a[128:143], v[164:167], v[88:91], a[128:143]
ds_read_b128 v[120:123], v6 offset:2048
s_waitcnt lgkmcnt(7)
v_mfma_f32_32x32x16_bf16 a[144:159], v[164:167], v[92:95], a[144:159]
ds_read_b128 v[124:127], v6 offset:3072
s_add_u32 m0, s25, 87040
s_add_u32 s26, s24, 458752
buffer_load_dwordx4 v3, s[8:11], s26 offen sc1 lds
s_waitcnt lgkmcnt(7)
v_mfma_f32_32x32x16_bf16 a[160:175], v[164:167], v[96:99], a[160:175]
ds_read_b128 v[64:67], v6 offset:4096
s_waitcnt lgkmcnt(7)
v_mfma_f32_32x32x16_bf16 a[176:191], v[164:167], v[100:103], a[176:191]
ds_read_b128 v[68:71], v6 offset:5120
s_waitcnt lgkmcnt(7)
v_mfma_f32_32x32x16_bf16 a[192:207], v[164:167], v[104:107], a[192:207]
ds_read_b128 v[72:75], v6 offset:6144
s_add_u32 m0, s25, 88064
s_add_u32 s26, s24, 917504
buffer_load_dwordx4 v3, s[8:11], s26 offen sc1 lds
s_waitcnt lgkmcnt(7)
v_mfma_f32_32x32x16_bf16 a[208:223], v[164:167], v[108:111], a[208:223]
ds_read_b128 v[76:79], v6 offset:7168
s_waitcnt lgkmcnt(7)
v_mfma_f32_32x32x16_bf16 a[0:15], v[168:171], v[112:115], a[0:15]
ds_read_b128 v[80:83], v6 offset:8192
s_waitcnt lgkmcnt(7)
v_mfma_f32_32x32x16_bf16 a[16:31], v[168:171], v[116:119], a[16:31]
ds_read_b128 v[84:87], v6 offset:9216
s_add_u32 m0, s25, 89088
s_add_u32 s26, s24, 1376256
buffer_load_dwordx4 v3, s[8:11], s26 offen sc1 lds
s_waitcnt lgkmcnt(7)
v_mfma_f32_32x32x16_bf16 a[32:47], v[168:171], v[120:123], a[32:47]
ds_read_b128 v[88:91], v6 offset:10240
s_waitcnt lgkmcnt(7)
v_mfma_f32_32x32x16_bf16 a[48:63], v[168:171], v[124:127], a[48:63]
ds_read_b128 v[92:95], v6 offset:11264
s_waitcnt lgkmcnt(7)
v_mfma_f32_32x32x16_bf16 a[64:79], v[168:171], v[64:67], a[64:79]
ds_read_b128 v[96:99], v6 offset:12288
s_add_u32 m0, s25, 90112
s_add_u32 s26, s24, 1835008
buffer_load_dwordx4 v3, s[8:11], s26 offen sc1 lds
s_waitcnt lgkmcnt(7)
v_mfma_f32_32x32x16_bf16 a[80:95], v[168:171], v[68:71], a[80:95]
ds_read_b128 v[100:103], v6 offset:13312
s_waitcnt lgkmcnt(7)
v_mfma_f32_32x32x16_bf16 a[96:111], v[168:171], v[72:75], a[96:111]
ds_read_b128 v[104:107], v6 offset:14336
s_waitcnt lgkmcnt(7)
v_mfma_f32_32x32x16_bf16 a[112:127], v[168:171], v[76:79], a[112:127]
ds_read_b128 v[108:111], v6 offset:15360
s_add_u32 m0, s25, 91136
s_add_u32 s26, s24, 2293760
buffer_load_dwordx4 v3, s[8:11], s26 offen sc1 lds
s_waitcnt lgkmcnt(7)
v_mfma_f32_32x32x16_bf16 a[128:143], v[168:171], v[80:83], a[128:143]
ds_read_b128 v[112:115], v6 offset:16384
s_waitcnt lgkmcnt(7)
v_mfma_f32_32x32x16_bf16 a[144:159], v[168:171], v[84:87], a[144:159]
ds_read_b128 v[116:119], v6 offset:17408
s_waitcnt lgkmcnt(7)
v_mfma_f32_32x32x16_bf16 a[160:175], v[168:171], v[88:91], a[160:175]
ds_read_b128 v[120:123], v6 offset:18432
s_add_u32 m0, s25, 92160
s_add_u32 s26, s24, 2752512
buffer_load_dwordx4 v3, s[8:11], s26 offen sc1 lds
s_add_u32 s24, s24, 1024
s_waitcnt lgkmcnt(7)
v_mfma_f32_32x32x16_bf16 a[176:191], v[168:171], v[92:95], a[176:191]
ds_read_b128 v[124:127], v6 offset:19456
s_waitcnt lgkmcnt(7)
v_mfma_f32_32x32x16_bf16 a[192:207], v[168:171], v[96:99], a[192:207]
ds_read_b128 v[64:67], v6 offset:20480
s_waitcnt lgkmcnt(7)
v_mfma_f32_32x32x16_bf16 a[208:223], v[168:171], v[100:103], a[208:223]
ds_read_b128 v[68:71], v6 offset:21504
s_waitcnt lgkmcnt(7)
v_mfma_f32_32x32x16_bf16 a[0:15], v[172:175], v[104:107], a[0:15]
ds_read_b128 v[72:75], v6 offset:22528
s_waitcnt lgkmcnt(7)
v_mfma_f32_32x32x16_bf16 a[16:31], v[172:175], v[108:111], a[16:31]
ds_read_b128 v[76:79], v6 offset:23552
s_waitcnt lgkmcnt(7)
v_mfma_f32_32x32x16_bf16 a[32:47], v[172:175], v[112:115], a[32:47]
ds_read_b128 v[80:83], v6 offset:24576
s_waitcnt lgkmcnt(7)
v_mfma_f32_32x32x16_bf16 a[48:63], v[172:175], v[116:119], a[48:63]
ds_read_b128 v[84:87], v6 offset:25600
s_waitcnt lgkmcnt(7)
v_mfma_f32_32x32x16_bf16 a[64:79], v[172:175], v[120:123], a[64:79]
ds_read_b128 v[88:91], v6 offset:26624
s_waitcnt lgkmcnt(7)
v_mfma_f32_32x32x16_bf16 a[80:95], v[172:175], v[124:127], a[80:95]
s_waitcnt vmcnt(7)
s_barrier
ds_read_b128 v[92:95], v6 offset:27648
s_add_u32 m0, s25, 0
s_add_u32 s26, s24, 0
buffer_load_dwordx4 v3, s[8:11], s26 offen sc1 lds
s_waitcnt lgkmcnt(7)
v_mfma_f32_32x32x16_bf16 a[96:111], v[172:175], v[64:67], a[96:111]
ds_read_b128 v[96:99], v7 offset:0
s_waitcnt lgkmcnt(7)
v_mfma_f32_32x32x16_bf16 a[112:127], v[172:175], v[68:71], a[112:127]
ds_read_b128 v[100:103], v7 offset:1024
s_waitcnt lgkmcnt(7)
v_mfma_f32_32x32x16_bf16 a[128:143], v[172:175], v[72:75], a[128:143]
ds_read_b128 v[104:107], v7 offset:2048
s_add_u32 m0, s25, 1024
s_add_u32 s26, s24, 458752
buffer_load_dwordx4 v3, s[8:11], s26 offen sc1 lds
s_waitcnt lgkmcnt(7)
v_mfma_f32_32x32x16_bf16 a[144:159], v[172:175], v[76:79], a[144:159]
ds_read_b128 v[108:111], v7 offset:3072
s_waitcnt lgkmcnt(7)
v_mfma_f32_32x32x16_bf16 a[160:175], v[172:175], v[80:83], a[160:175]
ds_read_b128 v[112:115], v7 offset:4096
s_waitcnt lgkmcnt(7)
v_mfma_f32_32x32x16_bf16 a[176:191], v[172:175], v[84:87], a[176:191]
ds_read_b128 v[116:119], v7 offset:5120
s_add_u32 m0, s25, 2048
s_add_u32 s26, s24, 917504
buffer_load_dwordx4 v3, s[8:11], s26 offen sc1 lds
s_waitcnt lgkmcnt(7)
v_mfma_f32_32x32x16_bf16 a[192:207], v[172:175], v[88:91], a[192:207]
ds_read_b128 v[120:123], v7 offset:6144
s_waitcnt lgkmcnt(7)
v_mfma_f32_32x32x16_bf16 a[208:223], v[172:175], v[92:95], a[208:223]
ds_read_b128 v[124:127], v7 offset:7168
s_waitcnt lgkmcnt(7)
v_mfma_f32_32x32x16_bf16 a[0:15], v[176:179], v[96:99], a[0:15]
ds_read_b128 v[64:67], v7 offset:8192
s_add_u32 m0, s25, 3072
s_add_u32 s26, s24, 1376256
buffer_load_dwordx4 v3, s[8:11], s26 offen sc1 lds
s_waitcnt lgkmcnt(7)
v_mfma_f32_32x32x16_bf16 a[16:31], v[176:179], v[100:103], a[16:31]
ds_read_b128 v[68:71], v7 offset:9216
s_waitcnt lgkmcnt(7)
v_mfma_f32_32x32x16_bf16 a[32:47], v[176:179], v[104:107], a[32:47]
ds_read_b128 v[72:75], v7 offset:10240
s_waitcnt lgkmcnt(7)
v_mfma_f32_32x32x16_bf16 a[48:63], v[176:179], v[108:111], a[48:63]
ds_read_b128 v[76:79], v7 offset:11264
s_add_u32 m0, s25, 4096
s_add_u32 s26, s24, 1835008
buffer_load_dwordx4 v3, s[8:11], s26 offen sc1 lds
s_waitcnt lgkmcnt(7)
v_mfma_f32_32x32x16_bf16 a[64:79], v[176:179], v[112:115], a[64:79]
ds_read_b128 v[80:83], v7 offset:12288
s_waitcnt lgkmcnt(7)
v_mfma_f32_32x32x16_bf16 a[80:95], v[176:179], v[116:119], a[80:95]
ds_read_b128 v[84:87], v7 offset:13312
s_waitcnt lgkmcnt(7)
v_mfma_f32_32x32x16_bf16 a[96:111], v[176:179], v[120:123], a[96:111]
ds_read_b128 v[88:91], v7 offset:14336
s_add_u32 m0, s25, 5120
s_add_u32 s26, s24, 2293760
buffer_load_dwordx4 v3, s[8:11], s26 offen sc1 lds
s_waitcnt lgkmcnt(7)
v_mfma_f32_32x32x16_bf16 a[112:127], v[176:179], v[124:127], a[112:127]
ds_read_b128 v[92:95], v7 offset:15360
s_waitcnt lgkmcnt(7)
v_mfma_f32_32x32x16_bf16 a[128:143], v[176:179], v[64:67], a[128:143]
ds_read_b128 v[96:99], v7 offset:16384
s_waitcnt lgkmcnt(7)
v_mfma_f32_32x32x16_bf16 a[144:159], v[176:179], v[68:71], a[144:159]
ds_read_b128 v[100:103], v7 offset:17408
s_add_u32 m0, s25, 6144
s_add_u32 s26, s24, 2752512
buffer_load_dwordx4 v3, s[8:11], s26 offen sc1 lds
s_add_u32 s24, s24, 1024
s_waitcnt lgkmcnt(7)
v_mfma_f32_32x32x16_bf16 a[160:175], v[176:179], v[72:75], a[160:175]
ds_read_b128 v[104:107], v7 offset:18432
s_waitcnt lgkmcnt(7)
v_mfma_f32_32x32x16_bf16 a[176:191], v[176:179], v[76:79], a[176:191]
ds_read_b128 v[108:111], v7 offset:19456
s_waitcnt lgkmcnt(7)
v_mfma_f32_32x32x16_bf16 a[192:207], v[176:179], v[80:83], a[192:207]
ds_read_b128 v[112:115], v7 offset:20480
s_waitcnt lgkmcnt(7)
v_mfma_f32_32x32x16_bf16 a[208:223], v[176:179], v[84:87], a[208:223]
ds_read_b128 v[116:119], v7 offset:21504
s_waitcnt lgkmcnt(7)
v_mfma_f32_32x32x16_bf16 a[0:15], v[180:183], v[88:91], a[0:15]
ds_read_b128 v[120:123], v7 offset:22528
s_waitcnt lgkmcnt(7)
v_mfma_f32_32x32x16_bf16 a[16:31], v[180:183], v[92:95], a[16:31]
ds_read_b128 v[124:127], v7 offset:23552
s_waitcnt lgkmcnt(7)
v_mfma_f32_32x32x16_bf16 a[32:47], v[180:183], v[96:99], a[32:47]
ds_read_b128 v[64:67], v7 offset:24576
s_waitcnt lgkmcnt(7)
v_mfma_f32_32x32x16_bf16 a[48:63], v[180:183], v[100:103], a[48:63]
ds_read_b128 v[68:71], v7 offset:25600
s_waitcnt lgkmcnt(7)
v_mfma_f32_32x32x16_bf16 a[64:79], v[180:183], v[104:107], a[64:79]
ds_read_b128 v[72:75], v7 offset:26624
s_waitcnt lgkmcnt(7)
v_mfma_f32_32x32x16_bf16 a[80:95], v[180:183], v[108:111], a[80:95]
s_waitcnt vmcnt(7)
s_barrier
ds_read_b128 v[76:79], v7 offset:27648
s_waitcnt lgkmcnt(7)
v_mfma_f32_32x32x16_bf16 a[96:111], v[180:183], v[112:115], a[96:111]
ds_read_b128 v[80:83], v8 offset:0
s_waitcnt lgkmcnt(7)
v_mfma_f32_32x32x16_bf16 a[112:127], v[180:183], v[116:119], a[112:127]
ds_read_b128 v[84:87], v8 offset:1024
s_add_u32 m0, s25, 28672
s_add_u32 s26, s24, 0
buffer_load_dwordx4 v3, s[8:11], s26 offen sc1 lds
s_waitcnt lgkmcnt(7)
v_mfma_f32_32x32x16_bf16 a[128:143], v[180:183], v[120:123], a[128:143]
ds_read_b128 v[88:91], v8 offset:2048
s_waitcnt lgkmcnt(7)
v_mfma_f32_32x32x16_bf16 a[144:159], v[180:183], v[124:127], a[144:159]
ds_read_b128 v[92:95], v8 offset:3072
s_waitcnt lgkmcnt(7)
v_mfma_f32_32x32x16_bf16 a[160:175], v[180:183], v[64:67], a[160:175]
ds_read_b128 v[96:99], v8 offset:4096
s_add_u32 m0, s25, 29696
s_add_u32 s26, s24, 458752
buffer_load_dwordx4 v3, s[8:11], s26 offen sc1 lds
s_waitcnt lgkmcnt(7)
v_mfma_f32_32x32x16_bf16 a[176:191], v[180:183], v[68:71], a[176:191]
ds_read_b128 v[100:103], v8 offset:5120
s_waitcnt lgkmcnt(7)
v_mfma_f32_32x32x16_bf16 a[192:207], v[180:183], v[72:75], a[192:207]
ds_read_b128 v[104:107], v8 offset:6144
s_waitcnt lgkmcnt(7)
v_mfma_f32_32x32x16_bf16 a[208:223], v[180:183], v[76:79], a[208:223]
ds_read_b128 v[108:111], v8 offset:7168
s_add_u32 m0, s25, 30720
s_add_u32 s26, s24, 917504
buffer_load_dwordx4 v3, s[8:11], s26 offen sc1 lds
s_waitcnt lgkmcnt(7)
v_mfma_f32_32x32x16_bf16 a[0:15], v[184:187], v[80:83], a[0:15]
ds_read_b128 v[112:115], v8 offset:8192
s_waitcnt lgkmcnt(7)
v_mfma_f32_32x32x16_bf16 a[16:31], v[184:187], v[84:87], a[16:31]
ds_read_b128 v[116:119], v8 offset:9216
s_waitcnt lgkmcnt(7)
v_mfma_f32_32x32x16_bf16 a[32:47], v[184:187], v[88:91], a[32:47]
ds_read_b128 v[120:123], v8 offset:10240
s_add_u32 m0, s25, 31744
s_add_u32 s26, s24, 1376256
buffer_load_dwordx4 v3, s[8:11], s26 offen sc1 lds
s_waitcnt lgkmcnt(7)
v_mfma_f32_32x32x16_bf16 a[48:63], v[184:187], v[92:95], a[48:63]
ds_read_b128 v[124:127], v8 offset:11264
s_waitcnt lgkmcnt(7)
v_mfma_f32_32x32x16_bf16 a[64:79], v[184:187], v[96:99], a[64:79]
ds_read_b128 v[64:67], v8 offset:12288
s_waitcnt lgkmcnt(7)
v_mfma_f32_32x32x16_bf16 a[80:95], v[184:187], v[100:103], a[80:95]
ds_read_b128 v[68:71], v8 offset:13312
s_add_u32 m0, s25, 32768
s_add_u32 s26, s24, 1835008
buffer_load_dwordx4 v3, s[8:11], s26 offen sc1 lds
s_waitcnt lgkmcnt(7)
v_mfma_f32_32x32x16_bf16 a[96:111], v[184:187], v[104:107], a[96:111]
ds_read_b128 v[72:75], v8 offset:14336
s_waitcnt lgkmcnt(7)
v_mfma_f32_32x32x16_bf16 a[112:127], v[184:187], v[108:111], a[112:127]
ds_read_b128 v[76:79], v8 offset:15360
s_waitcnt lgkmcnt(7)
v_mfma_f32_32x32x16_bf16 a[128:143], v[184:187], v[112:115], a[128:143]
ds_read_b128 v[80:83], v8 offset:16384
s_add_u32 m0, s25, 33792
s_add_u32 s26, s24, 2293760
buffer_load_dwordx4 v3, s[8:11], s26 offen sc1 lds
s_waitcnt lgkmcnt(7)
v_mfma_f32_32x32x16_bf16 a[144:159], v[184:187], v[116:119], a[144:159]
ds_read_b128 v[84:87], v8 offset:17408
s_waitcnt lgkmcnt(7)
v_mfma_f32_32x32x16_bf16 a[160:175], v[184:187], v[120:123], a[160:175]
ds_read_b128 v[88:91], v8 offset:18432
s_waitcnt lgkmcnt(7)
v_mfma_f32_32x32x16_bf16 a[176:191], v[184:187], v[124:127], a[176:191]
ds_read_b128 v[92:95], v8 offset:19456
s_add_u32 m0, s25, 34816
s_add_u32 s26, s24, 2752512
buffer_load_dwordx4 v3, s[8:11], s26 offen sc1 lds
s_add_u32 s24, s24, 1024
s_waitcnt lgkmcnt(7)
v_mfma_f32_32x32x16_bf16 a[192:207], v[184:187], v[64:67], a[192:207]
ds_read_b128 v[96:99], v8 offset:20480
s_waitcnt lgkmcnt(7)
v_mfma_f32_32x32x16_bf16 a[208:223], v[184:187], v[68:71], a[208:223]
ds_read_b128 v[100:103], v8 offset:21504
s_waitcnt lgkmcnt(7)
v_mfma_f32_32x32x16_bf16 a[0:15], v[188:191], v[72:75], a[0:15]
ds_read_b128 v[104:107], v8 offset:22528
s_waitcnt lgkmcnt(7)
v_mfma_f32_32x32x16_bf16 a[16:31], v[188:191], v[76:79], a[16:31]
ds_read_b128 v[108:111], v8 offset:23552
s_waitcnt lgkmcnt(7)
v_mfma_f32_32x32x16_bf16 a[32:47], v[188:191], v[80:83], a[32:47]
ds_read_b128 v[112:115], v8 offset:24576
s_waitcnt lgkmcnt(7)
v_mfma_f32_32x32x16_bf16 a[48:63], v[188:191], v[84:87], a[48:63]
ds_read_b128 v[116:119], v8 offset:25600
s_waitcnt lgkmcnt(7)
v_mfma_f32_32x32x16_bf16 a[64:79], v[188:191], v[88:91], a[64:79]
ds_read_b128 v[120:123], v8 offset:26624
s_waitcnt lgkmcnt(7)
v_mfma_f32_32x32x16_bf16 a[80:95], v[188:191], v[92:95], a[80:95]
s_waitcnt vmcnt(7)
s_barrier
ds_read_b128 v[124:127], v8 offset:27648
s_waitcnt lgkmcnt(7)
v_mfma_f32_32x32x16_bf16 a[96:111], v[188:191], v[96:99], a[96:111]
ds_read_b128 v[64:67], v5 offset:0
s_add_u32 m0, s25, 57344
s_add_u32 s26, s24, 0
buffer_load_dwordx4 v3, s[8:11], s26 offen sc1 lds
s_waitcnt lgkmcnt(7)
v_mfma_f32_32x32x16_bf16 a[112:127], v[188:191], v[100:103], a[112:127]
ds_read_b128 v[68:71], v5 offset:1024
s_waitcnt lgkmcnt(7)
v_mfma_f32_32x32x16_bf16 a[128:143], v[188:191], v[104:107], a[128:143]
ds_read_b128 v[72:75], v5 offset:2048
s_waitcnt lgkmcnt(7)
v_mfma_f32_32x32x16_bf16 a[144:159], v[188:191], v[108:111], a[144:159]
ds_read_b128 v[76:79], v5 offset:3072
s_add_u32 m0, s25, 58368
s_add_u32 s26, s24, 458752
buffer_load_dwordx4 v3, s[8:11], s26 offen sc1 lds
s_waitcnt lgkmcnt(7)
v_mfma_f32_32x32x16_bf16 a[160:175], v[188:191], v[112:115], a[160:175]
ds_read_b128 v[80:83], v5 offset:4096
s_waitcnt lgkmcnt(7)
v_mfma_f32_32x32x16_bf16 a[176:191], v[188:191], v[116:119], a[176:191]
ds_read_b128 v[84:87], v5 offset:5120
s_waitcnt lgkmcnt(7)
v_mfma_f32_32x32x16_bf16 a[192:207], v[188:191], v[120:123], a[192:207]
ds_read_b128 v[88:91], v5 offset:6144
s_add_u32 m0, s25, 59392
s_add_u32 s26, s24, 917504
buffer_load_dwordx4 v3, s[8:11], s26 offen sc1 lds
s_waitcnt lgkmcnt(7)
v_mfma_f32_32x32x16_bf16 a[208:223], v[188:191], v[124:127], a[208:223]
ds_read_b128 v[92:95], v5 offset:7168
s_waitcnt lgkmcnt(7)
v_mfma_f32_32x32x16_bf16 a[0:15], v[192:195], v[64:67], a[0:15]
ds_read_b128 v[96:99], v5 offset:8192
s_waitcnt lgkmcnt(7)
v_mfma_f32_32x32x16_bf16 a[16:31], v[192:195], v[68:71], a[16:31]
ds_read_b128 v[100:103], v5 offset:9216
s_add_u32 m0, s25, 60416
s_add_u32 s26, s24, 1376256
buffer_load_dwordx4 v3, s[8:11], s26 offen sc1 lds
s_waitcnt lgkmcnt(7)
v_mfma_f32_32x32x16_bf16 a[32:47], v[192:195], v[72:75], a[32:47]
ds_read_b128 v[104:107], v5 offset:10240
s_waitcnt lgkmcnt(7)
v_mfma_f32_32x32x16_bf16 a[48:63], v[192:195], v[76:79], a[48:63]
ds_read_b128 v[108:111], v5 offset:11264
s_waitcnt lgkmcnt(7)
v_mfma_f32_32x32x16_bf16 a[64:79], v[192:195], v[80:83], a[64:79]
ds_read_b128 v[112:115], v5 offset:12288
s_add_u32 m0, s25, 61440
s_add_u32 s26, s24, 1835008
buffer_load_dwordx4 v3, s[8:11], s26 offen sc1 lds
s_waitcnt lgkmcnt(7)
v_mfma_f32_32x32x16_bf16 a[80:95], v[192:195], v[84:87], a[80:95]
ds_read_b128 v[116:119], v5 offset:13312
s_waitcnt lgkmcnt(7)
v_mfma_f32_32x32x16_bf16 a[96:111], v[192:195], v[88:91], a[96:111]
ds_read_b128 v[120:123], v5 offset:14336
s_waitcnt lgkmcnt(7)
v_mfma_f32_32x32x16_bf16 a[112:127], v[192:195], v[92:95], a[112:127]
ds_read_b128 v[124:127], v5 offset:15360
s_add_u32 m0, s25, 62464
s_add_u32 s26, s24, 2293760
buffer_load_dwordx4 v3, s[8:11], s26 offen sc1 lds
s_waitcnt lgkmcnt(7)
v_mfma_f32_32x32x16_bf16 a[128:143], v[192:195], v[96:99], a[128:143]
ds_read_b128 v[64:67], v5 offset:16384
s_waitcnt lgkmcnt(7)
v_mfma_f32_32x32x16_bf16 a[144:159], v[192:195], v[100:103], a[144:159]
ds_read_b128 v[68:71], v5 offset:17408
s_waitcnt lgkmcnt(7)
v_mfma_f32_32x32x16_bf16 a[160:175], v[192:195], v[104:107], a[160:175]
ds_read_b128 v[72:75], v5 offset:18432
s_add_u32 m0, s25, 63488
s_add_u32 s26, s24, 2752512
buffer_load_dwordx4 v3, s[8:11], s26 offen sc1 lds
s_add_u32 s24, s24, 1024
s_waitcnt lgkmcnt(7)
v_mfma_f32_32x32x16_bf16 a[176:191], v[192:195], v[108:111], a[176:191]
ds_read_b128 v[76:79], v5 offset:19456
s_waitcnt lgkmcnt(7)
v_mfma_f32_32x32x16_bf16 a[192:207], v[192:195], v[112:115], a[192:207]
ds_read_b128 v[80:83], v5 offset:20480
s_waitcnt lgkmcnt(7)
v_mfma_f32_32x32x16_bf16 a[208:223], v[192:195], v[116:119], a[208:223]
ds_read_b128 v[84:87], v5 offset:21504
s_waitcnt lgkmcnt(7)
v_mfma_f32_32x32x16_bf16 a[0:15], v[196:199], v[120:123], a[0:15]
ds_read_b128 v[88:91], v5 offset:22528
s_waitcnt lgkmcnt(7)
v_mfma_f32_32x32x16_bf16 a[16:31], v[196:199], v[124:127], a[16:31]
ds_read_b128 v[92:95], v5 offset:23552
s_waitcnt lgkmcnt(7)
v_mfma_f32_32x32x16_bf16 a[32:47], v[196:199], v[64:67], a[32:47]
ds_read_b128 v[96:99], v5 offset:24576
s_waitcnt lgkmcnt(7)
v_mfma_f32_32x32x16_bf16 a[48:63], v[196:199], v[68:71], a[48:63]
ds_read_b128 v[100:103], v5 offset:25600
s_waitcnt lgkmcnt(7)
v_mfma_f32_32x32x16_bf16 a[64:79], v[196:199], v[72:75], a[64:79]
ds_read_b128 v[104:107], v5 offset:26624
s_waitcnt lgkmcnt(7)
v_mfma_f32_32x32x16_bf16 a[80:95], v[196:199], v[76:79], a[80:95]
s_waitcnt vmcnt(7)
s_barrier
ds_read_b128 v[108:111], v5 offset:27648
s_add_u32 m0, s25, 86016
s_add_u32 s26, s24, 0
buffer_load_dwordx4 v3, s[8:11], s26 offen sc1 lds
s_waitcnt lgkmcnt(7)
v_mfma_f32_32x32x16_bf16 a[96:111], v[196:199], v[80:83], a[96:111]
ds_read_b128 v[112:115], v6 offset:0
s_waitcnt lgkmcnt(7)
v_mfma_f32_32x32x16_bf16 a[112:127], v[196:199], v[84:87], a[112:127]
ds_read_b128 v[116:119], v6 offset:1024
s_waitcnt lgkmcnt(7)
v_mfma_f32_32x32x16_bf16 a[128:143], v[196:199], v[88:91], a[128:143]
ds_read_b128 v[120:123], v6 offset:2048
s_add_u32 m0, s25, 87040
s_add_u32 s26, s24, 458752
buffer_load_dwordx4 v3, s[8:11], s26 offen sc1 lds
s_waitcnt lgkmcnt(7)
v_mfma_f32_32x32x16_bf16 a[144:159], v[196:199], v[92:95], a[144:159]
ds_read_b128 v[124:127], v6 offset:3072
s_waitcnt lgkmcnt(7)
v_mfma_f32_32x32x16_bf16 a[160:175], v[196:199], v[96:99], a[160:175]
ds_read_b128 v[64:67], v6 offset:4096
s_waitcnt lgkmcnt(7)
v_mfma_f32_32x32x16_bf16 a[176:191], v[196:199], v[100:103], a[176:191]
ds_read_b128 v[68:71], v6 offset:5120
s_add_u32 m0, s25, 88064
s_add_u32 s26, s24, 917504
buffer_load_dwordx4 v3, s[8:11], s26 offen sc1 lds
s_waitcnt lgkmcnt(7)
v_mfma_f32_32x32x16_bf16 a[192:207], v[196:199], v[104:107], a[192:207]
ds_read_b128 v[72:75], v6 offset:6144
s_waitcnt lgkmcnt(7)
v_mfma_f32_32x32x16_bf16 a[208:223], v[196:199], v[108:111], a[208:223]
ds_read_b128 v[76:79], v6 offset:7168
s_waitcnt lgkmcnt(7)
v_mfma_f32_32x32x16_bf16 a[0:15], v[200:203], v[112:115], a[0:15]
ds_read_b128 v[80:83], v6 offset:8192
s_add_u32 m0, s25, 89088
s_add_u32 s26, s24, 1376256
buffer_load_dwordx4 v3, s[8:11], s26 offen sc1 lds
s_waitcnt lgkmcnt(7)
v_mfma_f32_32x32x16_bf16 a[16:31], v[200:203], v[116:119], a[16:31]
ds_read_b128 v[84:87], v6 offset:9216
s_waitcnt lgkmcnt(7)
v_mfma_f32_32x32x16_bf16 a[32:47], v[200:203], v[120:123], a[32:47]
ds_read_b128 v[88:91], v6 offset:10240
s_waitcnt lgkmcnt(7)
v_mfma_f32_32x32x16_bf16 a[48:63], v[200:203], v[124:127], a[48:63]
ds_read_b128 v[92:95], v6 offset:11264
s_add_u32 m0, s25, 90112
s_add_u32 s26, s24, 1835008
buffer_load_dwordx4 v3, s[8:11], s26 offen sc1 lds
s_waitcnt lgkmcnt(7)
v_mfma_f32_32x32x16_bf16 a[64:79], v[200:203], v[64:67], a[64:79]
ds_read_b128 v[96:99], v6 offset:12288
s_waitcnt lgkmcnt(7)
v_mfma_f32_32x32x16_bf16 a[80:95], v[200:203], v[68:71], a[80:95]
ds_read_b128 v[100:103], v6 offset:13312
s_waitcnt lgkmcnt(7)
v_mfma_f32_32x32x16_bf16 a[96:111], v[200:203], v[72:75], a[96:111]
ds_read_b128 v[104:107], v6 offset:14336
s_add_u32 m0, s25, 91136
s_add_u32 s26, s24, 2293760
buffer_load_dwordx4 v3, s[8:11], s26 offen sc1 lds
s_waitcnt lgkmcnt(7)
v_mfma_f32_32x32x16_bf16 a[112:127], v[200:203], v[76:79], a[112:127]
ds_read_b128 v[108:111], v6 offset:15360
s_waitcnt lgkmcnt(7)
v_mfma_f32_32x32x16_bf16 a[128:143], v[200:203], v[80:83], a[128:143]
ds_read_b128 v[112:115], v6 offset:16384
s_waitcnt lgkmcnt(7)
v_mfma_f32_32x32x16_bf16 a[144:159], v[200:203], v[84:87], a[144:159]
ds_read_b128 v[116:119], v6 offset:17408
s_add_u32 m0, s25, 92160
s_add_u32 s26, s24, 2752512
buffer_load_dwordx4 v3, s[8:11], s26 offen sc1 lds
s_add_u32 s24, s24, 1024
s_waitcnt lgkmcnt(7)
v_mfma_f32_32x32x16_bf16 a[160:175], v[200:203], v[88:91], a[160:175]
ds_read_b128 v[120:123], v6 offset:18432
s_waitcnt lgkmcnt(7)
v_mfma_f32_32x32x16_bf16 a[176:191], v[200:203], v[92:95], a[176:191]
ds_read_b128 v[124:127], v6 offset:19456
s_waitcnt lgkmcnt(7)
v_mfma_f32_32x32x16_bf16 a[192:207], v[200:203], v[96:99], a[192:207]
ds_read_b128 v[64:67], v6 offset:20480
s_waitcnt lgkmcnt(7)
v_mfma_f32_32x32x16_bf16 a[208:223], v[200:203], v[100:103], a[208:223]
ds_read_b128 v[68:71], v6 offset:21504
s_waitcnt lgkmcnt(7)
v_mfma_f32_32x32x16_bf16 a[0:15], v[204:207], v[104:107], a[0:15]
ds_read_b128 v[72:75], v6 offset:22528
s_waitcnt lgkmcnt(7)
v_mfma_f32_32x32x16_bf16 a[16:31], v[204:207], v[108:111], a[16:31]
ds_read_b128 v[76:79], v6 offset:23552
s_waitcnt lgkmcnt(7)
v_mfma_f32_32x32x16_bf16 a[32:47], v[204:207], v[112:115], a[32:47]
ds_read_b128 v[80:83], v6 offset:24576
s_waitcnt lgkmcnt(7)
v_mfma_f32_32x32x16_bf16 a[48:63], v[204:207], v[116:119], a[48:63]
ds_read_b128 v[84:87], v6 offset:25600
s_waitcnt lgkmcnt(7)
v_mfma_f32_32x32x16_bf16 a[64:79], v[204:207], v[120:123], a[64:79]
ds_read_b128 v[88:91], v6 offset:26624
s_waitcnt lgkmcnt(7)
v_mfma_f32_32x32x16_bf16 a[80:95], v[204:207], v[124:127], a[80:95]
s_waitcnt vmcnt(7)
s_barrier
ds_read_b128 v[92:95], v6 offset:27648
s_waitcnt lgkmcnt(7)
v_mfma_f32_32x32x16_bf16 a[96:111], v[204:207], v[64:67], a[96:111]
ds_read_b128 v[96:99], v7 offset:0
s_waitcnt lgkmcnt(7)
v_mfma_f32_32x32x16_bf16 a[112:127], v[204:207], v[68:71], a[112:127]
ds_read_b128 v[100:103], v7 offset:1024
s_add_u32 m0, s25, 0
s_add_u32 s26, s24, 0
buffer_load_dwordx4 v3, s[8:11], s26 offen sc1 lds
s_waitcnt lgkmcnt(7)
v_mfma_f32_32x32x16_bf16 a[128:143], v[204:207], v[72:75], a[128:143]
ds_read_b128 v[104:107], v7 offset:2048
s_waitcnt lgkmcnt(7)
v_mfma_f32_32x32x16_bf16 a[144:159], v[204:207], v[76:79], a[144:159]
ds_read_b128 v[108:111], v7 offset:3072
s_waitcnt lgkmcnt(7)
v_mfma_f32_32x32x16_bf16 a[160:175], v[204:207], v[80:83], a[160:175]
ds_read_b128 v[112:115], v7 offset:4096
s_add_u32 m0, s25, 1024
s_add_u32 s26, s24, 458752
buffer_load_dwordx4 v3, s[8:11], s26 offen sc1 lds
s_waitcnt lgkmcnt(7)
v_mfma_f32_32x32x16_bf16 a[176:191], v[204:207], v[84:87], a[176:191]
ds_read_b128 v[116:119], v7 offset:5120
s_waitcnt lgkmcnt(7)
v_mfma_f32_32x32x16_bf16 a[192:207], v[204:207], v[88:91], a[192:207]
ds_read_b128 v[120:123], v7 offset:6144
s_waitcnt lgkmcnt(7)
v_mfma_f32_32x32x16_bf16 a[208:223], v[204:207], v[92:95], a[208:223]
ds_read_b128 v[124:127], v7 offset:7168
s_add_u32 m0, s25, 2048
s_add_u32 s26, s24, 917504
buffer_load_dwordx4 v3, s[8:11], s26 offen sc1 lds
s_waitcnt lgkmcnt(7)
v_mfma_f32_32x32x16_bf16 a[0:15], v[208:211], v[96:99], a[0:15]
ds_read_b128 v[64:67], v7 offset:8192
s_waitcnt lgkmcnt(7)
v_mfma_f32_32x32x16_bf16 a[16:31], v[208:211], v[100:103], a[16:31]
ds_read_b128 v[68:71], v7 offset:9216
s_waitcnt lgkmcnt(7)
v_mfma_f32_32x32x16_bf16 a[32:47], v[208:211], v[104:107], a[32:47]
ds_read_b128 v[72:75], v7 offset:10240
s_add_u32 m0, s25, 3072
s_add_u32 s26, s24, 1376256
buffer_load_dwordx4 v3, s[8:11], s26 offen sc1 lds
s_waitcnt lgkmcnt(7)
v_mfma_f32_32x32x16_bf16 a[48:63], v[208:211], v[108:111], a[48:63]
ds_read_b128 v[76:79], v7 offset:11264
s_waitcnt lgkmcnt(7)
v_mfma_f32_32x32x16_bf16 a[64:79], v[208:211], v[112:115], a[64:79]
ds_read_b128 v[80:83], v7 offset:12288
s_waitcnt lgkmcnt(7)
v_mfma_f32_32x32x16_bf16 a[80:95], v[208:211], v[116:119], a[80:95]
ds_read_b128 v[84:87], v7 offset:13312
s_add_u32 m0, s25, 4096
s_add_u32 s26, s24, 1835008
buffer_load_dwordx4 v3, s[8:11], s26 offen sc1 lds
s_waitcnt lgkmcnt(7)
v_mfma_f32_32x32x16_bf16 a[96:111], v[208:211], v[120:123], a[96:111]
ds_read_b128 v[88:91], v7 offset:14336
s_waitcnt lgkmcnt(7)
v_mfma_f32_32x32x16_bf16 a[112:127], v[208:211], v[124:127], a[112:127]
ds_read_b128 v[92:95], v7 offset:15360
s_waitcnt lgkmcnt(7)
v_mfma_f32_32x32x16_bf16 a[128:143], v[208:211], v[64:67], a[128:143]
ds_read_b128 v[96:99], v7 offset:16384
s_add_u32 m0, s25, 5120
s_add_u32 s26, s24, 2293760
buffer_load_dwordx4 v3, s[8:11], s26 offen sc1 lds
s_waitcnt lgkmcnt(7)
v_mfma_f32_32x32x16_bf16 a[144:159], v[208:211], v[68:71], a[144:159]
ds_read_b128 v[100:103], v7 offset:17408
s_waitcnt lgkmcnt(7)
v_mfma_f32_32x32x16_bf16 a[160:175], v[208:211], v[72:75], a[160:175]
ds_read_b128 v[104:107], v7 offset:18432
s_waitcnt lgkmcnt(7)
v_mfma_f32_32x32x16_bf16 a[176:191], v[208:211], v[76:79], a[176:191]
ds_read_b128 v[108:111], v7 offset:19456
s_add_u32 m0, s25, 6144
s_add_u32 s26, s24, 2752512
buffer_load_dwordx4 v3, s[8:11], s26 offen sc1 lds
s_add_u32 s24, s24, 1024
s_waitcnt lgkmcnt(7)
v_mfma_f32_32x32x16_bf16 a[192:207], v[208:211], v[80:83], a[192:207]
ds_read_b128 v[112:115], v7 offset:20480
s_waitcnt lgkmcnt(7)
v_mfma_f32_32x32x16_bf16 a[208:223], v[208:211], v[84:87], a[208:223]
ds_read_b128 v[116:119], v7 offset:21504
s_waitcnt lgkmcnt(7)
v_mfma_f32_32x32x16_bf16 a[0:15], v[212:215], v[88:91], a[0:15]
ds_read_b128 v[120:123], v7 offset:22528
s_waitcnt lgkmcnt(7)
v_mfma_f32_32x32x16_bf16 a[16:31], v[212:215], v[92:95], a[16:31]
ds_read_b128 v[124:127], v7 offset:23552
s_waitcnt lgkmcnt(7)
v_mfma_f32_32x32x16_bf16 a[32:47], v[212:215], v[96:99], a[32:47]
ds_read_b128 v[64:67], v7 offset:24576
s_waitcnt lgkmcnt(7)
v_mfma_f32_32x32x16_bf16 a[48:63], v[212:215], v[100:103], a[48:63]
ds_read_b128 v[68:71], v7 offset:25600
s_waitcnt lgkmcnt(7)
v_mfma_f32_32x32x16_bf16 a[64:79], v[212:215], v[104:107], a[64:79]
ds_read_b128 v[72:75], v7 offset:26624
s_waitcnt lgkmcnt(7)
v_mfma_f32_32x32x16_bf16 a[80:95], v[212:215], v[108:111], a[80:95]
s_waitcnt vmcnt(7)
s_barrier
ds_read_b128 v[76:79], v7 offset:27648
s_waitcnt lgkmcnt(7)
v_mfma_f32_32x32x16_bf16 a[96:111], v[212:215], v[112:115], a[96:111]
ds_read_b128 v[80:83], v8 offset:0
s_add_u32 m0, s25, 28672
s_add_u32 s26, s24, 0
buffer_load_dwordx4 v3, s[8:11], s26 offen sc1 lds
s_waitcnt lgkmcnt(7)
v_mfma_f32_32x32x16_bf16 a[112:127], v[212:215], v[116:119], a[112:127]
ds_read_b128 v[84:87], v8 offset:1024
s_waitcnt lgkmcnt(7)
v_mfma_f32_32x32x16_bf16 a[128:143], v[212:215], v[120:123], a[128:143]
ds_read_b128 v[88:91], v8 offset:2048
s_waitcnt lgkmcnt(7)
v_mfma_f32_32x32x16_bf16 a[144:159], v[212:215], v[124:127], a[144:159]
ds_read_b128 v[92:95], v8 offset:3072
s_add_u32 m0, s25, 29696
s_add_u32 s26, s24, 458752
buffer_load_dwordx4 v3, s[8:11], s26 offen sc1 lds
s_waitcnt lgkmcnt(7)
v_mfma_f32_32x32x16_bf16 a[160:175], v[212:215], v[64:67], a[160:175]
ds_read_b128 v[96:99], v8 offset:4096
s_waitcnt lgkmcnt(7)
v_mfma_f32_32x32x16_bf16 a[176:191], v[212:215], v[68:71], a[176:191]
ds_read_b128 v[100:103], v8 offset:5120
s_waitcnt lgkmcnt(7)
v_mfma_f32_32x32x16_bf16 a[192:207], v[212:215], v[72:75], a[192:207]
ds_read_b128 v[104:107], v8 offset:6144
s_add_u32 m0, s25, 30720
s_add_u32 s26, s24, 917504
buffer_load_dwordx4 v3, s[8:11], s26 offen sc1 lds
s_waitcnt lgkmcnt(7)
v_mfma_f32_32x32x16_bf16 a[208:223], v[212:215], v[76:79], a[208:223]
ds_read_b128 v[108:111], v8 offset:7168
s_waitcnt lgkmcnt(7)
v_mfma_f32_32x32x16_bf16 a[0:15], v[216:219], v[80:83], a[0:15]
ds_read_b128 v[112:115], v8 offset:8192
s_waitcnt lgkmcnt(7)
v_mfma_f32_32x32x16_bf16 a[16:31], v[216:219], v[84:87], a[16:31]
ds_read_b128 v[116:119], v8 offset:9216
s_add_u32 m0, s25, 31744
s_add_u32 s26, s24, 1376256
buffer_load_dwordx4 v3, s[8:11], s26 offen sc1 lds
s_waitcnt lgkmcnt(7)
v_mfma_f32_32x32x16_bf16 a[32:47], v[216:219], v[88:91], a[32:47]
ds_read_b128 v[120:123], v8 offset:10240
s_waitcnt lgkmcnt(7)
v_mfma_f32_32x32x16_bf16 a[48:63], v[216:219], v[92:95], a[48:63]
ds_read_b128 v[124:127], v8 offset:11264
s_waitcnt lgkmcnt(7)
v_mfma_f32_32x32x16_bf16 a[64:79], v[216:219], v[96:99], a[64:79]
ds_read_b128 v[64:67], v8 offset:12288
s_add_u32 m0, s25, 32768
s_add_u32 s26, s24, 1835008
buffer_load_dwordx4 v3, s[8:11], s26 offen sc1 lds
s_waitcnt lgkmcnt(7)
v_mfma_f32_32x32x16_bf16 a[80:95], v[216:219], v[100:103], a[80:95]
ds_read_b128 v[68:71], v8 offset:13312
s_waitcnt lgkmcnt(7)
v_mfma_f32_32x32x16_bf16 a[96:111], v[216:219], v[104:107], a[96:111]
ds_read_b128 v[72:75], v8 offset:14336
s_waitcnt lgkmcnt(7)
v_mfma_f32_32x32x16_bf16 a[112:127], v[216:219], v[108:111], a[112:127]
ds_read_b128 v[76:79], v8 offset:15360
s_add_u32 m0, s25, 33792
s_add_u32 s26, s24, 2293760
buffer_load_dwordx4 v3, s[8:11], s26 offen sc1 lds
s_waitcnt lgkmcnt(7)
v_mfma_f32_32x32x16_bf16 a[128:143], v[216:219], v[112:115], a[128:143]
ds_read_b128 v[80:83], v8 offset:16384
s_waitcnt lgkmcnt(7)
v_mfma_f32_32x32x16_bf16 a[144:159], v[216:219], v[116:119], a[144:159]
ds_read_b128 v[84:87], v8 offset:17408
s_waitcnt lgkmcnt(7)
v_mfma_f32_32x32x16_bf16 a[160:175], v[216:219], v[120:123], a[160:175]
ds_read_b128 v[88:91], v8 offset:18432
s_add_u32 m0, s25, 34816
s_add_u32 s26, s24, 2752512
buffer_load_dwordx4 v3, s[8:11], s26 offen sc1 lds
s_add_u32 s24, s24, 1024
s_waitcnt lgkmcnt(7)
v_mfma_f32_32x32x16_bf16 a[176:191], v[216:219], v[124:127], a[176:191]
ds_read_b128 v[92:95], v8 offset:19456
s_waitcnt lgkmcnt(7)
v_mfma_f32_32x32x16_bf16 a[192:207], v[216:219], v[64:67], a[192:207]
ds_read_b128 v[96:99], v8 offset:20480
s_waitcnt lgkmcnt(7)
v_mfma_f32_32x32x16_bf16 a[208:223], v[216:219], v[68:71], a[208:223]
ds_read_b128 v[100:103], v8 offset:21504
s_waitcnt lgkmcnt(7)
v_mfma_f32_32x32x16_bf16 a[0:15], v[220:223], v[72:75], a[0:15]
ds_read_b128 v[104:107], v8 offset:22528
s_waitcnt lgkmcnt(7)
v_mfma_f32_32x32x16_bf16 a[16:31], v[220:223], v[76:79], a[16:31]
ds_read_b128 v[108:111], v8 offset:23552
s_waitcnt lgkmcnt(7)
v_mfma_f32_32x32x16_bf16 a[32:47], v[220:223], v[80:83], a[32:47]
ds_read_b128 v[112:115], v8 offset:24576
s_waitcnt lgkmcnt(7)
v_mfma_f32_32x32x16_bf16 a[48:63], v[220:223], v[84:87], a[48:63]
ds_read_b128 v[116:119], v8 offset:25600
s_waitcnt lgkmcnt(7)
v_mfma_f32_32x32x16_bf16 a[64:79], v[220:223], v[88:91], a[64:79]
ds_read_b128 v[120:123], v8 offset:26624
s_waitcnt lgkmcnt(7)
v_mfma_f32_32x32x16_bf16 a[80:95], v[220:223], v[92:95], a[80:95]
s_waitcnt vmcnt(7)
s_barrier
ds_read_b128 v[124:127], v8 offset:27648
s_waitcnt lgkmcnt(7)
v_mfma_f32_32x32x16_bf16 a[96:111], v[220:223], v[96:99], a[96:111]
ds_read_b128 v[64:67], v5 offset:0
s_waitcnt lgkmcnt(7)
v_mfma_f32_32x32x16_bf16 a[112:127], v[220:223], v[100:103], a[112:127]
ds_read_b128 v[68:71], v5 offset:1024
s_waitcnt lgkmcnt(7)
v_mfma_f32_32x32x16_bf16 a[128:143], v[220:223], v[104:107], a[128:143]
ds_read_b128 v[72:75], v5 offset:2048
s_waitcnt lgkmcnt(7)
v_mfma_f32_32x32x16_bf16 a[144:159], v[220:223], v[108:111], a[144:159]
ds_read_b128 v[76:79], v5 offset:3072
s_waitcnt lgkmcnt(7)
v_mfma_f32_32x32x16_bf16 a[160:175], v[220:223], v[112:115], a[160:175]
ds_read_b128 v[80:83], v5 offset:4096
s_waitcnt lgkmcnt(7)
v_mfma_f32_32x32x16_bf16 a[176:191], v[220:223], v[116:119], a[176:191]
ds_read_b128 v[84:87], v5 offset:5120
s_waitcnt lgkmcnt(7)
v_mfma_f32_32x32x16_bf16 a[192:207], v[220:223], v[120:123], a[192:207]
ds_read_b128 v[88:91], v5 offset:6144
s_waitcnt lgkmcnt(7)
v_mfma_f32_32x32x16_bf16 a[208:223], v[220:223], v[124:127], a[208:223]
ds_read_b128 v[92:95], v5 offset:7168
s_waitcnt lgkmcnt(7)
v_mfma_f32_32x32x16_bf16 a[0:15], v[224:227], v[64:67], a[0:15]
ds_read_b128 v[96:99], v5 offset:8192
s_waitcnt lgkmcnt(7)
v_mfma_f32_32x32x16_bf16 a[16:31], v[224:227], v[68:71], a[16:31]
ds_read_b128 v[100:103], v5 offset:9216
s_waitcnt lgkmcnt(7)
v_mfma_f32_32x32x16_bf16 a[32:47], v[224:227], v[72:75], a[32:47]
ds_read_b128 v[104:107], v5 offset:10240
s_waitcnt lgkmcnt(7)
v_mfma_f32_32x32x16_bf16 a[48:63], v[224:227], v[76:79], a[48:63]
ds_read_b128 v[108:111], v5 offset:11264
s_waitcnt lgkmcnt(7)
v_mfma_f32_32x32x16_bf16 a[64:79], v[224:227], v[80:83], a[64:79]
ds_read_b128 v[112:115], v5 offset:12288
s_waitcnt lgkmcnt(7)
v_mfma_f32_32x32x16_bf16 a[80:95], v[224:227], v[84:87], a[80:95]
ds_read_b128 v[116:119], v5 offset:13312
s_waitcnt lgkmcnt(7)
v_mfma_f32_32x32x16_bf16 a[96:111], v[224:227], v[88:91], a[96:111]
ds_read_b128 v[120:123], v5 offset:14336
s_waitcnt lgkmcnt(7)
v_mfma_f32_32x32x16_bf16 a[112:127], v[224:227], v[92:95], a[112:127]
ds_read_b128 v[124:127], v5 offset:15360
s_waitcnt lgkmcnt(7)
v_mfma_f32_32x32x16_bf16 a[128:143], v[224:227], v[96:99], a[128:143]
ds_read_b128 v[64:67], v5 offset:16384
s_waitcnt lgkmcnt(7)
v_mfma_f32_32x32x16_bf16 a[144:159], v[224:227], v[100:103], a[144:159]
ds_read_b128 v[68:71], v5 offset:17408
s_waitcnt lgkmcnt(7)
v_mfma_f32_32x32x16_bf16 a[160:175], v[224:227], v[104:107], a[160:175]
ds_read_b128 v[72:75], v5 offset:18432
s_waitcnt lgkmcnt(7)
v_mfma_f32_32x32x16_bf16 a[176:191], v[224:227], v[108:111], a[176:191]
ds_read_b128 v[76:79], v5 offset:19456
s_waitcnt lgkmcnt(7)
v_mfma_f32_32x32x16_bf16 a[192:207], v[224:227], v[112:115], a[192:207]
ds_read_b128 v[80:83], v5 offset:20480
s_waitcnt lgkmcnt(7)
v_mfma_f32_32x32x16_bf16 a[208:223], v[224:227], v[116:119], a[208:223]
ds_read_b128 v[84:87], v5 offset:21504
s_waitcnt lgkmcnt(7)
v_mfma_f32_32x32x16_bf16 a[0:15], v[228:231], v[120:123], a[0:15]
ds_read_b128 v[88:91], v5 offset:22528
s_waitcnt lgkmcnt(7)
v_mfma_f32_32x32x16_bf16 a[16:31], v[228:231], v[124:127], a[16:31]
ds_read_b128 v[92:95], v5 offset:23552
s_waitcnt lgkmcnt(7)
v_mfma_f32_32x32x16_bf16 a[32:47], v[228:231], v[64:67], a[32:47]
ds_read_b128 v[96:99], v5 offset:24576
s_waitcnt lgkmcnt(7)
v_mfma_f32_32x32x16_bf16 a[48:63], v[228:231], v[68:71], a[48:63]
ds_read_b128 v[100:103], v5 offset:25600
s_waitcnt lgkmcnt(7)
v_mfma_f32_32x32x16_bf16 a[64:79], v[228:231], v[72:75], a[64:79]
ds_read_b128 v[104:107], v5 offset:26624
s_waitcnt lgkmcnt(7)
v_mfma_f32_32x32x16_bf16 a[80:95], v[228:231], v[76:79], a[80:95]
s_waitcnt vmcnt(0)
s_barrier
ds_read_b128 v[108:111], v5 offset:27648
s_waitcnt lgkmcnt(7)
v_mfma_f32_32x32x16_bf16 a[96:111], v[228:231], v[80:83], a[96:111]
ds_read_b128 v[112:115], v6 offset:0
s_waitcnt lgkmcnt(7)
v_mfma_f32_32x32x16_bf16 a[112:127], v[228:231], v[84:87], a[112:127]
ds_read_b128 v[116:119], v6 offset:1024
s_waitcnt lgkmcnt(7)
v_mfma_f32_32x32x16_bf16 a[128:143], v[228:231], v[88:91], a[128:143]
ds_read_b128 v[120:123], v6 offset:2048
s_waitcnt lgkmcnt(7)
v_mfma_f32_32x32x16_bf16 a[144:159], v[228:231], v[92:95], a[144:159]
ds_read_b128 v[124:127], v6 offset:3072
s_waitcnt lgkmcnt(7)
v_mfma_f32_32x32x16_bf16 a[160:175], v[228:231], v[96:99], a[160:175]
ds_read_b128 v[64:67], v6 offset:4096
s_waitcnt lgkmcnt(7)
v_mfma_f32_32x32x16_bf16 a[176:191], v[228:231], v[100:103], a[176:191]
ds_read_b128 v[68:71], v6 offset:5120
s_waitcnt lgkmcnt(7)
v_mfma_f32_32x32x16_bf16 a[192:207], v[228:231], v[104:107], a[192:207]
ds_read_b128 v[72:75], v6 offset:6144
s_waitcnt lgkmcnt(7)
v_mfma_f32_32x32x16_bf16 a[208:223], v[228:231], v[108:111], a[208:223]
ds_read_b128 v[76:79], v6 offset:7168
s_waitcnt lgkmcnt(7)
v_mfma_f32_32x32x16_bf16 a[0:15], v[232:235], v[112:115], a[0:15]
ds_read_b128 v[80:83], v6 offset:8192
s_waitcnt lgkmcnt(7)
v_mfma_f32_32x32x16_bf16 a[16:31], v[232:235], v[116:119], a[16:31]
ds_read_b128 v[84:87], v6 offset:9216
s_waitcnt lgkmcnt(7)
v_mfma_f32_32x32x16_bf16 a[32:47], v[232:235], v[120:123], a[32:47]
ds_read_b128 v[88:91], v6 offset:10240
s_waitcnt lgkmcnt(7)
v_mfma_f32_32x32x16_bf16 a[48:63], v[232:235], v[124:127], a[48:63]
ds_read_b128 v[92:95], v6 offset:11264
s_waitcnt lgkmcnt(7)
v_mfma_f32_32x32x16_bf16 a[64:79], v[232:235], v[64:67], a[64:79]
ds_read_b128 v[96:99], v6 offset:12288
s_waitcnt lgkmcnt(7)
v_mfma_f32_32x32x16_bf16 a[80:95], v[232:235], v[68:71], a[80:95]
ds_read_b128 v[100:103], v6 offset:13312
s_waitcnt lgkmcnt(7)
v_mfma_f32_32x32x16_bf16 a[96:111], v[232:235], v[72:75], a[96:111]
ds_read_b128 v[104:107], v6 offset:14336
s_waitcnt lgkmcnt(7)
v_mfma_f32_32x32x16_bf16 a[112:127], v[232:235], v[76:79], a[112:127]
ds_read_b128 v[108:111], v6 offset:15360
s_waitcnt lgkmcnt(7)
v_mfma_f32_32x32x16_bf16 a[128:143], v[232:235], v[80:83], a[128:143]
ds_read_b128 v[112:115], v6 offset:16384
s_waitcnt lgkmcnt(7)
v_mfma_f32_32x32x16_bf16 a[144:159], v[232:235], v[84:87], a[144:159]
ds_read_b128 v[116:119], v6 offset:17408
s_waitcnt lgkmcnt(7)
v_mfma_f32_32x32x16_bf16 a[160:175], v[232:235], v[88:91], a[160:175]
ds_read_b128 v[120:123], v6 offset:18432
s_waitcnt lgkmcnt(7)
v_mfma_f32_32x32x16_bf16 a[176:191], v[232:235], v[92:95], a[176:191]
ds_read_b128 v[124:127], v6 offset:19456
s_waitcnt lgkmcnt(7)
v_mfma_f32_32x32x16_bf16 a[192:207], v[232:235], v[96:99], a[192:207]
ds_read_b128 v[64:67], v6 offset:20480
s_waitcnt lgkmcnt(7)
v_mfma_f32_32x32x16_bf16 a[208:223], v[232:235], v[100:103], a[208:223]
ds_read_b128 v[68:71], v6 offset:21504
s_waitcnt lgkmcnt(7)
v_mfma_f32_32x32x16_bf16 a[0:15], v[236:239], v[104:107], a[0:15]
ds_read_b128 v[72:75], v6 offset:22528
s_waitcnt lgkmcnt(7)
v_mfma_f32_32x32x16_bf16 a[16:31], v[236:239], v[108:111], a[16:31]
ds_read_b128 v[76:79], v6 offset:23552
s_waitcnt lgkmcnt(7)
v_mfma_f32_32x32x16_bf16 a[32:47], v[236:239], v[112:115], a[32:47]
ds_read_b128 v[80:83], v6 offset:24576
s_waitcnt lgkmcnt(7)
v_mfma_f32_32x32x16_bf16 a[48:63], v[236:239], v[116:119], a[48:63]
ds_read_b128 v[84:87], v6 offset:25600
s_waitcnt lgkmcnt(7)
v_mfma_f32_32x32x16_bf16 a[64:79], v[236:239], v[120:123], a[64:79]
ds_read_b128 v[88:91], v6 offset:26624
s_waitcnt lgkmcnt(7)
v_mfma_f32_32x32x16_bf16 a[80:95], v[236:239], v[124:127], a[80:95]
ds_read_b128 v[92:95], v6 offset:27648
s_waitcnt lgkmcnt(7)
v_mfma_f32_32x32x16_bf16 a[96:111], v[236:239], v[64:67], a[96:111]
s_waitcnt lgkmcnt(6)
v_mfma_f32_32x32x16_bf16 a[112:127], v[236:239], v[68:71], a[112:127]
s_waitcnt lgkmcnt(5)
v_mfma_f32_32x32x16_bf16 a[128:143], v[236:239], v[72:75], a[128:143]
s_waitcnt lgkmcnt(4)
v_mfma_f32_32x32x16_bf16 a[144:159], v[236:239], v[76:79], a[144:159]
s_waitcnt lgkmcnt(3)
v_mfma_f32_32x32x16_bf16 a[160:175], v[236:239], v[80:83], a[160:175]
s_waitcnt lgkmcnt(2)
v_mfma_f32_32x32x16_bf16 a[176:191], v[236:239], v[84:87], a[176:191]
s_waitcnt lgkmcnt(1)
v_mfma_f32_32x32x16_bf16 a[192:207], v[236:239], v[88:91], a[192:207]
s_waitcnt lgkmcnt(0)
v_mfma_f32_32x32x16_bf16 a[208:223], v[236:239], v[92:95], a[208:223]
s_nop 15
v_bfe_u32 v26, v1, 4, 1
v_lshlrev_b32 v26, 14, v26
v_lshrrev_b32 v27, 5, v1
v_lshl_add_u32 v26, v27, 8, v26
v_and_b32 v27, 15, v1
v_lshl_add_u32 v26, v27, 4, v26
s_mul_i32 s26, s23, 458752
s_lshl_b32 s27, s22, 10
s_add_u32 s26, s26, s27
s_add_u32 s26, s26, 16777216
v_accvgpr_read_b32 v32, a0
v_accvgpr_read_b32 v33, a1
v_accvgpr_read_b32 v34, a2
v_accvgpr_read_b32 v35, a3
v_accvgpr_read_b32 v36, a4
v_accvgpr_read_b32 v37, a5
v_accvgpr_read_b32 v38, a6
v_accvgpr_read_b32 v39, a7
v_accvgpr_read_b32 v40, a8
v_accvgpr_read_b32 v41, a9
v_accvgpr_read_b32 v42, a10
v_accvgpr_read_b32 v43, a11
v_accvgpr_read_b32 v44, a12
v_accvgpr_read_b32 v45, a13
v_accvgpr_read_b32 v46, a14
v_accvgpr_read_b32 v47, a15
v_cvt_pk_bf16_f32 v32, v32, v33
v_cvt_pk_bf16_f32 v33, v34, v35
v_cvt_pk_bf16_f32 v34, v36, v37
v_cvt_pk_bf16_f32 v35, v38, v39
v_cvt_pk_bf16_f32 v36, v40, v41
v_cvt_pk_bf16_f32 v37, v42, v43
v_cvt_pk_bf16_f32 v38, v44, v45
v_cvt_pk_bf16_f32 v39, v46, v47
buffer_store_dwordx4 v[32:35], v26, s[8:11], s26 offen sc1
buffer_store_dwordx4 v[36:39], v26, s[8:11], s26 offen offset:512 sc1
s_add_u32 s26, s26, 32768
v_accvgpr_read_b32 v48, a16
v_accvgpr_read_b32 v49, a17
v_accvgpr_read_b32 v50, a18
v_accvgpr_read_b32 v51, a19
v_accvgpr_read_b32 v52, a20
v_accvgpr_read_b32 v53, a21
v_accvgpr_read_b32 v54, a22
v_accvgpr_read_b32 v55, a23
v_accvgpr_read_b32 v56, a24
v_accvgpr_read_b32 v57, a25
v_accvgpr_read_b32 v58, a26
v_accvgpr_read_b32 v59, a27
v_accvgpr_read_b32 v60, a28
v_accvgpr_read_b32 v61, a29
v_accvgpr_read_b32 v62, a30
v_accvgpr_read_b32 v63, a31
v_cvt_pk_bf16_f32 v48, v48, v49
v_cvt_pk_bf16_f32 v49, v50, v51
v_cvt_pk_bf16_f32 v50, v52, v53
v_cvt_pk_bf16_f32 v51, v54, v55
v_cvt_pk_bf16_f32 v52, v56, v57
v_cvt_pk_bf16_f32 v53, v58, v59
v_cvt_pk_bf16_f32 v54, v60, v61
v_cvt_pk_bf16_f32 v55, v62, v63
buffer_store_dwordx4 v[48:51], v26, s[8:11], s26 offen sc1
buffer_store_dwordx4 v[52:55], v26, s[8:11], s26 offen offset:512 sc1
s_add_u32 s26, s26, 32768
v_accvgpr_read_b32 v32, a32
v_accvgpr_read_b32 v33, a33
v_accvgpr_read_b32 v34, a34
v_accvgpr_read_b32 v35, a35
v_accvgpr_read_b32 v36, a36
v_accvgpr_read_b32 v37, a37
v_accvgpr_read_b32 v38, a38
v_accvgpr_read_b32 v39, a39
v_accvgpr_read_b32 v40, a40
v_accvgpr_read_b32 v41, a41
v_accvgpr_read_b32 v42, a42
v_accvgpr_read_b32 v43, a43
v_accvgpr_read_b32 v44, a44
v_accvgpr_read_b32 v45, a45
v_accvgpr_read_b32 v46, a46
v_accvgpr_read_b32 v47, a47
v_cvt_pk_bf16_f32 v32, v32, v33
v_cvt_pk_bf16_f32 v33, v34, v35
v_cvt_pk_bf16_f32 v34, v36, v37
v_cvt_pk_bf16_f32 v35, v38, v39
v_cvt_pk_bf16_f32 v36, v40, v41
v_cvt_pk_bf16_f32 v37, v42, v43
v_cvt_pk_bf16_f32 v38, v44, v45
v_cvt_pk_bf16_f32 v39, v46, v47
buffer_store_dwordx4 v[32:35], v26, s[8:11], s26 offen sc1
buffer_store_dwordx4 v[36:39], v26, s[8:11], s26 offen offset:512 sc1
s_add_u32 s26, s26, 32768
v_accvgpr_read_b32 v48, a48
v_accvgpr_read_b32 v49, a49
v_accvgpr_read_b32 v50, a50
v_accvgpr_read_b32 v51, a51
v_accvgpr_read_b32 v52, a52
v_accvgpr_read_b32 v53, a53
v_accvgpr_read_b32 v54, a54
v_accvgpr_read_b32 v55, a55
v_accvgpr_read_b32 v56, a56
v_accvgpr_read_b32 v57, a57
v_accvgpr_read_b32 v58, a58
v_accvgpr_read_b32 v59, a59
v_accvgpr_read_b32 v60, a60
v_accvgpr_read_b32 v61, a61
v_accvgpr_read_b32 v62, a62
v_accvgpr_read_b32 v63, a63
v_cvt_pk_bf16_f32 v48, v48, v49
v_cvt_pk_bf16_f32 v49, v50, v51
v_cvt_pk_bf16_f32 v50, v52, v53
v_cvt_pk_bf16_f32 v51, v54, v55
v_cvt_pk_bf16_f32 v52, v56, v57
v_cvt_pk_bf16_f32 v53, v58, v59
v_cvt_pk_bf16_f32 v54, v60, v61
v_cvt_pk_bf16_f32 v55, v62, v63
buffer_store_dwordx4 v[48:51], v26, s[8:11], s26 offen sc1
buffer_store_dwordx4 v[52:55], v26, s[8:11], s26 offen offset:512 sc1
s_add_u32 s26, s26, 32768
v_accvgpr_read_b32 v32, a64
v_accvgpr_read_b32 v33, a65
v_accvgpr_read_b32 v34, a66
v_accvgpr_read_b32 v35, a67
v_accvgpr_read_b32 v36, a68
v_accvgpr_read_b32 v37, a69
v_accvgpr_read_b32 v38, a70
v_accvgpr_read_b32 v39, a71
v_accvgpr_read_b32 v40, a72
v_accvgpr_read_b32 v41, a73
v_accvgpr_read_b32 v42, a74
v_accvgpr_read_b32 v43, a75
v_accvgpr_read_b32 v44, a76
v_accvgpr_read_b32 v45, a77
v_accvgpr_read_b32 v46, a78
v_accvgpr_read_b32 v47, a79
v_cvt_pk_bf16_f32 v32, v32, v33
v_cvt_pk_bf16_f32 v33, v34, v35
v_cvt_pk_bf16_f32 v34, v36, v37
v_cvt_pk_bf16_f32 v35, v38, v39
v_cvt_pk_bf16_f32 v36, v40, v41
v_cvt_pk_bf16_f32 v37, v42, v43
v_cvt_pk_bf16_f32 v38, v44, v45
v_cvt_pk_bf16_f32 v39, v46, v47
buffer_store_dwordx4 v[32:35], v26, s[8:11], s26 offen sc1
buffer_store_dwordx4 v[36:39], v26, s[8:11], s26 offen offset:512 sc1
s_add_u32 s26, s26, 32768
v_accvgpr_read_b32 v48, a80
v_accvgpr_read_b32 v49, a81
v_accvgpr_read_b32 v50, a82
v_accvgpr_read_b32 v51, a83
v_accvgpr_read_b32 v52, a84
v_accvgpr_read_b32 v53, a85
v_accvgpr_read_b32 v54, a86
v_accvgpr_read_b32 v55, a87
v_accvgpr_read_b32 v56, a88
v_accvgpr_read_b32 v57, a89
v_accvgpr_read_b32 v58, a90
v_accvgpr_read_b32 v59, a91
v_accvgpr_read_b32 v60, a92
v_accvgpr_read_b32 v61, a93
v_accvgpr_read_b32 v62, a94
v_accvgpr_read_b32 v63, a95
v_cvt_pk_bf16_f32 v48, v48, v49
v_cvt_pk_bf16_f32 v49, v50, v51
v_cvt_pk_bf16_f32 v50, v52, v53
v_cvt_pk_bf16_f32 v51, v54, v55
v_cvt_pk_bf16_f32 v52, v56, v57
v_cvt_pk_bf16_f32 v53, v58, v59
v_cvt_pk_bf16_f32 v54, v60, v61
v_cvt_pk_bf16_f32 v55, v62, v63
buffer_store_dwordx4 v[48:51], v26, s[8:11], s26 offen sc1
buffer_store_dwordx4 v[52:55], v26, s[8:11], s26 offen offset:512 sc1
s_add_u32 s26, s26, 32768
v_accvgpr_read_b32 v32, a96
v_accvgpr_read_b32 v33, a97
v_accvgpr_read_b32 v34, a98
v_accvgpr_read_b32 v35, a99
v_accvgpr_read_b32 v36, a100
v_accvgpr_read_b32 v37, a101
v_accvgpr_read_b32 v38, a102
v_accvgpr_read_b32 v39, a103
v_accvgpr_read_b32 v40, a104
v_accvgpr_read_b32 v41, a105
v_accvgpr_read_b32 v42, a106
v_accvgpr_read_b32 v43, a107
v_accvgpr_read_b32 v44, a108
v_accvgpr_read_b32 v45, a109
v_accvgpr_read_b32 v46, a110
v_accvgpr_read_b32 v47, a111
v_cvt_pk_bf16_f32 v32, v32, v33
v_cvt_pk_bf16_f32 v33, v34, v35
v_cvt_pk_bf16_f32 v34, v36, v37
v_cvt_pk_bf16_f32 v35, v38, v39
v_cvt_pk_bf16_f32 v36, v40, v41
v_cvt_pk_bf16_f32 v37, v42, v43
v_cvt_pk_bf16_f32 v38, v44, v45
v_cvt_pk_bf16_f32 v39, v46, v47
buffer_store_dwordx4 v[32:35], v26, s[8:11], s26 offen sc1
buffer_store_dwordx4 v[36:39], v26, s[8:11], s26 offen offset:512 sc1
s_add_u32 s26, s26, 32768
v_accvgpr_read_b32 v48, a112
v_accvgpr_read_b32 v49, a113
v_accvgpr_read_b32 v50, a114
v_accvgpr_read_b32 v51, a115
v_accvgpr_read_b32 v52, a116
v_accvgpr_read_b32 v53, a117
v_accvgpr_read_b32 v54, a118
v_accvgpr_read_b32 v55, a119
v_accvgpr_read_b32 v56, a120
v_accvgpr_read_b32 v57, a121
v_accvgpr_read_b32 v58, a122
v_accvgpr_read_b32 v59, a123
v_accvgpr_read_b32 v60, a124
v_accvgpr_read_b32 v61, a125
v_accvgpr_read_b32 v62, a126
v_accvgpr_read_b32 v63, a127
v_cvt_pk_bf16_f32 v48, v48, v49
v_cvt_pk_bf16_f32 v49, v50, v51
v_cvt_pk_bf16_f32 v50, v52, v53
v_cvt_pk_bf16_f32 v51, v54, v55
v_cvt_pk_bf16_f32 v52, v56, v57
v_cvt_pk_bf16_f32 v53, v58, v59
v_cvt_pk_bf16_f32 v54, v60, v61
v_cvt_pk_bf16_f32 v55, v62, v63
buffer_store_dwordx4 v[48:51], v26, s[8:11], s26 offen sc1
buffer_store_dwordx4 v[52:55], v26, s[8:11], s26 offen offset:512 sc1
s_add_u32 s26, s26, 32768
v_accvgpr_read_b32 v32, a128
v_accvgpr_read_b32 v33, a129
v_accvgpr_read_b32 v34, a130
v_accvgpr_read_b32 v35, a131
v_accvgpr_read_b32 v36, a132
v_accvgpr_read_b32 v37, a133
v_accvgpr_read_b32 v38, a134
v_accvgpr_read_b32 v39, a135
v_accvgpr_read_b32 v40, a136
v_accvgpr_read_b32 v41, a137
v_accvgpr_read_b32 v42, a138
v_accvgpr_read_b32 v43, a139
v_accvgpr_read_b32 v44, a140
v_accvgpr_read_b32 v45, a141
v_accvgpr_read_b32 v46, a142
v_accvgpr_read_b32 v47, a143
v_cvt_pk_bf16_f32 v32, v32, v33
v_cvt_pk_bf16_f32 v33, v34, v35
v_cvt_pk_bf16_f32 v34, v36, v37
v_cvt_pk_bf16_f32 v35, v38, v39
v_cvt_pk_bf16_f32 v36, v40, v41
v_cvt_pk_bf16_f32 v37, v42, v43
v_cvt_pk_bf16_f32 v38, v44, v45
v_cvt_pk_bf16_f32 v39, v46, v47
buffer_store_dwordx4 v[32:35], v26, s[8:11], s26 offen sc1
buffer_store_dwordx4 v[36:39], v26, s[8:11], s26 offen offset:512 sc1
s_add_u32 s26, s26, 32768
v_accvgpr_read_b32 v48, a144
v_accvgpr_read_b32 v49, a145
v_accvgpr_read_b32 v50, a146
v_accvgpr_read_b32 v51, a147
v_accvgpr_read_b32 v52, a148
v_accvgpr_read_b32 v53, a149
v_accvgpr_read_b32 v54, a150
v_accvgpr_read_b32 v55, a151
v_accvgpr_read_b32 v56, a152
v_accvgpr_read_b32 v57, a153
v_accvgpr_read_b32 v58, a154
v_accvgpr_read_b32 v59, a155
v_accvgpr_read_b32 v60, a156
v_accvgpr_read_b32 v61, a157
v_accvgpr_read_b32 v62, a158
v_accvgpr_read_b32 v63, a159
v_cvt_pk_bf16_f32 v48, v48, v49
v_cvt_pk_bf16_f32 v49, v50, v51
v_cvt_pk_bf16_f32 v50, v52, v53
v_cvt_pk_bf16_f32 v51, v54, v55
v_cvt_pk_bf16_f32 v52, v56, v57
v_cvt_pk_bf16_f32 v53, v58, v59
v_cvt_pk_bf16_f32 v54, v60, v61
v_cvt_pk_bf16_f32 v55, v62, v63
buffer_store_dwordx4 v[48:51], v26, s[8:11], s26 offen sc1
buffer_store_dwordx4 v[52:55], v26, s[8:11], s26 offen offset:512 sc1
s_add_u32 s26, s26, 32768
v_accvgpr_read_b32 v32, a160
v_accvgpr_read_b32 v33, a161
v_accvgpr_read_b32 v34, a162
v_accvgpr_read_b32 v35, a163
v_accvgpr_read_b32 v36, a164
v_accvgpr_read_b32 v37, a165
v_accvgpr_read_b32 v38, a166
v_accvgpr_read_b32 v39, a167
v_accvgpr_read_b32 v40, a168
v_accvgpr_read_b32 v41, a169
v_accvgpr_read_b32 v42, a170
v_accvgpr_read_b32 v43, a171
v_accvgpr_read_b32 v44, a172
v_accvgpr_read_b32 v45, a173
v_accvgpr_read_b32 v46, a174
v_accvgpr_read_b32 v47, a175
v_cvt_pk_bf16_f32 v32, v32, v33
v_cvt_pk_bf16_f32 v33, v34, v35
v_cvt_pk_bf16_f32 v34, v36, v37
v_cvt_pk_bf16_f32 v35, v38, v39
v_cvt_pk_bf16_f32 v36, v40, v41
v_cvt_pk_bf16_f32 v37, v42, v43
v_cvt_pk_bf16_f32 v38, v44, v45
v_cvt_pk_bf16_f32 v39, v46, v47
buffer_store_dwordx4 v[32:35], v26, s[8:11], s26 offen sc1
buffer_store_dwordx4 v[36:39], v26, s[8:11], s26 offen offset:512 sc1
s_add_u32 s26, s26, 32768
v_accvgpr_read_b32 v48, a176
v_accvgpr_read_b32 v49, a177
v_accvgpr_read_b32 v50, a178
v_accvgpr_read_b32 v51, a179
v_accvgpr_read_b32 v52, a180
v_accvgpr_read_b32 v53, a181
v_accvgpr_read_b32 v54, a182
v_accvgpr_read_b32 v55, a183
v_accvgpr_read_b32 v56, a184
v_accvgpr_read_b32 v57, a185
v_accvgpr_read_b32 v58, a186
v_accvgpr_read_b32 v59, a187
v_accvgpr_read_b32 v60, a188
v_accvgpr_read_b32 v61, a189
v_accvgpr_read_b32 v62, a190
v_accvgpr_read_b32 v63, a191
v_cvt_pk_bf16_f32 v48, v48, v49
v_cvt_pk_bf16_f32 v49, v50, v51
v_cvt_pk_bf16_f32 v50, v52, v53
v_cvt_pk_bf16_f32 v51, v54, v55
v_cvt_pk_bf16_f32 v52, v56, v57
v_cvt_pk_bf16_f32 v53, v58, v59
v_cvt_pk_bf16_f32 v54, v60, v61
v_cvt_pk_bf16_f32 v55, v62, v63
buffer_store_dwordx4 v[48:51], v26, s[8:11], s26 offen sc1
buffer_store_dwordx4 v[52:55], v26, s[8:11], s26 offen offset:512 sc1
s_add_u32 s26, s26, 32768
v_accvgpr_read_b32 v32, a192
v_accvgpr_read_b32 v33, a193
v_accvgpr_read_b32 v34, a194
v_accvgpr_read_b32 v35, a195
v_accvgpr_read_b32 v36, a196
v_accvgpr_read_b32 v37, a197
v_accvgpr_read_b32 v38, a198
v_accvgpr_read_b32 v39, a199
v_accvgpr_read_b32 v40, a200
v_accvgpr_read_b32 v41, a201
v_accvgpr_read_b32 v42, a202
v_accvgpr_read_b32 v43, a203
v_accvgpr_read_b32 v44, a204
v_accvgpr_read_b32 v45, a205
v_accvgpr_read_b32 v46, a206
v_accvgpr_read_b32 v47, a207
v_cvt_pk_bf16_f32 v32, v32, v33
v_cvt_pk_bf16_f32 v33, v34, v35
v_cvt_pk_bf16_f32 v34, v36, v37
v_cvt_pk_bf16_f32 v35, v38, v39
v_cvt_pk_bf16_f32 v36, v40, v41
v_cvt_pk_bf16_f32 v37, v42, v43
v_cvt_pk_bf16_f32 v38, v44, v45
v_cvt_pk_bf16_f32 v39, v46, v47
buffer_store_dwordx4 v[32:35], v26, s[8:11], s26 offen sc1
buffer_store_dwordx4 v[36:39], v26, s[8:11], s26 offen offset:512 sc1
s_add_u32 s26, s26, 32768
v_accvgpr_read_b32 v48, a208
v_accvgpr_read_b32 v49, a209
v_accvgpr_read_b32 v50, a210
v_accvgpr_read_b32 v51, a211
v_accvgpr_read_b32 v52, a212
v_accvgpr_read_b32 v53, a213
v_accvgpr_read_b32 v54, a214
v_accvgpr_read_b32 v55, a215
v_accvgpr_read_b32 v56, a216
v_accvgpr_read_b32 v57, a217
v_accvgpr_read_b32 v58, a218
v_accvgpr_read_b32 v59, a219
v_accvgpr_read_b32 v60, a220
v_accvgpr_read_b32 v61, a221
v_accvgpr_read_b32 v62, a222
v_accvgpr_read_b32 v63, a223
v_cvt_pk_bf16_f32 v48, v48, v49
v_cvt_pk_bf16_f32 v49, v50, v51
v_cvt_pk_bf16_f32 v50, v52, v53
v_cvt_pk_bf16_f32 v51, v54, v55
v_cvt_pk_bf16_f32 v52, v56, v57
v_cvt_pk_bf16_f32 v53, v58, v59
v_cvt_pk_bf16_f32 v54, v60, v61
v_cvt_pk_bf16_f32 v55, v62, v63
buffer_store_dwordx4 v[48:51], v26, s[8:11], s26 offen sc1
buffer_store_dwordx4 v[52:55], v26, s[8:11], s26 offen offset:512 sc1
s_add_u32 s26, s26, 32768
s_waitcnt vmcnt(0)
s_barrier
s_cmp_lg_u32 s17, 0
s_cbranch_scc1 Lsig_58
s_lshl_b32 s26, s21, 7
s_add_u32 s26, s26, 54853632
v_mov_b32 v26, 2
v_mov_b32 v27, 1073741824
v_cmp_eq_u32 vcc, 0, v1
s_nop 1
v_cndmask_b32 v27, v27, v25, vcc
buffer_atomic_add v26, v27, s[8:11], s26 offen
Lsig_58:
s_branch Lnext_23
.p2align 6
LiF1_25:
v_lshrrev_b32 v26, 5, v1
v_bfe_u32 v27, v1, 2, 3
v_xor_b32 v27, v27, v26
v_and_b32 v28, 3, v1
v_mul_u32_u24 v29, 3584, v26
v_lshl_add_u32 v29, v28, 4, v29
v_mov_b32 v30, 1073741824
v_lshl_add_u32 v3, v27, 6, v29
v_cmp_gt_u32 vcc, 7, v27
v_xor_b32 v27, 2, v27
v_lshl_add_u32 v4, v27, 6, v29
v_cndmask_b32 v3, v30, v3, vcc
v_cmp_gt_u32 vcc, 7, v27
s_nop 1
v_cndmask_b32 v4, v30, v4, vcc
v_bfe_u32 v26, v1, 2, 2
v_lshrrev_b32 v27, 5, v1
v_lshl_add_u32 v27, v27, 3, v26
v_lshlrev_b32 v27, 9, v27
v_bfe_u32 v28, v1, 4, 1
v_lshl_add_u32 v27, v28, 5, v27
v_and_b32 v28, 1, v1
v_lshl_add_u32 v27, v28, 4, v27
v_bfe_u32 v28, v1, 1, 1
v_lshl_add_u32 v27, v28, 3, v27
v_xor_b32 v28, 0, v26
v_lshl_add_u32 v5, v28, 6, v27
v_add_u32 v12, 0x10000, v5
v_xor_b32 v28, 1, v26
v_lshl_add_u32 v6, v28, 6, v27
v_add_u32 v13, 0x10000, v6
v_xor_b32 v28, 2, v26
v_lshl_add_u32 v7, v28, 6, v27
v_add_u32 v14, 0x10000, v7
v_xor_b32 v28, 3, v26
v_lshl_add_u32 v8, v28, 6, v27
v_add_u32 v15, 0x10000, v8
v_xor_b32 v28, 4, v26
v_lshl_add_u32 v9, v28, 6, v27
v_add_u32 v16, 0x10000, v9
v_xor_b32 v28, 5, v26
v_lshl_add_u32 v10, v28, 6, v27
v_add_u32 v17, 0x10000, v10
v_xor_b32 v28, 6, v26
v_lshl_add_u32 v11, v28, 6, v27
v_add_u32 v18, 0x10000, v11
s_lshl_b32 s25, s17, 13
s_and_b32 s26, s17, 1
s_cmp_eq_u32 s26, 0
s_cselect_b32 s52, s40, s44
s_cselect_b32 s53, s41, s45
s_mov_b32 s54, 1605632
s_mov_b32 s55, 0x00020000
s_lshr_b32 s26, s17, 1
s_mul_i32 s24, s26, 57344
s_mul_i32 s26, s22, 448
s_add_u32 s24, s24, s26
s_mul_i32 s29, s23, 28672
s_add_u32 s29, s29, 55574528
s_lshl_b32 s27, s21, 7
s_add_u32 s27, s27, 54865920
s_cmp_lg_u32 s17, 0
s_cbranch_scc1 Lwo_60
Lwm_59:
buffer_load_dword v26, v25, s[8:11], s27 offen sc1
s_waitcnt vmcnt(0)
v_cmp_gt_u32 vcc, 16, v26
s_cbranch_vccz Lwo_60
s_sleep 2
s_sub_u32 s19, s19, 1
s_cbranch_scc0 Lwm_59
s_mov_b32 s19, 0
Lwo_60:
s_barrier
s_add_u32 m0, s25, 0
s_add_u32 s26, s24, 0
buffer_load_dwordx4 v3, s[52:55], s26 offen lds
s_add_u32 m0, s25, 1024
s_add_u32 s26, s24, 7168
buffer_load_dwordx4 v4, s[52:55], s26 offen lds
s_add_u32 m0, s25, 2048
s_add_u32 s26, s24, 14336
buffer_load_dwordx4 v3, s[52:55], s26 offen lds
s_add_u32 m0, s25, 3072
s_add_u32 s26, s24, 21504
buffer_load_dwordx4 v4, s[52:55], s26 offen lds
s_add_u32 m0, s25, 4096
s_add_u32 s26, s24, 28672
buffer_load_dwordx4 v3, s[52:55], s26 offen lds
s_add_u32 m0, s25, 5120
s_add_u32 s26, s24, 35840
buffer_load_dwordx4 v4, s[52:55], s26 offen lds
s_add_u32 m0, s25, 6144
s_add_u32 s26, s24, 43008
buffer_load_dwordx4 v3, s[52:55], s26 offen lds
s_add_u32 m0, s25, 7168
s_add_u32 s26, s24, 50176
buffer_load_dwordx4 v4, s[52:55], s26 offen lds
s_add_u32 s24, s24, 114688
buffer_load_dwordx4 v[128:131], v2, s[8:11], s29 offen offset:0 sc1
buffer_load_dwordx4 v[132:135], v2, s[8:11], s29 offen offset:1024 sc1
buffer_load_dwordx4 v[136:139], v2, s[8:11], s29 offen offset:2048 sc1
buffer_load_dwordx4 v[140:143], v2, s[8:11], s29 offen offset:3072 sc1
s_add_u32 s29, s29, 4096
buffer_load_dwordx4 v[144:147], v2, s[8:11], s29 offen offset:0 sc1
buffer_load_dwordx4 v[148:151], v2, s[8:11], s29 offen offset:1024 sc1
buffer_load_dwordx4 v[152:155], v2, s[8:11], s29 offen offset:2048 sc1
buffer_load_dwordx4 v[156:159], v2, s[8:11], s29 offen offset:3072 sc1
s_add_u32 s29, s29, 4096
buffer_load_dwordx4 v[160:163], v2, s[8:11], s29 offen offset:0 sc1
buffer_load_dwordx4 v[164:167], v2, s[8:11], s29 offen offset:1024 sc1
buffer_load_dwordx4 v[168:171], v2, s[8:11], s29 offen offset:2048 sc1
buffer_load_dwordx4 v[172:175], v2, s[8:11], s29 offen offset:3072 sc1
s_add_u32 s29, s29, 4096
buffer_load_dwordx4 v[176:179], v2, s[8:11], s29 offen offset:0 sc1
buffer_load_dwordx4 v[180:183], v2, s[8:11], s29 offen offset:1024 sc1
buffer_load_dwordx4 v[184:187], v2, s[8:11], s29 offen offset:2048 sc1
buffer_load_dwordx4 v[188:191], v2, s[8:11], s29 offen offset:3072 sc1
s_add_u32 s29, s29, 4096
buffer_load_dwordx4 v[192:195], v2, s[8:11], s29 offen offset:0 sc1
buffer_load_dwordx4 v[196:199], v2, s[8:11], s29 offen offset:1024 sc1
buffer_load_dwordx4 v[200:203], v2, s[8:11], s29 offen offset:2048 sc1
buffer_load_dwordx4 v[204:207], v2, s[8:11], s29 offen offset:3072 sc1
s_add_u32 s29, s29, 4096
buffer_load_dwordx4 v[208:211], v2, s[8:11], s29 offen offset:0 sc1
buffer_load_dwordx4 v[212:215], v2, s[8:11], s29 offen offset:1024 sc1
buffer_load_dwordx4 v[216:219], v2, s[8:11], s29 offen offset:2048 sc1
buffer_load_dwordx4 v[220:223], v2, s[8:11], s29 offen offset:3072 sc1
s_add_u32 s29, s29, 4096
buffer_load_dwordx4 v[224:227], v2, s[8:11], s29 offen offset:0 sc1
buffer_load_dwordx4 v[228:231], v2, s[8:11], s29 offen offset:1024 sc1
buffer_load_dwordx4 v[232:235], v2, s[8:11], s29 offen offset:2048 sc1
buffer_load_dwordx4 v[236:239], v2, s[8:11], s29 offen offset:3072 sc1
s_add_u32 m0, s25, 32768
s_add_u32 s26, s24, 0
buffer_load_dwordx4 v3, s[52:55], s26 offen lds
s_add_u32 m0, s25, 33792
s_add_u32 s26, s24, 7168
buffer_load_dwordx4 v4, s[52:55], s26 offen lds
s_add_u32 m0, s25, 34816
s_add_u32 s26, s24, 14336
buffer_load_dwordx4 v3, s[52:55], s26 offen lds
s_add_u32 m0, s25, 35840
s_add_u32 s26, s24, 21504
buffer_load_dwordx4 v4, s[52:55], s26 offen lds
s_add_u32 m0, s25, 36864
s_add_u32 s26, s24, 28672
buffer_load_dwordx4 v3, s[52:55], s26 offen lds
s_add_u32 m0, s25, 37888
s_add_u32 s26, s24, 35840
buffer_load_dwordx4 v4, s[52:55], s26 offen lds
s_add_u32 m0, s25, 38912
s_add_u32 s26, s24, 43008
buffer_load_dwordx4 v3, s[52:55], s26 offen lds
s_add_u32 m0, s25, 39936
s_add_u32 s26, s24, 50176
buffer_load_dwordx4 v4, s[52:55], s26 offen lds
s_add_u32 s24, s24, 114688
s_add_u32 m0, s25, 65536
s_add_u32 s26, s24, 0
buffer_load_dwordx4 v3, s[52:55], s26 offen lds
s_add_u32 m0, s25, 66560
s_add_u32 s26, s24, 7168
buffer_load_dwordx4 v4, s[52:55], s26 offen lds
s_add_u32 m0, s25, 67584
s_add_u32 s26, s24, 14336
buffer_load_dwordx4 v3, s[52:55], s26 offen lds
s_add_u32 m0, s25, 68608
s_add_u32 s26, s24, 21504
buffer_load_dwordx4 v4, s[52:55], s26 offen lds
s_add_u32 m0, s25, 69632
s_add_u32 s26, s24, 28672
buffer_load_dwordx4 v3, s[52:55], s26 offen lds
s_add_u32 m0, s25, 70656
s_add_u32 s26, s24, 35840
buffer_load_dwordx4 v4, s[52:55], s26 offen lds
s_add_u32 m0, s25, 71680
s_add_u32 s26, s24, 43008
buffer_load_dwordx4 v3, s[52:55], s26 offen lds
s_add_u32 m0, s25, 72704
s_add_u32 s26, s24, 50176
buffer_load_dwordx4 v4, s[52:55], s26 offen lds
s_add_u32 s24, s24, 114688
s_waitcnt vmcnt(16)
s_barrier
ds_read_b64_tr_b16 v[64:65], v5 offset:0
ds_read_b64_tr_b16 v[66:67], v5 offset:2048
ds_read_b64_tr_b16 v[68:69], v6 offset:0
ds_read_b64_tr_b16 v[70:71], v6 offset:2048
ds_read_b64_tr_b16 v[72:73], v7 offset:0
ds_read_b64_tr_b16 v[74:75], v7 offset:2048
ds_read_b64_tr_b16 v[76:77], v8 offset:0
ds_read_b64_tr_b16 v[78:79], v8 offset:2048
ds_read_b64_tr_b16 v[80:81], v9 offset:0
ds_read_b64_tr_b16 v[82:83], v9 offset:2048
ds_read_b64_tr_b16 v[84:85], v10 offset:0
ds_read_b64_tr_b16 v[86:87], v10 offset:2048
ds_read_b64_tr_b16 v[88:89], v11 offset:0
ds_read_b64_tr_b16 v[90:91], v11 offset:2048
ds_read_b64_tr_b16 v[92:93], v5 offset:8192
ds_read_b64_tr_b16 v[94:95], v5 offset:10240
s_waitcnt lgkmcnt(14)
v_mfma_f32_32x32x16_bf16 a[0:15], v[64:67], v[128:131], 0
ds_read_b64_tr_b16 v[96:97], v6 offset:8192
ds_read_b64_tr_b16 v[98:99], v6 offset:10240
s_waitcnt lgkmcnt(14)
v_mfma_f32_32x32x16_bf16 a[16:31], v[68:71], v[128:131], 0
ds_read_b64_tr_b16 v[100:101], v7 offset:8192
ds_read_b64_tr_b16 v[102:103], v7 offset:10240
s_waitcnt lgkmcnt(14)
v_mfma_f32_32x32x16_bf16 a[32:47], v[72:75], v[128:131], 0
ds_read_b64_tr_b16 v[104:105], v8 offset:8192
ds_read_b64_tr_b16 v[106:107], v8 offset:10240
s_waitcnt lgkmcnt(14)
v_mfma_f32_32x32x16_bf16 a[48:63], v[76:79], v[128:131], 0
ds_read_b64_tr_b16 v[108:109], v9 offset:8192
ds_read_b64_tr_b16 v[110:111], v9 offset:10240
s_waitcnt lgkmcnt(14)
v_mfma_f32_32x32x16_bf16 a[64:79], v[80:83], v[128:131], 0
ds_read_b64_tr_b16 v[112:113], v10 offset:8192
ds_read_b64_tr_b16 v[114:115], v10 offset:10240
s_waitcnt lgkmcnt(14)
v_mfma_f32_32x32x16_bf16 a[80:95], v[84:87], v[128:131], 0
ds_read_b64_tr_b16 v[116:117], v11 offset:8192
ds_read_b64_tr_b16 v[118:119], v11 offset:10240
s_waitcnt lgkmcnt(14)
v_mfma_f32_32x32x16_bf16 a[96:111], v[88:91], v[128:131], 0
ds_read_b64_tr_b16 v[120:121], v5 offset:16384
ds_read_b64_tr_b16 v[122:123], v5 offset:18432
s_waitcnt lgkmcnt(14)
v_mfma_f32_32x32x16_bf16 a[112:127], v[92:95], v[128:131], 0
ds_read_b64_tr_b16 v[124:125], v6 offset:16384
ds_read_b64_tr_b16 v[126:127], v6 offset:18432
s_waitcnt lgkmcnt(14)
v_mfma_f32_32x32x16_bf16 a[128:143], v[96:99], v[128:131], 0
ds_read_b64_tr_b16 v[64:65], v7 offset:16384
ds_read_b64_tr_b16 v[66:67], v7 offset:18432
s_waitcnt lgkmcnt(14)
v_mfma_f32_32x32x16_bf16 a[144:159], v[100:103], v[128:131], 0
ds_read_b64_tr_b16 v[68:69], v8 offset:16384
ds_read_b64_tr_b16 v[70:71], v8 offset:18432
s_waitcnt lgkmcnt(14)
v_mfma_f32_32x32x16_bf16 a[160:175], v[104:107], v[128:131], 0
ds_read_b64_tr_b16 v[72:73], v9 offset:16384
ds_read_b64_tr_b16 v[74:75], v9 offset:18432
s_waitcnt lgkmcnt(14)
v_mfma_f32_32x32x16_bf16 a[176:191], v[108:111], v[128:131], 0
ds_read_b64_tr_b16 v[76:77], v10 offset:16384
ds_read_b64_tr_b16 v[78:79], v10 offset:18432
s_waitcnt lgkmcnt(14)
v_mfma_f32_32x32x16_bf16 a[192:207], v[112:115], v[128:131], 0
ds_read_b64_tr_b16 v[80:81], v11 offset:16384
ds_read_b64_tr_b16 v[82:83], v11 offset:18432
s_waitcnt lgkmcnt(14)
v_mfma_f32_32x32x16_bf16 a[208:223], v[116:119], v[128:131], 0
ds_read_b64_tr_b16 v[84:85], v5 offset:24576
ds_read_b64_tr_b16 v[86:87], v5 offset:26624
s_waitcnt lgkmcnt(14)
v_mfma_f32_32x32x16_bf16 a[0:15], v[120:123], v[132:135], a[0:15]
ds_read_b64_tr_b16 v[88:89], v6 offset:24576
ds_read_b64_tr_b16 v[90:91], v6 offset:26624
s_waitcnt lgkmcnt(14)
v_mfma_f32_32x32x16_bf16 a[16:31], v[124:127], v[132:135], a[16:31]
ds_read_b64_tr_b16 v[92:93], v7 offset:24576
ds_read_b64_tr_b16 v[94:95], v7 offset:26624
s_waitcnt lgkmcnt(14)
v_mfma_f32_32x32x16_bf16 a[32:47], v[64:67], v[132:135], a[32:47]
ds_read_b64_tr_b16 v[96:97], v8 offset:24576
ds_read_b64_tr_b16 v[98:99], v8 offset:26624
s_waitcnt lgkmcnt(14)
v_mfma_f32_32x32x16_bf16 a[48:63], v[68:71], v[132:135], a[48:63]
ds_read_b64_tr_b16 v[100:101], v9 offset:24576
ds_read_b64_tr_b16 v[102:103], v9 offset:26624
s_waitcnt lgkmcnt(14)
v_mfma_f32_32x32x16_bf16 a[64:79], v[72:75], v[132:135], a[64:79]
ds_read_b64_tr_b16 v[104:105], v10 offset:24576
ds_read_b64_tr_b16 v[106:107], v10 offset:26624
s_waitcnt lgkmcnt(14)
v_mfma_f32_32x32x16_bf16 a[80:95], v[76:79], v[132:135], a[80:95]
s_waitcnt vmcnt(8)
s_barrier
ds_read_b64_tr_b16 v[108:109], v11 offset:24576
ds_read_b64_tr_b16 v[110:111], v11 offset:26624
s_waitcnt lgkmcnt(14)
v_mfma_f32_32x32x16_bf16 a[96:111], v[80:83], v[132:135], a[96:111]
ds_read_b64_tr_b16 v[112:113], v5 offset:32768
ds_read_b64_tr_b16 v[114:115], v5 offset:34816
s_waitcnt lgkmcnt(14)
v_mfma_f32_32x32x16_bf16 a[112:127], v[84:87], v[132:135], a[112:127]
ds_read_b64_tr_b16 v[116:117], v6 offset:32768
ds_read_b64_tr_b16 v[118:119], v6 offset:34816
s_add_u32 m0, s25, 98304
s_add_u32 s26, s24, 0
buffer_load_dwordx4 v3, s[52:55], s26 offen lds
s_waitcnt lgkmcnt(14)
v_mfma_f32_32x32x16_bf16 a[128:143], v[88:91], v[132:135], a[128:143]
ds_read_b64_tr_b16 v[120:121], v7 offset:32768
ds_read_b64_tr_b16 v[122:123], v7 offset:34816
s_waitcnt lgkmcnt(14)
v_mfma_f32_32x32x16_bf16 a[144:159], v[92:95], v[132:135], a[144:159]
ds_read_b64_tr_b16 v[124:125], v8 offset:32768
ds_read_b64_tr_b16 v[126:127], v8 offset:34816
s_waitcnt lgkmcnt(14)
v_mfma_f32_32x32x16_bf16 a[160:175], v[96:99], v[132:135], a[160:175]
ds_read_b64_tr_b16 v[64:65], v9 offset:32768
ds_read_b64_tr_b16 v[66:67], v9 offset:34816
s_add_u32 m0, s25, 99328
s_add_u32 s26, s24, 7168
buffer_load_dwordx4 v4, s[52:55], s26 offen lds
s_waitcnt lgkmcnt(14)
v_mfma_f32_32x32x16_bf16 a[176:191], v[100:103], v[132:135], a[176:191]
ds_read_b64_tr_b16 v[68:69], v10 offset:32768
ds_read_b64_tr_b16 v[70:71], v10 offset:34816
s_waitcnt lgkmcnt(14)
v_mfma_f32_32x32x16_bf16 a[192:207], v[104:107], v[132:135], a[192:207]
ds_read_b64_tr_b16 v[72:73], v11 offset:32768
ds_read_b64_tr_b16 v[74:75], v11 offset:34816
s_waitcnt lgkmcnt(14)
v_mfma_f32_32x32x16_bf16 a[208:223], v[108:111], v[132:135], a[208:223]
ds_read_b64_tr_b16 v[76:77], v5 offset:40960
ds_read_b64_tr_b16 v[78:79], v5 offset:43008
s_add_u32 m0, s25, 100352
s_add_u32 s26, s24, 14336
buffer_load_dwordx4 v3, s[52:55], s26 offen lds
s_waitcnt lgkmcnt(14)
v_mfma_f32_32x32x16_bf16 a[0:15], v[112:115], v[136:139], a[0:15]
ds_read_b64_tr_b16 v[80:81], v6 offset:40960
ds_read_b64_tr_b16 v[82:83], v6 offset:43008
s_waitcnt lgkmcnt(14)
v_mfma_f32_32x32x16_bf16 a[16:31], v[116:119], v[136:139], a[16:31]
ds_read_b64_tr_b16 v[84:85], v7 offset:40960
ds_read_b64_tr_b16 v[86:87], v7 offset:43008
s_waitcnt lgkmcnt(14)
v_mfma_f32_32x32x16_bf16 a[32:47], v[120:123], v[136:139], a[32:47]
ds_read_b64_tr_b16 v[88:89], v8 offset:40960
ds_read_b64_tr_b16 v[90:91], v8 offset:43008
s_add_u32 m0, s25, 101376
s_add_u32 s26, s24, 21504
buffer_load_dwordx4 v4, s[52:55], s26 offen lds
s_waitcnt lgkmcnt(14)
v_mfma_f32_32x32x16_bf16 a[48:63], v[124:127], v[136:139], a[48:63]
ds_read_b64_tr_b16 v[92:93], v9 offset:40960
ds_read_b64_tr_b16 v[94:95], v9 offset:43008
s_waitcnt lgkmcnt(14)
v_mfma_f32_32x32x16_bf16 a[64:79], v[64:67], v[136:139], a[64:79]
ds_read_b64_tr_b16 v[96:97], v10 offset:40960
ds_read_b64_tr_b16 v[98:99], v10 offset:43008
s_waitcnt lgkmcnt(14)
v_mfma_f32_32x32x16_bf16 a[80:95], v[68:71], v[136:139], a[80:95]
ds_read_b64_tr_b16 v[100:101], v11 offset:40960
ds_read_b64_tr_b16 v[102:103], v11 offset:43008
s_add_u32 m0, s25, 102400
s_add_u32 s26, s24, 28672
buffer_load_dwordx4 v3, s[52:55], s26 offen lds
s_waitcnt lgkmcnt(14)
v_mfma_f32_32x32x16_bf16 a[96:111], v[72:75], v[136:139], a[96:111]
ds_read_b64_tr_b16 v[104:105], v5 offset:49152
ds_read_b64_tr_b16 v[106:107], v5 offset:51200
s_waitcnt lgkmcnt(14)
v_mfma_f32_32x32x16_bf16 a[112:127], v[76:79], v[136:139], a[112:127]
ds_read_b64_tr_b16 v[108:109], v6 offset:49152
ds_read_b64_tr_b16 v[110:111], v6 offset:51200
s_waitcnt lgkmcnt(14)
v_mfma_f32_32x32x16_bf16 a[128:143], v[80:83], v[136:139], a[128:143]
ds_read_b64_tr_b16 v[112:113], v7 offset:49152
ds_read_b64_tr_b16 v[114:115], v7 offset:51200
s_add_u32 m0, s25, 103424
s_add_u32 s26, s24, 35840
buffer_load_dwordx4 v4, s[52:55], s26 offen lds
s_waitcnt lgkmcnt(14)
v_mfma_f32_32x32x16_bf16 a[144:159], v[84:87], v[136:139], a[144:159]
ds_read_b64_tr_b16 v[116:117], v8 offset:49152
ds_read_b64_tr_b16 v[118:119], v8 offset:51200
s_waitcnt lgkmcnt(14)
v_mfma_f32_32x32x16_bf16 a[160:175], v[88:91], v[136:139], a[160:175]
ds_read_b64_tr_b16 v[120:121], v9 offset:49152
ds_read_b64_tr_b16 v[122:123], v9 offset:51200
s_waitcnt lgkmcnt(14)
v_mfma_f32_32x32x16_bf16 a[176:191], v[92:95], v[136:139], a[176:191]
ds_read_b64_tr_b16 v[124:125], v10 offset:49152
ds_read_b64_tr_b16 v[126:127], v10 offset:51200
s_add_u32 m0, s25, 104448
s_add_u32 s26, s24, 43008
buffer_load_dwordx4 v3, s[52:55], s26 offen lds
s_waitcnt lgkmcnt(14)
v_mfma_f32_32x32x16_bf16 a[192:207], v[96:99], v[136:139], a[192:207]
ds_read_b64_tr_b16 v[64:65], v11 offset:49152
ds_read_b64_tr_b16 v[66:67], v11 offset:51200
s_waitcnt lgkmcnt(14)
v_mfma_f32_32x32x16_bf16 a[208:223], v[100:103], v[136:139], a[208:223]
ds_read_b64_tr_b16 v[68:69], v5 offset:57344
ds_read_b64_tr_b16 v[70:71], v5 offset:59392
s_waitcnt lgkmcnt(14)
v_mfma_f32_32x32x16_bf16 a[0:15], v[104:107], v[140:143], a[0:15]
ds_read_b64_tr_b16 v[72:73], v6 offset:57344
ds_read_b64_tr_b16 v[74:75], v6 offset:59392
s_add_u32 m0, s25, 105472
s_add_u32 s26, s24, 50176
buffer_load_dwordx4 v4, s[52:55], s26 offen lds
s_add_u32 s24, s24, 114688
s_waitcnt lgkmcnt(14)
v_mfma_f32_32x32x16_bf16 a[16:31], v[108:111], v[140:143], a[16:31]
ds_read_b64_tr_b16 v[76:77], v7 offset:57344
ds_read_b64_tr_b16 v[78:79], v7 offset:59392
s_waitcnt lgkmcnt(14)
v_mfma_f32_32x32x16_bf16 a[32:47], v[112:115], v[140:143], a[32:47]
ds_read_b64_tr_b16 v[80:81], v8 offset:57344
ds_read_b64_tr_b16 v[82:83], v8 offset:59392
s_waitcnt lgkmcnt(14)
v_mfma_f32_32x32x16_bf16 a[48:63], v[116:119], v[140:143], a[48:63]
ds_read_b64_tr_b16 v[84:85], v9 offset:57344
ds_read_b64_tr_b16 v[86:87], v9 offset:59392
s_waitcnt lgkmcnt(14)
v_mfma_f32_32x32x16_bf16 a[64:79], v[120:123], v[140:143], a[64:79]
ds_read_b64_tr_b16 v[88:89], v10 offset:57344
ds_read_b64_tr_b16 v[90:91], v10 offset:59392
s_waitcnt lgkmcnt(14)
v_mfma_f32_32x32x16_bf16 a[80:95], v[124:127], v[140:143], a[80:95]
s_waitcnt vmcnt(8)
s_barrier
ds_read_b64_tr_b16 v[92:93], v11 offset:57344
ds_read_b64_tr_b16 v[94:95], v11 offset:59392
s_waitcnt lgkmcnt(14)
v_mfma_f32_32x32x16_bf16 a[96:111], v[64:67], v[140:143], a[96:111]
ds_read_b64_tr_b16 v[96:97], v12 offset:0
ds_read_b64_tr_b16 v[98:99], v12 offset:2048
s_add_u32 m0, s25, 0
s_add_u32 s26, s24, 0
buffer_load_dwordx4 v3, s[52:55], s26 offen lds
s_waitcnt lgkmcnt(14)
v_mfma_f32_32x32x16_bf16 a[112:127], v[68:71], v[140:143], a[112:127]
ds_read_b64_tr_b16 v[100:101], v13 offset:0
ds_read_b64_tr_b16 v[102:103], v13 offset:2048
s_waitcnt lgkmcnt(14)
v_mfma_f32_32x32x16_bf16 a[128:143], v[72:75], v[140:143], a[128:143]
ds_read_b64_tr_b16 v[104:105], v14 offset:0
ds_read_b64_tr_b16 v[106:107], v14 offset:2048
s_waitcnt lgkmcnt(14)
v_mfma_f32_32x32x16_bf16 a[144:159], v[76:79], v[140:143], a[144:159]
ds_read_b64_tr_b16 v[108:109], v15 offset:0
ds_read_b64_tr_b16 v[110:111], v15 offset:2048
s_add_u32 m0, s25, 1024
s_add_u32 s26, s24, 7168
buffer_load_dwordx4 v4, s[52:55], s26 offen lds
s_waitcnt lgkmcnt(14)
v_mfma_f32_32x32x16_bf16 a[160:175], v[80:83], v[140:143], a[160:175]
ds_read_b64_tr_b16 v[112:113], v16 offset:0
ds_read_b64_tr_b16 v[114:115], v16 offset:2048
s_waitcnt lgkmcnt(14)
v_mfma_f32_32x32x16_bf16 a[176:191], v[84:87], v[140:143], a[176:191]
ds_read_b64_tr_b16 v[116:117], v17 offset:0
ds_read_b64_tr_b16 v[118:119], v17 offset:2048
s_waitcnt lgkmcnt(14)
v_mfma_f32_32x32x16_bf16 a[192:207], v[88:91], v[140:143], a[192:207]
ds_read_b64_tr_b16 v[120:121], v18 offset:0
ds_read_b64_tr_b16 v[122:123], v18 offset:2048
s_add_u32 m0, s25, 2048
s_add_u32 s26, s24, 14336
buffer_load_dwordx4 v3, s[52:55], s26 offen lds
s_waitcnt lgkmcnt(14)
v_mfma_f32_32x32x16_bf16 a[208:223], v[92:95], v[140:143], a[208:223]
ds_read_b64_tr_b16 v[124:125], v12 offset:8192
ds_read_b64_tr_b16 v[126:127], v12 offset:10240
s_waitcnt lgkmcnt(14)
v_mfma_f32_32x32x16_bf16 a[0:15], v[96:99], v[144:147], a[0:15]
ds_read_b64_tr_b16 v[64:65], v13 offset:8192
ds_read_b64_tr_b16 v[66:67], v13 offset:10240
s_waitcnt lgkmcnt(14)
v_mfma_f32_32x32x16_bf16 a[16:31], v[100:103], v[144:147], a[16:31]
ds_read_b64_tr_b16 v[68:69], v14 offset:8192
ds_read_b64_tr_b16 v[70:71], v14 offset:10240
s_add_u32 m0, s25, 3072
s_add_u32 s26, s24, 21504
buffer_load_dwordx4 v4, s[52:55], s26 offen lds
s_waitcnt lgkmcnt(14)
v_mfma_f32_32x32x16_bf16 a[32:47], v[104:107], v[144:147], a[32:47]
ds_read_b64_tr_b16 v[72:73], v15 offset:8192
ds_read_b64_tr_b16 v[74:75], v15 offset:10240
s_waitcnt lgkmcnt(14)
v_mfma_f32_32x32x16_bf16 a[48:63], v[108:111], v[144:147], a[48:63]
ds_read_b64_tr_b16 v[76:77], v16 offset:8192
ds_read_b64_tr_b16 v[78:79], v16 offset:10240
s_waitcnt lgkmcnt(14)
v_mfma_f32_32x32x16_bf16 a[64:79], v[112:115], v[144:147], a[64:79]
ds_read_b64_tr_b16 v[80:81], v17 offset:8192
ds_read_b64_tr_b16 v[82:83], v17 offset:10240
s_add_u32 m0, s25, 4096
s_add_u32 s26, s24, 28672
buffer_load_dwordx4 v3, s[52:55], s26 offen lds
s_waitcnt lgkmcnt(14)
v_mfma_f32_32x32x16_bf16 a[80:95], v[116:119], v[144:147], a[80:95]
ds_read_b64_tr_b16 v[84:85], v18 offset:8192
ds_read_b64_tr_b16 v[86:87], v18 offset:10240
s_waitcnt lgkmcnt(14)
v_mfma_f32_32x32x16_bf16 a[96:111], v[120:123], v[144:147], a[96:111]
ds_read_b64_tr_b16 v[88:89], v12 offset:16384
ds_read_b64_tr_b16 v[90:91], v12 offset:18432
s_waitcnt lgkmcnt(14)
v_mfma_f32_32x32x16_bf16 a[112:127], v[124:127], v[144:147], a[112:127]
ds_read_b64_tr_b16 v[92:93], v13 offset:16384
ds_read_b64_tr_b16 v[94:95], v13 offset:18432
s_add_u32 m0, s25, 5120
s_add_u32 s26, s24, 35840
buffer_load_dwordx4 v4, s[52:55], s26 offen lds
s_waitcnt lgkmcnt(14)
v_mfma_f32_32x32x16_bf16 a[128:143], v[64:67], v[144:147], a[128:143]
ds_read_b64_tr_b16 v[96:97], v14 offset:16384
ds_read_b64_tr_b16 v[98:99], v14 offset:18432
s_waitcnt lgkmcnt(14)
v_mfma_f32_32x32x16_bf16 a[144:159], v[68:71], v[144:147], a[144:159]
ds_read_b64_tr_b16 v[100:101], v15 offset:16384
ds_read_b64_tr_b16 v[102:103], v15 offset:18432
s_waitcnt lgkmcnt(14)
v_mfma_f32_32x32x16_bf16 a[160:175], v[72:75], v[144:147], a[160:175]
ds_read_b64_tr_b16 v[104:105], v16 offset:16384
ds_read_b64_tr_b16 v[106:107], v16 offset:18432
s_add_u32 m0, s25, 6144
s_add_u32 s26, s24, 43008
buffer_load_dwordx4 v3, s[52:55], s26 offen lds
s_waitcnt lgkmcnt(14)
v_mfma_f32_32x32x16_bf16 a[176:191], v[76:79], v[144:147], a[176:191]
ds_read_b64_tr_b16 v[108:109], v17 offset:16384
ds_read_b64_tr_b16 v[110:111], v17 offset:18432
s_waitcnt lgkmcnt(14)
v_mfma_f32_32x32x16_bf16 a[192:207], v[80:83], v[144:147], a[192:207]
ds_read_b64_tr_b16 v[112:113], v18 offset:16384
ds_read_b64_tr_b16 v[114:115], v18 offset:18432
s_waitcnt lgkmcnt(14)
v_mfma_f32_32x32x16_bf16 a[208:223], v[84:87], v[144:147], a[208:223]
ds_read_b64_tr_b16 v[116:117], v12 offset:24576
ds_read_b64_tr_b16 v[118:119], v12 offset:26624
s_add_u32 m0, s25, 7168
s_add_u32 s26, s24, 50176
buffer_load_dwordx4 v4, s[52:55], s26 offen lds
s_add_u32 s24, s24, 114688
s_waitcnt lgkmcnt(14)
v_mfma_f32_32x32x16_bf16 a[0:15], v[88:91], v[148:151], a[0:15]
ds_read_b64_tr_b16 v[120:121], v13 offset:24576
ds_read_b64_tr_b16 v[122:123], v13 offset:26624
s_waitcnt lgkmcnt(14)
v_mfma_f32_32x32x16_bf16 a[16:31], v[92:95], v[148:151], a[16:31]
ds_read_b64_tr_b16 v[124:125], v14 offset:24576
ds_read_b64_tr_b16 v[126:127], v14 offset:26624
s_waitcnt lgkmcnt(14)
v_mfma_f32_32x32x16_bf16 a[32:47], v[96:99], v[148:151], a[32:47]
ds_read_b64_tr_b16 v[64:65], v15 offset:24576
ds_read_b64_tr_b16 v[66:67], v15 offset:26624
s_waitcnt lgkmcnt(14)
v_mfma_f32_32x32x16_bf16 a[48:63], v[100:103], v[148:151], a[48:63]
ds_read_b64_tr_b16 v[68:69], v16 offset:24576
ds_read_b64_tr_b16 v[70:71], v16 offset:26624
s_waitcnt lgkmcnt(14)
v_mfma_f32_32x32x16_bf16 a[64:79], v[104:107], v[148:151], a[64:79]
ds_read_b64_tr_b16 v[72:73], v17 offset:24576
ds_read_b64_tr_b16 v[74:75], v17 offset:26624
s_waitcnt lgkmcnt(14)
v_mfma_f32_32x32x16_bf16 a[80:95], v[108:111], v[148:151], a[80:95]
s_waitcnt vmcnt(8)
s_barrier
ds_read_b64_tr_b16 v[76:77], v18 offset:24576
ds_read_b64_tr_b16 v[78:79], v18 offset:26624
s_add_u32 m0, s25, 32768
s_add_u32 s26, s24, 0
buffer_load_dwordx4 v3, s[52:55], s26 offen lds
s_waitcnt lgkmcnt(14)
v_mfma_f32_32x32x16_bf16 a[96:111], v[112:115], v[148:151], a[96:111]
ds_read_b64_tr_b16 v[80:81], v12 offset:32768
ds_read_b64_tr_b16 v[82:83], v12 offset:34816
s_waitcnt lgkmcnt(14)
v_mfma_f32_32x32x16_bf16 a[112:127], v[116:119], v[148:151], a[112:127]
ds_read_b64_tr_b16 v[84:85], v13 offset:32768
ds_read_b64_tr_b16 v[86:87], v13 offset:34816
s_waitcnt lgkmcnt(14)
v_mfma_f32_32x32x16_bf16 a[128:143], v[120:123], v[148:151], a[128:143]
ds_read_b64_tr_b16 v[88:89], v14 offset:32768
ds_read_b64_tr_b16 v[90:91], v14 offset:34816
s_add_u32 m0, s25, 33792
s_add_u32 s26, s24, 7168
buffer_load_dwordx4 v4, s[52:55], s26 offen lds
s_waitcnt lgkmcnt(14)
v_mfma_f32_32x32x16_bf16 a[144:159], v[124:127], v[148:151], a[144:159]
ds_read_b64_tr_b16 v[92:93], v15 offset:32768
ds_read_b64_tr_b16 v[94:95], v15 offset:34816
s_waitcnt lgkmcnt(14)
v_mfma_f32_32x32x16_bf16 a[160:175], v[64:67], v[148:151], a[160:175]
ds_read_b64_tr_b16 v[96:97], v16 offset:32768
ds_read_b64_tr_b16 v[98:99], v16 offset:34816
s_waitcnt lgkmcnt(14)
v_mfma_f32_32x32x16_bf16 a[176:191], v[68:71], v[148:151], a[176:191]
ds_read_b64_tr_b16 v[100:101], v17 offset:32768
ds_read_b64_tr_b16 v[102:103], v17 offset:34816
s_add_u32 m0, s25, 34816
s_add_u32 s26, s24, 14336
buffer_load_dwordx4 v3, s[52:55], s26 offen lds
s_waitcnt lgkmcnt(14)
v_mfma_f32_32x32x16_bf16 a[192:207], v[72:75], v[148:151], a[192:207]
ds_read_b64_tr_b16 v[104:105], v18 offset:32768
ds_read_b64_tr_b16 v[106:107], v18 offset:34816
s_waitcnt lgkmcnt(14)
v_mfma_f32_32x32x16_bf16 a[208:223], v[76:79], v[148:151], a[208:223]
ds_read_b64_tr_b16 v[108:109], v12 offset:40960
ds_read_b64_tr_b16 v[110:111], v12 offset:43008
s_waitcnt lgkmcnt(14)
v_mfma_f32_32x32x16_bf16 a[0:15], v[80:83], v[152:155], a[0:15]
ds_read_b64_tr_b16 v[112:113], v13 offset:40960
ds_read_b64_tr_b16 v[114:115], v13 offset:43008
s_add_u32 m0, s25, 35840
s_add_u32 s26, s24, 21504
buffer_load_dwordx4 v4, s[52:55], s26 offen lds
s_waitcnt lgkmcnt(14)
v_mfma_f32_32x32x16_bf16 a[16:31], v[84:87], v[152:155], a[16:31]
ds_read_b64_tr_b16 v[116:117], v14 offset:40960
ds_read_b64_tr_b16 v[118:119], v14 offset:43008
s_waitcnt lgkmcnt(14)
v_mfma_f32_32x32x16_bf16 a[32:47], v[88:91], v[152:155], a[32:47]
ds_read_b64_tr_b16 v[120:121], v15 offset:40960
ds_read_b64_tr_b16 v[122:123], v15 offset:43008
s_waitcnt lgkmcnt(14)
v_mfma_f32_32x32x16_bf16 a[48:63], v[92:95], v[152:155], a[48:63]
ds_read_b64_tr_b16 v[124:125], v16 offset:40960
ds_read_b64_tr_b16 v[126:127], v16 offset:43008
s_add_u32 m0, s25, 36864
s_add_u32 s26, s24, 28672
buffer_load_dwordx4 v3, s[52:55], s26 offen lds
s_waitcnt lgkmcnt(14)
v_mfma_f32_32x32x16_bf16 a[64:79], v[96:99], v[152:155], a[64:79]
ds_read_b64_tr_b16 v[64:65], v17 offset:40960
ds_read_b64_tr_b16 v[66:67], v17 offset:43008
s_waitcnt lgkmcnt(14)
v_mfma_f32_32x32x16_bf16 a[80:95], v[100:103], v[152:155], a[80:95]
ds_read_b64_tr_b16 v[68:69], v18 offset:40960
ds_read_b64_tr_b16 v[70:71], v18 offset:43008
s_waitcnt lgkmcnt(14)
v_mfma_f32_32x32x16_bf16 a[96:111], v[104:107], v[152:155], a[96:111]
ds_read_b64_tr_b16 v[72:73], v12 offset:49152
ds_read_b64_tr_b16 v[74:75], v12 offset:51200
s_add_u32 m0, s25, 37888
s_add_u32 s26, s24, 35840
buffer_load_dwordx4 v4, s[52:55], s26 offen lds
s_waitcnt lgkmcnt(14)
v_mfma_f32_32x32x16_bf16 a[112:127], v[108:111], v[152:155], a[112:127]
ds_read_b64_tr_b16 v[76:77], v13 offset:49152
ds_read_b64_tr_b16 v[78:79], v13 offset:51200
s_waitcnt lgkmcnt(14)
v_mfma_f32_32x32x16_bf16 a[128:143], v[112:115], v[152:155], a[128:143]
ds_read_b64_tr_b16 v[80:81], v14 offset:49152
ds_read_b64_tr_b16 v[82:83], v14 offset:51200
s_waitcnt lgkmcnt(14)
v_mfma_f32_32x32x16_bf16 a[144:159], v[116:119], v[152:155], a[144:159]
ds_read_b64_tr_b16 v[84:85], v15 offset:49152
ds_read_b64_tr_b16 v[86:87], v15 offset:51200
s_add_u32 m0, s25, 38912
s_add_u32 s26, s24, 43008
buffer_load_dwordx4 v3, s[52:55], s26 offen lds
s_waitcnt lgkmcnt(14)
v_mfma_f32_32x32x16_bf16 a[160:175], v[120:123], v[152:155], a[160:175]
ds_read_b64_tr_b16 v[88:89], v16 offset:49152
ds_read_b64_tr_b16 v[90:91], v16 offset:51200
s_waitcnt lgkmcnt(14)
v_mfma_f32_32x32x16_bf16 a[176:191], v[124:127], v[152:155], a[176:191]
ds_read_b64_tr_b16 v[92:93], v17 offset:49152
ds_read_b64_tr_b16 v[94:95], v17 offset:51200
s_waitcnt lgkmcnt(14)
v_mfma_f32_32x32x16_bf16 a[192:207], v[64:67], v[152:155], a[192:207]
ds_read_b64_tr_b16 v[96:97], v18 offset:49152
ds_read_b64_tr_b16 v[98:99], v18 offset:51200
s_add_u32 m0, s25, 39936
s_add_u32 s26, s24, 50176
buffer_load_dwordx4 v4, s[52:55], s26 offen lds
s_add_u32 s24, s24, 114688
s_waitcnt lgkmcnt(14)
v_mfma_f32_32x32x16_bf16 a[208:223], v[68:71], v[152:155], a[208:223]
ds_read_b64_tr_b16 v[100:101], v12 offset:57344
ds_read_b64_tr_b16 v[102:103], v12 offset:59392
s_waitcnt lgkmcnt(14)
v_mfma_f32_32x32x16_bf16 a[0:15], v[72:75], v[156:159], a[0:15]
ds_read_b64_tr_b16 v[104:105], v13 offset:57344
ds_read_b64_tr_b16 v[106:107], v13 offset:59392
s_waitcnt lgkmcnt(14)
v_mfma_f32_32x32x16_bf16 a[16:31], v[76:79], v[156:159], a[16:31]
ds_read_b64_tr_b16 v[108:109], v14 offset:57344
ds_read_b64_tr_b16 v[110:111], v14 offset:59392
s_waitcnt lgkmcnt(14)
v_mfma_f32_32x32x16_bf16 a[32:47], v[80:83], v[156:159], a[32:47]
ds_read_b64_tr_b16 v[112:113], v15 offset:57344
ds_read_b64_tr_b16 v[114:115], v15 offset:59392
s_waitcnt lgkmcnt(14)
v_mfma_f32_32x32x16_bf16 a[48:63], v[84:87], v[156:159], a[48:63]
ds_read_b64_tr_b16 v[116:117], v16 offset:57344
ds_read_b64_tr_b16 v[118:119], v16 offset:59392
s_waitcnt lgkmcnt(14)
v_mfma_f32_32x32x16_bf16 a[64:79], v[88:91], v[156:159], a[64:79]
ds_read_b64_tr_b16 v[120:121], v17 offset:57344
ds_read_b64_tr_b16 v[122:123], v17 offset:59392
s_waitcnt lgkmcnt(14)
v_mfma_f32_32x32x16_bf16 a[80:95], v[92:95], v[156:159], a[80:95]
s_waitcnt vmcnt(8)
s_barrier
ds_read_b64_tr_b16 v[124:125], v18 offset:57344
ds_read_b64_tr_b16 v[126:127], v18 offset:59392
s_waitcnt lgkmcnt(14)
v_mfma_f32_32x32x16_bf16 a[96:111], v[96:99], v[156:159], a[96:111]
ds_read_b64_tr_b16 v[64:65], v5 offset:0
ds_read_b64_tr_b16 v[66:67], v5 offset:2048
s_waitcnt lgkmcnt(14)
v_mfma_f32_32x32x16_bf16 a[112:127], v[100:103], v[156:159], a[112:127]
ds_read_b64_tr_b16 v[68:69], v6 offset:0
ds_read_b64_tr_b16 v[70:71], v6 offset:2048
s_add_u32 m0, s25, 65536
s_add_u32 s26, s24, 0
buffer_load_dwordx4 v3, s[52:55], s26 offen lds
s_waitcnt lgkmcnt(14)
v_mfma_f32_32x32x16_bf16 a[128:143], v[104:107], v[156:159], a[128:143]
ds_read_b64_tr_b16 v[72:73], v7 offset:0
ds_read_b64_tr_b16 v[74:75], v7 offset:2048
s_waitcnt lgkmcnt(14)
v_mfma_f32_32x32x16_bf16 a[144:159], v[108:111], v[156:159], a[144:159]
ds_read_b64_tr_b16 v[76:77], v8 offset:0
ds_read_b64_tr_b16 v[78:79], v8 offset:2048
s_waitcnt lgkmcnt(14)
v_mfma_f32_32x32x16_bf16 a[160:175], v[112:115], v[156:159], a[160:175]
ds_read_b64_tr_b16 v[80:81], v9 offset:0
ds_read_b64_tr_b16 v[82:83], v9 offset:2048
s_add_u32 m0, s25, 66560
s_add_u32 s26, s24, 7168
buffer_load_dwordx4 v4, s[52:55], s26 offen lds
s_waitcnt lgkmcnt(14)
v_mfma_f32_32x32x16_bf16 a[176:191], v[116:119], v[156:159], a[176:191]
ds_read_b64_tr_b16 v[84:85], v10 offset:0
ds_read_b64_tr_b16 v[86:87], v10 offset:2048
s_waitcnt lgkmcnt(14)
v_mfma_f32_32x32x16_bf16 a[192:207], v[120:123], v[156:159], a[192:207]
ds_read_b64_tr_b16 v[88:89], v11 offset:0
ds_read_b64_tr_b16 v[90:91], v11 offset:2048
s_waitcnt lgkmcnt(14)
v_mfma_f32_32x32x16_bf16 a[208:223], v[124:127], v[156:159], a[208:223]
ds_read_b64_tr_b16 v[92:93], v5 offset:8192
ds_read_b64_tr_b16 v[94:95], v5 offset:10240
s_add_u32 m0, s25, 67584
s_add_u32 s26, s24, 14336
buffer_load_dwordx4 v3, s[52:55], s26 offen lds
s_waitcnt lgkmcnt(14)
v_mfma_f32_32x32x16_bf16 a[0:15], v[64:67], v[160:163], a[0:15]
ds_read_b64_tr_b16 v[96:97], v6 offset:8192
ds_read_b64_tr_b16 v[98:99], v6 offset:10240
s_waitcnt lgkmcnt(14)
v_mfma_f32_32x32x16_bf16 a[16:31], v[68:71], v[160:163], a[16:31]
ds_read_b64_tr_b16 v[100:101], v7 offset:8192
ds_read_b64_tr_b16 v[102:103], v7 offset:10240
s_waitcnt lgkmcnt(14)
v_mfma_f32_32x32x16_bf16 a[32:47], v[72:75], v[160:163], a[32:47]
ds_read_b64_tr_b16 v[104:105], v8 offset:8192
ds_read_b64_tr_b16 v[106:107], v8 offset:10240
s_add_u32 m0, s25, 68608
s_add_u32 s26, s24, 21504
buffer_load_dwordx4 v4, s[52:55], s26 offen lds
s_waitcnt lgkmcnt(14)
v_mfma_f32_32x32x16_bf16 a[48:63], v[76:79], v[160:163], a[48:63]
ds_read_b64_tr_b16 v[108:109], v9 offset:8192
ds_read_b64_tr_b16 v[110:111], v9 offset:10240
s_waitcnt lgkmcnt(14)
v_mfma_f32_32x32x16_bf16 a[64:79], v[80:83], v[160:163], a[64:79]
ds_read_b64_tr_b16 v[112:113], v10 offset:8192
ds_read_b64_tr_b16 v[114:115], v10 offset:10240
s_waitcnt lgkmcnt(14)
v_mfma_f32_32x32x16_bf16 a[80:95], v[84:87], v[160:163], a[80:95]
ds_read_b64_tr_b16 v[116:117], v11 offset:8192
ds_read_b64_tr_b16 v[118:119], v11 offset:10240
s_add_u32 m0, s25, 69632
s_add_u32 s26, s24, 28672
buffer_load_dwordx4 v3, s[52:55], s26 offen lds
s_waitcnt lgkmcnt(14)
v_mfma_f32_32x32x16_bf16 a[96:111], v[88:91], v[160:163], a[96:111]
ds_read_b64_tr_b16 v[120:121], v5 offset:16384
ds_read_b64_tr_b16 v[122:123], v5 offset:18432
s_waitcnt lgkmcnt(14)
v_mfma_f32_32x32x16_bf16 a[112:127], v[92:95], v[160:163], a[112:127]
ds_read_b64_tr_b16 v[124:125], v6 offset:16384
ds_read_b64_tr_b16 v[126:127], v6 offset:18432
s_waitcnt lgkmcnt(14)
v_mfma_f32_32x32x16_bf16 a[128:143], v[96:99], v[160:163], a[128:143]
ds_read_b64_tr_b16 v[64:65], v7 offset:16384
ds_read_b64_tr_b16 v[66:67], v7 offset:18432
s_add_u32 m0, s25, 70656
s_add_u32 s26, s24, 35840
buffer_load_dwordx4 v4, s[52:55], s26 offen lds
s_waitcnt lgkmcnt(14)
v_mfma_f32_32x32x16_bf16 a[144:159], v[100:103], v[160:163], a[144:159]
ds_read_b64_tr_b16 v[68:69], v8 offset:16384
ds_read_b64_tr_b16 v[70:71], v8 offset:18432
s_waitcnt lgkmcnt(14)
v_mfma_f32_32x32x16_bf16 a[160:175], v[104:107], v[160:163], a[160:175]
ds_read_b64_tr_b16 v[72:73], v9 offset:16384
ds_read_b64_tr_b16 v[74:75], v9 offset:18432
s_waitcnt lgkmcnt(14)
v_mfma_f32_32x32x16_bf16 a[176:191], v[108:111], v[160:163], a[176:191]
ds_read_b64_tr_b16 v[76:77], v10 offset:16384
ds_read_b64_tr_b16 v[78:79], v10 offset:18432
s_add_u32 m0, s25, 71680
s_add_u32 s26, s24, 43008
buffer_load_dwordx4 v3, s[52:55], s26 offen lds
s_waitcnt lgkmcnt(14)
v_mfma_f32_32x32x16_bf16 a[192:207], v[112:115], v[160:163], a[192:207]
ds_read_b64_tr_b16 v[80:81], v11 offset:16384
ds_read_b64_tr_b16 v[82:83], v11 offset:18432
s_waitcnt lgkmcnt(14)
v_mfma_f32_32x32x16_bf16 a[208:223], v[116:119], v[160:163], a[208:223]
ds_read_b64_tr_b16 v[84:85], v5 offset:24576
ds_read_b64_tr_b16 v[86:87], v5 offset:26624
s_waitcnt lgkmcnt(14)
v_mfma_f32_32x32x16_bf16 a[0:15], v[120:123], v[164:167], a[0:15]
ds_read_b64_tr_b16 v[88:89], v6 offset:24576
ds_read_b64_tr_b16 v[90:91], v6 offset:26624
s_add_u32 m0, s25, 72704
s_add_u32 s26, s24, 50176
buffer_load_dwordx4 v4, s[52:55], s26 offen lds
s_add_u32 s24, s24, 114688
s_waitcnt lgkmcnt(14)
v_mfma_f32_32x32x16_bf16 a[16:31], v[124:127], v[164:167], a[16:31]
ds_read_b64_tr_b16 v[92:93], v7 offset:24576
ds_read_b64_tr_b16 v[94:95], v7 offset:26624
s_waitcnt lgkmcnt(14)
v_mfma_f32_32x32x16_bf16 a[32:47], v[64:67], v[164:167], a[32:47]
ds_read_b64_tr_b16 v[96:97], v8 offset:24576
ds_read_b64_tr_b16 v[98:99], v8 offset:26624
s_waitcnt lgkmcnt(14)
v_mfma_f32_32x32x16_bf16 a[48:63], v[68:71], v[164:167], a[48:63]
ds_read_b64_tr_b16 v[100:101], v9 offset:24576
ds_read_b64_tr_b16 v[102:103], v9 offset:26624
s_waitcnt lgkmcnt(14)
v_mfma_f32_32x32x16_bf16 a[64:79], v[72:75], v[164:167], a[64:79]
ds_read_b64_tr_b16 v[104:105], v10 offset:24576
ds_read_b64_tr_b16 v[106:107], v10 offset:26624
s_waitcnt lgkmcnt(14)
v_mfma_f32_32x32x16_bf16 a[80:95], v[76:79], v[164:167], a[80:95]
s_waitcnt vmcnt(8)
s_barrier
ds_read_b64_tr_b16 v[108:109], v11 offset:24576
ds_read_b64_tr_b16 v[110:111], v11 offset:26624
s_waitcnt lgkmcnt(14)
v_mfma_f32_32x32x16_bf16 a[96:111], v[80:83], v[164:167], a[96:111]
ds_read_b64_tr_b16 v[112:113], v5 offset:32768
ds_read_b64_tr_b16 v[114:115], v5 offset:34816
s_add_u32 m0, s25, 98304
s_add_u32 s26, s24, 0
buffer_load_dwordx4 v3, s[52:55], s26 offen lds
s_waitcnt lgkmcnt(14)
v_mfma_f32_32x32x16_bf16 a[112:127], v[84:87], v[164:167], a[112:127]
ds_read_b64_tr_b16 v[116:117], v6 offset:32768
ds_read_b64_tr_b16 v[118:119], v6 offset:34816
s_waitcnt lgkmcnt(14)
v_mfma_f32_32x32x16_bf16 a[128:143], v[88:91], v[164:167], a[128:143]
ds_read_b64_tr_b16 v[120:121], v7 offset:32768
ds_read_b64_tr_b16 v[122:123], v7 offset:34816
s_waitcnt lgkmcnt(14)
v_mfma_f32_32x32x16_bf16 a[144:159], v[92:95], v[164:167], a[144:159]
ds_read_b64_tr_b16 v[124:125], v8 offset:32768
ds_read_b64_tr_b16 v[126:127], v8 offset:34816
s_add_u32 m0, s25, 99328
s_add_u32 s26, s24, 7168
buffer_load_dwordx4 v4, s[52:55], s26 offen lds
s_waitcnt lgkmcnt(14)
v_mfma_f32_32x32x16_bf16 a[160:175], v[96:99], v[164:167], a[160:175]
ds_read_b64_tr_b16 v[64:65], v9 offset:32768
ds_read_b64_tr_b16 v[66:67], v9 offset:34816
s_waitcnt lgkmcnt(14)
v_mfma_f32_32x32x16_bf16 a[176:191], v[100:103], v[164:167], a[176:191]
ds_read_b64_tr_b16 v[68:69], v10 offset:32768
ds_read_b64_tr_b16 v[70:71], v10 offset:34816
s_waitcnt lgkmcnt(14)
v_mfma_f32_32x32x16_bf16 a[192:207], v[104:107], v[164:167], a[192:207]
ds_read_b64_tr_b16 v[72:73], v11 offset:32768
ds_read_b64_tr_b16 v[74:75], v11 offset:34816
s_add_u32 m0, s25, 100352
s_add_u32 s26, s24, 14336
buffer_load_dwordx4 v3, s[52:55], s26 offen lds
s_waitcnt lgkmcnt(14)
v_mfma_f32_32x32x16_bf16 a[208:223], v[108:111], v[164:167], a[208:223]
ds_read_b64_tr_b16 v[76:77], v5 offset:40960
ds_read_b64_tr_b16 v[78:79], v5 offset:43008
s_waitcnt lgkmcnt(14)
v_mfma_f32_32x32x16_bf16 a[0:15], v[112:115], v[168:171], a[0:15]
ds_read_b64_tr_b16 v[80:81], v6 offset:40960
ds_read_b64_tr_b16 v[82:83], v6 offset:43008
s_waitcnt lgkmcnt(14)
v_mfma_f32_32x32x16_bf16 a[16:31], v[116:119], v[168:171], a[16:31]
ds_read_b64_tr_b16 v[84:85], v7 offset:40960
ds_read_b64_tr_b16 v[86:87], v7 offset:43008
s_add_u32 m0, s25, 101376
s_add_u32 s26, s24, 21504
buffer_load_dwordx4 v4, s[52:55], s26 offen lds
s_waitcnt lgkmcnt(14)
v_mfma_f32_32x32x16_bf16 a[32:47], v[120:123], v[168:171], a[32:47]
ds_read_b64_tr_b16 v[88:89], v8 offset:40960
ds_read_b64_tr_b16 v[90:91], v8 offset:43008
s_waitcnt lgkmcnt(14)
v_mfma_f32_32x32x16_bf16 a[48:63], v[124:127], v[168:171], a[48:63]
ds_read_b64_tr_b16 v[92:93], v9 offset:40960
ds_read_b64_tr_b16 v[94:95], v9 offset:43008
s_waitcnt lgkmcnt(14)
v_mfma_f32_32x32x16_bf16 a[64:79], v[64:67], v[168:171], a[64:79]
ds_read_b64_tr_b16 v[96:97], v10 offset:40960
ds_read_b64_tr_b16 v[98:99], v10 offset:43008
s_add_u32 m0, s25, 102400
s_add_u32 s26, s24, 28672
buffer_load_dwordx4 v3, s[52:55], s26 offen lds
s_waitcnt lgkmcnt(14)
v_mfma_f32_32x32x16_bf16 a[80:95], v[68:71], v[168:171], a[80:95]
ds_read_b64_tr_b16 v[100:101], v11 offset:40960
ds_read_b64_tr_b16 v[102:103], v11 offset:43008
s_waitcnt lgkmcnt(14)
v_mfma_f32_32x32x16_bf16 a[96:111], v[72:75], v[168:171], a[96:111]
ds_read_b64_tr_b16 v[104:105], v5 offset:49152
ds_read_b64_tr_b16 v[106:107], v5 offset:51200
s_waitcnt lgkmcnt(14)
v_mfma_f32_32x32x16_bf16 a[112:127], v[76:79], v[168:171], a[112:127]
ds_read_b64_tr_b16 v[108:109], v6 offset:49152
ds_read_b64_tr_b16 v[110:111], v6 offset:51200
s_add_u32 m0, s25, 103424
s_add_u32 s26, s24, 35840
buffer_load_dwordx4 v4, s[52:55], s26 offen lds
s_waitcnt lgkmcnt(14)
v_mfma_f32_32x32x16_bf16 a[128:143], v[80:83], v[168:171], a[128:143]
ds_read_b64_tr_b16 v[112:113], v7 offset:49152
ds_read_b64_tr_b16 v[114:115], v7 offset:51200
s_waitcnt lgkmcnt(14)
v_mfma_f32_32x32x16_bf16 a[144:159], v[84:87], v[168:171], a[144:159]
ds_read_b64_tr_b16 v[116:117], v8 offset:49152
ds_read_b64_tr_b16 v[118:119], v8 offset:51200
s_waitcnt lgkmcnt(14)
v_mfma_f32_32x32x16_bf16 a[160:175], v[88:91], v[168:171], a[160:175]
ds_read_b64_tr_b16 v[120:121], v9 offset:49152
ds_read_b64_tr_b16 v[122:123], v9 offset:51200
s_add_u32 m0, s25, 104448
s_add_u32 s26, s24, 43008
buffer_load_dwordx4 v3, s[52:55], s26 offen lds
s_waitcnt lgkmcnt(14)
v_mfma_f32_32x32x16_bf16 a[176:191], v[92:95], v[168:171], a[176:191]
ds_read_b64_tr_b16 v[124:125], v10 offset:49152
ds_read_b64_tr_b16 v[126:127], v10 offset:51200
s_waitcnt lgkmcnt(14)
v_mfma_f32_32x32x16_bf16 a[192:207], v[96:99], v[168:171], a[192:207]
ds_read_b64_tr_b16 v[64:65], v11 offset:49152
ds_read_b64_tr_b16 v[66:67], v11 offset:51200
s_waitcnt lgkmcnt(14)
v_mfma_f32_32x32x16_bf16 a[208:223], v[100:103], v[168:171], a[208:223]
ds_read_b64_tr_b16 v[68:69], v5 offset:57344
ds_read_b64_tr_b16 v[70:71], v5 offset:59392
s_add_u32 m0, s25, 105472
s_add_u32 s26, s24, 50176
buffer_load_dwordx4 v4, s[52:55], s26 offen lds
s_add_u32 s24, s24, 114688
s_waitcnt lgkmcnt(14)
v_mfma_f32_32x32x16_bf16 a[0:15], v[104:107], v[172:175], a[0:15]
ds_read_b64_tr_b16 v[72:73], v6 offset:57344
ds_read_b64_tr_b16 v[74:75], v6 offset:59392
s_waitcnt lgkmcnt(14)
v_mfma_f32_32x32x16_bf16 a[16:31], v[108:111], v[172:175], a[16:31]
ds_read_b64_tr_b16 v[76:77], v7 offset:57344
ds_read_b64_tr_b16 v[78:79], v7 offset:59392
s_waitcnt lgkmcnt(14)
v_mfma_f32_32x32x16_bf16 a[32:47], v[112:115], v[172:175], a[32:47]
ds_read_b64_tr_b16 v[80:81], v8 offset:57344
ds_read_b64_tr_b16 v[82:83], v8 offset:59392
s_waitcnt lgkmcnt(14)
v_mfma_f32_32x32x16_bf16 a[48:63], v[116:119], v[172:175], a[48:63]
ds_read_b64_tr_b16 v[84:85], v9 offset:57344
ds_read_b64_tr_b16 v[86:87], v9 offset:59392
s_waitcnt lgkmcnt(14)
v_mfma_f32_32x32x16_bf16 a[64:79], v[120:123], v[172:175], a[64:79]
ds_read_b64_tr_b16 v[88:89], v10 offset:57344
ds_read_b64_tr_b16 v[90:91], v10 offset:59392
s_waitcnt lgkmcnt(14)
v_mfma_f32_32x32x16_bf16 a[80:95], v[124:127], v[172:175], a[80:95]
s_waitcnt vmcnt(8)
s_barrier
ds_read_b64_tr_b16 v[92:93], v11 offset:57344
ds_read_b64_tr_b16 v[94:95], v11 offset:59392
s_add_u32 m0, s25, 0
s_add_u32 s26, s24, 0
buffer_load_dwordx4 v3, s[52:55], s26 offen lds
s_waitcnt lgkmcnt(14)
v_mfma_f32_32x32x16_bf16 a[96:111], v[64:67], v[172:175], a[96:111]
ds_read_b64_tr_b16 v[96:97], v12 offset:0
ds_read_b64_tr_b16 v[98:99], v12 offset:2048
s_waitcnt lgkmcnt(14)
v_mfma_f32_32x32x16_bf16 a[112:127], v[68:71], v[172:175], a[112:127]
ds_read_b64_tr_b16 v[100:101], v13 offset:0
ds_read_b64_tr_b16 v[102:103], v13 offset:2048
s_waitcnt lgkmcnt(14)
v_mfma_f32_32x32x16_bf16 a[128:143], v[72:75], v[172:175], a[128:143]
ds_read_b64_tr_b16 v[104:105], v14 offset:0
ds_read_b64_tr_b16 v[106:107], v14 offset:2048
s_add_u32 m0, s25, 1024
s_add_u32 s26, s24, 7168
buffer_load_dwordx4 v4, s[52:55], s26 offen lds
s_waitcnt lgkmcnt(14)
v_mfma_f32_32x32x16_bf16 a[144:159], v[76:79], v[172:175], a[144:159]
ds_read_b64_tr_b16 v[108:109], v15 offset:0
ds_read_b64_tr_b16 v[110:111], v15 offset:2048
s_waitcnt lgkmcnt(14)
v_mfma_f32_32x32x16_bf16 a[160:175], v[80:83], v[172:175], a[160:175]
ds_read_b64_tr_b16 v[112:113], v16 offset:0
ds_read_b64_tr_b16 v[114:115], v16 offset:2048
s_waitcnt lgkmcnt(14)
v_mfma_f32_32x32x16_bf16 a[176:191], v[84:87], v[172:175], a[176:191]
ds_read_b64_tr_b16 v[116:117], v17 offset:0
ds_read_b64_tr_b16 v[118:119], v17 offset:2048
s_add_u32 m0, s25, 2048
s_add_u32 s26, s24, 14336
buffer_load_dwordx4 v3, s[52:55], s26 offen lds
s_waitcnt lgkmcnt(14)
v_mfma_f32_32x32x16_bf16 a[192:207], v[88:91], v[172:175], a[192:207]
ds_read_b64_tr_b16 v[120:121], v18 offset:0
ds_read_b64_tr_b16 v[122:123], v18 offset:2048
s_waitcnt lgkmcnt(14)
v_mfma_f32_32x32x16_bf16 a[208:223], v[92:95], v[172:175], a[208:223]
ds_read_b64_tr_b16 v[124:125], v12 offset:8192
ds_read_b64_tr_b16 v[126:127], v12 offset:10240
s_waitcnt lgkmcnt(14)
v_mfma_f32_32x32x16_bf16 a[0:15], v[96:99], v[176:179], a[0:15]
ds_read_b64_tr_b16 v[64:65], v13 offset:8192
ds_read_b64_tr_b16 v[66:67], v13 offset:10240
s_add_u32 m0, s25, 3072
s_add_u32 s26, s24, 21504
buffer_load_dwordx4 v4, s[52:55], s26 offen lds
s_waitcnt lgkmcnt(14)
v_mfma_f32_32x32x16_bf16 a[16:31], v[100:103], v[176:179], a[16:31]
ds_read_b64_tr_b16 v[68:69], v14 offset:8192
ds_read_b64_tr_b16 v[70:71], v14 offset:10240
s_waitcnt lgkmcnt(14)
v_mfma_f32_32x32x16_bf16 a[32:47], v[104:107], v[176:179], a[32:47]
ds_read_b64_tr_b16 v[72:73], v15 offset:8192
ds_read_b64_tr_b16 v[74:75], v15 offset:10240
s_waitcnt lgkmcnt(14)
v_mfma_f32_32x32x16_bf16 a[48:63], v[108:111], v[176:179], a[48:63]
ds_read_b64_tr_b16 v[76:77], v16 offset:8192
ds_read_b64_tr_b16 v[78:79], v16 offset:10240
s_add_u32 m0, s25, 4096
s_add_u32 s26, s24, 28672
buffer_load_dwordx4 v3, s[52:55], s26 offen lds
s_waitcnt lgkmcnt(14)
v_mfma_f32_32x32x16_bf16 a[64:79], v[112:115], v[176:179], a[64:79]
ds_read_b64_tr_b16 v[80:81], v17 offset:8192
ds_read_b64_tr_b16 v[82:83], v17 offset:10240
s_waitcnt lgkmcnt(14)
v_mfma_f32_32x32x16_bf16 a[80:95], v[116:119], v[176:179], a[80:95]
ds_read_b64_tr_b16 v[84:85], v18 offset:8192
ds_read_b64_tr_b16 v[86:87], v18 offset:10240
s_waitcnt lgkmcnt(14)
v_mfma_f32_32x32x16_bf16 a[96:111], v[120:123], v[176:179], a[96:111]
ds_read_b64_tr_b16 v[88:89], v12 offset:16384
ds_read_b64_tr_b16 v[90:91], v12 offset:18432
s_add_u32 m0, s25, 5120
s_add_u32 s26, s24, 35840
buffer_load_dwordx4 v4, s[52:55], s26 offen lds
s_waitcnt lgkmcnt(14)
v_mfma_f32_32x32x16_bf16 a[112:127], v[124:127], v[176:179], a[112:127]
ds_read_b64_tr_b16 v[92:93], v13 offset:16384
ds_read_b64_tr_b16 v[94:95], v13 offset:18432
s_waitcnt lgkmcnt(14)
v_mfma_f32_32x32x16_bf16 a[128:143], v[64:67], v[176:179], a[128:143]
ds_read_b64_tr_b16 v[96:97], v14 offset:16384
ds_read_b64_tr_b16 v[98:99], v14 offset:18432
s_waitcnt lgkmcnt(14)
v_mfma_f32_32x32x16_bf16 a[144:159], v[68:71], v[176:179], a[144:159]
ds_read_b64_tr_b16 v[100:101], v15 offset:16384
ds_read_b64_tr_b16 v[102:103], v15 offset:18432
s_add_u32 m0, s25, 6144
s_add_u32 s26, s24, 43008
buffer_load_dwordx4 v3, s[52:55], s26 offen lds
s_waitcnt lgkmcnt(14)
v_mfma_f32_32x32x16_bf16 a[160:175], v[72:75], v[176:179], a[160:175]
ds_read_b64_tr_b16 v[104:105], v16 offset:16384
ds_read_b64_tr_b16 v[106:107], v16 offset:18432
s_waitcnt lgkmcnt(14)
v_mfma_f32_32x32x16_bf16 a[176:191], v[76:79], v[176:179], a[176:191]
ds_read_b64_tr_b16 v[108:109], v17 offset:16384
ds_read_b64_tr_b16 v[110:111], v17 offset:18432
s_waitcnt lgkmcnt(14)
v_mfma_f32_32x32x16_bf16 a[192:207], v[80:83], v[176:179], a[192:207]
ds_read_b64_tr_b16 v[112:113], v18 offset:16384
ds_read_b64_tr_b16 v[114:115], v18 offset:18432
s_add_u32 m0, s25, 7168
s_add_u32 s26, s24, 50176
buffer_load_dwordx4 v4, s[52:55], s26 offen lds
s_add_u32 s24, s24, 114688
s_waitcnt lgkmcnt(14)
v_mfma_f32_32x32x16_bf16 a[208:223], v[84:87], v[176:179], a[208:223]
ds_read_b64_tr_b16 v[116:117], v12 offset:24576
ds_read_b64_tr_b16 v[118:119], v12 offset:26624
s_waitcnt lgkmcnt(14)
v_mfma_f32_32x32x16_bf16 a[0:15], v[88:91], v[180:183], a[0:15]
ds_read_b64_tr_b16 v[120:121], v13 offset:24576
ds_read_b64_tr_b16 v[122:123], v13 offset:26624
s_waitcnt lgkmcnt(14)
v_mfma_f32_32x32x16_bf16 a[16:31], v[92:95], v[180:183], a[16:31]
ds_read_b64_tr_b16 v[124:125], v14 offset:24576
ds_read_b64_tr_b16 v[126:127], v14 offset:26624
s_waitcnt lgkmcnt(14)
v_mfma_f32_32x32x16_bf16 a[32:47], v[96:99], v[180:183], a[32:47]
ds_read_b64_tr_b16 v[64:65], v15 offset:24576
ds_read_b64_tr_b16 v[66:67], v15 offset:26624
s_waitcnt lgkmcnt(14)
v_mfma_f32_32x32x16_bf16 a[48:63], v[100:103], v[180:183], a[48:63]
ds_read_b64_tr_b16 v[68:69], v16 offset:24576
ds_read_b64_tr_b16 v[70:71], v16 offset:26624
s_waitcnt lgkmcnt(14)
v_mfma_f32_32x32x16_bf16 a[64:79], v[104:107], v[180:183], a[64:79]
ds_read_b64_tr_b16 v[72:73], v17 offset:24576
ds_read_b64_tr_b16 v[74:75], v17 offset:26624
s_waitcnt lgkmcnt(14)
v_mfma_f32_32x32x16_bf16 a[80:95], v[108:111], v[180:183], a[80:95]
s_waitcnt vmcnt(8)
s_barrier
ds_read_b64_tr_b16 v[76:77], v18 offset:24576
ds_read_b64_tr_b16 v[78:79], v18 offset:26624
s_waitcnt lgkmcnt(14)
v_mfma_f32_32x32x16_bf16 a[96:111], v[112:115], v[180:183], a[96:111]
ds_read_b64_tr_b16 v[80:81], v12 offset:32768
ds_read_b64_tr_b16 v[82:83], v12 offset:34816
s_waitcnt lgkmcnt(14)
v_mfma_f32_32x32x16_bf16 a[112:127], v[116:119], v[180:183], a[112:127]
ds_read_b64_tr_b16 v[84:85], v13 offset:32768
ds_read_b64_tr_b16 v[86:87], v13 offset:34816
s_add_u32 m0, s25, 32768
s_add_u32 s26, s24, 0
buffer_load_dwordx4 v3, s[52:55], s26 offen lds
s_waitcnt lgkmcnt(14)
v_mfma_f32_32x32x16_bf16 a[128:143], v[120:123], v[180:183], a[128:143]
ds_read_b64_tr_b16 v[88:89], v14 offset:32768
ds_read_b64_tr_b16 v[90:91], v14 offset:34816
s_waitcnt lgkmcnt(14)
v_mfma_f32_32x32x16_bf16 a[144:159], v[124:127], v[180:183], a[144:159]
ds_read_b64_tr_b16 v[92:93], v15 offset:32768
ds_read_b64_tr_b16 v[94:95], v15 offset:34816
s_waitcnt lgkmcnt(14)
v_mfma_f32_32x32x16_bf16 a[160:175], v[64:67], v[180:183], a[160:175]
ds_read_b64_tr_b16 v[96:97], v16 offset:32768
ds_read_b64_tr_b16 v[98:99], v16 offset:34816
s_add_u32 m0, s25, 33792
s_add_u32 s26, s24, 7168
buffer_load_dwordx4 v4, s[52:55], s26 offen lds
s_waitcnt lgkmcnt(14)
v_mfma_f32_32x32x16_bf16 a[176:191], v[68:71], v[180:183], a[176:191]
ds_read_b64_tr_b16 v[100:101], v17 offset:32768
ds_read_b64_tr_b16 v[102:103], v17 offset:34816
s_waitcnt lgkmcnt(14)
v_mfma_f32_32x32x16_bf16 a[192:207], v[72:75], v[180:183], a[192:207]
ds_read_b64_tr_b16 v[104:105], v18 offset:32768
ds_read_b64_tr_b16 v[106:107], v18 offset:34816
s_waitcnt lgkmcnt(14)
v_mfma_f32_32x32x16_bf16 a[208:223], v[76:79], v[180:183], a[208:223]
ds_read_b64_tr_b16 v[108:109], v12 offset:40960
ds_read_b64_tr_b16 v[110:111], v12 offset:43008
s_add_u32 m0, s25, 34816
s_add_u32 s26, s24, 14336
buffer_load_dwordx4 v3, s[52:55], s26 offen lds
s_waitcnt lgkmcnt(14)
v_mfma_f32_32x32x16_bf16 a[0:15], v[80:83], v[184:187], a[0:15]
ds_read_b64_tr_b16 v[112:113], v13 offset:40960
ds_read_b64_tr_b16 v[114:115], v13 offset:43008
s_waitcnt lgkmcnt(14)
v_mfma_f32_32x32x16_bf16 a[16:31], v[84:87], v[184:187], a[16:31]
ds_read_b64_tr_b16 v[116:117], v14 offset:40960
ds_read_b64_tr_b16 v[118:119], v14 offset:43008
s_waitcnt lgkmcnt(14)
v_mfma_f32_32x32x16_bf16 a[32:47], v[88:91], v[184:187], a[32:47]
ds_read_b64_tr_b16 v[120:121], v15 offset:40960
ds_read_b64_tr_b16 v[122:123], v15 offset:43008
s_add_u32 m0, s25, 35840
s_add_u32 s26, s24, 21504
buffer_load_dwordx4 v4, s[52:55], s26 offen lds
s_waitcnt lgkmcnt(14)
v_mfma_f32_32x32x16_bf16 a[48:63], v[92:95], v[184:187], a[48:63]
ds_read_b64_tr_b16 v[124:125], v16 offset:40960
ds_read_b64_tr_b16 v[126:127], v16 offset:43008
s_waitcnt lgkmcnt(14)
v_mfma_f32_32x32x16_bf16 a[64:79], v[96:99], v[184:187], a[64:79]
ds_read_b64_tr_b16 v[64:65], v17 offset:40960
ds_read_b64_tr_b16 v[66:67], v17 offset:43008
s_waitcnt lgkmcnt(14)
v_mfma_f32_32x32x16_bf16 a[80:95], v[100:103], v[184:187], a[80:95]
ds_read_b64_tr_b16 v[68:69], v18 offset:40960
ds_read_b64_tr_b16 v[70:71], v18 offset:43008
s_add_u32 m0, s25, 36864
s_add_u32 s26, s24, 28672
buffer_load_dwordx4 v3, s[52:55], s26 offen lds
s_waitcnt lgkmcnt(14)
v_mfma_f32_32x32x16_bf16 a[96:111], v[104:107], v[184:187], a[96:111]
ds_read_b64_tr_b16 v[72:73], v12 offset:49152
ds_read_b64_tr_b16 v[74:75], v12 offset:51200
s_waitcnt lgkmcnt(14)
v_mfma_f32_32x32x16_bf16 a[112:127], v[108:111], v[184:187], a[112:127]
ds_read_b64_tr_b16 v[76:77], v13 offset:49152
ds_read_b64_tr_b16 v[78:79], v13 offset:51200
s_waitcnt lgkmcnt(14)
v_mfma_f32_32x32x16_bf16 a[128:143], v[112:115], v[184:187], a[128:143]
ds_read_b64_tr_b16 v[80:81], v14 offset:49152
ds_read_b64_tr_b16 v[82:83], v14 offset:51200
s_add_u32 m0, s25, 37888
s_add_u32 s26, s24, 35840
buffer_load_dwordx4 v4, s[52:55], s26 offen lds
s_waitcnt lgkmcnt(14)
v_mfma_f32_32x32x16_bf16 a[144:159], v[116:119], v[184:187], a[144:159]
ds_read_b64_tr_b16 v[84:85], v15 offset:49152
ds_read_b64_tr_b16 v[86:87], v15 offset:51200
s_waitcnt lgkmcnt(14)
v_mfma_f32_32x32x16_bf16 a[160:175], v[120:123], v[184:187], a[160:175]
ds_read_b64_tr_b16 v[88:89], v16 offset:49152
ds_read_b64_tr_b16 v[90:91], v16 offset:51200
s_waitcnt lgkmcnt(14)
v_mfma_f32_32x32x16_bf16 a[176:191], v[124:127], v[184:187], a[176:191]
ds_read_b64_tr_b16 v[92:93], v17 offset:49152
ds_read_b64_tr_b16 v[94:95], v17 offset:51200
s_add_u32 m0, s25, 38912
s_add_u32 s26, s24, 43008
buffer_load_dwordx4 v3, s[52:55], s26 offen lds
s_waitcnt lgkmcnt(14)
v_mfma_f32_32x32x16_bf16 a[192:207], v[64:67], v[184:187], a[192:207]
ds_read_b64_tr_b16 v[96:97], v18 offset:49152
ds_read_b64_tr_b16 v[98:99], v18 offset:51200
s_waitcnt lgkmcnt(14)
v_mfma_f32_32x32x16_bf16 a[208:223], v[68:71], v[184:187], a[208:223]
ds_read_b64_tr_b16 v[100:101], v12 offset:57344
ds_read_b64_tr_b16 v[102:103], v12 offset:59392
s_waitcnt lgkmcnt(14)
v_mfma_f32_32x32x16_bf16 a[0:15], v[72:75], v[188:191], a[0:15]
ds_read_b64_tr_b16 v[104:105], v13 offset:57344
ds_read_b64_tr_b16 v[106:107], v13 offset:59392
s_add_u32 m0, s25, 39936
s_add_u32 s26, s24, 50176
buffer_load_dwordx4 v4, s[52:55], s26 offen lds
s_add_u32 s24, s24, 114688
s_waitcnt lgkmcnt(14)
v_mfma_f32_32x32x16_bf16 a[16:31], v[76:79], v[188:191], a[16:31]
ds_read_b64_tr_b16 v[108:109], v14 offset:57344
ds_read_b64_tr_b16 v[110:111], v14 offset:59392
s_waitcnt lgkmcnt(14)
v_mfma_f32_32x32x16_bf16 a[32:47], v[80:83], v[188:191], a[32:47]
ds_read_b64_tr_b16 v[112:113], v15 offset:57344
ds_read_b64_tr_b16 v[114:115], v15 offset:59392
s_waitcnt lgkmcnt(14)
v_mfma_f32_32x32x16_bf16 a[48:63], v[84:87], v[188:191], a[48:63]
ds_read_b64_tr_b16 v[116:117], v16 offset:57344
ds_read_b64_tr_b16 v[118:119], v16 offset:59392
s_waitcnt lgkmcnt(14)
v_mfma_f32_32x32x16_bf16 a[64:79], v[88:91], v[188:191], a[64:79]
ds_read_b64_tr_b16 v[120:121], v17 offset:57344
ds_read_b64_tr_b16 v[122:123], v17 offset:59392
s_waitcnt lgkmcnt(14)
v_mfma_f32_32x32x16_bf16 a[80:95], v[92:95], v[188:191], a[80:95]
s_waitcnt vmcnt(8)
s_barrier
ds_read_b64_tr_b16 v[124:125], v18 offset:57344
ds_read_b64_tr_b16 v[126:127], v18 offset:59392
s_waitcnt lgkmcnt(14)
v_mfma_f32_32x32x16_bf16 a[96:111], v[96:99], v[188:191], a[96:111]
ds_read_b64_tr_b16 v[64:65], v5 offset:0
ds_read_b64_tr_b16 v[66:67], v5 offset:2048
s_add_u32 m0, s25, 65536
s_add_u32 s26, s24, 0
buffer_load_dwordx4 v3, s[52:55], s26 offen lds
s_waitcnt lgkmcnt(14)
v_mfma_f32_32x32x16_bf16 a[112:127], v[100:103], v[188:191], a[112:127]
ds_read_b64_tr_b16 v[68:69], v6 offset:0
ds_read_b64_tr_b16 v[70:71], v6 offset:2048
s_waitcnt lgkmcnt(14)
v_mfma_f32_32x32x16_bf16 a[128:143], v[104:107], v[188:191], a[128:143]
ds_read_b64_tr_b16 v[72:73], v7 offset:0
ds_read_b64_tr_b16 v[74:75], v7 offset:2048
s_waitcnt lgkmcnt(14)
v_mfma_f32_32x32x16_bf16 a[144:159], v[108:111], v[188:191], a[144:159]
ds_read_b64_tr_b16 v[76:77], v8 offset:0
ds_read_b64_tr_b16 v[78:79], v8 offset:2048
s_add_u32 m0, s25, 66560
s_add_u32 s26, s24, 7168
buffer_load_dwordx4 v4, s[52:55], s26 offen lds
s_waitcnt lgkmcnt(14)
v_mfma_f32_32x32x16_bf16 a[160:175], v[112:115], v[188:191], a[160:175]
ds_read_b64_tr_b16 v[80:81], v9 offset:0
ds_read_b64_tr_b16 v[82:83], v9 offset:2048
s_waitcnt lgkmcnt(14)
v_mfma_f32_32x32x16_bf16 a[176:191], v[116:119], v[188:191], a[176:191]
ds_read_b64_tr_b16 v[84:85], v10 offset:0
ds_read_b64_tr_b16 v[86:87], v10 offset:2048
s_waitcnt lgkmcnt(14)
v_mfma_f32_32x32x16_bf16 a[192:207], v[120:123], v[188:191], a[192:207]
ds_read_b64_tr_b16 v[88:89], v11 offset:0
ds_read_b64_tr_b16 v[90:91], v11 offset:2048
s_add_u32 m0, s25, 67584
s_add_u32 s26, s24, 14336
buffer_load_dwordx4 v3, s[52:55], s26 offen lds
s_waitcnt lgkmcnt(14)
v_mfma_f32_32x32x16_bf16 a[208:223], v[124:127], v[188:191], a[208:223]
ds_read_b64_tr_b16 v[92:93], v5 offset:8192
ds_read_b64_tr_b16 v[94:95], v5 offset:10240
s_waitcnt lgkmcnt(14)
v_mfma_f32_32x32x16_bf16 a[0:15], v[64:67], v[192:195], a[0:15]
ds_read_b64_tr_b16 v[96:97], v6 offset:8192
ds_read_b64_tr_b16 v[98:99], v6 offset:10240
s_waitcnt lgkmcnt(14)
v_mfma_f32_32x32x16_bf16 a[16:31], v[68:71], v[192:195], a[16:31]
ds_read_b64_tr_b16 v[100:101], v7 offset:8192
ds_read_b64_tr_b16 v[102:103], v7 offset:10240
s_add_u32 m0, s25, 68608
s_add_u32 s26, s24, 21504
buffer_load_dwordx4 v4, s[52:55], s26 offen lds
s_waitcnt lgkmcnt(14)
v_mfma_f32_32x32x16_bf16 a[32:47], v[72:75], v[192:195], a[32:47]
ds_read_b64_tr_b16 v[104:105], v8 offset:8192
ds_read_b64_tr_b16 v[106:107], v8 offset:10240
s_waitcnt lgkmcnt(14)
v_mfma_f32_32x32x16_bf16 a[48:63], v[76:79], v[192:195], a[48:63]
ds_read_b64_tr_b16 v[108:109], v9 offset:8192
ds_read_b64_tr_b16 v[110:111], v9 offset:10240
s_waitcnt lgkmcnt(14)
v_mfma_f32_32x32x16_bf16 a[64:79], v[80:83], v[192:195], a[64:79]
ds_read_b64_tr_b16 v[112:113], v10 offset:8192
ds_read_b64_tr_b16 v[114:115], v10 offset:10240
s_add_u32 m0, s25, 69632
s_add_u32 s26, s24, 28672
buffer_load_dwordx4 v3, s[52:55], s26 offen lds
s_waitcnt lgkmcnt(14)
v_mfma_f32_32x32x16_bf16 a[80:95], v[84:87], v[192:195], a[80:95]
ds_read_b64_tr_b16 v[116:117], v11 offset:8192
ds_read_b64_tr_b16 v[118:119], v11 offset:10240
s_waitcnt lgkmcnt(14)
v_mfma_f32_32x32x16_bf16 a[96:111], v[88:91], v[192:195], a[96:111]
ds_read_b64_tr_b16 v[120:121], v5 offset:16384
ds_read_b64_tr_b16 v[122:123], v5 offset:18432
s_waitcnt lgkmcnt(14)
v_mfma_f32_32x32x16_bf16 a[112:127], v[92:95], v[192:195], a[112:127]
ds_read_b64_tr_b16 v[124:125], v6 offset:16384
ds_read_b64_tr_b16 v[126:127], v6 offset:18432
s_add_u32 m0, s25, 70656
s_add_u32 s26, s24, 35840
buffer_load_dwordx4 v4, s[52:55], s26 offen lds
s_waitcnt lgkmcnt(14)
v_mfma_f32_32x32x16_bf16 a[128:143], v[96:99], v[192:195], a[128:143]
ds_read_b64_tr_b16 v[64:65], v7 offset:16384
ds_read_b64_tr_b16 v[66:67], v7 offset:18432
s_waitcnt lgkmcnt(14)
v_mfma_f32_32x32x16_bf16 a[144:159], v[100:103], v[192:195], a[144:159]
ds_read_b64_tr_b16 v[68:69], v8 offset:16384
ds_read_b64_tr_b16 v[70:71], v8 offset:18432
s_waitcnt lgkmcnt(14)
v_mfma_f32_32x32x16_bf16 a[160:175], v[104:107], v[192:195], a[160:175]
ds_read_b64_tr_b16 v[72:73], v9 offset:16384
ds_read_b64_tr_b16 v[74:75], v9 offset:18432
s_add_u32 m0, s25, 71680
s_add_u32 s26, s24, 43008
buffer_load_dwordx4 v3, s[52:55], s26 offen lds
s_waitcnt lgkmcnt(14)
v_mfma_f32_32x32x16_bf16 a[176:191], v[108:111], v[192:195], a[176:191]
ds_read_b64_tr_b16 v[76:77], v10 offset:16384
ds_read_b64_tr_b16 v[78:79], v10 offset:18432
s_waitcnt lgkmcnt(14)
v_mfma_f32_32x32x16_bf16 a[192:207], v[112:115], v[192:195], a[192:207]
ds_read_b64_tr_b16 v[80:81], v11 offset:16384
ds_read_b64_tr_b16 v[82:83], v11 offset:18432
s_waitcnt lgkmcnt(14)
v_mfma_f32_32x32x16_bf16 a[208:223], v[116:119], v[192:195], a[208:223]
ds_read_b64_tr_b16 v[84:85], v5 offset:24576
ds_read_b64_tr_b16 v[86:87], v5 offset:26624
s_add_u32 m0, s25, 72704
s_add_u32 s26, s24, 50176
buffer_load_dwordx4 v4, s[52:55], s26 offen lds
s_add_u32 s24, s24, 114688
s_waitcnt lgkmcnt(14)
v_mfma_f32_32x32x16_bf16 a[0:15], v[120:123], v[196:199], a[0:15]
ds_read_b64_tr_b16 v[88:89], v6 offset:24576
ds_read_b64_tr_b16 v[90:91], v6 offset:26624
s_waitcnt lgkmcnt(14)
v_mfma_f32_32x32x16_bf16 a[16:31], v[124:127], v[196:199], a[16:31]
ds_read_b64_tr_b16 v[92:93], v7 offset:24576
ds_read_b64_tr_b16 v[94:95], v7 offset:26624
s_waitcnt lgkmcnt(14)
v_mfma_f32_32x32x16_bf16 a[32:47], v[64:67], v[196:199], a[32:47]
ds_read_b64_tr_b16 v[96:97], v8 offset:24576
ds_read_b64_tr_b16 v[98:99], v8 offset:26624
s_waitcnt lgkmcnt(14)
v_mfma_f32_32x32x16_bf16 a[48:63], v[68:71], v[196:199], a[48:63]
ds_read_b64_tr_b16 v[100:101], v9 offset:24576
ds_read_b64_tr_b16 v[102:103], v9 offset:26624
s_waitcnt lgkmcnt(14)
v_mfma_f32_32x32x16_bf16 a[64:79], v[72:75], v[196:199], a[64:79]
ds_read_b64_tr_b16 v[104:105], v10 offset:24576
ds_read_b64_tr_b16 v[106:107], v10 offset:26624
s_waitcnt lgkmcnt(14)
v_mfma_f32_32x32x16_bf16 a[80:95], v[76:79], v[196:199], a[80:95]
s_waitcnt vmcnt(8)
s_barrier
ds_read_b64_tr_b16 v[108:109], v11 offset:24576
ds_read_b64_tr_b16 v[110:111], v11 offset:26624
s_add_u32 m0, s25, 98304
s_add_u32 s26, s24, 0
buffer_load_dwordx4 v3, s[52:55], s26 offen lds
s_waitcnt lgkmcnt(14)
v_mfma_f32_32x32x16_bf16 a[96:111], v[80:83], v[196:199], a[96:111]
ds_read_b64_tr_b16 v[112:113], v5 offset:32768
ds_read_b64_tr_b16 v[114:115], v5 offset:34816
s_waitcnt lgkmcnt(14)
v_mfma_f32_32x32x16_bf16 a[112:127], v[84:87], v[196:199], a[112:127]
ds_read_b64_tr_b16 v[116:117], v6 offset:32768
ds_read_b64_tr_b16 v[118:119], v6 offset:34816
s_waitcnt lgkmcnt(14)
v_mfma_f32_32x32x16_bf16 a[128:143], v[88:91], v[196:199], a[128:143]
ds_read_b64_tr_b16 v[120:121], v7 offset:32768
ds_read_b64_tr_b16 v[122:123], v7 offset:34816
s_add_u32 m0, s25, 99328
s_add_u32 s26, s24, 7168
buffer_load_dwordx4 v4, s[52:55], s26 offen lds
s_waitcnt lgkmcnt(14)
v_mfma_f32_32x32x16_bf16 a[144:159], v[92:95], v[196:199], a[144:159]
ds_read_b64_tr_b16 v[124:125], v8 offset:32768
ds_read_b64_tr_b16 v[126:127], v8 offset:34816
s_waitcnt lgkmcnt(14)
v_mfma_f32_32x32x16_bf16 a[160:175], v[96:99], v[196:199], a[160:175]
ds_read_b64_tr_b16 v[64:65], v9 offset:32768
ds_read_b64_tr_b16 v[66:67], v9 offset:34816
s_waitcnt lgkmcnt(14)
v_mfma_f32_32x32x16_bf16 a[176:191], v[100:103], v[196:199], a[176:191]
ds_read_b64_tr_b16 v[68:69], v10 offset:32768
ds_read_b64_tr_b16 v[70:71], v10 offset:34816
s_add_u32 m0, s25, 100352
s_add_u32 s26, s24, 14336
buffer_load_dwordx4 v3, s[52:55], s26 offen lds
s_waitcnt lgkmcnt(14)
v_mfma_f32_32x32x16_bf16 a[192:207], v[104:107], v[196:199], a[192:207]
ds_read_b64_tr_b16 v[72:73], v11 offset:32768
ds_read_b64_tr_b16 v[74:75], v11 offset:34816
s_waitcnt lgkmcnt(14)
v_mfma_f32_32x32x16_bf16 a[208:223], v[108:111], v[196:199], a[208:223]
ds_read_b64_tr_b16 v[76:77], v5 offset:40960
ds_read_b64_tr_b16 v[78:79], v5 offset:43008
s_waitcnt lgkmcnt(14)
v_mfma_f32_32x32x16_bf16 a[0:15], v[112:115], v[200:203], a[0:15]
ds_read_b64_tr_b16 v[80:81], v6 offset:40960
ds_read_b64_tr_b16 v[82:83], v6 offset:43008
s_add_u32 m0, s25, 101376
s_add_u32 s26, s24, 21504
buffer_load_dwordx4 v4, s[52:55], s26 offen lds
s_waitcnt lgkmcnt(14)
v_mfma_f32_32x32x16_bf16 a[16:31], v[116:119], v[200:203], a[16:31]
ds_read_b64_tr_b16 v[84:85], v7 offset:40960
ds_read_b64_tr_b16 v[86:87], v7 offset:43008
s_waitcnt lgkmcnt(14)
v_mfma_f32_32x32x16_bf16 a[32:47], v[120:123], v[200:203], a[32:47]
ds_read_b64_tr_b16 v[88:89], v8 offset:40960
ds_read_b64_tr_b16 v[90:91], v8 offset:43008
s_waitcnt lgkmcnt(14)
v_mfma_f32_32x32x16_bf16 a[48:63], v[124:127], v[200:203], a[48:63]
ds_read_b64_tr_b16 v[92:93], v9 offset:40960
ds_read_b64_tr_b16 v[94:95], v9 offset:43008
s_add_u32 m0, s25, 102400
s_add_u32 s26, s24, 28672
buffer_load_dwordx4 v3, s[52:55], s26 offen lds
s_waitcnt lgkmcnt(14)
v_mfma_f32_32x32x16_bf16 a[64:79], v[64:67], v[200:203], a[64:79]
ds_read_b64_tr_b16 v[96:97], v10 offset:40960
ds_read_b64_tr_b16 v[98:99], v10 offset:43008
s_waitcnt lgkmcnt(14)
v_mfma_f32_32x32x16_bf16 a[80:95], v[68:71], v[200:203], a[80:95]
ds_read_b64_tr_b16 v[100:101], v11 offset:40960
ds_read_b64_tr_b16 v[102:103], v11 offset:43008
s_waitcnt lgkmcnt(14)
v_mfma_f32_32x32x16_bf16 a[96:111], v[72:75], v[200:203], a[96:111]
ds_read_b64_tr_b16 v[104:105], v5 offset:49152
ds_read_b64_tr_b16 v[106:107], v5 offset:51200
s_add_u32 m0, s25, 103424
s_add_u32 s26, s24, 35840
buffer_load_dwordx4 v4, s[52:55], s26 offen lds
s_waitcnt lgkmcnt(14)
v_mfma_f32_32x32x16_bf16 a[112:127], v[76:79], v[200:203], a[112:127]
ds_read_b64_tr_b16 v[108:109], v6 offset:49152
ds_read_b64_tr_b16 v[110:111], v6 offset:51200
s_waitcnt lgkmcnt(14)
v_mfma_f32_32x32x16_bf16 a[128:143], v[80:83], v[200:203], a[128:143]
ds_read_b64_tr_b16 v[112:113], v7 offset:49152
ds_read_b64_tr_b16 v[114:115], v7 offset:51200
s_waitcnt lgkmcnt(14)
v_mfma_f32_32x32x16_bf16 a[144:159], v[84:87], v[200:203], a[144:159]
ds_read_b64_tr_b16 v[116:117], v8 offset:49152
ds_read_b64_tr_b16 v[118:119], v8 offset:51200
s_add_u32 m0, s25, 104448
s_add_u32 s26, s24, 43008
buffer_load_dwordx4 v3, s[52:55], s26 offen lds
s_waitcnt lgkmcnt(14)
v_mfma_f32_32x32x16_bf16 a[160:175], v[88:91], v[200:203], a[160:175]
ds_read_b64_tr_b16 v[120:121], v9 offset:49152
ds_read_b64_tr_b16 v[122:123], v9 offset:51200
s_waitcnt lgkmcnt(14)
v_mfma_f32_32x32x16_bf16 a[176:191], v[92:95], v[200:203], a[176:191]
ds_read_b64_tr_b16 v[124:125], v10 offset:49152
ds_read_b64_tr_b16 v[126:127], v10 offset:51200
s_waitcnt lgkmcnt(14)
v_mfma_f32_32x32x16_bf16 a[192:207], v[96:99], v[200:203], a[192:207]
ds_read_b64_tr_b16 v[64:65], v11 offset:49152
ds_read_b64_tr_b16 v[66:67], v11 offset:51200
s_add_u32 m0, s25, 105472
s_add_u32 s26, s24, 50176
buffer_load_dwordx4 v4, s[52:55], s26 offen lds
s_add_u32 s24, s24, 114688
s_waitcnt lgkmcnt(14)
v_mfma_f32_32x32x16_bf16 a[208:223], v[100:103], v[200:203], a[208:223]
ds_read_b64_tr_b16 v[68:69], v5 offset:57344
ds_read_b64_tr_b16 v[70:71], v5 offset:59392
s_waitcnt lgkmcnt(14)
v_mfma_f32_32x32x16_bf16 a[0:15], v[104:107], v[204:207], a[0:15]
ds_read_b64_tr_b16 v[72:73], v6 offset:57344
ds_read_b64_tr_b16 v[74:75], v6 offset:59392
s_waitcnt lgkmcnt(14)
v_mfma_f32_32x32x16_bf16 a[16:31], v[108:111], v[204:207], a[16:31]
ds_read_b64_tr_b16 v[76:77], v7 offset:57344
ds_read_b64_tr_b16 v[78:79], v7 offset:59392
s_waitcnt lgkmcnt(14)
v_mfma_f32_32x32x16_bf16 a[32:47], v[112:115], v[204:207], a[32:47]
ds_read_b64_tr_b16 v[80:81], v8 offset:57344
ds_read_b64_tr_b16 v[82:83], v8 offset:59392
s_waitcnt lgkmcnt(14)
v_mfma_f32_32x32x16_bf16 a[48:63], v[116:119], v[204:207], a[48:63]
ds_read_b64_tr_b16 v[84:85], v9 offset:57344
ds_read_b64_tr_b16 v[86:87], v9 offset:59392
s_waitcnt lgkmcnt(14)
v_mfma_f32_32x32x16_bf16 a[64:79], v[120:123], v[204:207], a[64:79]
ds_read_b64_tr_b16 v[88:89], v10 offset:57344
ds_read_b64_tr_b16 v[90:91], v10 offset:59392
s_waitcnt lgkmcnt(14)
v_mfma_f32_32x32x16_bf16 a[80:95], v[124:127], v[204:207], a[80:95]
s_waitcnt vmcnt(8)
s_barrier
ds_read_b64_tr_b16 v[92:93], v11 offset:57344
ds_read_b64_tr_b16 v[94:95], v11 offset:59392
s_waitcnt lgkmcnt(14)
v_mfma_f32_32x32x16_bf16 a[96:111], v[64:67], v[204:207], a[96:111]
ds_read_b64_tr_b16 v[96:97], v12 offset:0
ds_read_b64_tr_b16 v[98:99], v12 offset:2048
s_waitcnt lgkmcnt(14)
v_mfma_f32_32x32x16_bf16 a[112:127], v[68:71], v[204:207], a[112:127]
ds_read_b64_tr_b16 v[100:101], v13 offset:0
ds_read_b64_tr_b16 v[102:103], v13 offset:2048
s_add_u32 m0, s25, 0
s_add_u32 s26, s24, 0
buffer_load_dwordx4 v3, s[52:55], s26 offen lds
s_waitcnt lgkmcnt(14)
v_mfma_f32_32x32x16_bf16 a[128:143], v[72:75], v[204:207], a[128:143]
ds_read_b64_tr_b16 v[104:105], v14 offset:0
ds_read_b64_tr_b16 v[106:107], v14 offset:2048
s_waitcnt lgkmcnt(14)
v_mfma_f32_32x32x16_bf16 a[144:159], v[76:79], v[204:207], a[144:159]
ds_read_b64_tr_b16 v[108:109], v15 offset:0
ds_read_b64_tr_b16 v[110:111], v15 offset:2048
s_waitcnt lgkmcnt(14)
v_mfma_f32_32x32x16_bf16 a[160:175], v[80:83], v[204:207], a[160:175]
ds_read_b64_tr_b16 v[112:113], v16 offset:0
ds_read_b64_tr_b16 v[114:115], v16 offset:2048
s_add_u32 m0, s25, 1024
s_add_u32 s26, s24, 7168
buffer_load_dwordx4 v4, s[52:55], s26 offen lds
s_waitcnt lgkmcnt(14)
v_mfma_f32_32x32x16_bf16 a[176:191], v[84:87], v[204:207], a[176:191]
ds_read_b64_tr_b16 v[116:117], v17 offset:0
ds_read_b64_tr_b16 v[118:119], v17 offset:2048
s_waitcnt lgkmcnt(14)
v_mfma_f32_32x32x16_bf16 a[192:207], v[88:91], v[204:207], a[192:207]
ds_read_b64_tr_b16 v[120:121], v18 offset:0
ds_read_b64_tr_b16 v[122:123], v18 offset:2048
s_waitcnt lgkmcnt(14)
v_mfma_f32_32x32x16_bf16 a[208:223], v[92:95], v[204:207], a[208:223]
ds_read_b64_tr_b16 v[124:125], v12 offset:8192
ds_read_b64_tr_b16 v[126:127], v12 offset:10240
s_add_u32 m0, s25, 2048
s_add_u32 s26, s24, 14336
buffer_load_dwordx4 v3, s[52:55], s26 offen lds
s_waitcnt lgkmcnt(14)
v_mfma_f32_32x32x16_bf16 a[0:15], v[96:99], v[208:211], a[0:15]
ds_read_b64_tr_b16 v[64:65], v13 offset:8192
ds_read_b64_tr_b16 v[66:67], v13 offset:10240
s_waitcnt lgkmcnt(14)
v_mfma_f32_32x32x16_bf16 a[16:31], v[100:103], v[208:211], a[16:31]
ds_read_b64_tr_b16 v[68:69], v14 offset:8192
ds_read_b64_tr_b16 v[70:71], v14 offset:10240
s_waitcnt lgkmcnt(14)
v_mfma_f32_32x32x16_bf16 a[32:47], v[104:107], v[208:211], a[32:47]
ds_read_b64_tr_b16 v[72:73], v15 offset:8192
ds_read_b64_tr_b16 v[74:75], v15 offset:10240
s_add_u32 m0, s25, 3072
s_add_u32 s26, s24, 21504
buffer_load_dwordx4 v4, s[52:55], s26 offen lds
s_waitcnt lgkmcnt(14)
v_mfma_f32_32x32x16_bf16 a[48:63], v[108:111], v[208:211], a[48:63]
ds_read_b64_tr_b16 v[76:77], v16 offset:8192
ds_read_b64_tr_b16 v[78:79], v16 offset:10240
s_waitcnt lgkmcnt(14)
v_mfma_f32_32x32x16_bf16 a[64:79], v[112:115], v[208:211], a[64:79]
ds_read_b64_tr_b16 v[80:81], v17 offset:8192
ds_read_b64_tr_b16 v[82:83], v17 offset:10240
s_waitcnt lgkmcnt(14)
v_mfma_f32_32x32x16_bf16 a[80:95], v[116:119], v[208:211], a[80:95]
ds_read_b64_tr_b16 v[84:85], v18 offset:8192
ds_read_b64_tr_b16 v[86:87], v18 offset:10240
s_add_u32 m0, s25, 4096
s_add_u32 s26, s24, 28672
buffer_load_dwordx4 v3, s[52:55], s26 offen lds
s_waitcnt lgkmcnt(14)
v_mfma_f32_32x32x16_bf16 a[96:111], v[120:123], v[208:211], a[96:111]
ds_read_b64_tr_b16 v[88:89], v12 offset:16384
ds_read_b64_tr_b16 v[90:91], v12 offset:18432
s_waitcnt lgkmcnt(14)
v_mfma_f32_32x32x16_bf16 a[112:127], v[124:127], v[208:211], a[112:127]
ds_read_b64_tr_b16 v[92:93], v13 offset:16384
ds_read_b64_tr_b16 v[94:95], v13 offset:18432
s_waitcnt lgkmcnt(14)
v_mfma_f32_32x32x16_bf16 a[128:143], v[64:67], v[208:211], a[128:143]
ds_read_b64_tr_b16 v[96:97], v14 offset:16384
ds_read_b64_tr_b16 v[98:99], v14 offset:18432
s_add_u32 m0, s25, 5120
s_add_u32 s26, s24, 35840
buffer_load_dwordx4 v4, s[52:55], s26 offen lds
s_waitcnt lgkmcnt(14)
v_mfma_f32_32x32x16_bf16 a[144:159], v[68:71], v[208:211], a[144:159]
ds_read_b64_tr_b16 v[100:101], v15 offset:16384
ds_read_b64_tr_b16 v[102:103], v15 offset:18432
s_waitcnt lgkmcnt(14)
v_mfma_f32_32x32x16_bf16 a[160:175], v[72:75], v[208:211], a[160:175]
ds_read_b64_tr_b16 v[104:105], v16 offset:16384
ds_read_b64_tr_b16 v[106:107], v16 offset:18432
s_waitcnt lgkmcnt(14)
v_mfma_f32_32x32x16_bf16 a[176:191], v[76:79], v[208:211], a[176:191]
ds_read_b64_tr_b16 v[108:109], v17 offset:16384
ds_read_b64_tr_b16 v[110:111], v17 offset:18432
s_add_u32 m0, s25, 6144
s_add_u32 s26, s24, 43008
buffer_load_dwordx4 v3, s[52:55], s26 offen lds
s_waitcnt lgkmcnt(14)
v_mfma_f32_32x32x16_bf16 a[192:207], v[80:83], v[208:211], a[192:207]
ds_read_b64_tr_b16 v[112:113], v18 offset:16384
ds_read_b64_tr_b16 v[114:115], v18 offset:18432
s_waitcnt lgkmcnt(14)
v_mfma_f32_32x32x16_bf16 a[208:223], v[84:87], v[208:211], a[208:223]
ds_read_b64_tr_b16 v[116:117], v12 offset:24576
ds_read_b64_tr_b16 v[118:119], v12 offset:26624
s_waitcnt lgkmcnt(14)
v_mfma_f32_32x32x16_bf16 a[0:15], v[88:91], v[212:215], a[0:15]
ds_read_b64_tr_b16 v[120:121], v13 offset:24576
ds_read_b64_tr_b16 v[122:123], v13 offset:26624
s_add_u32 m0, s25, 7168
s_add_u32 s26, s24, 50176
buffer_load_dwordx4 v4, s[52:55], s26 offen lds
s_add_u32 s24, s24, 114688
s_waitcnt lgkmcnt(14)
v_mfma_f32_32x32x16_bf16 a[16:31], v[92:95], v[212:215], a[16:31]
ds_read_b64_tr_b16 v[124:125], v14 offset:24576
ds_read_b64_tr_b16 v[126:127], v14 offset:26624
s_waitcnt lgkmcnt(14)
v_mfma_f32_32x32x16_bf16 a[32:47], v[96:99], v[212:215], a[32:47]
ds_read_b64_tr_b16 v[64:65], v15 offset:24576
ds_read_b64_tr_b16 v[66:67], v15 offset:26624
s_waitcnt lgkmcnt(14)
v_mfma_f32_32x32x16_bf16 a[48:63], v[100:103], v[212:215], a[48:63]
ds_read_b64_tr_b16 v[68:69], v16 offset:24576
ds_read_b64_tr_b16 v[70:71], v16 offset:26624
s_waitcnt lgkmcnt(14)
v_mfma_f32_32x32x16_bf16 a[64:79], v[104:107], v[212:215], a[64:79]
ds_read_b64_tr_b16 v[72:73], v17 offset:24576
ds_read_b64_tr_b16 v[74:75], v17 offset:26624
s_waitcnt lgkmcnt(14)
v_mfma_f32_32x32x16_bf16 a[80:95], v[108:111], v[212:215], a[80:95]
s_waitcnt vmcnt(8)
s_barrier
ds_read_b64_tr_b16 v[76:77], v18 offset:24576
ds_read_b64_tr_b16 v[78:79], v18 offset:26624
s_waitcnt lgkmcnt(14)
v_mfma_f32_32x32x16_bf16 a[96:111], v[112:115], v[212:215], a[96:111]
ds_read_b64_tr_b16 v[80:81], v12 offset:32768
ds_read_b64_tr_b16 v[82:83], v12 offset:34816
s_add_u32 m0, s25, 32768
s_add_u32 s26, s24, 0
buffer_load_dwordx4 v3, s[52:55], s26 offen lds
s_waitcnt lgkmcnt(14)
v_mfma_f32_32x32x16_bf16 a[112:127], v[116:119], v[212:215], a[112:127]
ds_read_b64_tr_b16 v[84:85], v13 offset:32768
ds_read_b64_tr_b16 v[86:87], v13 offset:34816
s_waitcnt lgkmcnt(14)
v_mfma_f32_32x32x16_bf16 a[128:143], v[120:123], v[212:215], a[128:143]
ds_read_b64_tr_b16 v[88:89], v14 offset:32768
ds_read_b64_tr_b16 v[90:91], v14 offset:34816
s_waitcnt lgkmcnt(14)
v_mfma_f32_32x32x16_bf16 a[144:159], v[124:127], v[212:215], a[144:159]
ds_read_b64_tr_b16 v[92:93], v15 offset:32768
ds_read_b64_tr_b16 v[94:95], v15 offset:34816
s_add_u32 m0, s25, 33792
s_add_u32 s26, s24, 7168
buffer_load_dwordx4 v4, s[52:55], s26 offen lds
s_waitcnt lgkmcnt(14)
v_mfma_f32_32x32x16_bf16 a[160:175], v[64:67], v[212:215], a[160:175]
ds_read_b64_tr_b16 v[96:97], v16 offset:32768
ds_read_b64_tr_b16 v[98:99], v16 offset:34816
s_waitcnt lgkmcnt(14)
v_mfma_f32_32x32x16_bf16 a[176:191], v[68:71], v[212:215], a[176:191]
ds_read_b64_tr_b16 v[100:101], v17 offset:32768
ds_read_b64_tr_b16 v[102:103], v17 offset:34816
s_waitcnt lgkmcnt(14)
v_mfma_f32_32x32x16_bf16 a[192:207], v[72:75], v[212:215], a[192:207]
ds_read_b64_tr_b16 v[104:105], v18 offset:32768
ds_read_b64_tr_b16 v[106:107], v18 offset:34816
s_add_u32 m0, s25, 34816
s_add_u32 s26, s24, 14336
buffer_load_dwordx4 v3, s[52:55], s26 offen lds
s_waitcnt lgkmcnt(14)
v_mfma_f32_32x32x16_bf16 a[208:223], v[76:79], v[212:215], a[208:223]
ds_read_b64_tr_b16 v[108:109], v12 offset:40960
ds_read_b64_tr_b16 v[110:111], v12 offset:43008
s_waitcnt lgkmcnt(14)
v_mfma_f32_32x32x16_bf16 a[0:15], v[80:83], v[216:219], a[0:15]
ds_read_b64_tr_b16 v[112:113], v13 offset:40960
ds_read_b64_tr_b16 v[114:115], v13 offset:43008
s_waitcnt lgkmcnt(14)
v_mfma_f32_32x32x16_bf16 a[16:31], v[84:87], v[216:219], a[16:31]
ds_read_b64_tr_b16 v[116:117], v14 offset:40960
ds_read_b64_tr_b16 v[118:119], v14 offset:43008
s_add_u32 m0, s25, 35840
s_add_u32 s26, s24, 21504
buffer_load_dwordx4 v4, s[52:55], s26 offen lds
s_waitcnt lgkmcnt(14)
v_mfma_f32_32x32x16_bf16 a[32:47], v[88:91], v[216:219], a[32:47]
ds_read_b64_tr_b16 v[120:121], v15 offset:40960
ds_read_b64_tr_b16 v[122:123], v15 offset:43008
s_waitcnt lgkmcnt(14)
v_mfma_f32_32x32x16_bf16 a[48:63], v[92:95], v[216:219], a[48:63]
ds_read_b64_tr_b16 v[124:125], v16 offset:40960
ds_read_b64_tr_b16 v[126:127], v16 offset:43008
s_waitcnt lgkmcnt(14)
v_mfma_f32_32x32x16_bf16 a[64:79], v[96:99], v[216:219], a[64:79]
ds_read_b64_tr_b16 v[64:65], v17 offset:40960
ds_read_b64_tr_b16 v[66:67], v17 offset:43008
s_add_u32 m0, s25, 36864
s_add_u32 s26, s24, 28672
buffer_load_dwordx4 v3, s[52:55], s26 offen lds
s_waitcnt lgkmcnt(14)
v_mfma_f32_32x32x16_bf16 a[80:95], v[100:103], v[216:219], a[80:95]
ds_read_b64_tr_b16 v[68:69], v18 offset:40960
ds_read_b64_tr_b16 v[70:71], v18 offset:43008
s_waitcnt lgkmcnt(14)
v_mfma_f32_32x32x16_bf16 a[96:111], v[104:107], v[216:219], a[96:111]
ds_read_b64_tr_b16 v[72:73], v12 offset:49152
ds_read_b64_tr_b16 v[74:75], v12 offset:51200
s_waitcnt lgkmcnt(14)
v_mfma_f32_32x32x16_bf16 a[112:127], v[108:111], v[216:219], a[112:127]
ds_read_b64_tr_b16 v[76:77], v13 offset:49152
ds_read_b64_tr_b16 v[78:79], v13 offset:51200
s_add_u32 m0, s25, 37888
s_add_u32 s26, s24, 35840
buffer_load_dwordx4 v4, s[52:55], s26 offen lds
s_waitcnt lgkmcnt(14)
v_mfma_f32_32x32x16_bf16 a[128:143], v[112:115], v[216:219], a[128:143]
ds_read_b64_tr_b16 v[80:81], v14 offset:49152
ds_read_b64_tr_b16 v[82:83], v14 offset:51200
s_waitcnt lgkmcnt(14)
v_mfma_f32_32x32x16_bf16 a[144:159], v[116:119], v[216:219], a[144:159]
ds_read_b64_tr_b16 v[84:85], v15 offset:49152
ds_read_b64_tr_b16 v[86:87], v15 offset:51200
s_waitcnt lgkmcnt(14)
v_mfma_f32_32x32x16_bf16 a[160:175], v[120:123], v[216:219], a[160:175]
ds_read_b64_tr_b16 v[88:89], v16 offset:49152
ds_read_b64_tr_b16 v[90:91], v16 offset:51200
s_add_u32 m0, s25, 38912
s_add_u32 s26, s24, 43008
buffer_load_dwordx4 v3, s[52:55], s26 offen lds
s_waitcnt lgkmcnt(14)
v_mfma_f32_32x32x16_bf16 a[176:191], v[124:127], v[216:219], a[176:191]
ds_read_b64_tr_b16 v[92:93], v17 offset:49152
ds_read_b64_tr_b16 v[94:95], v17 offset:51200
s_waitcnt lgkmcnt(14)
v_mfma_f32_32x32x16_bf16 a[192:207], v[64:67], v[216:219], a[192:207]
ds_read_b64_tr_b16 v[96:97], v18 offset:49152
ds_read_b64_tr_b16 v[98:99], v18 offset:51200
s_waitcnt lgkmcnt(14)
v_mfma_f32_32x32x16_bf16 a[208:223], v[68:71], v[216:219], a[208:223]
ds_read_b64_tr_b16 v[100:101], v12 offset:57344
ds_read_b64_tr_b16 v[102:103], v12 offset:59392
s_add_u32 m0, s25, 39936
s_add_u32 s26, s24, 50176
buffer_load_dwordx4 v4, s[52:55], s26 offen lds
s_add_u32 s24, s24, 114688
s_waitcnt lgkmcnt(14)
v_mfma_f32_32x32x16_bf16 a[0:15], v[72:75], v[220:223], a[0:15]
ds_read_b64_tr_b16 v[104:105], v13 offset:57344
ds_read_b64_tr_b16 v[106:107], v13 offset:59392
s_waitcnt lgkmcnt(14)
v_mfma_f32_32x32x16_bf16 a[16:31], v[76:79], v[220:223], a[16:31]
ds_read_b64_tr_b16 v[108:109], v14 offset:57344
ds_read_b64_tr_b16 v[110:111], v14 offset:59392
s_waitcnt lgkmcnt(14)
v_mfma_f32_32x32x16_bf16 a[32:47], v[80:83], v[220:223], a[32:47]
ds_read_b64_tr_b16 v[112:113], v15 offset:57344
ds_read_b64_tr_b16 v[114:115], v15 offset:59392
s_waitcnt lgkmcnt(14)
v_mfma_f32_32x32x16_bf16 a[48:63], v[84:87], v[220:223], a[48:63]
ds_read_b64_tr_b16 v[116:117], v16 offset:57344
ds_read_b64_tr_b16 v[118:119], v16 offset:59392
s_waitcnt lgkmcnt(14)
v_mfma_f32_32x32x16_bf16 a[64:79], v[88:91], v[220:223], a[64:79]
ds_read_b64_tr_b16 v[120:121], v17 offset:57344
ds_read_b64_tr_b16 v[122:123], v17 offset:59392
s_waitcnt lgkmcnt(14)
v_mfma_f32_32x32x16_bf16 a[80:95], v[92:95], v[220:223], a[80:95]
s_waitcnt vmcnt(8)
s_barrier
ds_read_b64_tr_b16 v[124:125], v18 offset:57344
ds_read_b64_tr_b16 v[126:127], v18 offset:59392
s_waitcnt lgkmcnt(14)
v_mfma_f32_32x32x16_bf16 a[96:111], v[96:99], v[220:223], a[96:111]
ds_read_b64_tr_b16 v[64:65], v5 offset:0
ds_read_b64_tr_b16 v[66:67], v5 offset:2048
s_waitcnt lgkmcnt(14)
v_mfma_f32_32x32x16_bf16 a[112:127], v[100:103], v[220:223], a[112:127]
ds_read_b64_tr_b16 v[68:69], v6 offset:0
ds_read_b64_tr_b16 v[70:71], v6 offset:2048
s_waitcnt lgkmcnt(14)
v_mfma_f32_32x32x16_bf16 a[128:143], v[104:107], v[220:223], a[128:143]
ds_read_b64_tr_b16 v[72:73], v7 offset:0
ds_read_b64_tr_b16 v[74:75], v7 offset:2048
s_waitcnt lgkmcnt(14)
v_mfma_f32_32x32x16_bf16 a[144:159], v[108:111], v[220:223], a[144:159]
ds_read_b64_tr_b16 v[76:77], v8 offset:0
ds_read_b64_tr_b16 v[78:79], v8 offset:2048
s_waitcnt lgkmcnt(14)
v_mfma_f32_32x32x16_bf16 a[160:175], v[112:115], v[220:223], a[160:175]
ds_read_b64_tr_b16 v[80:81], v9 offset:0
ds_read_b64_tr_b16 v[82:83], v9 offset:2048
s_waitcnt lgkmcnt(14)
v_mfma_f32_32x32x16_bf16 a[176:191], v[116:119], v[220:223], a[176:191]
ds_read_b64_tr_b16 v[84:85], v10 offset:0
ds_read_b64_tr_b16 v[86:87], v10 offset:2048
s_waitcnt lgkmcnt(14)
v_mfma_f32_32x32x16_bf16 a[192:207], v[120:123], v[220:223], a[192:207]
ds_read_b64_tr_b16 v[88:89], v11 offset:0
ds_read_b64_tr_b16 v[90:91], v11 offset:2048
s_waitcnt lgkmcnt(14)
v_mfma_f32_32x32x16_bf16 a[208:223], v[124:127], v[220:223], a[208:223]
ds_read_b64_tr_b16 v[92:93], v5 offset:8192
ds_read_b64_tr_b16 v[94:95], v5 offset:10240
s_waitcnt lgkmcnt(14)
v_mfma_f32_32x32x16_bf16 a[0:15], v[64:67], v[224:227], a[0:15]
ds_read_b64_tr_b16 v[96:97], v6 offset:8192
ds_read_b64_tr_b16 v[98:99], v6 offset:10240
s_waitcnt lgkmcnt(14)
v_mfma_f32_32x32x16_bf16 a[16:31], v[68:71], v[224:227], a[16:31]
ds_read_b64_tr_b16 v[100:101], v7 offset:8192
ds_read_b64_tr_b16 v[102:103], v7 offset:10240
s_waitcnt lgkmcnt(14)
v_mfma_f32_32x32x16_bf16 a[32:47], v[72:75], v[224:227], a[32:47]
ds_read_b64_tr_b16 v[104:105], v8 offset:8192
ds_read_b64_tr_b16 v[106:107], v8 offset:10240
s_waitcnt lgkmcnt(14)
v_mfma_f32_32x32x16_bf16 a[48:63], v[76:79], v[224:227], a[48:63]
ds_read_b64_tr_b16 v[108:109], v9 offset:8192
ds_read_b64_tr_b16 v[110:111], v9 offset:10240
s_waitcnt lgkmcnt(14)
v_mfma_f32_32x32x16_bf16 a[64:79], v[80:83], v[224:227], a[64:79]
ds_read_b64_tr_b16 v[112:113], v10 offset:8192
ds_read_b64_tr_b16 v[114:115], v10 offset:10240
s_waitcnt lgkmcnt(14)
v_mfma_f32_32x32x16_bf16 a[80:95], v[84:87], v[224:227], a[80:95]
ds_read_b64_tr_b16 v[116:117], v11 offset:8192
ds_read_b64_tr_b16 v[118:119], v11 offset:10240
s_waitcnt lgkmcnt(14)
v_mfma_f32_32x32x16_bf16 a[96:111], v[88:91], v[224:227], a[96:111]
ds_read_b64_tr_b16 v[120:121], v5 offset:16384
ds_read_b64_tr_b16 v[122:123], v5 offset:18432
s_waitcnt lgkmcnt(14)
v_mfma_f32_32x32x16_bf16 a[112:127], v[92:95], v[224:227], a[112:127]
ds_read_b64_tr_b16 v[124:125], v6 offset:16384
ds_read_b64_tr_b16 v[126:127], v6 offset:18432
s_waitcnt lgkmcnt(14)
v_mfma_f32_32x32x16_bf16 a[128:143], v[96:99], v[224:227], a[128:143]
ds_read_b64_tr_b16 v[64:65], v7 offset:16384
ds_read_b64_tr_b16 v[66:67], v7 offset:18432
s_waitcnt lgkmcnt(14)
v_mfma_f32_32x32x16_bf16 a[144:159], v[100:103], v[224:227], a[144:159]
ds_read_b64_tr_b16 v[68:69], v8 offset:16384
ds_read_b64_tr_b16 v[70:71], v8 offset:18432
s_waitcnt lgkmcnt(14)
v_mfma_f32_32x32x16_bf16 a[160:175], v[104:107], v[224:227], a[160:175]
ds_read_b64_tr_b16 v[72:73], v9 offset:16384
ds_read_b64_tr_b16 v[74:75], v9 offset:18432
s_waitcnt lgkmcnt(14)
v_mfma_f32_32x32x16_bf16 a[176:191], v[108:111], v[224:227], a[176:191]
ds_read_b64_tr_b16 v[76:77], v10 offset:16384
ds_read_b64_tr_b16 v[78:79], v10 offset:18432
s_waitcnt lgkmcnt(14)
v_mfma_f32_32x32x16_bf16 a[192:207], v[112:115], v[224:227], a[192:207]
ds_read_b64_tr_b16 v[80:81], v11 offset:16384
ds_read_b64_tr_b16 v[82:83], v11 offset:18432
s_waitcnt lgkmcnt(14)
v_mfma_f32_32x32x16_bf16 a[208:223], v[116:119], v[224:227], a[208:223]
ds_read_b64_tr_b16 v[84:85], v5 offset:24576
ds_read_b64_tr_b16 v[86:87], v5 offset:26624
s_waitcnt lgkmcnt(14)
v_mfma_f32_32x32x16_bf16 a[0:15], v[120:123], v[228:231], a[0:15]
ds_read_b64_tr_b16 v[88:89], v6 offset:24576
ds_read_b64_tr_b16 v[90:91], v6 offset:26624
s_waitcnt lgkmcnt(14)
v_mfma_f32_32x32x16_bf16 a[16:31], v[124:127], v[228:231], a[16:31]
ds_read_b64_tr_b16 v[92:93], v7 offset:24576
ds_read_b64_tr_b16 v[94:95], v7 offset:26624
s_waitcnt lgkmcnt(14)
v_mfma_f32_32x32x16_bf16 a[32:47], v[64:67], v[228:231], a[32:47]
ds_read_b64_tr_b16 v[96:97], v8 offset:24576
ds_read_b64_tr_b16 v[98:99], v8 offset:26624
s_waitcnt lgkmcnt(14)
v_mfma_f32_32x32x16_bf16 a[48:63], v[68:71], v[228:231], a[48:63]
ds_read_b64_tr_b16 v[100:101], v9 offset:24576
ds_read_b64_tr_b16 v[102:103], v9 offset:26624
s_waitcnt lgkmcnt(14)
v_mfma_f32_32x32x16_bf16 a[64:79], v[72:75], v[228:231], a[64:79]
ds_read_b64_tr_b16 v[104:105], v10 offset:24576
ds_read_b64_tr_b16 v[106:107], v10 offset:26624
s_waitcnt lgkmcnt(14)
v_mfma_f32_32x32x16_bf16 a[80:95], v[76:79], v[228:231], a[80:95]
s_waitcnt vmcnt(0)
s_barrier
ds_read_b64_tr_b16 v[108:109], v11 offset:24576
ds_read_b64_tr_b16 v[110:111], v11 offset:26624
s_waitcnt lgkmcnt(14)
v_mfma_f32_32x32x16_bf16 a[96:111], v[80:83], v[228:231], a[96:111]
ds_read_b64_tr_b16 v[112:113], v5 offset:32768
ds_read_b64_tr_b16 v[114:115], v5 offset:34816
s_waitcnt lgkmcnt(14)
v_mfma_f32_32x32x16_bf16 a[112:127], v[84:87], v[228:231], a[112:127]
ds_read_b64_tr_b16 v[116:117], v6 offset:32768
ds_read_b64_tr_b16 v[118:119], v6 offset:34816
s_waitcnt lgkmcnt(14)
v_mfma_f32_32x32x16_bf16 a[128:143], v[88:91], v[228:231], a[128:143]
ds_read_b64_tr_b16 v[120:121], v7 offset:32768
ds_read_b64_tr_b16 v[122:123], v7 offset:34816
s_waitcnt lgkmcnt(14)
v_mfma_f32_32x32x16_bf16 a[144:159], v[92:95], v[228:231], a[144:159]
ds_read_b64_tr_b16 v[124:125], v8 offset:32768
ds_read_b64_tr_b16 v[126:127], v8 offset:34816
s_waitcnt lgkmcnt(14)
v_mfma_f32_32x32x16_bf16 a[160:175], v[96:99], v[228:231], a[160:175]
ds_read_b64_tr_b16 v[64:65], v9 offset:32768
ds_read_b64_tr_b16 v[66:67], v9 offset:34816
s_waitcnt lgkmcnt(14)
v_mfma_f32_32x32x16_bf16 a[176:191], v[100:103], v[228:231], a[176:191]
ds_read_b64_tr_b16 v[68:69], v10 offset:32768
ds_read_b64_tr_b16 v[70:71], v10 offset:34816
s_waitcnt lgkmcnt(14)
v_mfma_f32_32x32x16_bf16 a[192:207], v[104:107], v[228:231], a[192:207]
ds_read_b64_tr_b16 v[72:73], v11 offset:32768
ds_read_b64_tr_b16 v[74:75], v11 offset:34816
s_waitcnt lgkmcnt(14)
v_mfma_f32_32x32x16_bf16 a[208:223], v[108:111], v[228:231], a[208:223]
ds_read_b64_tr_b16 v[76:77], v5 offset:40960
ds_read_b64_tr_b16 v[78:79], v5 offset:43008
s_waitcnt lgkmcnt(14)
v_mfma_f32_32x32x16_bf16 a[0:15], v[112:115], v[232:235], a[0:15]
ds_read_b64_tr_b16 v[80:81], v6 offset:40960
ds_read_b64_tr_b16 v[82:83], v6 offset:43008
s_waitcnt lgkmcnt(14)
v_mfma_f32_32x32x16_bf16 a[16:31], v[116:119], v[232:235], a[16:31]
ds_read_b64_tr_b16 v[84:85], v7 offset:40960
ds_read_b64_tr_b16 v[86:87], v7 offset:43008
s_waitcnt lgkmcnt(14)
v_mfma_f32_32x32x16_bf16 a[32:47], v[120:123], v[232:235], a[32:47]
ds_read_b64_tr_b16 v[88:89], v8 offset:40960
ds_read_b64_tr_b16 v[90:91], v8 offset:43008
s_waitcnt lgkmcnt(14)
v_mfma_f32_32x32x16_bf16 a[48:63], v[124:127], v[232:235], a[48:63]
ds_read_b64_tr_b16 v[92:93], v9 offset:40960
ds_read_b64_tr_b16 v[94:95], v9 offset:43008
s_waitcnt lgkmcnt(14)
v_mfma_f32_32x32x16_bf16 a[64:79], v[64:67], v[232:235], a[64:79]
ds_read_b64_tr_b16 v[96:97], v10 offset:40960
ds_read_b64_tr_b16 v[98:99], v10 offset:43008
s_waitcnt lgkmcnt(14)
v_mfma_f32_32x32x16_bf16 a[80:95], v[68:71], v[232:235], a[80:95]
ds_read_b64_tr_b16 v[100:101], v11 offset:40960
ds_read_b64_tr_b16 v[102:103], v11 offset:43008
s_waitcnt lgkmcnt(14)
v_mfma_f32_32x32x16_bf16 a[96:111], v[72:75], v[232:235], a[96:111]
ds_read_b64_tr_b16 v[104:105], v5 offset:49152
ds_read_b64_tr_b16 v[106:107], v5 offset:51200
s_waitcnt lgkmcnt(14)
v_mfma_f32_32x32x16_bf16 a[112:127], v[76:79], v[232:235], a[112:127]
ds_read_b64_tr_b16 v[108:109], v6 offset:49152
ds_read_b64_tr_b16 v[110:111], v6 offset:51200
s_waitcnt lgkmcnt(14)
v_mfma_f32_32x32x16_bf16 a[128:143], v[80:83], v[232:235], a[128:143]
ds_read_b64_tr_b16 v[112:113], v7 offset:49152
ds_read_b64_tr_b16 v[114:115], v7 offset:51200
s_waitcnt lgkmcnt(14)
v_mfma_f32_32x32x16_bf16 a[144:159], v[84:87], v[232:235], a[144:159]
ds_read_b64_tr_b16 v[116:117], v8 offset:49152
ds_read_b64_tr_b16 v[118:119], v8 offset:51200
s_waitcnt lgkmcnt(14)
v_mfma_f32_32x32x16_bf16 a[160:175], v[88:91], v[232:235], a[160:175]
ds_read_b64_tr_b16 v[120:121], v9 offset:49152
ds_read_b64_tr_b16 v[122:123], v9 offset:51200
s_waitcnt lgkmcnt(14)
v_mfma_f32_32x32x16_bf16 a[176:191], v[92:95], v[232:235], a[176:191]
ds_read_b64_tr_b16 v[124:125], v10 offset:49152
ds_read_b64_tr_b16 v[126:127], v10 offset:51200
s_waitcnt lgkmcnt(14)
v_mfma_f32_32x32x16_bf16 a[192:207], v[96:99], v[232:235], a[192:207]
ds_read_b64_tr_b16 v[64:65], v11 offset:49152
ds_read_b64_tr_b16 v[66:67], v11 offset:51200
s_waitcnt lgkmcnt(14)
v_mfma_f32_32x32x16_bf16 a[208:223], v[100:103], v[232:235], a[208:223]
ds_read_b64_tr_b16 v[68:69], v5 offset:57344
ds_read_b64_tr_b16 v[70:71], v5 offset:59392
s_waitcnt lgkmcnt(14)
v_mfma_f32_32x32x16_bf16 a[0:15], v[104:107], v[236:239], a[0:15]
ds_read_b64_tr_b16 v[72:73], v6 offset:57344
ds_read_b64_tr_b16 v[74:75], v6 offset:59392
s_waitcnt lgkmcnt(14)
v_mfma_f32_32x32x16_bf16 a[16:31], v[108:111], v[236:239], a[16:31]
ds_read_b64_tr_b16 v[76:77], v7 offset:57344
ds_read_b64_tr_b16 v[78:79], v7 offset:59392
s_waitcnt lgkmcnt(14)
v_mfma_f32_32x32x16_bf16 a[32:47], v[112:115], v[236:239], a[32:47]
ds_read_b64_tr_b16 v[80:81], v8 offset:57344
ds_read_b64_tr_b16 v[82:83], v8 offset:59392
s_waitcnt lgkmcnt(14)
v_mfma_f32_32x32x16_bf16 a[48:63], v[116:119], v[236:239], a[48:63]
ds_read_b64_tr_b16 v[84:85], v9 offset:57344
ds_read_b64_tr_b16 v[86:87], v9 offset:59392
s_waitcnt lgkmcnt(14)
v_mfma_f32_32x32x16_bf16 a[64:79], v[120:123], v[236:239], a[64:79]
ds_read_b64_tr_b16 v[88:89], v10 offset:57344
ds_read_b64_tr_b16 v[90:91], v10 offset:59392
s_waitcnt lgkmcnt(14)
v_mfma_f32_32x32x16_bf16 a[80:95], v[124:127], v[236:239], a[80:95]
ds_read_b64_tr_b16 v[92:93], v11 offset:57344
ds_read_b64_tr_b16 v[94:95], v11 offset:59392
s_waitcnt lgkmcnt(14)
v_mfma_f32_32x32x16_bf16 a[96:111], v[64:67], v[236:239], a[96:111]
s_waitcnt lgkmcnt(12)
v_mfma_f32_32x32x16_bf16 a[112:127], v[68:71], v[236:239], a[112:127]
s_waitcnt lgkmcnt(10)
v_mfma_f32_32x32x16_bf16 a[128:143], v[72:75], v[236:239], a[128:143]
s_waitcnt lgkmcnt(8)
v_mfma_f32_32x32x16_bf16 a[144:159], v[76:79], v[236:239], a[144:159]
s_waitcnt lgkmcnt(6)
v_mfma_f32_32x32x16_bf16 a[160:175], v[80:83], v[236:239], a[160:175]
s_waitcnt lgkmcnt(4)
v_mfma_f32_32x32x16_bf16 a[176:191], v[84:87], v[236:239], a[176:191]
s_waitcnt lgkmcnt(2)
v_mfma_f32_32x32x16_bf16 a[192:207], v[88:91], v[236:239], a[192:207]
s_waitcnt lgkmcnt(0)
v_mfma_f32_32x32x16_bf16 a[208:223], v[92:95], v[236:239], a[208:223]
s_nop 15
s_mul_i32 s26, s23, 114688
s_mul_i32 s27, s22, 14336
s_add_u32 s26, s26, s27
s_add_u32 s26, s26, 57671680
s_mov_b32 s28, 3216550459
v_accvgpr_read_b32 v64, a0
v_accvgpr_read_b32 v65, a1
v_accvgpr_read_b32 v66, a2
v_accvgpr_read_b32 v67, a3
v_accvgpr_read_b32 v68, a4
v_accvgpr_read_b32 v69, a5
v_accvgpr_read_b32 v70, a6
v_accvgpr_read_b32 v71, a7
v_accvgpr_read_b32 v72, a8
v_accvgpr_read_b32 v73, a9
v_accvgpr_read_b32 v74, a10
v_accvgpr_read_b32 v75, a11
v_accvgpr_read_b32 v76, a12
v_accvgpr_read_b32 v77, a13
v_accvgpr_read_b32 v78, a14
v_accvgpr_read_b32 v79, a15
v_accvgpr_read_b32 v80, a112
v_accvgpr_read_b32 v81, a113
v_accvgpr_read_b32 v82, a114
v_accvgpr_read_b32 v83, a115
v_accvgpr_read_b32 v84, a116
v_accvgpr_read_b32 v85, a117
v_accvgpr_read_b32 v86, a118
v_accvgpr_read_b32 v87, a119
v_accvgpr_read_b32 v88, a120
v_accvgpr_read_b32 v89, a121
v_accvgpr_read_b32 v90, a122
v_accvgpr_read_b32 v91, a123
v_accvgpr_read_b32 v92, a124
v_accvgpr_read_b32 v93, a125
v_accvgpr_read_b32 v94, a126
v_accvgpr_read_b32 v95, a127
v_mul_f32 v32, s28, v64
v_mul_f32 v33, s28, v65
v_mul_f32 v34, s28, v66
v_mul_f32 v35, s28, v67
v_mul_f32 v36, s28, v68
v_mul_f32 v37, s28, v69
v_mul_f32 v38, s28, v70
v_mul_f32 v39, s28, v71
v_mul_f32 v40, s28, v72
v_mul_f32 v41, s28, v73
v_mul_f32 v42, s28, v74
v_mul_f32 v43, s28, v75
v_mul_f32 v44, s28, v76
v_mul_f32 v45, s28, v77
v_mul_f32 v46, s28, v78
v_mul_f32 v47, s28, v79
v_exp_f32 v32, v32
v_exp_f32 v33, v33
v_exp_f32 v34, v34
v_exp_f32 v35, v35
v_exp_f32 v36, v36
v_exp_f32 v37, v37
v_exp_f32 v38, v38
v_exp_f32 v39, v39
v_exp_f32 v40, v40
v_exp_f32 v41, v41
v_exp_f32 v42, v42
v_exp_f32 v43, v43
v_exp_f32 v44, v44
v_exp_f32 v45, v45
v_exp_f32 v46, v46
v_exp_f32 v47, v47
v_add_f32 v32, 1.0, v32
v_add_f32 v33, 1.0, v33
v_add_f32 v34, 1.0, v34
v_add_f32 v35, 1.0, v35
v_add_f32 v36, 1.0, v36
v_add_f32 v37, 1.0, v37
v_add_f32 v38, 1.0, v38
v_add_f32 v39, 1.0, v39
v_add_f32 v40, 1.0, v40
v_add_f32 v41, 1.0, v41
v_add_f32 v42, 1.0, v42
v_add_f32 v43, 1.0, v43
v_add_f32 v44, 1.0, v44
v_add_f32 v45, 1.0, v45
v_add_f32 v46, 1.0, v46
v_add_f32 v47, 1.0, v47
v_rcp_f32 v32, v32
v_rcp_f32 v33, v33
v_rcp_f32 v34, v34
v_rcp_f32 v35, v35
v_rcp_f32 v36, v36
v_rcp_f32 v37, v37
v_rcp_f32 v38, v38
v_rcp_f32 v39, v39
v_rcp_f32 v40, v40
v_rcp_f32 v41, v41
v_rcp_f32 v42, v42
v_rcp_f32 v43, v43
v_rcp_f32 v44, v44
v_rcp_f32 v45, v45
v_rcp_f32 v46, v46
v_rcp_f32 v47, v47
v_mul_f32 v64, v64, v32
v_mul_f32 v65, v65, v33
v_mul_f32 v66, v66, v34
v_mul_f32 v67, v67, v35
v_mul_f32 v68, v68, v36
v_mul_f32 v69, v69, v37
v_mul_f32 v70, v70, v38
v_mul_f32 v71, v71, v39
v_mul_f32 v72, v72, v40
v_mul_f32 v73, v73, v41
v_mul_f32 v74, v74, v42
v_mul_f32 v75, v75, v43
v_mul_f32 v76, v76, v44
v_mul_f32 v77, v77, v45
v_mul_f32 v78, v78, v46
v_mul_f32 v79, v79, v47
v_mul_f32 v64, v64, v80
v_mul_f32 v65, v65, v81
v_mul_f32 v66, v66, v82
v_mul_f32 v67, v67, v83
v_mul_f32 v68, v68, v84
v_mul_f32 v69, v69, v85
v_mul_f32 v70, v70, v86
v_mul_f32 v71, v71, v87
v_mul_f32 v72, v72, v88
v_mul_f32 v73, v73, v89
v_mul_f32 v74, v74, v90
v_mul_f32 v75, v75, v91
v_mul_f32 v76, v76, v92
v_mul_f32 v77, v77, v93
v_mul_f32 v78, v78, v94
v_mul_f32 v79, v79, v95
v_cvt_pk_bf16_f32 v64, v64, v65
v_cvt_pk_bf16_f32 v65, v66, v67
v_cvt_pk_bf16_f32 v66, v68, v69
v_cvt_pk_bf16_f32 v67, v70, v71
v_cvt_pk_bf16_f32 v68, v72, v73
v_cvt_pk_bf16_f32 v69, v74, v75
v_cvt_pk_bf16_f32 v70, v76, v77
v_cvt_pk_bf16_f32 v71, v78, v79
buffer_store_dwordx4 v[64:67], v2, s[8:11], s26 offen sc1
buffer_store_dwordx4 v[68:71], v2, s[8:11], s26 offen offset:1024 sc1
s_add_u32 s26, s26, 2048
v_accvgpr_read_b32 v96, a16
v_accvgpr_read_b32 v97, a17
v_accvgpr_read_b32 v98, a18
v_accvgpr_read_b32 v99, a19
v_accvgpr_read_b32 v100, a20
v_accvgpr_read_b32 v101, a21
v_accvgpr_read_b32 v102, a22
v_accvgpr_read_b32 v103, a23
v_accvgpr_read_b32 v104, a24
v_accvgpr_read_b32 v105, a25
v_accvgpr_read_b32 v106, a26
v_accvgpr_read_b32 v107, a27
v_accvgpr_read_b32 v108, a28
v_accvgpr_read_b32 v109, a29
v_accvgpr_read_b32 v110, a30
v_accvgpr_read_b32 v111, a31
v_accvgpr_read_b32 v112, a128
v_accvgpr_read_b32 v113, a129
v_accvgpr_read_b32 v114, a130
v_accvgpr_read_b32 v115, a131
v_accvgpr_read_b32 v116, a132
v_accvgpr_read_b32 v117, a133
v_accvgpr_read_b32 v118, a134
v_accvgpr_read_b32 v119, a135
v_accvgpr_read_b32 v120, a136
v_accvgpr_read_b32 v121, a137
v_accvgpr_read_b32 v122, a138
v_accvgpr_read_b32 v123, a139
v_accvgpr_read_b32 v124, a140
v_accvgpr_read_b32 v125, a141
v_accvgpr_read_b32 v126, a142
v_accvgpr_read_b32 v127, a143
v_mul_f32 v32, s28, v96
v_mul_f32 v33, s28, v97
v_mul_f32 v34, s28, v98
v_mul_f32 v35, s28, v99
v_mul_f32 v36, s28, v100
v_mul_f32 v37, s28, v101
v_mul_f32 v38, s28, v102
v_mul_f32 v39, s28, v103
v_mul_f32 v40, s28, v104
v_mul_f32 v41, s28, v105
v_mul_f32 v42, s28, v106
v_mul_f32 v43, s28, v107
v_mul_f32 v44, s28, v108
v_mul_f32 v45, s28, v109
v_mul_f32 v46, s28, v110
v_mul_f32 v47, s28, v111
v_exp_f32 v32, v32
v_exp_f32 v33, v33
v_exp_f32 v34, v34
v_exp_f32 v35, v35
v_exp_f32 v36, v36
v_exp_f32 v37, v37
v_exp_f32 v38, v38
v_exp_f32 v39, v39
v_exp_f32 v40, v40
v_exp_f32 v41, v41
v_exp_f32 v42, v42
v_exp_f32 v43, v43
v_exp_f32 v44, v44
v_exp_f32 v45, v45
v_exp_f32 v46, v46
v_exp_f32 v47, v47
v_add_f32 v32, 1.0, v32
v_add_f32 v33, 1.0, v33
v_add_f32 v34, 1.0, v34
v_add_f32 v35, 1.0, v35
v_add_f32 v36, 1.0, v36
v_add_f32 v37, 1.0, v37
v_add_f32 v38, 1.0, v38
v_add_f32 v39, 1.0, v39
v_add_f32 v40, 1.0, v40
v_add_f32 v41, 1.0, v41
v_add_f32 v42, 1.0, v42
v_add_f32 v43, 1.0, v43
v_add_f32 v44, 1.0, v44
v_add_f32 v45, 1.0, v45
v_add_f32 v46, 1.0, v46
v_add_f32 v47, 1.0, v47
v_rcp_f32 v32, v32
v_rcp_f32 v33, v33
v_rcp_f32 v34, v34
v_rcp_f32 v35, v35
v_rcp_f32 v36, v36
v_rcp_f32 v37, v37
v_rcp_f32 v38, v38
v_rcp_f32 v39, v39
v_rcp_f32 v40, v40
v_rcp_f32 v41, v41
v_rcp_f32 v42, v42
v_rcp_f32 v43, v43
v_rcp_f32 v44, v44
v_rcp_f32 v45, v45
v_rcp_f32 v46, v46
v_rcp_f32 v47, v47
v_mul_f32 v96, v96, v32
v_mul_f32 v97, v97, v33
v_mul_f32 v98, v98, v34
v_mul_f32 v99, v99, v35
v_mul_f32 v100, v100, v36
v_mul_f32 v101, v101, v37
v_mul_f32 v102, v102, v38
v_mul_f32 v103, v103, v39
v_mul_f32 v104, v104, v40
v_mul_f32 v105, v105, v41
v_mul_f32 v106, v106, v42
v_mul_f32 v107, v107, v43
v_mul_f32 v108, v108, v44
v_mul_f32 v109, v109, v45
v_mul_f32 v110, v110, v46
v_mul_f32 v111, v111, v47
v_mul_f32 v96, v96, v112
v_mul_f32 v97, v97, v113
v_mul_f32 v98, v98, v114
v_mul_f32 v99, v99, v115
v_mul_f32 v100, v100, v116
v_mul_f32 v101, v101, v117
v_mul_f32 v102, v102, v118
v_mul_f32 v103, v103, v119
v_mul_f32 v104, v104, v120
v_mul_f32 v105, v105, v121
v_mul_f32 v106, v106, v122
v_mul_f32 v107, v107, v123
v_mul_f32 v108, v108, v124
v_mul_f32 v109, v109, v125
v_mul_f32 v110, v110, v126
v_mul_f32 v111, v111, v127
v_cvt_pk_bf16_f32 v96, v96, v97
v_cvt_pk_bf16_f32 v97, v98, v99
v_cvt_pk_bf16_f32 v98, v100, v101
v_cvt_pk_bf16_f32 v99, v102, v103
v_cvt_pk_bf16_f32 v100, v104, v105
v_cvt_pk_bf16_f32 v101, v106, v107
v_cvt_pk_bf16_f32 v102, v108, v109
v_cvt_pk_bf16_f32 v103, v110, v111
buffer_store_dwordx4 v[96:99], v2, s[8:11], s26 offen sc1
buffer_store_dwordx4 v[100:103], v2, s[8:11], s26 offen offset:1024 sc1
s_add_u32 s26, s26, 2048
v_accvgpr_read_b32 v64, a32
v_accvgpr_read_b32 v65, a33
v_accvgpr_read_b32 v66, a34
v_accvgpr_read_b32 v67, a35
v_accvgpr_read_b32 v68, a36
v_accvgpr_read_b32 v69, a37
v_accvgpr_read_b32 v70, a38
v_accvgpr_read_b32 v71, a39
v_accvgpr_read_b32 v72, a40
v_accvgpr_read_b32 v73, a41
v_accvgpr_read_b32 v74, a42
v_accvgpr_read_b32 v75, a43
v_accvgpr_read_b32 v76, a44
v_accvgpr_read_b32 v77, a45
v_accvgpr_read_b32 v78, a46
v_accvgpr_read_b32 v79, a47
v_accvgpr_read_b32 v80, a144
v_accvgpr_read_b32 v81, a145
v_accvgpr_read_b32 v82, a146
v_accvgpr_read_b32 v83, a147
v_accvgpr_read_b32 v84, a148
v_accvgpr_read_b32 v85, a149
v_accvgpr_read_b32 v86, a150
v_accvgpr_read_b32 v87, a151
v_accvgpr_read_b32 v88, a152
v_accvgpr_read_b32 v89, a153
v_accvgpr_read_b32 v90, a154
v_accvgpr_read_b32 v91, a155
v_accvgpr_read_b32 v92, a156
v_accvgpr_read_b32 v93, a157
v_accvgpr_read_b32 v94, a158
v_accvgpr_read_b32 v95, a159
v_mul_f32 v32, s28, v64
v_mul_f32 v33, s28, v65
v_mul_f32 v34, s28, v66
v_mul_f32 v35, s28, v67
v_mul_f32 v36, s28, v68
v_mul_f32 v37, s28, v69
v_mul_f32 v38, s28, v70
v_mul_f32 v39, s28, v71
v_mul_f32 v40, s28, v72
v_mul_f32 v41, s28, v73
v_mul_f32 v42, s28, v74
v_mul_f32 v43, s28, v75
v_mul_f32 v44, s28, v76
v_mul_f32 v45, s28, v77
v_mul_f32 v46, s28, v78
v_mul_f32 v47, s28, v79
v_exp_f32 v32, v32
v_exp_f32 v33, v33
v_exp_f32 v34, v34
v_exp_f32 v35, v35
v_exp_f32 v36, v36
v_exp_f32 v37, v37
v_exp_f32 v38, v38
v_exp_f32 v39, v39
v_exp_f32 v40, v40
v_exp_f32 v41, v41
v_exp_f32 v42, v42
v_exp_f32 v43, v43
v_exp_f32 v44, v44
v_exp_f32 v45, v45
v_exp_f32 v46, v46
v_exp_f32 v47, v47
v_add_f32 v32, 1.0, v32
v_add_f32 v33, 1.0, v33
v_add_f32 v34, 1.0, v34
v_add_f32 v35, 1.0, v35
v_add_f32 v36, 1.0, v36
v_add_f32 v37, 1.0, v37
v_add_f32 v38, 1.0, v38
v_add_f32 v39, 1.0, v39
v_add_f32 v40, 1.0, v40
v_add_f32 v41, 1.0, v41
v_add_f32 v42, 1.0, v42
v_add_f32 v43, 1.0, v43
v_add_f32 v44, 1.0, v44
v_add_f32 v45, 1.0, v45
v_add_f32 v46, 1.0, v46
v_add_f32 v47, 1.0, v47
v_rcp_f32 v32, v32
v_rcp_f32 v33, v33
v_rcp_f32 v34, v34
v_rcp_f32 v35, v35
v_rcp_f32 v36, v36
v_rcp_f32 v37, v37
v_rcp_f32 v38, v38
v_rcp_f32 v39, v39
v_rcp_f32 v40, v40
v_rcp_f32 v41, v41
v_rcp_f32 v42, v42
v_rcp_f32 v43, v43
v_rcp_f32 v44, v44
v_rcp_f32 v45, v45
v_rcp_f32 v46, v46
v_rcp_f32 v47, v47
v_mul_f32 v64, v64, v32
v_mul_f32 v65, v65, v33
v_mul_f32 v66, v66, v34
v_mul_f32 v67, v67, v35
v_mul_f32 v68, v68, v36
v_mul_f32 v69, v69, v37
v_mul_f32 v70, v70, v38
v_mul_f32 v71, v71, v39
v_mul_f32 v72, v72, v40
v_mul_f32 v73, v73, v41
v_mul_f32 v74, v74, v42
v_mul_f32 v75, v75, v43
v_mul_f32 v76, v76, v44
v_mul_f32 v77, v77, v45
v_mul_f32 v78, v78, v46
v_mul_f32 v79, v79, v47
v_mul_f32 v64, v64, v80
v_mul_f32 v65, v65, v81
v_mul_f32 v66, v66, v82
v_mul_f32 v67, v67, v83
v_mul_f32 v68, v68, v84
v_mul_f32 v69, v69, v85
v_mul_f32 v70, v70, v86
v_mul_f32 v71, v71, v87
v_mul_f32 v72, v72, v88
v_mul_f32 v73, v73, v89
v_mul_f32 v74, v74, v90
v_mul_f32 v75, v75, v91
v_mul_f32 v76, v76, v92
v_mul_f32 v77, v77, v93
v_mul_f32 v78, v78, v94
v_mul_f32 v79, v79, v95
v_cvt_pk_bf16_f32 v64, v64, v65
v_cvt_pk_bf16_f32 v65, v66, v67
v_cvt_pk_bf16_f32 v66, v68, v69
v_cvt_pk_bf16_f32 v67, v70, v71
v_cvt_pk_bf16_f32 v68, v72, v73
v_cvt_pk_bf16_f32 v69, v74, v75
v_cvt_pk_bf16_f32 v70, v76, v77
v_cvt_pk_bf16_f32 v71, v78, v79
buffer_store_dwordx4 v[64:67], v2, s[8:11], s26 offen sc1
buffer_store_dwordx4 v[68:71], v2, s[8:11], s26 offen offset:1024 sc1
s_add_u32 s26, s26, 2048
v_accvgpr_read_b32 v96, a48
v_accvgpr_read_b32 v97, a49
v_accvgpr_read_b32 v98, a50
v_accvgpr_read_b32 v99, a51
v_accvgpr_read_b32 v100, a52
v_accvgpr_read_b32 v101, a53
v_accvgpr_read_b32 v102, a54
v_accvgpr_read_b32 v103, a55
v_accvgpr_read_b32 v104, a56
v_accvgpr_read_b32 v105, a57
v_accvgpr_read_b32 v106, a58
v_accvgpr_read_b32 v107, a59
v_accvgpr_read_b32 v108, a60
v_accvgpr_read_b32 v109, a61
v_accvgpr_read_b32 v110, a62
v_accvgpr_read_b32 v111, a63
v_accvgpr_read_b32 v112, a160
v_accvgpr_read_b32 v113, a161
v_accvgpr_read_b32 v114, a162
v_accvgpr_read_b32 v115, a163
v_accvgpr_read_b32 v116, a164
v_accvgpr_read_b32 v117, a165
v_accvgpr_read_b32 v118, a166
v_accvgpr_read_b32 v119, a167
v_accvgpr_read_b32 v120, a168
v_accvgpr_read_b32 v121, a169
v_accvgpr_read_b32 v122, a170
v_accvgpr_read_b32 v123, a171
v_accvgpr_read_b32 v124, a172
v_accvgpr_read_b32 v125, a173
v_accvgpr_read_b32 v126, a174
v_accvgpr_read_b32 v127, a175
v_mul_f32 v32, s28, v96
v_mul_f32 v33, s28, v97
v_mul_f32 v34, s28, v98
v_mul_f32 v35, s28, v99
v_mul_f32 v36, s28, v100
v_mul_f32 v37, s28, v101
v_mul_f32 v38, s28, v102
v_mul_f32 v39, s28, v103
v_mul_f32 v40, s28, v104
v_mul_f32 v41, s28, v105
v_mul_f32 v42, s28, v106
v_mul_f32 v43, s28, v107
v_mul_f32 v44, s28, v108
v_mul_f32 v45, s28, v109
v_mul_f32 v46, s28, v110
v_mul_f32 v47, s28, v111
v_exp_f32 v32, v32
v_exp_f32 v33, v33
v_exp_f32 v34, v34
v_exp_f32 v35, v35
v_exp_f32 v36, v36
v_exp_f32 v37, v37
v_exp_f32 v38, v38
v_exp_f32 v39, v39
v_exp_f32 v40, v40
v_exp_f32 v41, v41
v_exp_f32 v42, v42
v_exp_f32 v43, v43
v_exp_f32 v44, v44
v_exp_f32 v45, v45
v_exp_f32 v46, v46
v_exp_f32 v47, v47
v_add_f32 v32, 1.0, v32
v_add_f32 v33, 1.0, v33
v_add_f32 v34, 1.0, v34
v_add_f32 v35, 1.0, v35
v_add_f32 v36, 1.0, v36
v_add_f32 v37, 1.0, v37
v_add_f32 v38, 1.0, v38
v_add_f32 v39, 1.0, v39
v_add_f32 v40, 1.0, v40
v_add_f32 v41, 1.0, v41
v_add_f32 v42, 1.0, v42
v_add_f32 v43, 1.0, v43
v_add_f32 v44, 1.0, v44
v_add_f32 v45, 1.0, v45
v_add_f32 v46, 1.0, v46
v_add_f32 v47, 1.0, v47
v_rcp_f32 v32, v32
v_rcp_f32 v33, v33
v_rcp_f32 v34, v34
v_rcp_f32 v35, v35
v_rcp_f32 v36, v36
v_rcp_f32 v37, v37
v_rcp_f32 v38, v38
v_rcp_f32 v39, v39
v_rcp_f32 v40, v40
v_rcp_f32 v41, v41
v_rcp_f32 v42, v42
v_rcp_f32 v43, v43
v_rcp_f32 v44, v44
v_rcp_f32 v45, v45
v_rcp_f32 v46, v46
v_rcp_f32 v47, v47
v_mul_f32 v96, v96, v32
v_mul_f32 v97, v97, v33
v_mul_f32 v98, v98, v34
v_mul_f32 v99, v99, v35
v_mul_f32 v100, v100, v36
v_mul_f32 v101, v101, v37
v_mul_f32 v102, v102, v38
v_mul_f32 v103, v103, v39
v_mul_f32 v104, v104, v40
v_mul_f32 v105, v105, v41
v_mul_f32 v106, v106, v42
v_mul_f32 v107, v107, v43
v_mul_f32 v108, v108, v44
v_mul_f32 v109, v109, v45
v_mul_f32 v110, v110, v46
v_mul_f32 v111, v111, v47
v_mul_f32 v96, v96, v112
v_mul_f32 v97, v97, v113
v_mul_f32 v98, v98, v114
v_mul_f32 v99, v99, v115
v_mul_f32 v100, v100, v116
v_mul_f32 v101, v101, v117
v_mul_f32 v102, v102, v118
v_mul_f32 v103, v103, v119
v_mul_f32 v104, v104, v120
v_mul_f32 v105, v105, v121
v_mul_f32 v106, v106, v122
v_mul_f32 v107, v107, v123
v_mul_f32 v108, v108, v124
v_mul_f32 v109, v109, v125
v_mul_f32 v110, v110, v126
v_mul_f32 v111, v111, v127
v_cvt_pk_bf16_f32 v96, v96, v97
v_cvt_pk_bf16_f32 v97, v98, v99
v_cvt_pk_bf16_f32 v98, v100, v101
v_cvt_pk_bf16_f32 v99, v102, v103
v_cvt_pk_bf16_f32 v100, v104, v105
v_cvt_pk_bf16_f32 v101, v106, v107
v_cvt_pk_bf16_f32 v102, v108, v109
v_cvt_pk_bf16_f32 v103, v110, v111
buffer_store_dwordx4 v[96:99], v2, s[8:11], s26 offen sc1
buffer_store_dwordx4 v[100:103], v2, s[8:11], s26 offen offset:1024 sc1
s_add_u32 s26, s26, 2048
v_accvgpr_read_b32 v64, a64
v_accvgpr_read_b32 v65, a65
v_accvgpr_read_b32 v66, a66
v_accvgpr_read_b32 v67, a67
v_accvgpr_read_b32 v68, a68
v_accvgpr_read_b32 v69, a69
v_accvgpr_read_b32 v70, a70
v_accvgpr_read_b32 v71, a71
v_accvgpr_read_b32 v72, a72
v_accvgpr_read_b32 v73, a73
v_accvgpr_read_b32 v74, a74
v_accvgpr_read_b32 v75, a75
v_accvgpr_read_b32 v76, a76
v_accvgpr_read_b32 v77, a77
v_accvgpr_read_b32 v78, a78
v_accvgpr_read_b32 v79, a79
v_accvgpr_read_b32 v80, a176
v_accvgpr_read_b32 v81, a177
v_accvgpr_read_b32 v82, a178
v_accvgpr_read_b32 v83, a179
v_accvgpr_read_b32 v84, a180
v_accvgpr_read_b32 v85, a181
v_accvgpr_read_b32 v86, a182
v_accvgpr_read_b32 v87, a183
v_accvgpr_read_b32 v88, a184
v_accvgpr_read_b32 v89, a185
v_accvgpr_read_b32 v90, a186
v_accvgpr_read_b32 v91, a187
v_accvgpr_read_b32 v92, a188
v_accvgpr_read_b32 v93, a189
v_accvgpr_read_b32 v94, a190
v_accvgpr_read_b32 v95, a191
v_mul_f32 v32, s28, v64
v_mul_f32 v33, s28, v65
v_mul_f32 v34, s28, v66
v_mul_f32 v35, s28, v67
v_mul_f32 v36, s28, v68
v_mul_f32 v37, s28, v69
v_mul_f32 v38, s28, v70
v_mul_f32 v39, s28, v71
v_mul_f32 v40, s28, v72
v_mul_f32 v41, s28, v73
v_mul_f32 v42, s28, v74
v_mul_f32 v43, s28, v75
v_mul_f32 v44, s28, v76
v_mul_f32 v45, s28, v77
v_mul_f32 v46, s28, v78
v_mul_f32 v47, s28, v79
v_exp_f32 v32, v32
v_exp_f32 v33, v33
v_exp_f32 v34, v34
v_exp_f32 v35, v35
v_exp_f32 v36, v36
v_exp_f32 v37, v37
v_exp_f32 v38, v38
v_exp_f32 v39, v39
v_exp_f32 v40, v40
v_exp_f32 v41, v41
v_exp_f32 v42, v42
v_exp_f32 v43, v43
v_exp_f32 v44, v44
v_exp_f32 v45, v45
v_exp_f32 v46, v46
v_exp_f32 v47, v47
v_add_f32 v32, 1.0, v32
v_add_f32 v33, 1.0, v33
v_add_f32 v34, 1.0, v34
v_add_f32 v35, 1.0, v35
v_add_f32 v36, 1.0, v36
v_add_f32 v37, 1.0, v37
v_add_f32 v38, 1.0, v38
v_add_f32 v39, 1.0, v39
v_add_f32 v40, 1.0, v40
v_add_f32 v41, 1.0, v41
v_add_f32 v42, 1.0, v42
v_add_f32 v43, 1.0, v43
v_add_f32 v44, 1.0, v44
v_add_f32 v45, 1.0, v45
v_add_f32 v46, 1.0, v46
v_add_f32 v47, 1.0, v47
v_rcp_f32 v32, v32
v_rcp_f32 v33, v33
v_rcp_f32 v34, v34
v_rcp_f32 v35, v35
v_rcp_f32 v36, v36
v_rcp_f32 v37, v37
v_rcp_f32 v38, v38
v_rcp_f32 v39, v39
v_rcp_f32 v40, v40
v_rcp_f32 v41, v41
v_rcp_f32 v42, v42
v_rcp_f32 v43, v43
v_rcp_f32 v44, v44
v_rcp_f32 v45, v45
v_rcp_f32 v46, v46
v_rcp_f32 v47, v47
v_mul_f32 v64, v64, v32
v_mul_f32 v65, v65, v33
v_mul_f32 v66, v66, v34
v_mul_f32 v67, v67, v35
v_mul_f32 v68, v68, v36
v_mul_f32 v69, v69, v37
v_mul_f32 v70, v70, v38
v_mul_f32 v71, v71, v39
v_mul_f32 v72, v72, v40
v_mul_f32 v73, v73, v41
v_mul_f32 v74, v74, v42
v_mul_f32 v75, v75, v43
v_mul_f32 v76, v76, v44
v_mul_f32 v77, v77, v45
v_mul_f32 v78, v78, v46
v_mul_f32 v79, v79, v47
v_mul_f32 v64, v64, v80
v_mul_f32 v65, v65, v81
v_mul_f32 v66, v66, v82
v_mul_f32 v67, v67, v83
v_mul_f32 v68, v68, v84
v_mul_f32 v69, v69, v85
v_mul_f32 v70, v70, v86
v_mul_f32 v71, v71, v87
v_mul_f32 v72, v72, v88
v_mul_f32 v73, v73, v89
v_mul_f32 v74, v74, v90
v_mul_f32 v75, v75, v91
v_mul_f32 v76, v76, v92
v_mul_f32 v77, v77, v93
v_mul_f32 v78, v78, v94
v_mul_f32 v79, v79, v95
v_cvt_pk_bf16_f32 v64, v64, v65
v_cvt_pk_bf16_f32 v65, v66, v67
v_cvt_pk_bf16_f32 v66, v68, v69
v_cvt_pk_bf16_f32 v67, v70, v71
v_cvt_pk_bf16_f32 v68, v72, v73
v_cvt_pk_bf16_f32 v69, v74, v75
v_cvt_pk_bf16_f32 v70, v76, v77
v_cvt_pk_bf16_f32 v71, v78, v79
buffer_store_dwordx4 v[64:67], v2, s[8:11], s26 offen sc1
buffer_store_dwordx4 v[68:71], v2, s[8:11], s26 offen offset:1024 sc1
s_add_u32 s26, s26, 2048
v_accvgpr_read_b32 v96, a80
v_accvgpr_read_b32 v97, a81
v_accvgpr_read_b32 v98, a82
v_accvgpr_read_b32 v99, a83
v_accvgpr_read_b32 v100, a84
v_accvgpr_read_b32 v101, a85
v_accvgpr_read_b32 v102, a86
v_accvgpr_read_b32 v103, a87
v_accvgpr_read_b32 v104, a88
v_accvgpr_read_b32 v105, a89
v_accvgpr_read_b32 v106, a90
v_accvgpr_read_b32 v107, a91
v_accvgpr_read_b32 v108, a92
v_accvgpr_read_b32 v109, a93
v_accvgpr_read_b32 v110, a94
v_accvgpr_read_b32 v111, a95
v_accvgpr_read_b32 v112, a192
v_accvgpr_read_b32 v113, a193
v_accvgpr_read_b32 v114, a194
v_accvgpr_read_b32 v115, a195
v_accvgpr_read_b32 v116, a196
v_accvgpr_read_b32 v117, a197
v_accvgpr_read_b32 v118, a198
v_accvgpr_read_b32 v119, a199
v_accvgpr_read_b32 v120, a200
v_accvgpr_read_b32 v121, a201
v_accvgpr_read_b32 v122, a202
v_accvgpr_read_b32 v123, a203
v_accvgpr_read_b32 v124, a204
v_accvgpr_read_b32 v125, a205
v_accvgpr_read_b32 v126, a206
v_accvgpr_read_b32 v127, a207
v_mul_f32 v32, s28, v96
v_mul_f32 v33, s28, v97
v_mul_f32 v34, s28, v98
v_mul_f32 v35, s28, v99
v_mul_f32 v36, s28, v100
v_mul_f32 v37, s28, v101
v_mul_f32 v38, s28, v102
v_mul_f32 v39, s28, v103
v_mul_f32 v40, s28, v104
v_mul_f32 v41, s28, v105
v_mul_f32 v42, s28, v106
v_mul_f32 v43, s28, v107
v_mul_f32 v44, s28, v108
v_mul_f32 v45, s28, v109
v_mul_f32 v46, s28, v110
v_mul_f32 v47, s28, v111
v_exp_f32 v32, v32
v_exp_f32 v33, v33
v_exp_f32 v34, v34
v_exp_f32 v35, v35
v_exp_f32 v36, v36
v_exp_f32 v37, v37
v_exp_f32 v38, v38
v_exp_f32 v39, v39
v_exp_f32 v40, v40
v_exp_f32 v41, v41
v_exp_f32 v42, v42
v_exp_f32 v43, v43
v_exp_f32 v44, v44
v_exp_f32 v45, v45
v_exp_f32 v46, v46
v_exp_f32 v47, v47
v_add_f32 v32, 1.0, v32
v_add_f32 v33, 1.0, v33
v_add_f32 v34, 1.0, v34
v_add_f32 v35, 1.0, v35
v_add_f32 v36, 1.0, v36
v_add_f32 v37, 1.0, v37
v_add_f32 v38, 1.0, v38
v_add_f32 v39, 1.0, v39
v_add_f32 v40, 1.0, v40
v_add_f32 v41, 1.0, v41
v_add_f32 v42, 1.0, v42
v_add_f32 v43, 1.0, v43
v_add_f32 v44, 1.0, v44
v_add_f32 v45, 1.0, v45
v_add_f32 v46, 1.0, v46
v_add_f32 v47, 1.0, v47
v_rcp_f32 v32, v32
v_rcp_f32 v33, v33
v_rcp_f32 v34, v34
v_rcp_f32 v35, v35
v_rcp_f32 v36, v36
v_rcp_f32 v37, v37
v_rcp_f32 v38, v38
v_rcp_f32 v39, v39
v_rcp_f32 v40, v40
v_rcp_f32 v41, v41
v_rcp_f32 v42, v42
v_rcp_f32 v43, v43
v_rcp_f32 v44, v44
v_rcp_f32 v45, v45
v_rcp_f32 v46, v46
v_rcp_f32 v47, v47
v_mul_f32 v96, v96, v32
v_mul_f32 v97, v97, v33
v_mul_f32 v98, v98, v34
v_mul_f32 v99, v99, v35
v_mul_f32 v100, v100, v36
v_mul_f32 v101, v101, v37
v_mul_f32 v102, v102, v38
v_mul_f32 v103, v103, v39
v_mul_f32 v104, v104, v40
v_mul_f32 v105, v105, v41
v_mul_f32 v106, v106, v42
v_mul_f32 v107, v107, v43
v_mul_f32 v108, v108, v44
v_mul_f32 v109, v109, v45
v_mul_f32 v110, v110, v46
v_mul_f32 v111, v111, v47
v_mul_f32 v96, v96, v112
v_mul_f32 v97, v97, v113
v_mul_f32 v98, v98, v114
v_mul_f32 v99, v99, v115
v_mul_f32 v100, v100, v116
v_mul_f32 v101, v101, v117
v_mul_f32 v102, v102, v118
v_mul_f32 v103, v103, v119
v_mul_f32 v104, v104, v120
v_mul_f32 v105, v105, v121
v_mul_f32 v106, v106, v122
v_mul_f32 v107, v107, v123
v_mul_f32 v108, v108, v124
v_mul_f32 v109, v109, v125
v_mul_f32 v110, v110, v126
v_mul_f32 v111, v111, v127
v_cvt_pk_bf16_f32 v96, v96, v97
v_cvt_pk_bf16_f32 v97, v98, v99
v_cvt_pk_bf16_f32 v98, v100, v101
v_cvt_pk_bf16_f32 v99, v102, v103
v_cvt_pk_bf16_f32 v100, v104, v105
v_cvt_pk_bf16_f32 v101, v106, v107
v_cvt_pk_bf16_f32 v102, v108, v109
v_cvt_pk_bf16_f32 v103, v110, v111
buffer_store_dwordx4 v[96:99], v2, s[8:11], s26 offen sc1
buffer_store_dwordx4 v[100:103], v2, s[8:11], s26 offen offset:1024 sc1
s_add_u32 s26, s26, 2048
v_accvgpr_read_b32 v64, a96
v_accvgpr_read_b32 v65, a97
v_accvgpr_read_b32 v66, a98
v_accvgpr_read_b32 v67, a99
v_accvgpr_read_b32 v68, a100
v_accvgpr_read_b32 v69, a101
v_accvgpr_read_b32 v70, a102
v_accvgpr_read_b32 v71, a103
v_accvgpr_read_b32 v72, a104
v_accvgpr_read_b32 v73, a105
v_accvgpr_read_b32 v74, a106
v_accvgpr_read_b32 v75, a107
v_accvgpr_read_b32 v76, a108
v_accvgpr_read_b32 v77, a109
v_accvgpr_read_b32 v78, a110
v_accvgpr_read_b32 v79, a111
v_accvgpr_read_b32 v80, a208
v_accvgpr_read_b32 v81, a209
v_accvgpr_read_b32 v82, a210
v_accvgpr_read_b32 v83, a211
v_accvgpr_read_b32 v84, a212
v_accvgpr_read_b32 v85, a213
v_accvgpr_read_b32 v86, a214
v_accvgpr_read_b32 v87, a215
v_accvgpr_read_b32 v88, a216
v_accvgpr_read_b32 v89, a217
v_accvgpr_read_b32 v90, a218
v_accvgpr_read_b32 v91, a219
v_accvgpr_read_b32 v92, a220
v_accvgpr_read_b32 v93, a221
v_accvgpr_read_b32 v94, a222
v_accvgpr_read_b32 v95, a223
v_mul_f32 v32, s28, v64
v_mul_f32 v33, s28, v65
v_mul_f32 v34, s28, v66
v_mul_f32 v35, s28, v67
v_mul_f32 v36, s28, v68
v_mul_f32 v37, s28, v69
v_mul_f32 v38, s28, v70
v_mul_f32 v39, s28, v71
v_mul_f32 v40, s28, v72
v_mul_f32 v41, s28, v73
v_mul_f32 v42, s28, v74
v_mul_f32 v43, s28, v75
v_mul_f32 v44, s28, v76
v_mul_f32 v45, s28, v77
v_mul_f32 v46, s28, v78
v_mul_f32 v47, s28, v79
v_exp_f32 v32, v32
v_exp_f32 v33, v33
v_exp_f32 v34, v34
v_exp_f32 v35, v35
v_exp_f32 v36, v36
v_exp_f32 v37, v37
v_exp_f32 v38, v38
v_exp_f32 v39, v39
v_exp_f32 v40, v40
v_exp_f32 v41, v41
v_exp_f32 v42, v42
v_exp_f32 v43, v43
v_exp_f32 v44, v44
v_exp_f32 v45, v45
v_exp_f32 v46, v46
v_exp_f32 v47, v47
v_add_f32 v32, 1.0, v32
v_add_f32 v33, 1.0, v33
v_add_f32 v34, 1.0, v34
v_add_f32 v35, 1.0, v35
v_add_f32 v36, 1.0, v36
v_add_f32 v37, 1.0, v37
v_add_f32 v38, 1.0, v38
v_add_f32 v39, 1.0, v39
v_add_f32 v40, 1.0, v40
v_add_f32 v41, 1.0, v41
v_add_f32 v42, 1.0, v42
v_add_f32 v43, 1.0, v43
v_add_f32 v44, 1.0, v44
v_add_f32 v45, 1.0, v45
v_add_f32 v46, 1.0, v46
v_add_f32 v47, 1.0, v47
v_rcp_f32 v32, v32
v_rcp_f32 v33, v33
v_rcp_f32 v34, v34
v_rcp_f32 v35, v35
v_rcp_f32 v36, v36
v_rcp_f32 v37, v37
v_rcp_f32 v38, v38
v_rcp_f32 v39, v39
v_rcp_f32 v40, v40
v_rcp_f32 v41, v41
v_rcp_f32 v42, v42
v_rcp_f32 v43, v43
v_rcp_f32 v44, v44
v_rcp_f32 v45, v45
v_rcp_f32 v46, v46
v_rcp_f32 v47, v47
v_mul_f32 v64, v64, v32
v_mul_f32 v65, v65, v33
v_mul_f32 v66, v66, v34
v_mul_f32 v67, v67, v35
v_mul_f32 v68, v68, v36
v_mul_f32 v69, v69, v37
v_mul_f32 v70, v70, v38
v_mul_f32 v71, v71, v39
v_mul_f32 v72, v72, v40
v_mul_f32 v73, v73, v41
v_mul_f32 v74, v74, v42
v_mul_f32 v75, v75, v43
v_mul_f32 v76, v76, v44
v_mul_f32 v77, v77, v45
v_mul_f32 v78, v78, v46
v_mul_f32 v79, v79, v47
v_mul_f32 v64, v64, v80
v_mul_f32 v65, v65, v81
v_mul_f32 v66, v66, v82
v_mul_f32 v67, v67, v83
v_mul_f32 v68, v68, v84
v_mul_f32 v69, v69, v85
v_mul_f32 v70, v70, v86
v_mul_f32 v71, v71, v87
v_mul_f32 v72, v72, v88
v_mul_f32 v73, v73, v89
v_mul_f32 v74, v74, v90
v_mul_f32 v75, v75, v91
v_mul_f32 v76, v76, v92
v_mul_f32 v77, v77, v93
v_mul_f32 v78, v78, v94
v_mul_f32 v79, v79, v95
v_cvt_pk_bf16_f32 v64, v64, v65
v_cvt_pk_bf16_f32 v65, v66, v67
v_cvt_pk_bf16_f32 v66, v68, v69
v_cvt_pk_bf16_f32 v67, v70, v71
v_cvt_pk_bf16_f32 v68, v72, v73
v_cvt_pk_bf16_f32 v69, v74, v75
v_cvt_pk_bf16_f32 v70, v76, v77
v_cvt_pk_bf16_f32 v71, v78, v79
buffer_store_dwordx4 v[64:67], v2, s[8:11], s26 offen sc1
buffer_store_dwordx4 v[68:71], v2, s[8:11], s26 offen offset:1024 sc1
s_add_u32 s26, s26, 2048
s_waitcnt vmcnt(0)
s_barrier
s_cmp_lg_u32 s17, 0
s_cbranch_scc1 Lsig_62
s_lshl_b32 s26, s21, 7
s_add_u32 s26, s26, 54855680
v_mov_b32 v26, 1
v_mov_b32 v27, 1073741824
v_cmp_eq_u32 vcc, 0, v1
s_nop 1
v_cndmask_b32 v27, v27, v25, vcc
buffer_atomic_add v26, v27, s[8:11], s26 offen
Lsig_62:
s_branch Lnext_23
.p2align 6
LiF2_26:
v_lshrrev_b32 v26, 5, v1
v_bfe_u32 v27, v1, 2, 3
v_xor_b32 v27, v27, v26
v_and_b32 v28, 3, v1
v_mul_u32_u24 v29, 896, v26
v_lshl_add_u32 v29, v28, 4, v29
v_mov_b32 v30, 1073741824
v_lshl_add_u32 v3, v27, 6, v29
v_cmp_gt_u32 vcc, 7, v27
v_xor_b32 v27, 2, v27
v_lshl_add_u32 v4, v27, 6, v29
v_cndmask_b32 v3, v30, v3, vcc
v_cmp_gt_u32 vcc, 7, v27
s_nop 1
v_cndmask_b32 v4, v30, v4, vcc
v_bfe_u32 v26, v1, 2, 2
v_lshrrev_b32 v27, 5, v1
v_lshl_add_u32 v27, v27, 3, v26
v_lshlrev_b32 v27, 9, v27
v_bfe_u32 v28, v1, 4, 1
v_lshl_add_u32 v27, v28, 5, v27
v_and_b32 v28, 1, v1
v_lshl_add_u32 v27, v28, 4, v27
v_bfe_u32 v28, v1, 1, 1
v_lshl_add_u32 v27, v28, 3, v27
v_xor_b32 v28, 0, v26
v_lshl_add_u32 v5, v28, 6, v27
v_add_u32 v12, 0x10000, v5
v_xor_b32 v28, 1, v26
v_lshl_add_u32 v6, v28, 6, v27
v_add_u32 v13, 0x10000, v6
v_xor_b32 v28, 2, v26
v_lshl_add_u32 v7, v28, 6, v27
v_add_u32 v14, 0x10000, v7
v_xor_b32 v28, 3, v26
v_lshl_add_u32 v8, v28, 6, v27
v_add_u32 v15, 0x10000, v8
v_xor_b32 v28, 4, v26
v_lshl_add_u32 v9, v28, 6, v27
v_add_u32 v16, 0x10000, v9
v_xor_b32 v28, 5, v26
v_lshl_add_u32 v10, v28, 6, v27
v_add_u32 v17, 0x10000, v10
v_xor_b32 v28, 6, v26
v_lshl_add_u32 v11, v28, 6, v27
v_add_u32 v18, 0x10000, v11
s_lshl_b32 s25, s17, 13
s_mov_b32 s52, s48
s_mov_b32 s53, s49
s_mov_b32 s54, 1605632
s_mov_b32 s55, 0x00020000
s_mul_i32 s24, s17, 14336
s_mul_i32 s26, s22, 448
s_add_u32 s24, s24, s26
s_mul_i32 s29, s23, 114688
s_add_u32 s29, s29, 57671680
s_lshl_b32 s27, s21, 7
s_add_u32 s27, s27, 54855680
s_cmp_lg_u32 s17, 0
s_cbranch_scc1 Lwo_64
Lwm_63:
buffer_load_dword v26, v25, s[8:11], s27 offen sc1
s_waitcnt vmcnt(0)
v_cmp_gt_u32 vcc, 8, v26
s_cbranch_vccz Lwo_64
s_sleep 8
s_sub_u32 s19, s19, 1
s_cbranch_scc0 Lwm_63
s_mov_b32 s19, 0
Lwo_64:
s_barrier
s_add_u32 m0, s25, 0
s_add_u32 s26, s24, 0
buffer_load_dwordx4 v3, s[52:55], s26 offen lds
s_add_u32 m0, s25, 1024
s_add_u32 s26, s24, 1792
buffer_load_dwordx4 v4, s[52:55], s26 offen lds
s_add_u32 m0, s25, 2048
s_add_u32 s26, s24, 3584
buffer_load_dwordx4 v3, s[52:55], s26 offen lds
s_add_u32 m0, s25, 3072
s_add_u32 s26, s24, 5376
buffer_load_dwordx4 v4, s[52:55], s26 offen lds
s_add_u32 m0, s25, 4096
s_add_u32 s26, s24, 7168
buffer_load_dwordx4 v3, s[52:55], s26 offen lds
s_add_u32 m0, s25, 5120
s_add_u32 s26, s24, 8960
buffer_load_dwordx4 v4, s[52:55], s26 offen lds
s_add_u32 m0, s25, 6144
s_add_u32 s26, s24, 10752
buffer_load_dwordx4 v3, s[52:55], s26 offen lds
s_add_u32 m0, s25, 7168
s_add_u32 s26, s24, 12544
buffer_load_dwordx4 v4, s[52:55], s26 offen lds
s_add_u32 s24, s24, 57344
buffer_load_dwordx4 v[128:131], v2, s[8:11], s29 offen offset:0 sc1
buffer_load_dwordx4 v[132:135], v2, s[8:11], s29 offen offset:1024 sc1
buffer_load_dwordx4 v[136:139], v2, s[8:11], s29 offen offset:2048 sc1
buffer_load_dwordx4 v[140:143], v2, s[8:11], s29 offen offset:3072 sc1
s_add_u32 s29, s29, 4096
s_add_u32 m0, s25, 32768
s_add_u32 s26, s24, 0
buffer_load_dwordx4 v3, s[52:55], s26 offen lds
s_add_u32 m0, s25, 33792
s_add_u32 s26, s24, 1792
buffer_load_dwordx4 v4, s[52:55], s26 offen lds
s_add_u32 m0, s25, 34816
s_add_u32 s26, s24, 3584
buffer_load_dwordx4 v3, s[52:55], s26 offen lds
s_add_u32 m0, s25, 35840
s_add_u32 s26, s24, 5376
buffer_load_dwordx4 v4, s[52:55], s26 offen lds
s_add_u32 m0, s25, 36864
s_add_u32 s26, s24, 7168
buffer_load_dwordx4 v3, s[52:55], s26 offen lds
s_add_u32 m0, s25, 37888
s_add_u32 s26, s24, 8960
buffer_load_dwordx4 v4, s[52:55], s26 offen lds
s_add_u32 m0, s25, 38912
s_add_u32 s26, s24, 10752
buffer_load_dwordx4 v3, s[52:55], s26 offen lds
s_add_u32 m0, s25, 39936
s_add_u32 s26, s24, 12544
buffer_load_dwordx4 v4, s[52:55], s26 offen lds
s_add_u32 s24, s24, 57344
buffer_load_dwordx4 v[144:147], v2, s[8:11], s29 offen offset:0 sc1
buffer_load_dwordx4 v[148:151], v2, s[8:11], s29 offen offset:1024 sc1
buffer_load_dwordx4 v[152:155], v2, s[8:11], s29 offen offset:2048 sc1
buffer_load_dwordx4 v[156:159], v2, s[8:11], s29 offen offset:3072 sc1
s_add_u32 s29, s29, 4096
s_add_u32 m0, s25, 65536
s_add_u32 s26, s24, 0
buffer_load_dwordx4 v3, s[52:55], s26 offen lds
s_add_u32 m0, s25, 66560
s_add_u32 s26, s24, 1792
buffer_load_dwordx4 v4, s[52:55], s26 offen lds
s_add_u32 m0, s25, 67584
s_add_u32 s26, s24, 3584
buffer_load_dwordx4 v3, s[52:55], s26 offen lds
s_add_u32 m0, s25, 68608
s_add_u32 s26, s24, 5376
buffer_load_dwordx4 v4, s[52:55], s26 offen lds
s_add_u32 m0, s25, 69632
s_add_u32 s26, s24, 7168
buffer_load_dwordx4 v3, s[52:55], s26 offen lds
s_add_u32 m0, s25, 70656
s_add_u32 s26, s24, 8960
buffer_load_dwordx4 v4, s[52:55], s26 offen lds
s_add_u32 m0, s25, 71680
s_add_u32 s26, s24, 10752
buffer_load_dwordx4 v3, s[52:55], s26 offen lds
s_add_u32 m0, s25, 72704
s_add_u32 s26, s24, 12544
buffer_load_dwordx4 v4, s[52:55], s26 offen lds
s_add_u32 s24, s24, 57344
buffer_load_dwordx4 v[160:163], v2, s[8:11], s29 offen offset:0 sc1
buffer_load_dwordx4 v[164:167], v2, s[8:11], s29 offen offset:1024 sc1
buffer_load_dwordx4 v[168:171], v2, s[8:11], s29 offen offset:2048 sc1
buffer_load_dwordx4 v[172:175], v2, s[8:11], s29 offen offset:3072 sc1
s_add_u32 s29, s29, 4096
v_accvgpr_write_b32 a0, 0
v_accvgpr_write_b32 a1, 0
v_accvgpr_write_b32 a2, 0
v_accvgpr_write_b32 a3, 0
v_accvgpr_write_b32 a4, 0
v_accvgpr_write_b32 a5, 0
v_accvgpr_write_b32 a6, 0
v_accvgpr_write_b32 a7, 0
v_accvgpr_write_b32 a8, 0
v_accvgpr_write_b32 a9, 0
v_accvgpr_write_b32 a10, 0
v_accvgpr_write_b32 a11, 0
v_accvgpr_write_b32 a12, 0
v_accvgpr_write_b32 a13, 0
v_accvgpr_write_b32 a14, 0
v_accvgpr_write_b32 a15, 0
v_accvgpr_write_b32 a16, 0
v_accvgpr_write_b32 a17, 0
v_accvgpr_write_b32 a18, 0
v_accvgpr_write_b32 a19, 0
v_accvgpr_write_b32 a20, 0
v_accvgpr_write_b32 a21, 0
v_accvgpr_write_b32 a22, 0
v_accvgpr_write_b32 a23, 0
v_accvgpr_write_b32 a24, 0
v_accvgpr_write_b32 a25, 0
v_accvgpr_write_b32 a26, 0
v_accvgpr_write_b32 a27, 0
v_accvgpr_write_b32 a28, 0
v_accvgpr_write_b32 a29, 0
v_accvgpr_write_b32 a30, 0
v_accvgpr_write_b32 a31, 0
v_accvgpr_write_b32 a32, 0
v_accvgpr_write_b32 a33, 0
v_accvgpr_write_b32 a34, 0
v_accvgpr_write_b32 a35, 0
v_accvgpr_write_b32 a36, 0
v_accvgpr_write_b32 a37, 0
v_accvgpr_write_b32 a38, 0
v_accvgpr_write_b32 a39, 0
v_accvgpr_write_b32 a40, 0
v_accvgpr_write_b32 a41, 0
v_accvgpr_write_b32 a42, 0
v_accvgpr_write_b32 a43, 0
v_accvgpr_write_b32 a44, 0
v_accvgpr_write_b32 a45, 0
v_accvgpr_write_b32 a46, 0
v_accvgpr_write_b32 a47, 0
v_accvgpr_write_b32 a48, 0
v_accvgpr_write_b32 a49, 0
v_accvgpr_write_b32 a50, 0
v_accvgpr_write_b32 a51, 0
v_accvgpr_write_b32 a52, 0
v_accvgpr_write_b32 a53, 0
v_accvgpr_write_b32 a54, 0
v_accvgpr_write_b32 a55, 0
v_accvgpr_write_b32 a56, 0
v_accvgpr_write_b32 a57, 0
v_accvgpr_write_b32 a58, 0
v_accvgpr_write_b32 a59, 0
v_accvgpr_write_b32 a60, 0
v_accvgpr_write_b32 a61, 0
v_accvgpr_write_b32 a62, 0
v_accvgpr_write_b32 a63, 0
v_accvgpr_write_b32 a64, 0
v_accvgpr_write_b32 a65, 0
v_accvgpr_write_b32 a66, 0
v_accvgpr_write_b32 a67, 0
v_accvgpr_write_b32 a68, 0
v_accvgpr_write_b32 a69, 0
v_accvgpr_write_b32 a70, 0
v_accvgpr_write_b32 a71, 0
v_accvgpr_write_b32 a72, 0
v_accvgpr_write_b32 a73, 0
v_accvgpr_write_b32 a74, 0
v_accvgpr_write_b32 a75, 0
v_accvgpr_write_b32 a76, 0
v_accvgpr_write_b32 a77, 0
v_accvgpr_write_b32 a78, 0
v_accvgpr_write_b32 a79, 0
v_accvgpr_write_b32 a80, 0
v_accvgpr_write_b32 a81, 0
v_accvgpr_write_b32 a82, 0
v_accvgpr_write_b32 a83, 0
v_accvgpr_write_b32 a84, 0
v_accvgpr_write_b32 a85, 0
v_accvgpr_write_b32 a86, 0
v_accvgpr_write_b32 a87, 0
v_accvgpr_write_b32 a88, 0
v_accvgpr_write_b32 a89, 0
v_accvgpr_write_b32 a90, 0
v_accvgpr_write_b32 a91, 0
v_accvgpr_write_b32 a92, 0
v_accvgpr_write_b32 a93, 0
v_accvgpr_write_b32 a94, 0
v_accvgpr_write_b32 a95, 0
v_accvgpr_write_b32 a96, 0
v_accvgpr_write_b32 a97, 0
v_accvgpr_write_b32 a98, 0
v_accvgpr_write_b32 a99, 0
v_accvgpr_write_b32 a100, 0
v_accvgpr_write_b32 a101, 0
v_accvgpr_write_b32 a102, 0
v_accvgpr_write_b32 a103, 0
v_accvgpr_write_b32 a104, 0
v_accvgpr_write_b32 a105, 0
v_accvgpr_write_b32 a106, 0
v_accvgpr_write_b32 a107, 0
v_accvgpr_write_b32 a108, 0
v_accvgpr_write_b32 a109, 0
v_accvgpr_write_b32 a110, 0
v_accvgpr_write_b32 a111, 0
s_waitcnt vmcnt(24)
s_barrier
ds_read_b64_tr_b16 v[64:65], v5 offset:0
ds_read_b64_tr_b16 v[66:67], v5 offset:2048
ds_read_b64_tr_b16 v[68:69], v6 offset:0
ds_read_b64_tr_b16 v[70:71], v6 offset:2048
ds_read_b64_tr_b16 v[72:73], v7 offset:0
ds_read_b64_tr_b16 v[74:75], v7 offset:2048
ds_read_b64_tr_b16 v[76:77], v8 offset:0
ds_read_b64_tr_b16 v[78:79], v8 offset:2048
ds_read_b64_tr_b16 v[80:81], v9 offset:0
ds_read_b64_tr_b16 v[82:83], v9 offset:2048
ds_read_b64_tr_b16 v[84:85], v10 offset:0
ds_read_b64_tr_b16 v[86:87], v10 offset:2048
ds_read_b64_tr_b16 v[88:89], v11 offset:0
ds_read_b64_tr_b16 v[90:91], v11 offset:2048
ds_read_b64_tr_b16 v[92:93], v5 offset:8192
ds_read_b64_tr_b16 v[94:95], v5 offset:10240
s_mov_b32 s30, 7
Lf2_65:
s_waitcnt lgkmcnt(14)
v_mfma_f32_32x32x16_bf16 a[0:15], v[64:67], v[128:131], a[0:15]
ds_read_b64_tr_b16 v[96:97], v6 offset:8192
ds_read_b64_tr_b16 v[98:99], v6 offset:10240
s_waitcnt lgkmcnt(14)
v_mfma_f32_32x32x16_bf16 a[16:31], v[68:71], v[128:131], a[16:31]
ds_read_b64_tr_b16 v[100:101], v7 offset:8192
ds_read_b64_tr_b16 v[102:103], v7 offset:10240
s_waitcnt lgkmcnt(14)
v_mfma_f32_32x32x16_bf16 a[32:47], v[72:75], v[128:131], a[32:47]
ds_read_b64_tr_b16 v[104:105], v8 offset:8192
ds_read_b64_tr_b16 v[106:107], v8 offset:10240
s_waitcnt lgkmcnt(14)
v_mfma_f32_32x32x16_bf16 a[48:63], v[76:79], v[128:131], a[48:63]
ds_read_b64_tr_b16 v[108:109], v9 offset:8192
ds_read_b64_tr_b16 v[110:111], v9 offset:10240
s_waitcnt lgkmcnt(14)
v_mfma_f32_32x32x16_bf16 a[64:79], v[80:83], v[128:131], a[64:79]
ds_read_b64_tr_b16 v[112:113], v10 offset:8192
ds_read_b64_tr_b16 v[114:115], v10 offset:10240
s_waitcnt lgkmcnt(14)
v_mfma_f32_32x32x16_bf16 a[80:95], v[84:87], v[128:131], a[80:95]
ds_read_b64_tr_b16 v[116:117], v11 offset:8192
ds_read_b64_tr_b16 v[118:119], v11 offset:10240
s_waitcnt lgkmcnt(14)
v_mfma_f32_32x32x16_bf16 a[96:111], v[88:91], v[128:131], a[96:111]
ds_read_b64_tr_b16 v[120:121], v5 offset:16384
ds_read_b64_tr_b16 v[122:123], v5 offset:18432
s_waitcnt lgkmcnt(14)
v_mfma_f32_32x32x16_bf16 a[0:15], v[92:95], v[132:135], a[0:15]
ds_read_b64_tr_b16 v[124:125], v6 offset:16384
ds_read_b64_tr_b16 v[126:127], v6 offset:18432
s_waitcnt lgkmcnt(14)
v_mfma_f32_32x32x16_bf16 a[16:31], v[96:99], v[132:135], a[16:31]
ds_read_b64_tr_b16 v[64:65], v7 offset:16384
ds_read_b64_tr_b16 v[66:67], v7 offset:18432
s_waitcnt lgkmcnt(14)
v_mfma_f32_32x32x16_bf16 a[32:47], v[100:103], v[132:135], a[32:47]
ds_read_b64_tr_b16 v[68:69], v8 offset:16384
ds_read_b64_tr_b16 v[70:71], v8 offset:18432
s_waitcnt lgkmcnt(14)
v_mfma_f32_32x32x16_bf16 a[48:63], v[104:107], v[132:135], a[48:63]
ds_read_b64_tr_b16 v[72:73], v9 offset:16384
ds_read_b64_tr_b16 v[74:75], v9 offset:18432
s_waitcnt lgkmcnt(14)
v_mfma_f32_32x32x16_bf16 a[64:79], v[108:111], v[132:135], a[64:79]
ds_read_b64_tr_b16 v[76:77], v10 offset:16384
ds_read_b64_tr_b16 v[78:79], v10 offset:18432
s_waitcnt lgkmcnt(14)
v_mfma_f32_32x32x16_bf16 a[80:95], v[112:115], v[132:135], a[80:95]
ds_read_b64_tr_b16 v[80:81], v11 offset:16384
ds_read_b64_tr_b16 v[82:83], v11 offset:18432
s_waitcnt lgkmcnt(14)
v_mfma_f32_32x32x16_bf16 a[96:111], v[116:119], v[132:135], a[96:111]
ds_read_b64_tr_b16 v[84:85], v5 offset:24576
ds_read_b64_tr_b16 v[86:87], v5 offset:26624
s_waitcnt lgkmcnt(14)
v_mfma_f32_32x32x16_bf16 a[0:15], v[120:123], v[136:139], a[0:15]
ds_read_b64_tr_b16 v[88:89], v6 offset:24576
ds_read_b64_tr_b16 v[90:91], v6 offset:26624
s_waitcnt lgkmcnt(14)
v_mfma_f32_32x32x16_bf16 a[16:31], v[124:127], v[136:139], a[16:31]
ds_read_b64_tr_b16 v[92:93], v7 offset:24576
ds_read_b64_tr_b16 v[94:95], v7 offset:26624
s_waitcnt lgkmcnt(14)
v_mfma_f32_32x32x16_bf16 a[32:47], v[64:67], v[136:139], a[32:47]
ds_read_b64_tr_b16 v[96:97], v8 offset:24576
ds_read_b64_tr_b16 v[98:99], v8 offset:26624
s_waitcnt lgkmcnt(14)
v_mfma_f32_32x32x16_bf16 a[48:63], v[68:71], v[136:139], a[48:63]
ds_read_b64_tr_b16 v[100:101], v9 offset:24576
ds_read_b64_tr_b16 v[102:103], v9 offset:26624
s_waitcnt lgkmcnt(14)
v_mfma_f32_32x32x16_bf16 a[64:79], v[72:75], v[136:139], a[64:79]
ds_read_b64_tr_b16 v[104:105], v10 offset:24576
ds_read_b64_tr_b16 v[106:107], v10 offset:26624
s_waitcnt lgkmcnt(14)
v_mfma_f32_32x32x16_bf16 a[80:95], v[76:79], v[136:139], a[80:95]
s_waitcnt vmcnt(12)
s_barrier
ds_read_b64_tr_b16 v[108:109], v11 offset:24576
ds_read_b64_tr_b16 v[110:111], v11 offset:26624
s_waitcnt lgkmcnt(14)
v_mfma_f32_32x32x16_bf16 a[96:111], v[80:83], v[136:139], a[96:111]
ds_read_b64_tr_b16 v[112:113], v5 offset:32768
ds_read_b64_tr_b16 v[114:115], v5 offset:34816
s_add_u32 m0, s25, 98304
s_add_u32 s26, s24, 0
buffer_load_dwordx4 v3, s[52:55], s26 offen lds
s_waitcnt lgkmcnt(14)
v_mfma_f32_32x32x16_bf16 a[0:15], v[84:87], v[140:143], a[0:15]
ds_read_b64_tr_b16 v[116:117], v6 offset:32768
ds_read_b64_tr_b16 v[118:119], v6 offset:34816
s_waitcnt lgkmcnt(14)
v_mfma_f32_32x32x16_bf16 a[16:31], v[88:91], v[140:143], a[16:31]
ds_read_b64_tr_b16 v[120:121], v7 offset:32768
ds_read_b64_tr_b16 v[122:123], v7 offset:34816
s_add_u32 m0, s25, 99328
s_add_u32 s26, s24, 1792
buffer_load_dwordx4 v4, s[52:55], s26 offen lds
s_waitcnt lgkmcnt(14)
v_mfma_f32_32x32x16_bf16 a[32:47], v[92:95], v[140:143], a[32:47]
ds_read_b64_tr_b16 v[124:125], v8 offset:32768
ds_read_b64_tr_b16 v[126:127], v8 offset:34816
s_waitcnt lgkmcnt(14)
v_mfma_f32_32x32x16_bf16 a[48:63], v[96:99], v[140:143], a[48:63]
ds_read_b64_tr_b16 v[64:65], v9 offset:32768
ds_read_b64_tr_b16 v[66:67], v9 offset:34816
s_add_u32 m0, s25, 100352
s_add_u32 s26, s24, 3584
buffer_load_dwordx4 v3, s[52:55], s26 offen lds
s_waitcnt lgkmcnt(14)
v_mfma_f32_32x32x16_bf16 a[64:79], v[100:103], v[140:143], a[64:79]
ds_read_b64_tr_b16 v[68:69], v10 offset:32768
ds_read_b64_tr_b16 v[70:71], v10 offset:34816
s_waitcnt lgkmcnt(14)
v_mfma_f32_32x32x16_bf16 a[80:95], v[104:107], v[140:143], a[80:95]
ds_read_b64_tr_b16 v[72:73], v11 offset:32768
ds_read_b64_tr_b16 v[74:75], v11 offset:34816
s_add_u32 m0, s25, 101376
s_add_u32 s26, s24, 5376
buffer_load_dwordx4 v4, s[52:55], s26 offen lds
s_waitcnt lgkmcnt(14)
v_mfma_f32_32x32x16_bf16 a[96:111], v[108:111], v[140:143], a[96:111]
ds_read_b64_tr_b16 v[76:77], v5 offset:40960
ds_read_b64_tr_b16 v[78:79], v5 offset:43008
s_waitcnt lgkmcnt(14)
v_mfma_f32_32x32x16_bf16 a[0:15], v[112:115], v[144:147], a[0:15]
ds_read_b64_tr_b16 v[80:81], v6 offset:40960
ds_read_b64_tr_b16 v[82:83], v6 offset:43008
s_add_u32 m0, s25, 102400
s_add_u32 s26, s24, 7168
buffer_load_dwordx4 v3, s[52:55], s26 offen lds
s_waitcnt lgkmcnt(14)
v_mfma_f32_32x32x16_bf16 a[16:31], v[116:119], v[144:147], a[16:31]
ds_read_b64_tr_b16 v[84:85], v7 offset:40960
ds_read_b64_tr_b16 v[86:87], v7 offset:43008
s_waitcnt lgkmcnt(14)
v_mfma_f32_32x32x16_bf16 a[32:47], v[120:123], v[144:147], a[32:47]
ds_read_b64_tr_b16 v[88:89], v8 offset:40960
ds_read_b64_tr_b16 v[90:91], v8 offset:43008
s_add_u32 m0, s25, 103424
s_add_u32 s26, s24, 8960
buffer_load_dwordx4 v4, s[52:55], s26 offen lds
s_waitcnt lgkmcnt(14)
v_mfma_f32_32x32x16_bf16 a[48:63], v[124:127], v[144:147], a[48:63]
ds_read_b64_tr_b16 v[92:93], v9 offset:40960
ds_read_b64_tr_b16 v[94:95], v9 offset:43008
s_waitcnt lgkmcnt(14)
v_mfma_f32_32x32x16_bf16 a[64:79], v[64:67], v[144:147], a[64:79]
ds_read_b64_tr_b16 v[96:97], v10 offset:40960
ds_read_b64_tr_b16 v[98:99], v10 offset:43008
s_add_u32 m0, s25, 104448
s_add_u32 s26, s24, 10752
buffer_load_dwordx4 v3, s[52:55], s26 offen lds
s_waitcnt lgkmcnt(14)
v_mfma_f32_32x32x16_bf16 a[80:95], v[68:71], v[144:147], a[80:95]
ds_read_b64_tr_b16 v[100:101], v11 offset:40960
ds_read_b64_tr_b16 v[102:103], v11 offset:43008
s_waitcnt lgkmcnt(14)
v_mfma_f32_32x32x16_bf16 a[96:111], v[72:75], v[144:147], a[96:111]
ds_read_b64_tr_b16 v[104:105], v5 offset:49152
ds_read_b64_tr_b16 v[106:107], v5 offset:51200
s_add_u32 m0, s25, 105472
s_add_u32 s26, s24, 12544
buffer_load_dwordx4 v4, s[52:55], s26 offen lds
s_add_u32 s24, s24, 57344
s_waitcnt lgkmcnt(14)
v_mfma_f32_32x32x16_bf16 a[0:15], v[76:79], v[148:151], a[0:15]
ds_read_b64_tr_b16 v[108:109], v6 offset:49152
ds_read_b64_tr_b16 v[110:111], v6 offset:51200
s_waitcnt lgkmcnt(14)
v_mfma_f32_32x32x16_bf16 a[16:31], v[80:83], v[148:151], a[16:31]
ds_read_b64_tr_b16 v[112:113], v7 offset:49152
ds_read_b64_tr_b16 v[114:115], v7 offset:51200
buffer_load_dwordx4 v[176:179], v2, s[8:11], s29 offen offset:0 sc1
s_waitcnt lgkmcnt(14)
v_mfma_f32_32x32x16_bf16 a[32:47], v[84:87], v[148:151], a[32:47]
ds_read_b64_tr_b16 v[116:117], v8 offset:49152
ds_read_b64_tr_b16 v[118:119], v8 offset:51200
s_waitcnt lgkmcnt(14)
v_mfma_f32_32x32x16_bf16 a[48:63], v[88:91], v[148:151], a[48:63]
ds_read_b64_tr_b16 v[120:121], v9 offset:49152
ds_read_b64_tr_b16 v[122:123], v9 offset:51200
buffer_load_dwordx4 v[180:183], v2, s[8:11], s29 offen offset:1024 sc1
s_waitcnt lgkmcnt(14)
v_mfma_f32_32x32x16_bf16 a[64:79], v[92:95], v[148:151], a[64:79]
ds_read_b64_tr_b16 v[124:125], v10 offset:49152
ds_read_b64_tr_b16 v[126:127], v10 offset:51200
s_waitcnt lgkmcnt(14)
v_mfma_f32_32x32x16_bf16 a[80:95], v[96:99], v[148:151], a[80:95]
ds_read_b64_tr_b16 v[64:65], v11 offset:49152
ds_read_b64_tr_b16 v[66:67], v11 offset:51200
buffer_load_dwordx4 v[184:187], v2, s[8:11], s29 offen offset:2048 sc1
s_waitcnt lgkmcnt(14)
v_mfma_f32_32x32x16_bf16 a[96:111], v[100:103], v[148:151], a[96:111]
ds_read_b64_tr_b16 v[68:69], v5 offset:57344
ds_read_b64_tr_b16 v[70:71], v5 offset:59392
s_waitcnt lgkmcnt(14)
v_mfma_f32_32x32x16_bf16 a[0:15], v[104:107], v[152:155], a[0:15]
ds_read_b64_tr_b16 v[72:73], v6 offset:57344
ds_read_b64_tr_b16 v[74:75], v6 offset:59392
buffer_load_dwordx4 v[188:191], v2, s[8:11], s29 offen offset:3072 sc1
s_add_u32 s29, s29, 4096
s_waitcnt lgkmcnt(14)
v_mfma_f32_32x32x16_bf16 a[16:31], v[108:111], v[152:155], a[16:31]
ds_read_b64_tr_b16 v[76:77], v7 offset:57344
ds_read_b64_tr_b16 v[78:79], v7 offset:59392
s_waitcnt lgkmcnt(14)
v_mfma_f32_32x32x16_bf16 a[32:47], v[112:115], v[152:155], a[32:47]
ds_read_b64_tr_b16 v[80:81], v8 offset:57344
ds_read_b64_tr_b16 v[82:83], v8 offset:59392
s_waitcnt lgkmcnt(14)
v_mfma_f32_32x32x16_bf16 a[48:63], v[116:119], v[152:155], a[48:63]
ds_read_b64_tr_b16 v[84:85], v9 offset:57344
ds_read_b64_tr_b16 v[86:87], v9 offset:59392
s_waitcnt lgkmcnt(14)
v_mfma_f32_32x32x16_bf16 a[64:79], v[120:123], v[152:155], a[64:79]
ds_read_b64_tr_b16 v[88:89], v10 offset:57344
ds_read_b64_tr_b16 v[90:91], v10 offset:59392
s_waitcnt lgkmcnt(14)
v_mfma_f32_32x32x16_bf16 a[80:95], v[124:127], v[152:155], a[80:95]
s_waitcnt vmcnt(12)
s_barrier
ds_read_b64_tr_b16 v[92:93], v11 offset:57344
ds_read_b64_tr_b16 v[94:95], v11 offset:59392
s_waitcnt lgkmcnt(14)
v_mfma_f32_32x32x16_bf16 a[96:111], v[64:67], v[152:155], a[96:111]
ds_read_b64_tr_b16 v[96:97], v12 offset:0
ds_read_b64_tr_b16 v[98:99], v12 offset:2048
s_add_u32 m0, s25, 0
s_add_u32 s26, s24, 0
buffer_load_dwordx4 v3, s[52:55], s26 offen lds
s_waitcnt lgkmcnt(14)
v_mfma_f32_32x32x16_bf16 a[0:15], v[68:71], v[156:159], a[0:15]
ds_read_b64_tr_b16 v[100:101], v13 offset:0
ds_read_b64_tr_b16 v[102:103], v13 offset:2048
s_waitcnt lgkmcnt(14)
v_mfma_f32_32x32x16_bf16 a[16:31], v[72:75], v[156:159], a[16:31]
ds_read_b64_tr_b16 v[104:105], v14 offset:0
ds_read_b64_tr_b16 v[106:107], v14 offset:2048
s_add_u32 m0, s25, 1024
s_add_u32 s26, s24, 1792
buffer_load_dwordx4 v4, s[52:55], s26 offen lds
s_waitcnt lgkmcnt(14)
v_mfma_f32_32x32x16_bf16 a[32:47], v[76:79], v[156:159], a[32:47]
ds_read_b64_tr_b16 v[108:109], v15 offset:0
ds_read_b64_tr_b16 v[110:111], v15 offset:2048
s_waitcnt lgkmcnt(14)
v_mfma_f32_32x32x16_bf16 a[48:63], v[80:83], v[156:159], a[48:63]
ds_read_b64_tr_b16 v[112:113], v16 offset:0
ds_read_b64_tr_b16 v[114:115], v16 offset:2048
s_add_u32 m0, s25, 2048
s_add_u32 s26, s24, 3584
buffer_load_dwordx4 v3, s[52:55], s26 offen lds
s_waitcnt lgkmcnt(14)
v_mfma_f32_32x32x16_bf16 a[64:79], v[84:87], v[156:159], a[64:79]
ds_read_b64_tr_b16 v[116:117], v17 offset:0
ds_read_b64_tr_b16 v[118:119], v17 offset:2048
s_waitcnt lgkmcnt(14)
v_mfma_f32_32x32x16_bf16 a[80:95], v[88:91], v[156:159], a[80:95]
ds_read_b64_tr_b16 v[120:121], v18 offset:0
ds_read_b64_tr_b16 v[122:123], v18 offset:2048
s_add_u32 m0, s25, 3072
s_add_u32 s26, s24, 5376
buffer_load_dwordx4 v4, s[52:55], s26 offen lds
s_waitcnt lgkmcnt(14)
v_mfma_f32_32x32x16_bf16 a[96:111], v[92:95], v[156:159], a[96:111]
ds_read_b64_tr_b16 v[124:125], v12 offset:8192
ds_read_b64_tr_b16 v[126:127], v12 offset:10240
s_waitcnt lgkmcnt(14)
v_mfma_f32_32x32x16_bf16 a[0:15], v[96:99], v[160:163], a[0:15]
ds_read_b64_tr_b16 v[64:65], v13 offset:8192
ds_read_b64_tr_b16 v[66:67], v13 offset:10240
s_add_u32 m0, s25, 4096
s_add_u32 s26, s24, 7168
buffer_load_dwordx4 v3, s[52:55], s26 offen lds
s_waitcnt lgkmcnt(14)
v_mfma_f32_32x32x16_bf16 a[16:31], v[100:103], v[160:163], a[16:31]
ds_read_b64_tr_b16 v[68:69], v14 offset:8192
ds_read_b64_tr_b16 v[70:71], v14 offset:10240
s_waitcnt lgkmcnt(14)
v_mfma_f32_32x32x16_bf16 a[32:47], v[104:107], v[160:163], a[32:47]
ds_read_b64_tr_b16 v[72:73], v15 offset:8192
ds_read_b64_tr_b16 v[74:75], v15 offset:10240
s_add_u32 m0, s25, 5120
s_add_u32 s26, s24, 8960
buffer_load_dwordx4 v4, s[52:55], s26 offen lds
s_waitcnt lgkmcnt(14)
v_mfma_f32_32x32x16_bf16 a[48:63], v[108:111], v[160:163], a[48:63]
ds_read_b64_tr_b16 v[76:77], v16 offset:8192
ds_read_b64_tr_b16 v[78:79], v16 offset:10240
s_waitcnt lgkmcnt(14)
v_mfma_f32_32x32x16_bf16 a[64:79], v[112:115], v[160:163], a[64:79]
ds_read_b64_tr_b16 v[80:81], v17 offset:8192
ds_read_b64_tr_b16 v[82:83], v17 offset:10240
s_add_u32 m0, s25, 6144
s_add_u32 s26, s24, 10752
buffer_load_dwordx4 v3, s[52:55], s26 offen lds
s_waitcnt lgkmcnt(14)
v_mfma_f32_32x32x16_bf16 a[80:95], v[116:119], v[160:163], a[80:95]
ds_read_b64_tr_b16 v[84:85], v18 offset:8192
ds_read_b64_tr_b16 v[86:87], v18 offset:10240
s_waitcnt lgkmcnt(14)
v_mfma_f32_32x32x16_bf16 a[96:111], v[120:123], v[160:163], a[96:111]
ds_read_b64_tr_b16 v[88:89], v12 offset:16384
ds_read_b64_tr_b16 v[90:91], v12 offset:18432
s_add_u32 m0, s25, 7168
s_add_u32 s26, s24, 12544
buffer_load_dwordx4 v4, s[52:55], s26 offen lds
s_add_u32 s24, s24, 57344
s_waitcnt lgkmcnt(14)
v_mfma_f32_32x32x16_bf16 a[0:15], v[124:127], v[164:167], a[0:15]
ds_read_b64_tr_b16 v[92:93], v13 offset:16384
ds_read_b64_tr_b16 v[94:95], v13 offset:18432
s_waitcnt lgkmcnt(14)
v_mfma_f32_32x32x16_bf16 a[16:31], v[64:67], v[164:167], a[16:31]
ds_read_b64_tr_b16 v[96:97], v14 offset:16384
ds_read_b64_tr_b16 v[98:99], v14 offset:18432
buffer_load_dwordx4 v[128:131], v2, s[8:11], s29 offen offset:0 sc1
s_waitcnt lgkmcnt(14)
v_mfma_f32_32x32x16_bf16 a[32:47], v[68:71], v[164:167], a[32:47]
ds_read_b64_tr_b16 v[100:101], v15 offset:16384
ds_read_b64_tr_b16 v[102:103], v15 offset:18432
s_waitcnt lgkmcnt(14)
v_mfma_f32_32x32x16_bf16 a[48:63], v[72:75], v[164:167], a[48:63]
ds_read_b64_tr_b16 v[104:105], v16 offset:16384
ds_read_b64_tr_b16 v[106:107], v16 offset:18432
buffer_load_dwordx4 v[132:135], v2, s[8:11], s29 offen offset:1024 sc1
s_waitcnt lgkmcnt(14)
v_mfma_f32_32x32x16_bf16 a[64:79], v[76:79], v[164:167], a[64:79]
ds_read_b64_tr_b16 v[108:109], v17 offset:16384
ds_read_b64_tr_b16 v[110:111], v17 offset:18432
s_waitcnt lgkmcnt(14)
v_mfma_f32_32x32x16_bf16 a[80:95], v[80:83], v[164:167], a[80:95]
ds_read_b64_tr_b16 v[112:113], v18 offset:16384
ds_read_b64_tr_b16 v[114:115], v18 offset:18432
buffer_load_dwordx4 v[136:139], v2, s[8:11], s29 offen offset:2048 sc1
s_waitcnt lgkmcnt(14)
v_mfma_f32_32x32x16_bf16 a[96:111], v[84:87], v[164:167], a[96:111]
ds_read_b64_tr_b16 v[116:117], v12 offset:24576
ds_read_b64_tr_b16 v[118:119], v12 offset:26624
s_waitcnt lgkmcnt(14)
v_mfma_f32_32x32x16_bf16 a[0:15], v[88:91], v[168:171], a[0:15]
ds_read_b64_tr_b16 v[120:121], v13 offset:24576
ds_read_b64_tr_b16 v[122:123], v13 offset:26624
buffer_load_dwordx4 v[140:143], v2, s[8:11], s29 offen offset:3072 sc1
s_add_u32 s29, s29, 4096
s_waitcnt lgkmcnt(14)
v_mfma_f32_32x32x16_bf16 a[16:31], v[92:95], v[168:171], a[16:31]
ds_read_b64_tr_b16 v[124:125], v14 offset:24576
ds_read_b64_tr_b16 v[126:127], v14 offset:26624
s_waitcnt lgkmcnt(14)
v_mfma_f32_32x32x16_bf16 a[32:47], v[96:99], v[168:171], a[32:47]
ds_read_b64_tr_b16 v[64:65], v15 offset:24576
ds_read_b64_tr_b16 v[66:67], v15 offset:26624
s_waitcnt lgkmcnt(14)
v_mfma_f32_32x32x16_bf16 a[48:63], v[100:103], v[168:171], a[48:63]
ds_read_b64_tr_b16 v[68:69], v16 offset:24576
ds_read_b64_tr_b16 v[70:71], v16 offset:26624
s_waitcnt lgkmcnt(14)
v_mfma_f32_32x32x16_bf16 a[64:79], v[104:107], v[168:171], a[64:79]
ds_read_b64_tr_b16 v[72:73], v17 offset:24576
ds_read_b64_tr_b16 v[74:75], v17 offset:26624
s_waitcnt lgkmcnt(14)
v_mfma_f32_32x32x16_bf16 a[80:95], v[108:111], v[168:171], a[80:95]
s_waitcnt vmcnt(12)
s_barrier
ds_read_b64_tr_b16 v[76:77], v18 offset:24576
ds_read_b64_tr_b16 v[78:79], v18 offset:26624
s_waitcnt lgkmcnt(14)
v_mfma_f32_32x32x16_bf16 a[96:111], v[112:115], v[168:171], a[96:111]
ds_read_b64_tr_b16 v[80:81], v12 offset:32768
ds_read_b64_tr_b16 v[82:83], v12 offset:34816
s_add_u32 m0, s25, 32768
s_add_u32 s26, s24, 0
buffer_load_dwordx4 v3, s[52:55], s26 offen lds
s_waitcnt lgkmcnt(14)
v_mfma_f32_32x32x16_bf16 a[0:15], v[116:119], v[172:175], a[0:15]
ds_read_b64_tr_b16 v[84:85], v13 offset:32768
ds_read_b64_tr_b16 v[86:87], v13 offset:34816
s_waitcnt lgkmcnt(14)
v_mfma_f32_32x32x16_bf16 a[16:31], v[120:123], v[172:175], a[16:31]
ds_read_b64_tr_b16 v[88:89], v14 offset:32768
ds_read_b64_tr_b16 v[90:91], v14 offset:34816
s_add_u32 m0, s25, 33792
s_add_u32 s26, s24, 1792
buffer_load_dwordx4 v4, s[52:55], s26 offen lds
s_waitcnt lgkmcnt(14)
v_mfma_f32_32x32x16_bf16 a[32:47], v[124:127], v[172:175], a[32:47]
ds_read_b64_tr_b16 v[92:93], v15 offset:32768
ds_read_b64_tr_b16 v[94:95], v15 offset:34816
s_waitcnt lgkmcnt(14)
v_mfma_f32_32x32x16_bf16 a[48:63], v[64:67], v[172:175], a[48:63]
ds_read_b64_tr_b16 v[96:97], v16 offset:32768
ds_read_b64_tr_b16 v[98:99], v16 offset:34816
s_add_u32 m0, s25, 34816
s_add_u32 s26, s24, 3584
buffer_load_dwordx4 v3, s[52:55], s26 offen lds
s_waitcnt lgkmcnt(14)
v_mfma_f32_32x32x16_bf16 a[64:79], v[68:71], v[172:175], a[64:79]
ds_read_b64_tr_b16 v[100:101], v17 offset:32768
ds_read_b64_tr_b16 v[102:103], v17 offset:34816
s_waitcnt lgkmcnt(14)
v_mfma_f32_32x32x16_bf16 a[80:95], v[72:75], v[172:175], a[80:95]
ds_read_b64_tr_b16 v[104:105], v18 offset:32768
ds_read_b64_tr_b16 v[106:107], v18 offset:34816
s_add_u32 m0, s25, 35840
s_add_u32 s26, s24, 5376
buffer_load_dwordx4 v4, s[52:55], s26 offen lds
s_waitcnt lgkmcnt(14)
v_mfma_f32_32x32x16_bf16 a[96:111], v[76:79], v[172:175], a[96:111]
ds_read_b64_tr_b16 v[108:109], v12 offset:40960
ds_read_b64_tr_b16 v[110:111], v12 offset:43008
s_waitcnt lgkmcnt(14)
v_mfma_f32_32x32x16_bf16 a[0:15], v[80:83], v[176:179], a[0:15]
ds_read_b64_tr_b16 v[112:113], v13 offset:40960
ds_read_b64_tr_b16 v[114:115], v13 offset:43008
s_add_u32 m0, s25, 36864
s_add_u32 s26, s24, 7168
buffer_load_dwordx4 v3, s[52:55], s26 offen lds
s_waitcnt lgkmcnt(14)
v_mfma_f32_32x32x16_bf16 a[16:31], v[84:87], v[176:179], a[16:31]
ds_read_b64_tr_b16 v[116:117], v14 offset:40960
ds_read_b64_tr_b16 v[118:119], v14 offset:43008
s_waitcnt lgkmcnt(14)
v_mfma_f32_32x32x16_bf16 a[32:47], v[88:91], v[176:179], a[32:47]
ds_read_b64_tr_b16 v[120:121], v15 offset:40960
ds_read_b64_tr_b16 v[122:123], v15 offset:43008
s_add_u32 m0, s25, 37888
s_add_u32 s26, s24, 8960
buffer_load_dwordx4 v4, s[52:55], s26 offen lds
s_waitcnt lgkmcnt(14)
v_mfma_f32_32x32x16_bf16 a[48:63], v[92:95], v[176:179], a[48:63]
ds_read_b64_tr_b16 v[124:125], v16 offset:40960
ds_read_b64_tr_b16 v[126:127], v16 offset:43008
s_waitcnt lgkmcnt(14)
v_mfma_f32_32x32x16_bf16 a[64:79], v[96:99], v[176:179], a[64:79]
ds_read_b64_tr_b16 v[64:65], v17 offset:40960
ds_read_b64_tr_b16 v[66:67], v17 offset:43008
s_add_u32 m0, s25, 38912
s_add_u32 s26, s24, 10752
buffer_load_dwordx4 v3, s[52:55], s26 offen lds
s_waitcnt lgkmcnt(14)
v_mfma_f32_32x32x16_bf16 a[80:95], v[100:103], v[176:179], a[80:95]
ds_read_b64_tr_b16 v[68:69], v18 offset:40960
ds_read_b64_tr_b16 v[70:71], v18 offset:43008
s_waitcnt lgkmcnt(14)
v_mfma_f32_32x32x16_bf16 a[96:111], v[104:107], v[176:179], a[96:111]
ds_read_b64_tr_b16 v[72:73], v12 offset:49152
ds_read_b64_tr_b16 v[74:75], v12 offset:51200
s_add_u32 m0, s25, 39936
s_add_u32 s26, s24, 12544
buffer_load_dwordx4 v4, s[52:55], s26 offen lds
s_add_u32 s24, s24, 57344
s_waitcnt lgkmcnt(14)
v_mfma_f32_32x32x16_bf16 a[0:15], v[108:111], v[180:183], a[0:15]
ds_read_b64_tr_b16 v[76:77], v13 offset:49152
ds_read_b64_tr_b16 v[78:79], v13 offset:51200
s_waitcnt lgkmcnt(14)
v_mfma_f32_32x32x16_bf16 a[16:31], v[112:115], v[180:183], a[16:31]
ds_read_b64_tr_b16 v[80:81], v14 offset:49152
ds_read_b64_tr_b16 v[82:83], v14 offset:51200
buffer_load_dwordx4 v[144:147], v2, s[8:11], s29 offen offset:0 sc1
s_waitcnt lgkmcnt(14)
v_mfma_f32_32x32x16_bf16 a[32:47], v[116:119], v[180:183], a[32:47]
ds_read_b64_tr_b16 v[84:85], v15 offset:49152
ds_read_b64_tr_b16 v[86:87], v15 offset:51200
s_waitcnt lgkmcnt(14)
v_mfma_f32_32x32x16_bf16 a[48:63], v[120:123], v[180:183], a[48:63]
ds_read_b64_tr_b16 v[88:89], v16 offset:49152
ds_read_b64_tr_b16 v[90:91], v16 offset:51200
buffer_load_dwordx4 v[148:151], v2, s[8:11], s29 offen offset:1024 sc1
s_waitcnt lgkmcnt(14)
v_mfma_f32_32x32x16_bf16 a[64:79], v[124:127], v[180:183], a[64:79]
ds_read_b64_tr_b16 v[92:93], v17 offset:49152
ds_read_b64_tr_b16 v[94:95], v17 offset:51200
s_waitcnt lgkmcnt(14)
v_mfma_f32_32x32x16_bf16 a[80:95], v[64:67], v[180:183], a[80:95]
ds_read_b64_tr_b16 v[96:97], v18 offset:49152
ds_read_b64_tr_b16 v[98:99], v18 offset:51200
buffer_load_dwordx4 v[152:155], v2, s[8:11], s29 offen offset:2048 sc1
s_waitcnt lgkmcnt(14)
v_mfma_f32_32x32x16_bf16 a[96:111], v[68:71], v[180:183], a[96:111]
ds_read_b64_tr_b16 v[100:101], v12 offset:57344
ds_read_b64_tr_b16 v[102:103], v12 offset:59392
s_waitcnt lgkmcnt(14)
v_mfma_f32_32x32x16_bf16 a[0:15], v[72:75], v[184:187], a[0:15]
ds_read_b64_tr_b16 v[104:105], v13 offset:57344
ds_read_b64_tr_b16 v[106:107], v13 offset:59392
buffer_load_dwordx4 v[156:159], v2, s[8:11], s29 offen offset:3072 sc1
s_add_u32 s29, s29, 4096
s_waitcnt lgkmcnt(14)
v_mfma_f32_32x32x16_bf16 a[16:31], v[76:79], v[184:187], a[16:31]
ds_read_b64_tr_b16 v[108:109], v14 offset:57344
ds_read_b64_tr_b16 v[110:111], v14 offset:59392
s_waitcnt lgkmcnt(14)
v_mfma_f32_32x32x16_bf16 a[32:47], v[80:83], v[184:187], a[32:47]
ds_read_b64_tr_b16 v[112:113], v15 offset:57344
ds_read_b64_tr_b16 v[114:115], v15 offset:59392
s_waitcnt lgkmcnt(14)
v_mfma_f32_32x32x16_bf16 a[48:63], v[84:87], v[184:187], a[48:63]
ds_read_b64_tr_b16 v[116:117], v16 offset:57344
ds_read_b64_tr_b16 v[118:119], v16 offset:59392
s_waitcnt lgkmcnt(14)
v_mfma_f32_32x32x16_bf16 a[64:79], v[88:91], v[184:187], a[64:79]
ds_read_b64_tr_b16 v[120:121], v17 offset:57344
ds_read_b64_tr_b16 v[122:123], v17 offset:59392
s_waitcnt lgkmcnt(14)
v_mfma_f32_32x32x16_bf16 a[80:95], v[92:95], v[184:187], a[80:95]
s_waitcnt vmcnt(12)
s_barrier
ds_read_b64_tr_b16 v[124:125], v18 offset:57344
ds_read_b64_tr_b16 v[126:127], v18 offset:59392
s_waitcnt lgkmcnt(14)
v_mfma_f32_32x32x16_bf16 a[96:111], v[96:99], v[184:187], a[96:111]
ds_read_b64_tr_b16 v[64:65], v5 offset:0
ds_read_b64_tr_b16 v[66:67], v5 offset:2048
s_add_u32 m0, s25, 65536
s_add_u32 s26, s24, 0
buffer_load_dwordx4 v3, s[52:55], s26 offen lds
s_waitcnt lgkmcnt(14)
v_mfma_f32_32x32x16_bf16 a[0:15], v[100:103], v[188:191], a[0:15]
ds_read_b64_tr_b16 v[68:69], v6 offset:0
ds_read_b64_tr_b16 v[70:71], v6 offset:2048
s_waitcnt lgkmcnt(14)
v_mfma_f32_32x32x16_bf16 a[16:31], v[104:107], v[188:191], a[16:31]
ds_read_b64_tr_b16 v[72:73], v7 offset:0
ds_read_b64_tr_b16 v[74:75], v7 offset:2048
s_add_u32 m0, s25, 66560
s_add_u32 s26, s24, 1792
buffer_load_dwordx4 v4, s[52:55], s26 offen lds
s_waitcnt lgkmcnt(14)
v_mfma_f32_32x32x16_bf16 a[32:47], v[108:111], v[188:191], a[32:47]
ds_read_b64_tr_b16 v[76:77], v8 offset:0
ds_read_b64_tr_b16 v[78:79], v8 offset:2048
s_waitcnt lgkmcnt(14)
v_mfma_f32_32x32x16_bf16 a[48:63], v[112:115], v[188:191], a[48:63]
ds_read_b64_tr_b16 v[80:81], v9 offset:0
ds_read_b64_tr_b16 v[82:83], v9 offset:2048
s_add_u32 m0, s25, 67584
s_add_u32 s26, s24, 3584
buffer_load_dwordx4 v3, s[52:55], s26 offen lds
s_waitcnt lgkmcnt(14)
v_mfma_f32_32x32x16_bf16 a[64:79], v[116:119], v[188:191], a[64:79]
ds_read_b64_tr_b16 v[84:85], v10 offset:0
ds_read_b64_tr_b16 v[86:87], v10 offset:2048
s_waitcnt lgkmcnt(14)
v_mfma_f32_32x32x16_bf16 a[80:95], v[120:123], v[188:191], a[80:95]
ds_read_b64_tr_b16 v[88:89], v11 offset:0
ds_read_b64_tr_b16 v[90:91], v11 offset:2048
s_add_u32 m0, s25, 68608
s_add_u32 s26, s24, 5376
buffer_load_dwordx4 v4, s[52:55], s26 offen lds
s_waitcnt lgkmcnt(14)
v_mfma_f32_32x32x16_bf16 a[96:111], v[124:127], v[188:191], a[96:111]
ds_read_b64_tr_b16 v[92:93], v5 offset:8192
ds_read_b64_tr_b16 v[94:95], v5 offset:10240
s_add_u32 m0, s25, 69632
s_add_u32 s26, s24, 7168
buffer_load_dwordx4 v3, s[52:55], s26 offen lds
s_add_u32 m0, s25, 70656
s_add_u32 s26, s24, 8960
buffer_load_dwordx4 v4, s[52:55], s26 offen lds
s_add_u32 m0, s25, 71680
s_add_u32 s26, s24, 10752
buffer_load_dwordx4 v3, s[52:55], s26 offen lds
s_add_u32 m0, s25, 72704
s_add_u32 s26, s24, 12544
buffer_load_dwordx4 v4, s[52:55], s26 offen lds
s_add_u32 s24, s24, 57344
buffer_load_dwordx4 v[160:163], v2, s[8:11], s29 offen offset:0 sc1
buffer_load_dwordx4 v[164:167], v2, s[8:11], s29 offen offset:1024 sc1
buffer_load_dwordx4 v[168:171], v2, s[8:11], s29 offen offset:2048 sc1
buffer_load_dwordx4 v[172:175], v2, s[8:11], s29 offen offset:3072 sc1
s_add_u32 s29, s29, 4096
s_sub_u32 s30, s30, 1
s_cmp_lg_u32 s30, 0
s_cbranch_scc1 Lf2_65
s_waitcnt vmcnt(0) lgkmcnt(0)
s_nop 15
v_and_b32 v26, 31, v1
v_mul_u32_u24 v26, 896, v26
v_lshrrev_b32 v27, 5, v1
v_lshl_add_u32 v26, v27, 4, v26
s_mul_i32 s26, s23, 28672
s_mul_i32 s27, s22, 448
s_add_u32 s26, s26, s27
s_add_u32 s26, s26, 65011712
s_mov_b32 s28, 3216550459
v_accvgpr_read_b32 v64, a0
v_accvgpr_read_b32 v65, a1
v_accvgpr_read_b32 v66, a2
v_accvgpr_read_b32 v67, a3
v_accvgpr_read_b32 v68, a4
v_accvgpr_read_b32 v69, a5
v_accvgpr_read_b32 v70, a6
v_accvgpr_read_b32 v71, a7
v_accvgpr_read_b32 v72, a8
v_accvgpr_read_b32 v73, a9
v_accvgpr_read_b32 v74, a10
v_accvgpr_read_b32 v75, a11
v_accvgpr_read_b32 v76, a12
v_accvgpr_read_b32 v77, a13
v_accvgpr_read_b32 v78, a14
v_accvgpr_read_b32 v79, a15
v_mul_f32 v32, s28, v64
v_mul_f32 v33, s28, v65
v_mul_f32 v34, s28, v66
v_mul_f32 v35, s28, v67
v_mul_f32 v36, s28, v68
v_mul_f32 v37, s28, v69
v_mul_f32 v38, s28, v70
v_mul_f32 v39, s28, v71
v_mul_f32 v40, s28, v72
v_mul_f32 v41, s28, v73
v_mul_f32 v42, s28, v74
v_mul_f32 v43, s28, v75
v_mul_f32 v44, s28, v76
v_mul_f32 v45, s28, v77
v_mul_f32 v46, s28, v78
v_mul_f32 v47, s28, v79
v_exp_f32 v32, v32
v_exp_f32 v33, v33
v_exp_f32 v34, v34
v_exp_f32 v35, v35
v_exp_f32 v36, v36
v_exp_f32 v37, v37
v_exp_f32 v38, v38
v_exp_f32 v39, v39
v_exp_f32 v40, v40
v_exp_f32 v41, v41
v_exp_f32 v42, v42
v_exp_f32 v43, v43
v_exp_f32 v44, v44
v_exp_f32 v45, v45
v_exp_f32 v46, v46
v_exp_f32 v47, v47
v_add_f32 v32, 1.0, v32
v_add_f32 v33, 1.0, v33
v_add_f32 v34, 1.0, v34
v_add_f32 v35, 1.0, v35
v_add_f32 v36, 1.0, v36
v_add_f32 v37, 1.0, v37
v_add_f32 v38, 1.0, v38
v_add_f32 v39, 1.0, v39
v_add_f32 v40, 1.0, v40
v_add_f32 v41, 1.0, v41
v_add_f32 v42, 1.0, v42
v_add_f32 v43, 1.0, v43
v_add_f32 v44, 1.0, v44
v_add_f32 v45, 1.0, v45
v_add_f32 v46, 1.0, v46
v_add_f32 v47, 1.0, v47
v_rcp_f32 v32, v32
v_rcp_f32 v33, v33
v_rcp_f32 v34, v34
v_rcp_f32 v35, v35
v_rcp_f32 v36, v36
v_rcp_f32 v37, v37
v_rcp_f32 v38, v38
v_rcp_f32 v39, v39
v_rcp_f32 v40, v40
v_rcp_f32 v41, v41
v_rcp_f32 v42, v42
v_rcp_f32 v43, v43
v_rcp_f32 v44, v44
v_rcp_f32 v45, v45
v_rcp_f32 v46, v46
v_rcp_f32 v47, v47
v_mul_f32 v64, v64, v32
v_mul_f32 v65, v65, v33
v_mul_f32 v66, v66, v34
v_mul_f32 v67, v67, v35
v_mul_f32 v68, v68, v36
v_mul_f32 v69, v69, v37
v_mul_f32 v70, v70, v38
v_mul_f32 v71, v71, v39
v_mul_f32 v72, v72, v40
v_mul_f32 v73, v73, v41
v_mul_f32 v74, v74, v42
v_mul_f32 v75, v75, v43
v_mul_f32 v76, v76, v44
v_mul_f32 v77, v77, v45
v_mul_f32 v78, v78, v46
v_mul_f32 v79, v79, v47
v_cvt_pk_bf16_f32 v64, v64, v65
v_cvt_pk_bf16_f32 v65, v66, v67
v_cvt_pk_bf16_f32 v66, v68, v69
v_cvt_pk_bf16_f32 v67, v70, v71
v_cvt_pk_bf16_f32 v68, v72, v73
v_cvt_pk_bf16_f32 v69, v74, v75
v_cvt_pk_bf16_f32 v70, v76, v77
v_cvt_pk_bf16_f32 v71, v78, v79
buffer_store_dwordx4 v[64:67], v26, s[8:11], s26 offen offset:0 sc1
buffer_store_dwordx4 v[68:71], v26, s[8:11], s26 offen offset:32 sc1
v_accvgpr_read_b32 v80, a16
v_accvgpr_read_b32 v81, a17
v_accvgpr_read_b32 v82, a18
v_accvgpr_read_b32 v83, a19
v_accvgpr_read_b32 v84, a20
v_accvgpr_read_b32 v85, a21
v_accvgpr_read_b32 v86, a22
v_accvgpr_read_b32 v87, a23
v_accvgpr_read_b32 v88, a24
v_accvgpr_read_b32 v89, a25
v_accvgpr_read_b32 v90, a26
v_accvgpr_read_b32 v91, a27
v_accvgpr_read_b32 v92, a28
v_accvgpr_read_b32 v93, a29
v_accvgpr_read_b32 v94, a30
v_accvgpr_read_b32 v95, a31
v_mul_f32 v32, s28, v80
v_mul_f32 v33, s28, v81
v_mul_f32 v34, s28, v82
v_mul_f32 v35, s28, v83
v_mul_f32 v36, s28, v84
v_mul_f32 v37, s28, v85
v_mul_f32 v38, s28, v86
v_mul_f32 v39, s28, v87
v_mul_f32 v40, s28, v88
v_mul_f32 v41, s28, v89
v_mul_f32 v42, s28, v90
v_mul_f32 v43, s28, v91
v_mul_f32 v44, s28, v92
v_mul_f32 v45, s28, v93
v_mul_f32 v46, s28, v94
v_mul_f32 v47, s28, v95
v_exp_f32 v32, v32
v_exp_f32 v33, v33
v_exp_f32 v34, v34
v_exp_f32 v35, v35
v_exp_f32 v36, v36
v_exp_f32 v37, v37
v_exp_f32 v38, v38
v_exp_f32 v39, v39
v_exp_f32 v40, v40
v_exp_f32 v41, v41
v_exp_f32 v42, v42
v_exp_f32 v43, v43
v_exp_f32 v44, v44
v_exp_f32 v45, v45
v_exp_f32 v46, v46
v_exp_f32 v47, v47
v_add_f32 v32, 1.0, v32
v_add_f32 v33, 1.0, v33
v_add_f32 v34, 1.0, v34
v_add_f32 v35, 1.0, v35
v_add_f32 v36, 1.0, v36
v_add_f32 v37, 1.0, v37
v_add_f32 v38, 1.0, v38
v_add_f32 v39, 1.0, v39
v_add_f32 v40, 1.0, v40
v_add_f32 v41, 1.0, v41
v_add_f32 v42, 1.0, v42
v_add_f32 v43, 1.0, v43
v_add_f32 v44, 1.0, v44
v_add_f32 v45, 1.0, v45
v_add_f32 v46, 1.0, v46
v_add_f32 v47, 1.0, v47
v_rcp_f32 v32, v32
v_rcp_f32 v33, v33
v_rcp_f32 v34, v34
v_rcp_f32 v35, v35
v_rcp_f32 v36, v36
v_rcp_f32 v37, v37
v_rcp_f32 v38, v38
v_rcp_f32 v39, v39
v_rcp_f32 v40, v40
v_rcp_f32 v41, v41
v_rcp_f32 v42, v42
v_rcp_f32 v43, v43
v_rcp_f32 v44, v44
v_rcp_f32 v45, v45
v_rcp_f32 v46, v46
v_rcp_f32 v47, v47
v_mul_f32 v80, v80, v32
v_mul_f32 v81, v81, v33
v_mul_f32 v82, v82, v34
v_mul_f32 v83, v83, v35
v_mul_f32 v84, v84, v36
v_mul_f32 v85, v85, v37
v_mul_f32 v86, v86, v38
v_mul_f32 v87, v87, v39
v_mul_f32 v88, v88, v40
v_mul_f32 v89, v89, v41
v_mul_f32 v90, v90, v42
v_mul_f32 v91, v91, v43
v_mul_f32 v92, v92, v44
v_mul_f32 v93, v93, v45
v_mul_f32 v94, v94, v46
v_mul_f32 v95, v95, v47
v_cvt_pk_bf16_f32 v80, v80, v81
v_cvt_pk_bf16_f32 v81, v82, v83
v_cvt_pk_bf16_f32 v82, v84, v85
v_cvt_pk_bf16_f32 v83, v86, v87
v_cvt_pk_bf16_f32 v84, v88, v89
v_cvt_pk_bf16_f32 v85, v90, v91
v_cvt_pk_bf16_f32 v86, v92, v93
v_cvt_pk_bf16_f32 v87, v94, v95
buffer_store_dwordx4 v[80:83], v26, s[8:11], s26 offen offset:64 sc1
buffer_store_dwordx4 v[84:87], v26, s[8:11], s26 offen offset:96 sc1
v_accvgpr_read_b32 v64, a32
v_accvgpr_read_b32 v65, a33
v_accvgpr_read_b32 v66, a34
v_accvgpr_read_b32 v67, a35
v_accvgpr_read_b32 v68, a36
v_accvgpr_read_b32 v69, a37
v_accvgpr_read_b32 v70, a38
v_accvgpr_read_b32 v71, a39
v_accvgpr_read_b32 v72, a40
v_accvgpr_read_b32 v73, a41
v_accvgpr_read_b32 v74, a42
v_accvgpr_read_b32 v75, a43
v_accvgpr_read_b32 v76, a44
v_accvgpr_read_b32 v77, a45
v_accvgpr_read_b32 v78, a46
v_accvgpr_read_b32 v79, a47
v_mul_f32 v32, s28, v64
v_mul_f32 v33, s28, v65
v_mul_f32 v34, s28, v66
v_mul_f32 v35, s28, v67
v_mul_f32 v36, s28, v68
v_mul_f32 v37, s28, v69
v_mul_f32 v38, s28, v70
v_mul_f32 v39, s28, v71
v_mul_f32 v40, s28, v72
v_mul_f32 v41, s28, v73
v_mul_f32 v42, s28, v74
v_mul_f32 v43, s28, v75
v_mul_f32 v44, s28, v76
v_mul_f32 v45, s28, v77
v_mul_f32 v46, s28, v78
v_mul_f32 v47, s28, v79
v_exp_f32 v32, v32
v_exp_f32 v33, v33
v_exp_f32 v34, v34
v_exp_f32 v35, v35
v_exp_f32 v36, v36
v_exp_f32 v37, v37
v_exp_f32 v38, v38
v_exp_f32 v39, v39
v_exp_f32 v40, v40
v_exp_f32 v41, v41
v_exp_f32 v42, v42
v_exp_f32 v43, v43
v_exp_f32 v44, v44
v_exp_f32 v45, v45
v_exp_f32 v46, v46
v_exp_f32 v47, v47
v_add_f32 v32, 1.0, v32
v_add_f32 v33, 1.0, v33
v_add_f32 v34, 1.0, v34
v_add_f32 v35, 1.0, v35
v_add_f32 v36, 1.0, v36
v_add_f32 v37, 1.0, v37
v_add_f32 v38, 1.0, v38
v_add_f32 v39, 1.0, v39
v_add_f32 v40, 1.0, v40
v_add_f32 v41, 1.0, v41
v_add_f32 v42, 1.0, v42
v_add_f32 v43, 1.0, v43
v_add_f32 v44, 1.0, v44
v_add_f32 v45, 1.0, v45
v_add_f32 v46, 1.0, v46
v_add_f32 v47, 1.0, v47
v_rcp_f32 v32, v32
v_rcp_f32 v33, v33
v_rcp_f32 v34, v34
v_rcp_f32 v35, v35
v_rcp_f32 v36, v36
v_rcp_f32 v37, v37
v_rcp_f32 v38, v38
v_rcp_f32 v39, v39
v_rcp_f32 v40, v40
v_rcp_f32 v41, v41
v_rcp_f32 v42, v42
v_rcp_f32 v43, v43
v_rcp_f32 v44, v44
v_rcp_f32 v45, v45
v_rcp_f32 v46, v46
v_rcp_f32 v47, v47
v_mul_f32 v64, v64, v32
v_mul_f32 v65, v65, v33
v_mul_f32 v66, v66, v34
v_mul_f32 v67, v67, v35
v_mul_f32 v68, v68, v36
v_mul_f32 v69, v69, v37
v_mul_f32 v70, v70, v38
v_mul_f32 v71, v71, v39
v_mul_f32 v72, v72, v40
v_mul_f32 v73, v73, v41
v_mul_f32 v74, v74, v42
v_mul_f32 v75, v75, v43
v_mul_f32 v76, v76, v44
v_mul_f32 v77, v77, v45
v_mul_f32 v78, v78, v46
v_mul_f32 v79, v79, v47
v_cvt_pk_bf16_f32 v64, v64, v65
v_cvt_pk_bf16_f32 v65, v66, v67
v_cvt_pk_bf16_f32 v66, v68, v69
v_cvt_pk_bf16_f32 v67, v70, v71
v_cvt_pk_bf16_f32 v68, v72, v73
v_cvt_pk_bf16_f32 v69, v74, v75
v_cvt_pk_bf16_f32 v70, v76, v77
v_cvt_pk_bf16_f32 v71, v78, v79
buffer_store_dwordx4 v[64:67], v26, s[8:11], s26 offen offset:128 sc1
buffer_store_dwordx4 v[68:71], v26, s[8:11], s26 offen offset:160 sc1
v_accvgpr_read_b32 v80, a48
v_accvgpr_read_b32 v81, a49
v_accvgpr_read_b32 v82, a50
v_accvgpr_read_b32 v83, a51
v_accvgpr_read_b32 v84, a52
v_accvgpr_read_b32 v85, a53
v_accvgpr_read_b32 v86, a54
v_accvgpr_read_b32 v87, a55
v_accvgpr_read_b32 v88, a56
v_accvgpr_read_b32 v89, a57
v_accvgpr_read_b32 v90, a58
v_accvgpr_read_b32 v91, a59
v_accvgpr_read_b32 v92, a60
v_accvgpr_read_b32 v93, a61
v_accvgpr_read_b32 v94, a62
v_accvgpr_read_b32 v95, a63
v_mul_f32 v32, s28, v80
v_mul_f32 v33, s28, v81
v_mul_f32 v34, s28, v82
v_mul_f32 v35, s28, v83
v_mul_f32 v36, s28, v84
v_mul_f32 v37, s28, v85
v_mul_f32 v38, s28, v86
v_mul_f32 v39, s28, v87
v_mul_f32 v40, s28, v88
v_mul_f32 v41, s28, v89
v_mul_f32 v42, s28, v90
v_mul_f32 v43, s28, v91
v_mul_f32 v44, s28, v92
v_mul_f32 v45, s28, v93
v_mul_f32 v46, s28, v94
v_mul_f32 v47, s28, v95
v_exp_f32 v32, v32
v_exp_f32 v33, v33
v_exp_f32 v34, v34
v_exp_f32 v35, v35
v_exp_f32 v36, v36
v_exp_f32 v37, v37
v_exp_f32 v38, v38
v_exp_f32 v39, v39
v_exp_f32 v40, v40
v_exp_f32 v41, v41
v_exp_f32 v42, v42
v_exp_f32 v43, v43
v_exp_f32 v44, v44
v_exp_f32 v45, v45
v_exp_f32 v46, v46
v_exp_f32 v47, v47
v_add_f32 v32, 1.0, v32
v_add_f32 v33, 1.0, v33
v_add_f32 v34, 1.0, v34
v_add_f32 v35, 1.0, v35
v_add_f32 v36, 1.0, v36
v_add_f32 v37, 1.0, v37
v_add_f32 v38, 1.0, v38
v_add_f32 v39, 1.0, v39
v_add_f32 v40, 1.0, v40
v_add_f32 v41, 1.0, v41
v_add_f32 v42, 1.0, v42
v_add_f32 v43, 1.0, v43
v_add_f32 v44, 1.0, v44
v_add_f32 v45, 1.0, v45
v_add_f32 v46, 1.0, v46
v_add_f32 v47, 1.0, v47
v_rcp_f32 v32, v32
v_rcp_f32 v33, v33
v_rcp_f32 v34, v34
v_rcp_f32 v35, v35
v_rcp_f32 v36, v36
v_rcp_f32 v37, v37
v_rcp_f32 v38, v38
v_rcp_f32 v39, v39
v_rcp_f32 v40, v40
v_rcp_f32 v41, v41
v_rcp_f32 v42, v42
v_rcp_f32 v43, v43
v_rcp_f32 v44, v44
v_rcp_f32 v45, v45
v_rcp_f32 v46, v46
v_rcp_f32 v47, v47
v_mul_f32 v80, v80, v32
v_mul_f32 v81, v81, v33
v_mul_f32 v82, v82, v34
v_mul_f32 v83, v83, v35
v_mul_f32 v84, v84, v36
v_mul_f32 v85, v85, v37
v_mul_f32 v86, v86, v38
v_mul_f32 v87, v87, v39
v_mul_f32 v88, v88, v40
v_mul_f32 v89, v89, v41
v_mul_f32 v90, v90, v42
v_mul_f32 v91, v91, v43
v_mul_f32 v92, v92, v44
v_mul_f32 v93, v93, v45
v_mul_f32 v94, v94, v46
v_mul_f32 v95, v95, v47
v_cvt_pk_bf16_f32 v80, v80, v81
v_cvt_pk_bf16_f32 v81, v82, v83
v_cvt_pk_bf16_f32 v82, v84, v85
v_cvt_pk_bf16_f32 v83, v86, v87
v_cvt_pk_bf16_f32 v84, v88, v89
v_cvt_pk_bf16_f32 v85, v90, v91
v_cvt_pk_bf16_f32 v86, v92, v93
v_cvt_pk_bf16_f32 v87, v94, v95
buffer_store_dwordx4 v[80:83], v26, s[8:11], s26 offen offset:192 sc1
buffer_store_dwordx4 v[84:87], v26, s[8:11], s26 offen offset:224 sc1
v_accvgpr_read_b32 v64, a64
v_accvgpr_read_b32 v65, a65
v_accvgpr_read_b32 v66, a66
v_accvgpr_read_b32 v67, a67
v_accvgpr_read_b32 v68, a68
v_accvgpr_read_b32 v69, a69
v_accvgpr_read_b32 v70, a70
v_accvgpr_read_b32 v71, a71
v_accvgpr_read_b32 v72, a72
v_accvgpr_read_b32 v73, a73
v_accvgpr_read_b32 v74, a74
v_accvgpr_read_b32 v75, a75
v_accvgpr_read_b32 v76, a76
v_accvgpr_read_b32 v77, a77
v_accvgpr_read_b32 v78, a78
v_accvgpr_read_b32 v79, a79
v_mul_f32 v32, s28, v64
v_mul_f32 v33, s28, v65
v_mul_f32 v34, s28, v66
v_mul_f32 v35, s28, v67
v_mul_f32 v36, s28, v68
v_mul_f32 v37, s28, v69
v_mul_f32 v38, s28, v70
v_mul_f32 v39, s28, v71
v_mul_f32 v40, s28, v72
v_mul_f32 v41, s28, v73
v_mul_f32 v42, s28, v74
v_mul_f32 v43, s28, v75
v_mul_f32 v44, s28, v76
v_mul_f32 v45, s28, v77
v_mul_f32 v46, s28, v78
v_mul_f32 v47, s28, v79
v_exp_f32 v32, v32
v_exp_f32 v33, v33
v_exp_f32 v34, v34
v_exp_f32 v35, v35
v_exp_f32 v36, v36
v_exp_f32 v37, v37
v_exp_f32 v38, v38
v_exp_f32 v39, v39
v_exp_f32 v40, v40
v_exp_f32 v41, v41
v_exp_f32 v42, v42
v_exp_f32 v43, v43
v_exp_f32 v44, v44
v_exp_f32 v45, v45
v_exp_f32 v46, v46
v_exp_f32 v47, v47
v_add_f32 v32, 1.0, v32
v_add_f32 v33, 1.0, v33
v_add_f32 v34, 1.0, v34
v_add_f32 v35, 1.0, v35
v_add_f32 v36, 1.0, v36
v_add_f32 v37, 1.0, v37
v_add_f32 v38, 1.0, v38
v_add_f32 v39, 1.0, v39
v_add_f32 v40, 1.0, v40
v_add_f32 v41, 1.0, v41
v_add_f32 v42, 1.0, v42
v_add_f32 v43, 1.0, v43
v_add_f32 v44, 1.0, v44
v_add_f32 v45, 1.0, v45
v_add_f32 v46, 1.0, v46
v_add_f32 v47, 1.0, v47
v_rcp_f32 v32, v32
v_rcp_f32 v33, v33
v_rcp_f32 v34, v34
v_rcp_f32 v35, v35
v_rcp_f32 v36, v36
v_rcp_f32 v37, v37
v_rcp_f32 v38, v38
v_rcp_f32 v39, v39
v_rcp_f32 v40, v40
v_rcp_f32 v41, v41
v_rcp_f32 v42, v42
v_rcp_f32 v43, v43
v_rcp_f32 v44, v44
v_rcp_f32 v45, v45
v_rcp_f32 v46, v46
v_rcp_f32 v47, v47
v_mul_f32 v64, v64, v32
v_mul_f32 v65, v65, v33
v_mul_f32 v66, v66, v34
v_mul_f32 v67, v67, v35
v_mul_f32 v68, v68, v36
v_mul_f32 v69, v69, v37
v_mul_f32 v70, v70, v38
v_mul_f32 v71, v71, v39
v_mul_f32 v72, v72, v40
v_mul_f32 v73, v73, v41
v_mul_f32 v74, v74, v42
v_mul_f32 v75, v75, v43
v_mul_f32 v76, v76, v44
v_mul_f32 v77, v77, v45
v_mul_f32 v78, v78, v46
v_mul_f32 v79, v79, v47
v_cvt_pk_bf16_f32 v64, v64, v65
v_cvt_pk_bf16_f32 v65, v66, v67
v_cvt_pk_bf16_f32 v66, v68, v69
v_cvt_pk_bf16_f32 v67, v70, v71
v_cvt_pk_bf16_f32 v68, v72, v73
v_cvt_pk_bf16_f32 v69, v74, v75
v_cvt_pk_bf16_f32 v70, v76, v77
v_cvt_pk_bf16_f32 v71, v78, v79
buffer_store_dwordx4 v[64:67], v26, s[8:11], s26 offen offset:256 sc1
buffer_store_dwordx4 v[68:71], v26, s[8:11], s26 offen offset:288 sc1
v_accvgpr_read_b32 v80, a80
v_accvgpr_read_b32 v81, a81
v_accvgpr_read_b32 v82, a82
v_accvgpr_read_b32 v83, a83
v_accvgpr_read_b32 v84, a84
v_accvgpr_read_b32 v85, a85
v_accvgpr_read_b32 v86, a86
v_accvgpr_read_b32 v87, a87
v_accvgpr_read_b32 v88, a88
v_accvgpr_read_b32 v89, a89
v_accvgpr_read_b32 v90, a90
v_accvgpr_read_b32 v91, a91
v_accvgpr_read_b32 v92, a92
v_accvgpr_read_b32 v93, a93
v_accvgpr_read_b32 v94, a94
v_accvgpr_read_b32 v95, a95
v_mul_f32 v32, s28, v80
v_mul_f32 v33, s28, v81
v_mul_f32 v34, s28, v82
v_mul_f32 v35, s28, v83
v_mul_f32 v36, s28, v84
v_mul_f32 v37, s28, v85
v_mul_f32 v38, s28, v86
v_mul_f32 v39, s28, v87
v_mul_f32 v40, s28, v88
v_mul_f32 v41, s28, v89
v_mul_f32 v42, s28, v90
v_mul_f32 v43, s28, v91
v_mul_f32 v44, s28, v92
v_mul_f32 v45, s28, v93
v_mul_f32 v46, s28, v94
v_mul_f32 v47, s28, v95
v_exp_f32 v32, v32
v_exp_f32 v33, v33
v_exp_f32 v34, v34
v_exp_f32 v35, v35
v_exp_f32 v36, v36
v_exp_f32 v37, v37
v_exp_f32 v38, v38
v_exp_f32 v39, v39
v_exp_f32 v40, v40
v_exp_f32 v41, v41
v_exp_f32 v42, v42
v_exp_f32 v43, v43
v_exp_f32 v44, v44
v_exp_f32 v45, v45
v_exp_f32 v46, v46
v_exp_f32 v47, v47
v_add_f32 v32, 1.0, v32
v_add_f32 v33, 1.0, v33
v_add_f32 v34, 1.0, v34
v_add_f32 v35, 1.0, v35
v_add_f32 v36, 1.0, v36
v_add_f32 v37, 1.0, v37
v_add_f32 v38, 1.0, v38
v_add_f32 v39, 1.0, v39
v_add_f32 v40, 1.0, v40
v_add_f32 v41, 1.0, v41
v_add_f32 v42, 1.0, v42
v_add_f32 v43, 1.0, v43
v_add_f32 v44, 1.0, v44
v_add_f32 v45, 1.0, v45
v_add_f32 v46, 1.0, v46
v_add_f32 v47, 1.0, v47
v_rcp_f32 v32, v32
v_rcp_f32 v33, v33
v_rcp_f32 v34, v34
v_rcp_f32 v35, v35
v_rcp_f32 v36, v36
v_rcp_f32 v37, v37
v_rcp_f32 v38, v38
v_rcp_f32 v39, v39
v_rcp_f32 v40, v40
v_rcp_f32 v41, v41
v_rcp_f32 v42, v42
v_rcp_f32 v43, v43
v_rcp_f32 v44, v44
v_rcp_f32 v45, v45
v_rcp_f32 v46, v46
v_rcp_f32 v47, v47
v_mul_f32 v80, v80, v32
v_mul_f32 v81, v81, v33
v_mul_f32 v82, v82, v34
v_mul_f32 v83, v83, v35
v_mul_f32 v84, v84, v36
v_mul_f32 v85, v85, v37
v_mul_f32 v86, v86, v38
v_mul_f32 v87, v87, v39
v_mul_f32 v88, v88, v40
v_mul_f32 v89, v89, v41
v_mul_f32 v90, v90, v42
v_mul_f32 v91, v91, v43
v_mul_f32 v92, v92, v44
v_mul_f32 v93, v93, v45
v_mul_f32 v94, v94, v46
v_mul_f32 v95, v95, v47
v_cvt_pk_bf16_f32 v80, v80, v81
v_cvt_pk_bf16_f32 v81, v82, v83
v_cvt_pk_bf16_f32 v82, v84, v85
v_cvt_pk_bf16_f32 v83, v86, v87
v_cvt_pk_bf16_f32 v84, v88, v89
v_cvt_pk_bf16_f32 v85, v90, v91
v_cvt_pk_bf16_f32 v86, v92, v93
v_cvt_pk_bf16_f32 v87, v94, v95
buffer_store_dwordx4 v[80:83], v26, s[8:11], s26 offen offset:320 sc1
buffer_store_dwordx4 v[84:87], v26, s[8:11], s26 offen offset:352 sc1
v_accvgpr_read_b32 v64, a96
v_accvgpr_read_b32 v65, a97
v_accvgpr_read_b32 v66, a98
v_accvgpr_read_b32 v67, a99
v_accvgpr_read_b32 v68, a100
v_accvgpr_read_b32 v69, a101
v_accvgpr_read_b32 v70, a102
v_accvgpr_read_b32 v71, a103
v_accvgpr_read_b32 v72, a104
v_accvgpr_read_b32 v73, a105
v_accvgpr_read_b32 v74, a106
v_accvgpr_read_b32 v75, a107
v_accvgpr_read_b32 v76, a108
v_accvgpr_read_b32 v77, a109
v_accvgpr_read_b32 v78, a110
v_accvgpr_read_b32 v79, a111
v_mul_f32 v32, s28, v64
v_mul_f32 v33, s28, v65
v_mul_f32 v34, s28, v66
v_mul_f32 v35, s28, v67
v_mul_f32 v36, s28, v68
v_mul_f32 v37, s28, v69
v_mul_f32 v38, s28, v70
v_mul_f32 v39, s28, v71
v_mul_f32 v40, s28, v72
v_mul_f32 v41, s28, v73
v_mul_f32 v42, s28, v74
v_mul_f32 v43, s28, v75
v_mul_f32 v44, s28, v76
v_mul_f32 v45, s28, v77
v_mul_f32 v46, s28, v78
v_mul_f32 v47, s28, v79
v_exp_f32 v32, v32
v_exp_f32 v33, v33
v_exp_f32 v34, v34
v_exp_f32 v35, v35
v_exp_f32 v36, v36
v_exp_f32 v37, v37
v_exp_f32 v38, v38
v_exp_f32 v39, v39
v_exp_f32 v40, v40
v_exp_f32 v41, v41
v_exp_f32 v42, v42
v_exp_f32 v43, v43
v_exp_f32 v44, v44
v_exp_f32 v45, v45
v_exp_f32 v46, v46
v_exp_f32 v47, v47
v_add_f32 v32, 1.0, v32
v_add_f32 v33, 1.0, v33
v_add_f32 v34, 1.0, v34
v_add_f32 v35, 1.0, v35
v_add_f32 v36, 1.0, v36
v_add_f32 v37, 1.0, v37
v_add_f32 v38, 1.0, v38
v_add_f32 v39, 1.0, v39
v_add_f32 v40, 1.0, v40
v_add_f32 v41, 1.0, v41
v_add_f32 v42, 1.0, v42
v_add_f32 v43, 1.0, v43
v_add_f32 v44, 1.0, v44
v_add_f32 v45, 1.0, v45
v_add_f32 v46, 1.0, v46
v_add_f32 v47, 1.0, v47
v_rcp_f32 v32, v32
v_rcp_f32 v33, v33
v_rcp_f32 v34, v34
v_rcp_f32 v35, v35
v_rcp_f32 v36, v36
v_rcp_f32 v37, v37
v_rcp_f32 v38, v38
v_rcp_f32 v39, v39
v_rcp_f32 v40, v40
v_rcp_f32 v41, v41
v_rcp_f32 v42, v42
v_rcp_f32 v43, v43
v_rcp_f32 v44, v44
v_rcp_f32 v45, v45
v_rcp_f32 v46, v46
v_rcp_f32 v47, v47
v_mul_f32 v64, v64, v32
v_mul_f32 v65, v65, v33
v_mul_f32 v66, v66, v34
v_mul_f32 v67, v67, v35
v_mul_f32 v68, v68, v36
v_mul_f32 v69, v69, v37
v_mul_f32 v70, v70, v38
v_mul_f32 v71, v71, v39
v_mul_f32 v72, v72, v40
v_mul_f32 v73, v73, v41
v_mul_f32 v74, v74, v42
v_mul_f32 v75, v75, v43
v_mul_f32 v76, v76, v44
v_mul_f32 v77, v77, v45
v_mul_f32 v78, v78, v46
v_mul_f32 v79, v79, v47
v_cvt_pk_bf16_f32 v64, v64, v65
v_cvt_pk_bf16_f32 v65, v66, v67
v_cvt_pk_bf16_f32 v66, v68, v69
v_cvt_pk_bf16_f32 v67, v70, v71
v_cvt_pk_bf16_f32 v68, v72, v73
v_cvt_pk_bf16_f32 v69, v74, v75
v_cvt_pk_bf16_f32 v70, v76, v77
v_cvt_pk_bf16_f32 v71, v78, v79
buffer_store_dwordx4 v[64:67], v26, s[8:11], s26 offen offset:384 sc1
buffer_store_dwordx4 v[68:71], v26, s[8:11], s26 offen offset:416 sc1
s_waitcnt vmcnt(0)
s_barrier
s_cmp_lg_u32 s17, 0
s_cbranch_scc1 Lsig_66
s_lshl_b32 s26, s21, 7
s_add_u32 s26, s26, 54859776
v_mov_b32 v26, 1
v_mov_b32 v27, 1073741824
v_cmp_eq_u32 vcc, 0, v1
s_nop 1
v_cndmask_b32 v27, v27, v25, vcc
buffer_atomic_add v26, v27, s[8:11], s26 offen
Lsig_66:
s_branch Lnext_23
.p2align 6
LiS_27:
v_bfe_u32 v26, v1, 4, 1
s_mov_b32 s26, 100352
v_mul_lo_u32 v26, v26, s26
v_lshrrev_b32 v27, 5, v1
v_lshl_add_u32 v26, v27, 8, v26
v_and_b32 v27, 15, v1
v_and_b32 v28, 9, v27
v_bfe_u32 v29, v27, 1, 1
v_lshl_add_u32 v28, v29, 2, v28
v_bfe_u32 v29, v27, 2, 1
v_lshl_add_u32 v27, v29, 1, v28
v_lshl_add_u32 v3, v27, 4, v26
v_add_u32 v5, 0, v2
v_add_u32 v6, 28672, v2
v_add_u32 v7, 57344, v2
v_add_u32 v8, 86016, v2
s_mul_i32 s25, s17, 7168
v_and_b32 v28, 1, v27
s_mov_b32 s26, 14336
v_mul_lo_u32 v28, v28, s26
v_lshrrev_b32 v29, 1, v27
v_lshl_add_u32 v28, v29, 4, v28
v_bfe_u32 v29, v1, 4, 1
v_lshl_add_u32 v28, v29, 7, v28
v_lshrrev_b32 v29, 5, v1
v_lshl_add_u32 v28, v29, 8, v28
s_and_b32 s26, s17, 1
s_cmp_eq_u32 s26, 1
s_cselect_b64 vcc, -1, 0
v_cndmask_b32 v4, v28, v3, vcc
v_mov_b32 v3, v28
s_mov_b32 s76, 0
s_cselect_b32 s76, 229376, s76
s_mov_b32 s77, 28672
s_cselect_b32 s77, 258048, s77
s_mov_b32 s78, 57344
s_cselect_b32 s78, 301056, s78
s_mov_b32 s79, 100352
s_cselect_b32 s79, 329728, s79
s_mov_b32 s80, 129024
s_cselect_b32 s80, 358400, s80
s_mov_b32 s81, 157696
s_cselect_b32 s81, 86016, s81
s_mov_b32 s82, 200704
s_cselect_b32 s82, 286720, s82
s_lshr_b32 s26, s17, 1
s_lshl_b32 s24, s26, 9
s_mul_i32 s26, s22, 401408
s_add_u32 s24, s24, s26
s_add_u32 s24, s24, 0
s_mul_i32 s29, s23, 28672
s_add_u32 s29, s29, 55574528
v_bfe_u32 v26, v1, 4, 1
v_lshrrev_b32 v27, 5, v1
v_and_b32 v28, 15, v1
v_lshlrev_b32 v60, 14, v26
v_lshl_add_u32 v60, v27, 8, v60
v_lshl_add_u32 v60, v28, 4, v60
s_lshl_b32 s33, s23, 15
s_lshl_b32 s27, s22, 10
s_add_u32 s33, s33, s27
s_add_u32 s33, s33, 67108864
v_and_b32 v61, 31, v1
v_lshlrev_b32 v61, 4, v61
v_lshl_add_u32 v61, v27, 3, v61
s_lshl_b32 s34, s23, 13
s_lshl_b32 s27, s22, 9
s_add_u32 s34, s34, s27
s_add_u32 s34, s34, 69206016
v_mov_b32 v56, -1
v_mov_b32 v57, -1
v_mov_b32 v58, -1
v_mov_b32 v59, -1
buffer_store_dwordx4 v[56:59], v60, s[8:11], s33 offen sc1
buffer_store_dwordx4 v[56:59], v60, s[8:11], s33 offen offset:512 sc1
buffer_store_dwordx2 v[56:57], v61, s[8:11], s34 offen sc1
s_lshl_b32 s27, s21, 7
s_add_u32 s27, s27, 54865920
s_lshl_b32 s28, s22, 8
s_add_u32 s28, s28, 54861824
s_cmp_lg_u32 s17, 0
s_cbranch_scc1 Lwo_68
Lwm_67:
buffer_load_dword v26, v25, s[8:11], s27 offen sc1
buffer_load_dword v27, v25, s[8:11], s28 offen sc1
s_waitcnt vmcnt(0)
v_cmp_gt_u32 vcc, 16, v26
v_cmp_gt_u32 s[62:63], 8, v27
s_nop 3
s_or_b64 vcc, vcc, s[62:63]
s_cbranch_scc0 Lwo_68
s_sleep 2
s_sub_u32 s19, s19, 1
s_cbranch_scc0 Lwm_67
s_mov_b32 s19, 0
Lwo_68:
s_barrier
s_add_u32 m0, s25, 0
s_add_u32 s26, s24, s76
buffer_load_dwordx4 v3, s[8:11], s26 offen sc1 lds
s_add_u32 m0, s25, 1024
s_add_u32 s26, s24, s77
buffer_load_dwordx4 v3, s[8:11], s26 offen sc1 lds
s_add_u32 m0, s25, 2048
s_add_u32 s26, s24, s78
buffer_load_dwordx4 v3, s[8:11], s26 offen sc1 lds
s_add_u32 m0, s25, 3072
s_add_u32 s26, s24, s79
buffer_load_dwordx4 v3, s[8:11], s26 offen sc1 lds
s_add_u32 m0, s25, 4096
s_add_u32 s26, s24, s80
buffer_load_dwordx4 v3, s[8:11], s26 offen sc1 lds
s_add_u32 m0, s25, 5120
s_add_u32 s26, s24, s81
buffer_load_dwordx4 v4, s[8:11], s26 offen sc1 lds
s_add_u32 m0, s25, 6144
s_add_u32 s26, s24, s82
buffer_load_dwordx4 v4, s[8:11], s26 offen sc1 lds
s_add_u32 s24, s24, 1024
buffer_load_dwordx4 v[128:131], v2, s[8:11], s29 offen offset:0 sc1
buffer_load_dwordx4 v[132:135], v2, s[8:11], s29 offen offset:1024 sc1
buffer_load_dwordx4 v[136:139], v2, s[8:11], s29 offen offset:2048 sc1
buffer_load_dwordx4 v[140:143], v2, s[8:11], s29 offen offset:3072 sc1
s_add_u32 s29, s29, 4096
buffer_load_dwordx4 v[144:147], v2, s[8:11], s29 offen offset:0 sc1
buffer_load_dwordx4 v[148:151], v2, s[8:11], s29 offen offset:1024 sc1
buffer_load_dwordx4 v[152:155], v2, s[8:11], s29 offen offset:2048 sc1
buffer_load_dwordx4 v[156:159], v2, s[8:11], s29 offen offset:3072 sc1
s_add_u32 s29, s29, 4096
buffer_load_dwordx4 v[160:163], v2, s[8:11], s29 offen offset:0 sc1
buffer_load_dwordx4 v[164:167], v2, s[8:11], s29 offen offset:1024 sc1
buffer_load_dwordx4 v[168:171], v2, s[8:11], s29 offen offset:2048 sc1
buffer_load_dwordx4 v[172:175], v2, s[8:11], s29 offen offset:3072 sc1
s_add_u32 s29, s29, 4096
buffer_load_dwordx4 v[176:179], v2, s[8:11], s29 offen offset:0 sc1
buffer_load_dwordx4 v[180:183], v2, s[8:11], s29 offen offset:1024 sc1
buffer_load_dwordx4 v[184:187], v2, s[8:11], s29 offen offset:2048 sc1
buffer_load_dwordx4 v[188:191], v2, s[8:11], s29 offen offset:3072 sc1
s_add_u32 s29, s29, 4096
buffer_load_dwordx4 v[192:195], v2, s[8:11], s29 offen offset:0 sc1
buffer_load_dwordx4 v[196:199], v2, s[8:11], s29 offen offset:1024 sc1
buffer_load_dwordx4 v[200:203], v2, s[8:11], s29 offen offset:2048 sc1
buffer_load_dwordx4 v[204:207], v2, s[8:11], s29 offen offset:3072 sc1
s_add_u32 s29, s29, 4096
buffer_load_dwordx4 v[208:211], v2, s[8:11], s29 offen offset:0 sc1
buffer_load_dwordx4 v[212:215], v2, s[8:11], s29 offen offset:1024 sc1
buffer_load_dwordx4 v[216:219], v2, s[8:11], s29 offen offset:2048 sc1
buffer_load_dwordx4 v[220:223], v2, s[8:11], s29 offen offset:3072 sc1
s_add_u32 s29, s29, 4096
buffer_load_dwordx4 v[224:227], v2, s[8:11], s29 offen offset:0 sc1
buffer_load_dwordx4 v[228:231], v2, s[8:11], s29 offen offset:1024 sc1
buffer_load_dwordx4 v[232:235], v2, s[8:11], s29 offen offset:2048 sc1
buffer_load_dwordx4 v[236:239], v2, s[8:11], s29 offen offset:3072 sc1
s_add_u32 m0, s25, 28672
s_add_u32 s26, s24, s76
buffer_load_dwordx4 v3, s[8:11], s26 offen sc1 lds
s_add_u32 m0, s25, 29696
s_add_u32 s26, s24, s77
buffer_load_dwordx4 v3, s[8:11], s26 offen sc1 lds
s_add_u32 m0, s25, 30720
s_add_u32 s26, s24, s78
buffer_load_dwordx4 v3, s[8:11], s26 offen sc1 lds
s_add_u32 m0, s25, 31744
s_add_u32 s26, s24, s79
buffer_load_dwordx4 v3, s[8:11], s26 offen sc1 lds
s_add_u32 m0, s25, 32768
s_add_u32 s26, s24, s80
buffer_load_dwordx4 v3, s[8:11], s26 offen sc1 lds
s_add_u32 m0, s25, 33792
s_add_u32 s26, s24, s81
buffer_load_dwordx4 v4, s[8:11], s26 offen sc1 lds
s_add_u32 m0, s25, 34816
s_add_u32 s26, s24, s82
buffer_load_dwordx4 v4, s[8:11], s26 offen sc1 lds
s_add_u32 s24, s24, 1024
s_add_u32 m0, s25, 57344
s_add_u32 s26, s24, s76
buffer_load_dwordx4 v3, s[8:11], s26 offen sc1 lds
s_add_u32 m0, s25, 58368
s_add_u32 s26, s24, s77
buffer_load_dwordx4 v3, s[8:11], s26 offen sc1 lds
s_add_u32 m0, s25, 59392
s_add_u32 s26, s24, s78
buffer_load_dwordx4 v3, s[8:11], s26 offen sc1 lds
s_add_u32 m0, s25, 60416
s_add_u32 s26, s24, s79
buffer_load_dwordx4 v3, s[8:11], s26 offen sc1 lds
s_add_u32 m0, s25, 61440
s_add_u32 s26, s24, s80
buffer_load_dwordx4 v3, s[8:11], s26 offen sc1 lds
s_add_u32 m0, s25, 62464
s_add_u32 s26, s24, s81
buffer_load_dwordx4 v4, s[8:11], s26 offen sc1 lds
s_add_u32 m0, s25, 63488
s_add_u32 s26, s24, s82
buffer_load_dwordx4 v4, s[8:11], s26 offen sc1 lds
s_add_u32 s24, s24, 1024
s_waitcnt vmcnt(14)
s_barrier
ds_read_b128 v[64:67], v5 offset:0
ds_read_b128 v[68:71], v5 offset:1024
ds_read_b128 v[72:75], v5 offset:2048
ds_read_b128 v[76:79], v5 offset:3072
ds_read_b128 v[80:83], v5 offset:4096
ds_read_b128 v[84:87], v5 offset:5120
ds_read_b128 v[88:91], v5 offset:6144
ds_read_b128 v[92:95], v5 offset:7168
s_waitcnt lgkmcnt(7)
v_mfma_f32_32x32x16_bf16 a[0:15], v[64:67], v[128:131], 0
ds_read_b128 v[96:99], v5 offset:8192
s_waitcnt lgkmcnt(7)
v_mfma_f32_32x32x16_bf16 a[16:31], v[68:71], v[128:131], 0
ds_read_b128 v[100:103], v5 offset:9216
s_waitcnt lgkmcnt(7)
v_mfma_f32_32x32x16_bf16 a[32:47], v[72:75], v[128:131], 0
ds_read_b128 v[104:107], v5 offset:10240
s_waitcnt lgkmcnt(7)
v_mfma_f32_32x32x16_bf16 a[48:63], v[76:79], v[128:131], 0
ds_read_b128 v[108:111], v5 offset:11264
s_waitcnt lgkmcnt(7)
v_mfma_f32_32x32x16_bf16 a[64:79], v[80:83], v[128:131], 0
ds_read_b128 v[112:115], v5 offset:12288
s_waitcnt lgkmcnt(7)
v_mfma_f32_32x32x16_bf16 a[80:95], v[84:87], v[128:131], 0
ds_read_b128 v[116:119], v5 offset:13312
s_waitcnt lgkmcnt(7)
v_mfma_f32_32x32x16_bf16 a[96:111], v[88:91], v[128:131], 0
ds_read_b128 v[120:123], v5 offset:14336
s_waitcnt lgkmcnt(7)
v_mfma_f32_32x32x16_bf16 a[112:127], v[92:95], v[128:131], 0
ds_read_b128 v[124:127], v5 offset:15360
s_waitcnt lgkmcnt(7)
v_mfma_f32_32x32x16_bf16 a[128:143], v[96:99], v[128:131], 0
ds_read_b128 v[64:67], v5 offset:16384
s_waitcnt lgkmcnt(7)
v_mfma_f32_32x32x16_bf16 a[144:159], v[100:103], v[128:131], 0
ds_read_b128 v[68:71], v5 offset:17408
s_waitcnt lgkmcnt(7)
v_mfma_f32_32x32x16_bf16 a[160:175], v[104:107], v[128:131], 0
ds_read_b128 v[72:75], v5 offset:18432
s_waitcnt lgkmcnt(7)
v_mfma_f32_32x32x16_bf16 a[176:191], v[108:111], v[128:131], 0
ds_read_b128 v[76:79], v5 offset:19456
s_waitcnt lgkmcnt(7)
v_mfma_f32_32x32x16_bf16 a[192:207], v[112:115], v[128:131], 0
ds_read_b128 v[80:83], v5 offset:20480
s_waitcnt lgkmcnt(7)
v_mfma_f32_32x32x16_bf16 a[208:223], v[116:119], v[128:131], 0
ds_read_b128 v[84:87], v5 offset:21504
s_waitcnt lgkmcnt(7)
v_mfma_f32_32x32x16_bf16 a[0:15], v[120:123], v[132:135], a[0:15]
ds_read_b128 v[88:91], v5 offset:22528
s_waitcnt lgkmcnt(7)
v_mfma_f32_32x32x16_bf16 a[16:31], v[124:127], v[132:135], a[16:31]
ds_read_b128 v[92:95], v5 offset:23552
s_waitcnt lgkmcnt(7)
v_mfma_f32_32x32x16_bf16 a[32:47], v[64:67], v[132:135], a[32:47]
ds_read_b128 v[96:99], v5 offset:24576
s_waitcnt lgkmcnt(7)
v_mfma_f32_32x32x16_bf16 a[48:63], v[68:71], v[132:135], a[48:63]
ds_read_b128 v[100:103], v5 offset:25600
s_waitcnt lgkmcnt(7)
v_mfma_f32_32x32x16_bf16 a[64:79], v[72:75], v[132:135], a[64:79]
ds_read_b128 v[104:107], v5 offset:26624
s_waitcnt lgkmcnt(7)
v_mfma_f32_32x32x16_bf16 a[80:95], v[76:79], v[132:135], a[80:95]
s_waitcnt vmcnt(7)
s_barrier
ds_read_b128 v[108:111], v5 offset:27648
s_waitcnt lgkmcnt(7)
v_mfma_f32_32x32x16_bf16 a[96:111], v[80:83], v[132:135], a[96:111]
ds_read_b128 v[112:115], v6 offset:0
s_waitcnt lgkmcnt(7)
v_mfma_f32_32x32x16_bf16 a[112:127], v[84:87], v[132:135], a[112:127]
ds_read_b128 v[116:119], v6 offset:1024
s_add_u32 m0, s25, 86016
s_add_u32 s26, s24, s76
buffer_load_dwordx4 v3, s[8:11], s26 offen sc1 lds
s_waitcnt lgkmcnt(7)
v_mfma_f32_32x32x16_bf16 a[128:143], v[88:91], v[132:135], a[128:143]
ds_read_b128 v[120:123], v6 offset:2048
s_waitcnt lgkmcnt(7)
v_mfma_f32_32x32x16_bf16 a[144:159], v[92:95], v[132:135], a[144:159]
ds_read_b128 v[124:127], v6 offset:3072
s_waitcnt lgkmcnt(7)
v_mfma_f32_32x32x16_bf16 a[160:175], v[96:99], v[132:135], a[160:175]
ds_read_b128 v[64:67], v6 offset:4096
s_add_u32 m0, s25, 87040
s_add_u32 s26, s24, s77
buffer_load_dwordx4 v3, s[8:11], s26 offen sc1 lds
s_waitcnt lgkmcnt(7)
v_mfma_f32_32x32x16_bf16 a[176:191], v[100:103], v[132:135], a[176:191]
ds_read_b128 v[68:71], v6 offset:5120
s_waitcnt lgkmcnt(7)
v_mfma_f32_32x32x16_bf16 a[192:207], v[104:107], v[132:135], a[192:207]
ds_read_b128 v[72:75], v6 offset:6144
s_waitcnt lgkmcnt(7)
v_mfma_f32_32x32x16_bf16 a[208:223], v[108:111], v[132:135], a[208:223]
ds_read_b128 v[76:79], v6 offset:7168
s_add_u32 m0, s25, 88064
s_add_u32 s26, s24, s78
buffer_load_dwordx4 v3, s[8:11], s26 offen sc1 lds
s_waitcnt lgkmcnt(7)
v_mfma_f32_32x32x16_bf16 a[0:15], v[112:115], v[136:139], a[0:15]
ds_read_b128 v[80:83], v6 offset:8192
s_waitcnt lgkmcnt(7)
v_mfma_f32_32x32x16_bf16 a[16:31], v[116:119], v[136:139], a[16:31]
ds_read_b128 v[84:87], v6 offset:9216
s_waitcnt lgkmcnt(7)
v_mfma_f32_32x32x16_bf16 a[32:47], v[120:123], v[136:139], a[32:47]
ds_read_b128 v[88:91], v6 offset:10240
s_add_u32 m0, s25, 89088
s_add_u32 s26, s24, s79
buffer_load_dwordx4 v3, s[8:11], s26 offen sc1 lds
s_waitcnt lgkmcnt(7)
v_mfma_f32_32x32x16_bf16 a[48:63], v[124:127], v[136:139], a[48:63]
ds_read_b128 v[92:95], v6 offset:11264
s_waitcnt lgkmcnt(7)
v_mfma_f32_32x32x16_bf16 a[64:79], v[64:67], v[136:139], a[64:79]
ds_read_b128 v[96:99], v6 offset:12288
s_waitcnt lgkmcnt(7)
v_mfma_f32_32x32x16_bf16 a[80:95], v[68:71], v[136:139], a[80:95]
ds_read_b128 v[100:103], v6 offset:13312
s_add_u32 m0, s25, 90112
s_add_u32 s26, s24, s80
buffer_load_dwordx4 v3, s[8:11], s26 offen sc1 lds
s_waitcnt lgkmcnt(7)
v_mfma_f32_32x32x16_bf16 a[96:111], v[72:75], v[136:139], a[96:111]
ds_read_b128 v[104:107], v6 offset:14336
s_waitcnt lgkmcnt(7)
v_mfma_f32_32x32x16_bf16 a[112:127], v[76:79], v[136:139], a[112:127]
ds_read_b128 v[108:111], v6 offset:15360
s_waitcnt lgkmcnt(7)
v_mfma_f32_32x32x16_bf16 a[128:143], v[80:83], v[136:139], a[128:143]
ds_read_b128 v[112:115], v6 offset:16384
s_add_u32 m0, s25, 91136
s_add_u32 s26, s24, s81
buffer_load_dwordx4 v4, s[8:11], s26 offen sc1 lds
s_waitcnt lgkmcnt(7)
v_mfma_f32_32x32x16_bf16 a[144:159], v[84:87], v[136:139], a[144:159]
ds_read_b128 v[116:119], v6 offset:17408
s_waitcnt lgkmcnt(7)
v_mfma_f32_32x32x16_bf16 a[160:175], v[88:91], v[136:139], a[160:175]
ds_read_b128 v[120:123], v6 offset:18432
s_waitcnt lgkmcnt(7)
v_mfma_f32_32x32x16_bf16 a[176:191], v[92:95], v[136:139], a[176:191]
ds_read_b128 v[124:127], v6 offset:19456
s_add_u32 m0, s25, 92160
s_add_u32 s26, s24, s82
buffer_load_dwordx4 v4, s[8:11], s26 offen sc1 lds
s_add_u32 s24, s24, 1024
s_waitcnt lgkmcnt(7)
v_mfma_f32_32x32x16_bf16 a[192:207], v[96:99], v[136:139], a[192:207]
ds_read_b128 v[64:67], v6 offset:20480
s_waitcnt lgkmcnt(7)
v_mfma_f32_32x32x16_bf16 a[208:223], v[100:103], v[136:139], a[208:223]
ds_read_b128 v[68:71], v6 offset:21504
s_waitcnt lgkmcnt(7)
v_mfma_f32_32x32x16_bf16 a[0:15], v[104:107], v[140:143], a[0:15]
ds_read_b128 v[72:75], v6 offset:22528
s_waitcnt lgkmcnt(7)
v_mfma_f32_32x32x16_bf16 a[16:31], v[108:111], v[140:143], a[16:31]
ds_read_b128 v[76:79], v6 offset:23552
s_waitcnt lgkmcnt(7)
v_mfma_f32_32x32x16_bf16 a[32:47], v[112:115], v[140:143], a[32:47]
ds_read_b128 v[80:83], v6 offset:24576
s_waitcnt lgkmcnt(7)
v_mfma_f32_32x32x16_bf16 a[48:63], v[116:119], v[140:143], a[48:63]
ds_read_b128 v[84:87], v6 offset:25600
s_waitcnt lgkmcnt(7)
v_mfma_f32_32x32x16_bf16 a[64:79], v[120:123], v[140:143], a[64:79]
ds_read_b128 v[88:91], v6 offset:26624
s_waitcnt lgkmcnt(7)
v_mfma_f32_32x32x16_bf16 a[80:95], v[124:127], v[140:143], a[80:95]
s_waitcnt vmcnt(7)
s_barrier
ds_read_b128 v[92:95], v6 offset:27648
s_waitcnt lgkmcnt(7)
v_mfma_f32_32x32x16_bf16 a[96:111], v[64:67], v[140:143], a[96:111]
ds_read_b128 v[96:99], v7 offset:0
s_add_u32 m0, s25, 0
s_add_u32 s26, s24, s76
buffer_load_dwordx4 v3, s[8:11], s26 offen sc1 lds
s_waitcnt lgkmcnt(7)
v_mfma_f32_32x32x16_bf16 a[112:127], v[68:71], v[140:143], a[112:127]
ds_read_b128 v[100:103], v7 offset:1024
s_waitcnt lgkmcnt(7)
v_mfma_f32_32x32x16_bf16 a[128:143], v[72:75], v[140:143], a[128:143]
ds_read_b128 v[104:107], v7 offset:2048
s_waitcnt lgkmcnt(7)
v_mfma_f32_32x32x16_bf16 a[144:159], v[76:79], v[140:143], a[144:159]
ds_read_b128 v[108:111], v7 offset:3072
s_add_u32 m0, s25, 1024
s_add_u32 s26, s24, s77
buffer_load_dwordx4 v3, s[8:11], s26 offen sc1 lds
s_waitcnt lgkmcnt(7)
v_mfma_f32_32x32x16_bf16 a[160:175], v[80:83], v[140:143], a[160:175]
ds_read_b128 v[112:115], v7 offset:4096
s_waitcnt lgkmcnt(7)
v_mfma_f32_32x32x16_bf16 a[176:191], v[84:87], v[140:143], a[176:191]
ds_read_b128 v[116:119], v7 offset:5120
s_waitcnt lgkmcnt(7)
v_mfma_f32_32x32x16_bf16 a[192:207], v[88:91], v[140:143], a[192:207]
ds_read_b128 v[120:123], v7 offset:6144
s_add_u32 m0, s25, 2048
s_add_u32 s26, s24, s78
buffer_load_dwordx4 v3, s[8:11], s26 offen sc1 lds
s_waitcnt lgkmcnt(7)
v_mfma_f32_32x32x16_bf16 a[208:223], v[92:95], v[140:143], a[208:223]
ds_read_b128 v[124:127], v7 offset:7168
s_waitcnt lgkmcnt(7)
v_mfma_f32_32x32x16_bf16 a[0:15], v[96:99], v[144:147], a[0:15]
ds_read_b128 v[64:67], v7 offset:8192
s_waitcnt lgkmcnt(7)
v_mfma_f32_32x32x16_bf16 a[16:31], v[100:103], v[144:147], a[16:31]
ds_read_b128 v[68:71], v7 offset:9216
s_add_u32 m0, s25, 3072
s_add_u32 s26, s24, s79
buffer_load_dwordx4 v3, s[8:11], s26 offen sc1 lds
s_waitcnt lgkmcnt(7)
v_mfma_f32_32x32x16_bf16 a[32:47], v[104:107], v[144:147], a[32:47]
ds_read_b128 v[72:75], v7 offset:10240
s_waitcnt lgkmcnt(7)
v_mfma_f32_32x32x16_bf16 a[48:63], v[108:111], v[144:147], a[48:63]
ds_read_b128 v[76:79], v7 offset:11264
s_waitcnt lgkmcnt(7)
v_mfma_f32_32x32x16_bf16 a[64:79], v[112:115], v[144:147], a[64:79]
ds_read_b128 v[80:83], v7 offset:12288
s_add_u32 m0, s25, 4096
s_add_u32 s26, s24, s80
buffer_load_dwordx4 v3, s[8:11], s26 offen sc1 lds
s_waitcnt lgkmcnt(7)
v_mfma_f32_32x32x16_bf16 a[80:95], v[116:119], v[144:147], a[80:95]
ds_read_b128 v[84:87], v7 offset:13312
s_waitcnt lgkmcnt(7)
v_mfma_f32_32x32x16_bf16 a[96:111], v[120:123], v[144:147], a[96:111]
ds_read_b128 v[88:91], v7 offset:14336
s_waitcnt lgkmcnt(7)
v_mfma_f32_32x32x16_bf16 a[112:127], v[124:127], v[144:147], a[112:127]
ds_read_b128 v[92:95], v7 offset:15360
s_add_u32 m0, s25, 5120
s_add_u32 s26, s24, s81
buffer_load_dwordx4 v4, s[8:11], s26 offen sc1 lds
s_waitcnt lgkmcnt(7)
v_mfma_f32_32x32x16_bf16 a[128:143], v[64:67], v[144:147], a[128:143]
ds_read_b128 v[96:99], v7 offset:16384
s_waitcnt lgkmcnt(7)
v_mfma_f32_32x32x16_bf16 a[144:159], v[68:71], v[144:147], a[144:159]
ds_read_b128 v[100:103], v7 offset:17408
s_waitcnt lgkmcnt(7)
v_mfma_f32_32x32x16_bf16 a[160:175], v[72:75], v[144:147], a[160:175]
ds_read_b128 v[104:107], v7 offset:18432
s_add_u32 m0, s25, 6144
s_add_u32 s26, s24, s82
buffer_load_dwordx4 v4, s[8:11], s26 offen sc1 lds
s_add_u32 s24, s24, 1024
s_waitcnt lgkmcnt(7)
v_mfma_f32_32x32x16_bf16 a[176:191], v[76:79], v[144:147], a[176:191]
ds_read_b128 v[108:111], v7 offset:19456
s_waitcnt lgkmcnt(7)
v_mfma_f32_32x32x16_bf16 a[192:207], v[80:83], v[144:147], a[192:207]
ds_read_b128 v[112:115], v7 offset:20480
s_waitcnt lgkmcnt(7)
v_mfma_f32_32x32x16_bf16 a[208:223], v[84:87], v[144:147], a[208:223]
ds_read_b128 v[116:119], v7 offset:21504
s_waitcnt lgkmcnt(7)
v_mfma_f32_32x32x16_bf16 a[0:15], v[88:91], v[148:151], a[0:15]
ds_read_b128 v[120:123], v7 offset:22528
s_waitcnt lgkmcnt(7)
v_mfma_f32_32x32x16_bf16 a[16:31], v[92:95], v[148:151], a[16:31]
ds_read_b128 v[124:127], v7 offset:23552
s_waitcnt lgkmcnt(7)
v_mfma_f32_32x32x16_bf16 a[32:47], v[96:99], v[148:151], a[32:47]
ds_read_b128 v[64:67], v7 offset:24576
s_waitcnt lgkmcnt(7)
v_mfma_f32_32x32x16_bf16 a[48:63], v[100:103], v[148:151], a[48:63]
ds_read_b128 v[68:71], v7 offset:25600
s_waitcnt lgkmcnt(7)
v_mfma_f32_32x32x16_bf16 a[64:79], v[104:107], v[148:151], a[64:79]
ds_read_b128 v[72:75], v7 offset:26624
s_waitcnt lgkmcnt(7)
v_mfma_f32_32x32x16_bf16 a[80:95], v[108:111], v[148:151], a[80:95]
s_waitcnt vmcnt(7)
s_barrier
ds_read_b128 v[76:79], v7 offset:27648
s_add_u32 m0, s25, 28672
s_add_u32 s26, s24, s76
buffer_load_dwordx4 v3, s[8:11], s26 offen sc1 lds
s_waitcnt lgkmcnt(7)
v_mfma_f32_32x32x16_bf16 a[96:111], v[112:115], v[148:151], a[96:111]
ds_read_b128 v[80:83], v8 offset:0
s_waitcnt lgkmcnt(7)
v_mfma_f32_32x32x16_bf16 a[112:127], v[116:119], v[148:151], a[112:127]
ds_read_b128 v[84:87], v8 offset:1024
s_waitcnt lgkmcnt(7)
v_mfma_f32_32x32x16_bf16 a[128:143], v[120:123], v[148:151], a[128:143]
ds_read_b128 v[88:91], v8 offset:2048
s_add_u32 m0, s25, 29696
s_add_u32 s26, s24, s77
buffer_load_dwordx4 v3, s[8:11], s26 offen sc1 lds
s_waitcnt lgkmcnt(7)
v_mfma_f32_32x32x16_bf16 a[144:159], v[124:127], v[148:151], a[144:159]
ds_read_b128 v[92:95], v8 offset:3072
s_waitcnt lgkmcnt(7)
v_mfma_f32_32x32x16_bf16 a[160:175], v[64:67], v[148:151], a[160:175]
ds_read_b128 v[96:99], v8 offset:4096
s_waitcnt lgkmcnt(7)
v_mfma_f32_32x32x16_bf16 a[176:191], v[68:71], v[148:151], a[176:191]
ds_read_b128 v[100:103], v8 offset:5120
s_add_u32 m0, s25, 30720
s_add_u32 s26, s24, s78
buffer_load_dwordx4 v3, s[8:11], s26 offen sc1 lds
s_waitcnt lgkmcnt(7)
v_mfma_f32_32x32x16_bf16 a[192:207], v[72:75], v[148:151], a[192:207]
ds_read_b128 v[104:107], v8 offset:6144
s_waitcnt lgkmcnt(7)
v_mfma_f32_32x32x16_bf16 a[208:223], v[76:79], v[148:151], a[208:223]
ds_read_b128 v[108:111], v8 offset:7168
s_waitcnt lgkmcnt(7)
v_mfma_f32_32x32x16_bf16 a[0:15], v[80:83], v[152:155], a[0:15]
ds_read_b128 v[112:115], v8 offset:8192
s_add_u32 m0, s25, 31744
s_add_u32 s26, s24, s79
buffer_load_dwordx4 v3, s[8:11], s26 offen sc1 lds
s_waitcnt lgkmcnt(7)
v_mfma_f32_32x32x16_bf16 a[16:31], v[84:87], v[152:155], a[16:31]
ds_read_b128 v[116:119], v8 offset:9216
s_waitcnt lgkmcnt(7)
v_mfma_f32_32x32x16_bf16 a[32:47], v[88:91], v[152:155], a[32:47]
ds_read_b128 v[120:123], v8 offset:10240
s_waitcnt lgkmcnt(7)
v_mfma_f32_32x32x16_bf16 a[48:63], v[92:95], v[152:155], a[48:63]
ds_read_b128 v[124:127], v8 offset:11264
s_add_u32 m0, s25, 32768
s_add_u32 s26, s24, s80
buffer_load_dwordx4 v3, s[8:11], s26 offen sc1 lds
s_waitcnt lgkmcnt(7)
v_mfma_f32_32x32x16_bf16 a[64:79], v[96:99], v[152:155], a[64:79]
ds_read_b128 v[64:67], v8 offset:12288
s_waitcnt lgkmcnt(7)
v_mfma_f32_32x32x16_bf16 a[80:95], v[100:103], v[152:155], a[80:95]
ds_read_b128 v[68:71], v8 offset:13312
s_waitcnt lgkmcnt(7)
v_mfma_f32_32x32x16_bf16 a[96:111], v[104:107], v[152:155], a[96:111]
ds_read_b128 v[72:75], v8 offset:14336
s_add_u32 m0, s25, 33792
s_add_u32 s26, s24, s81
buffer_load_dwordx4 v4, s[8:11], s26 offen sc1 lds
s_waitcnt lgkmcnt(7)
v_mfma_f32_32x32x16_bf16 a[112:127], v[108:111], v[152:155], a[112:127]
ds_read_b128 v[76:79], v8 offset:15360
s_waitcnt lgkmcnt(7)
v_mfma_f32_32x32x16_bf16 a[128:143], v[112:115], v[152:155], a[128:143]
ds_read_b128 v[80:83], v8 offset:16384
s_waitcnt lgkmcnt(7)
v_mfma_f32_32x32x16_bf16 a[144:159], v[116:119], v[152:155], a[144:159]
ds_read_b128 v[84:87], v8 offset:17408
s_add_u32 m0, s25, 34816
s_add_u32 s26, s24, s82
buffer_load_dwordx4 v4, s[8:11], s26 offen sc1 lds
s_add_u32 s24, s24, 1024
s_waitcnt lgkmcnt(7)
v_mfma_f32_32x32x16_bf16 a[160:175], v[120:123], v[152:155], a[160:175]
ds_read_b128 v[88:91], v8 offset:18432
s_waitcnt lgkmcnt(7)
v_mfma_f32_32x32x16_bf16 a[176:191], v[124:127], v[152:155], a[176:191]
ds_read_b128 v[92:95], v8 offset:19456
s_waitcnt lgkmcnt(7)
v_mfma_f32_32x32x16_bf16 a[192:207], v[64:67], v[152:155], a[192:207]
ds_read_b128 v[96:99], v8 offset:20480
s_waitcnt lgkmcnt(7)
v_mfma_f32_32x32x16_bf16 a[208:223], v[68:71], v[152:155], a[208:223]
ds_read_b128 v[100:103], v8 offset:21504
s_waitcnt lgkmcnt(7)
v_mfma_f32_32x32x16_bf16 a[0:15], v[72:75], v[156:159], a[0:15]
ds_read_b128 v[104:107], v8 offset:22528
s_waitcnt lgkmcnt(7)
v_mfma_f32_32x32x16_bf16 a[16:31], v[76:79], v[156:159], a[16:31]
ds_read_b128 v[108:111], v8 offset:23552
s_waitcnt lgkmcnt(7)
v_mfma_f32_32x32x16_bf16 a[32:47], v[80:83], v[156:159], a[32:47]
ds_read_b128 v[112:115], v8 offset:24576
s_waitcnt lgkmcnt(7)
v_mfma_f32_32x32x16_bf16 a[48:63], v[84:87], v[156:159], a[48:63]
ds_read_b128 v[116:119], v8 offset:25600
s_waitcnt lgkmcnt(7)
v_mfma_f32_32x32x16_bf16 a[64:79], v[88:91], v[156:159], a[64:79]
ds_read_b128 v[120:123], v8 offset:26624
s_waitcnt lgkmcnt(7)
v_mfma_f32_32x32x16_bf16 a[80:95], v[92:95], v[156:159], a[80:95]
s_waitcnt vmcnt(7)
s_barrier
ds_read_b128 v[124:127], v8 offset:27648
s_waitcnt lgkmcnt(7)
v_mfma_f32_32x32x16_bf16 a[96:111], v[96:99], v[156:159], a[96:111]
ds_read_b128 v[64:67], v5 offset:0
s_waitcnt lgkmcnt(7)
v_mfma_f32_32x32x16_bf16 a[112:127], v[100:103], v[156:159], a[112:127]
ds_read_b128 v[68:71], v5 offset:1024
s_add_u32 m0, s25, 57344
s_add_u32 s26, s24, s76
buffer_load_dwordx4 v3, s[8:11], s26 offen sc1 lds
s_waitcnt lgkmcnt(7)
v_mfma_f32_32x32x16_bf16 a[128:143], v[104:107], v[156:159], a[128:143]
ds_read_b128 v[72:75], v5 offset:2048
s_waitcnt lgkmcnt(7)
v_mfma_f32_32x32x16_bf16 a[144:159], v[108:111], v[156:159], a[144:159]
ds_read_b128 v[76:79], v5 offset:3072
s_waitcnt lgkmcnt(7)
v_mfma_f32_32x32x16_bf16 a[160:175], v[112:115], v[156:159], a[160:175]
ds_read_b128 v[80:83], v5 offset:4096
s_add_u32 m0, s25, 58368
s_add_u32 s26, s24, s77
buffer_load_dwordx4 v3, s[8:11], s26 offen sc1 lds
s_waitcnt lgkmcnt(7)
v_mfma_f32_32x32x16_bf16 a[176:191], v[116:119], v[156:159], a[176:191]
ds_read_b128 v[84:87], v5 offset:5120
s_waitcnt lgkmcnt(7)
v_mfma_f32_32x32x16_bf16 a[192:207], v[120:123], v[156:159], a[192:207]
ds_read_b128 v[88:91], v5 offset:6144
s_waitcnt lgkmcnt(7)
v_mfma_f32_32x32x16_bf16 a[208:223], v[124:127], v[156:159], a[208:223]
ds_read_b128 v[92:95], v5 offset:7168
s_add_u32 m0, s25, 59392
s_add_u32 s26, s24, s78
buffer_load_dwordx4 v3, s[8:11], s26 offen sc1 lds
s_waitcnt lgkmcnt(7)
v_mfma_f32_32x32x16_bf16 a[0:15], v[64:67], v[160:163], a[0:15]
ds_read_b128 v[96:99], v5 offset:8192
s_waitcnt lgkmcnt(7)
v_mfma_f32_32x32x16_bf16 a[16:31], v[68:71], v[160:163], a[16:31]
ds_read_b128 v[100:103], v5 offset:9216
s_waitcnt lgkmcnt(7)
v_mfma_f32_32x32x16_bf16 a[32:47], v[72:75], v[160:163], a[32:47]
ds_read_b128 v[104:107], v5 offset:10240
s_add_u32 m0, s25, 60416
s_add_u32 s26, s24, s79
buffer_load_dwordx4 v3, s[8:11], s26 offen sc1 lds
s_waitcnt lgkmcnt(7)
v_mfma_f32_32x32x16_bf16 a[48:63], v[76:79], v[160:163], a[48:63]
ds_read_b128 v[108:111], v5 offset:11264
s_waitcnt lgkmcnt(7)
v_mfma_f32_32x32x16_bf16 a[64:79], v[80:83], v[160:163], a[64:79]
ds_read_b128 v[112:115], v5 offset:12288
s_waitcnt lgkmcnt(7)
v_mfma_f32_32x32x16_bf16 a[80:95], v[84:87], v[160:163], a[80:95]
ds_read_b128 v[116:119], v5 offset:13312
s_add_u32 m0, s25, 61440
s_add_u32 s26, s24, s80
buffer_load_dwordx4 v3, s[8:11], s26 offen sc1 lds
s_waitcnt lgkmcnt(7)
v_mfma_f32_32x32x16_bf16 a[96:111], v[88:91], v[160:163], a[96:111]
ds_read_b128 v[120:123], v5 offset:14336
s_waitcnt lgkmcnt(7)
v_mfma_f32_32x32x16_bf16 a[112:127], v[92:95], v[160:163], a[112:127]
ds_read_b128 v[124:127], v5 offset:15360
s_waitcnt lgkmcnt(7)
v_mfma_f32_32x32x16_bf16 a[128:143], v[96:99], v[160:163], a[128:143]
ds_read_b128 v[64:67], v5 offset:16384
s_add_u32 m0, s25, 62464
s_add_u32 s26, s24, s81
buffer_load_dwordx4 v4, s[8:11], s26 offen sc1 lds
s_waitcnt lgkmcnt(7)
v_mfma_f32_32x32x16_bf16 a[144:159], v[100:103], v[160:163], a[144:159]
ds_read_b128 v[68:71], v5 offset:17408
s_waitcnt lgkmcnt(7)
v_mfma_f32_32x32x16_bf16 a[160:175], v[104:107], v[160:163], a[160:175]
ds_read_b128 v[72:75], v5 offset:18432
s_waitcnt lgkmcnt(7)
v_mfma_f32_32x32x16_bf16 a[176:191], v[108:111], v[160:163], a[176:191]
ds_read_b128 v[76:79], v5 offset:19456
s_add_u32 m0, s25, 63488
s_add_u32 s26, s24, s82
buffer_load_dwordx4 v4, s[8:11], s26 offen sc1 lds
s_add_u32 s24, s24, 1024
s_waitcnt lgkmcnt(7)
v_mfma_f32_32x32x16_bf16 a[192:207], v[112:115], v[160:163], a[192:207]
ds_read_b128 v[80:83], v5 offset:20480
s_waitcnt lgkmcnt(7)
v_mfma_f32_32x32x16_bf16 a[208:223], v[116:119], v[160:163], a[208:223]
ds_read_b128 v[84:87], v5 offset:21504
s_waitcnt lgkmcnt(7)
v_mfma_f32_32x32x16_bf16 a[0:15], v[120:123], v[164:167], a[0:15]
ds_read_b128 v[88:91], v5 offset:22528
s_waitcnt lgkmcnt(7)
v_mfma_f32_32x32x16_bf16 a[16:31], v[124:127], v[164:167], a[16:31]
ds_read_b128 v[92:95], v5 offset:23552
s_waitcnt lgkmcnt(7)
v_mfma_f32_32x32x16_bf16 a[32:47], v[64:67], v[164:167], a[32:47]
ds_read_b128 v[96:99], v5 offset:24576
s_waitcnt lgkmcnt(7)
v_mfma_f32_32x32x16_bf16 a[48:63], v[68:71], v[164:167], a[48:63]
ds_read_b128 v[100:103], v5 offset:25600
s_waitcnt lgkmcnt(7)
v_mfma_f32_32x32x16_bf16 a[64:79], v[72:75], v[164:167], a[64:79]
ds_read_b128 v[104:107], v5 offset:26624
s_waitcnt lgkmcnt(7)
v_mfma_f32_32x32x16_bf16 a[80:95], v[76:79], v[164:167], a[80:95]
s_waitcnt vmcnt(7)
s_barrier
ds_read_b128 v[108:111], v5 offset:27648
s_waitcnt lgkmcnt(7)
v_mfma_f32_32x32x16_bf16 a[96:111], v[80:83], v[164:167], a[96:111]
ds_read_b128 v[112:115], v6 offset:0
s_add_u32 m0, s25, 86016
s_add_u32 s26, s24, s76
buffer_load_dwordx4 v3, s[8:11], s26 offen sc1 lds
s_waitcnt lgkmcnt(7)
v_mfma_f32_32x32x16_bf16 a[112:127], v[84:87], v[164:167], a[112:127]
ds_read_b128 v[116:119], v6 offset:1024
s_waitcnt lgkmcnt(7)
v_mfma_f32_32x32x16_bf16 a[128:143], v[88:91], v[164:167], a[128:143]
ds_read_b128 v[120:123], v6 offset:2048
s_waitcnt lgkmcnt(7)
v_mfma_f32_32x32x16_bf16 a[144:159], v[92:95], v[164:167], a[144:159]
ds_read_b128 v[124:127], v6 offset:3072
s_add_u32 m0, s25, 87040
s_add_u32 s26, s24, s77
buffer_load_dwordx4 v3, s[8:11], s26 offen sc1 lds
s_waitcnt lgkmcnt(7)
v_mfma_f32_32x32x16_bf16 a[160:175], v[96:99], v[164:167], a[160:175]
ds_read_b128 v[64:67], v6 offset:4096
s_waitcnt lgkmcnt(7)
v_mfma_f32_32x32x16_bf16 a[176:191], v[100:103], v[164:167], a[176:191]
ds_read_b128 v[68:71], v6 offset:5120
s_waitcnt lgkmcnt(7)
v_mfma_f32_32x32x16_bf16 a[192:207], v[104:107], v[164:167], a[192:207]
ds_read_b128 v[72:75], v6 offset:6144
s_add_u32 m0, s25, 88064
s_add_u32 s26, s24, s78
buffer_load_dwordx4 v3, s[8:11], s26 offen sc1 lds
s_waitcnt lgkmcnt(7)
v_mfma_f32_32x32x16_bf16 a[208:223], v[108:111], v[164:167], a[208:223]
ds_read_b128 v[76:79], v6 offset:7168
s_waitcnt lgkmcnt(7)
v_mfma_f32_32x32x16_bf16 a[0:15], v[112:115], v[168:171], a[0:15]
ds_read_b128 v[80:83], v6 offset:8192
s_waitcnt lgkmcnt(7)
v_mfma_f32_32x32x16_bf16 a[16:31], v[116:119], v[168:171], a[16:31]
ds_read_b128 v[84:87], v6 offset:9216
s_add_u32 m0, s25, 89088
s_add_u32 s26, s24, s79
buffer_load_dwordx4 v3, s[8:11], s26 offen sc1 lds
s_waitcnt lgkmcnt(7)
v_mfma_f32_32x32x16_bf16 a[32:47], v[120:123], v[168:171], a[32:47]
ds_read_b128 v[88:91], v6 offset:10240
s_waitcnt lgkmcnt(7)
v_mfma_f32_32x32x16_bf16 a[48:63], v[124:127], v[168:171], a[48:63]
ds_read_b128 v[92:95], v6 offset:11264
s_waitcnt lgkmcnt(7)
v_mfma_f32_32x32x16_bf16 a[64:79], v[64:67], v[168:171], a[64:79]
ds_read_b128 v[96:99], v6 offset:12288
s_add_u32 m0, s25, 90112
s_add_u32 s26, s24, s80
buffer_load_dwordx4 v3, s[8:11], s26 offen sc1 lds
s_waitcnt lgkmcnt(7)
v_mfma_f32_32x32x16_bf16 a[80:95], v[68:71], v[168:171], a[80:95]
ds_read_b128 v[100:103], v6 offset:13312
s_waitcnt lgkmcnt(7)
v_mfma_f32_32x32x16_bf16 a[96:111], v[72:75], v[168:171], a[96:111]
ds_read_b128 v[104:107], v6 offset:14336
s_waitcnt lgkmcnt(7)
v_mfma_f32_32x32x16_bf16 a[112:127], v[76:79], v[168:171], a[112:127]
ds_read_b128 v[108:111], v6 offset:15360
s_add_u32 m0, s25, 91136
s_add_u32 s26, s24, s81
buffer_load_dwordx4 v4, s[8:11], s26 offen sc1 lds
s_waitcnt lgkmcnt(7)
v_mfma_f32_32x32x16_bf16 a[128:143], v[80:83], v[168:171], a[128:143]
ds_read_b128 v[112:115], v6 offset:16384
s_waitcnt lgkmcnt(7)
v_mfma_f32_32x32x16_bf16 a[144:159], v[84:87], v[168:171], a[144:159]
ds_read_b128 v[116:119], v6 offset:17408
s_waitcnt lgkmcnt(7)
v_mfma_f32_32x32x16_bf16 a[160:175], v[88:91], v[168:171], a[160:175]
ds_read_b128 v[120:123], v6 offset:18432
s_add_u32 m0, s25, 92160
s_add_u32 s26, s24, s82
buffer_load_dwordx4 v4, s[8:11], s26 offen sc1 lds
s_add_u32 s24, s24, 1024
s_waitcnt lgkmcnt(7)
v_mfma_f32_32x32x16_bf16 a[176:191], v[92:95], v[168:171], a[176:191]
ds_read_b128 v[124:127], v6 offset:19456
s_waitcnt lgkmcnt(7)
v_mfma_f32_32x32x16_bf16 a[192:207], v[96:99], v[168:171], a[192:207]
ds_read_b128 v[64:67], v6 offset:20480
s_waitcnt lgkmcnt(7)
v_mfma_f32_32x32x16_bf16 a[208:223], v[100:103], v[168:171], a[208:223]
ds_read_b128 v[68:71], v6 offset:21504
s_waitcnt lgkmcnt(7)
v_mfma_f32_32x32x16_bf16 a[0:15], v[104:107], v[172:175], a[0:15]
ds_read_b128 v[72:75], v6 offset:22528
s_waitcnt lgkmcnt(7)
v_mfma_f32_32x32x16_bf16 a[16:31], v[108:111], v[172:175], a[16:31]
ds_read_b128 v[76:79], v6 offset:23552
s_waitcnt lgkmcnt(7)
v_mfma_f32_32x32x16_bf16 a[32:47], v[112:115], v[172:175], a[32:47]
ds_read_b128 v[80:83], v6 offset:24576
s_waitcnt lgkmcnt(7)
v_mfma_f32_32x32x16_bf16 a[48:63], v[116:119], v[172:175], a[48:63]
ds_read_b128 v[84:87], v6 offset:25600
s_waitcnt lgkmcnt(7)
v_mfma_f32_32x32x16_bf16 a[64:79], v[120:123], v[172:175], a[64:79]
ds_read_b128 v[88:91], v6 offset:26624
s_waitcnt lgkmcnt(7)
v_mfma_f32_32x32x16_bf16 a[80:95], v[124:127], v[172:175], a[80:95]
s_waitcnt vmcnt(7)
s_barrier
ds_read_b128 v[92:95], v6 offset:27648
s_add_u32 m0, s25, 0
s_add_u32 s26, s24, s76
buffer_load_dwordx4 v3, s[8:11], s26 offen sc1 lds
s_waitcnt lgkmcnt(7)
v_mfma_f32_32x32x16_bf16 a[96:111], v[64:67], v[172:175], a[96:111]
ds_read_b128 v[96:99], v7 offset:0
s_waitcnt lgkmcnt(7)
v_mfma_f32_32x32x16_bf16 a[112:127], v[68:71], v[172:175], a[112:127]
ds_read_b128 v[100:103], v7 offset:1024
s_waitcnt lgkmcnt(7)
v_mfma_f32_32x32x16_bf16 a[128:143], v[72:75], v[172:175], a[128:143]
ds_read_b128 v[104:107], v7 offset:2048
s_add_u32 m0, s25, 1024
s_add_u32 s26, s24, s77
buffer_load_dwordx4 v3, s[8:11], s26 offen sc1 lds
s_waitcnt lgkmcnt(7)
v_mfma_f32_32x32x16_bf16 a[144:159], v[76:79], v[172:175], a[144:159]
ds_read_b128 v[108:111], v7 offset:3072
s_waitcnt lgkmcnt(7)
v_mfma_f32_32x32x16_bf16 a[160:175], v[80:83], v[172:175], a[160:175]
ds_read_b128 v[112:115], v7 offset:4096
s_waitcnt lgkmcnt(7)
v_mfma_f32_32x32x16_bf16 a[176:191], v[84:87], v[172:175], a[176:191]
ds_read_b128 v[116:119], v7 offset:5120
s_add_u32 m0, s25, 2048
s_add_u32 s26, s24, s78
buffer_load_dwordx4 v3, s[8:11], s26 offen sc1 lds
s_waitcnt lgkmcnt(7)
v_mfma_f32_32x32x16_bf16 a[192:207], v[88:91], v[172:175], a[192:207]
ds_read_b128 v[120:123], v7 offset:6144
s_waitcnt lgkmcnt(7)
v_mfma_f32_32x32x16_bf16 a[208:223], v[92:95], v[172:175], a[208:223]
ds_read_b128 v[124:127], v7 offset:7168
s_waitcnt lgkmcnt(7)
v_mfma_f32_32x32x16_bf16 a[0:15], v[96:99], v[176:179], a[0:15]
ds_read_b128 v[64:67], v7 offset:8192
s_add_u32 m0, s25, 3072
s_add_u32 s26, s24, s79
buffer_load_dwordx4 v3, s[8:11], s26 offen sc1 lds
s_waitcnt lgkmcnt(7)
v_mfma_f32_32x32x16_bf16 a[16:31], v[100:103], v[176:179], a[16:31]
ds_read_b128 v[68:71], v7 offset:9216
s_waitcnt lgkmcnt(7)
v_mfma_f32_32x32x16_bf16 a[32:47], v[104:107], v[176:179], a[32:47]
ds_read_b128 v[72:75], v7 offset:10240
s_waitcnt lgkmcnt(7)
v_mfma_f32_32x32x16_bf16 a[48:63], v[108:111], v[176:179], a[48:63]
ds_read_b128 v[76:79], v7 offset:11264
s_add_u32 m0, s25, 4096
s_add_u32 s26, s24, s80
buffer_load_dwordx4 v3, s[8:11], s26 offen sc1 lds
s_waitcnt lgkmcnt(7)
v_mfma_f32_32x32x16_bf16 a[64:79], v[112:115], v[176:179], a[64:79]
ds_read_b128 v[80:83], v7 offset:12288
s_waitcnt lgkmcnt(7)
v_mfma_f32_32x32x16_bf16 a[80:95], v[116:119], v[176:179], a[80:95]
ds_read_b128 v[84:87], v7 offset:13312
s_waitcnt lgkmcnt(7)
v_mfma_f32_32x32x16_bf16 a[96:111], v[120:123], v[176:179], a[96:111]
ds_read_b128 v[88:91], v7 offset:14336
s_add_u32 m0, s25, 5120
s_add_u32 s26, s24, s81
buffer_load_dwordx4 v4, s[8:11], s26 offen sc1 lds
s_waitcnt lgkmcnt(7)
v_mfma_f32_32x32x16_bf16 a[112:127], v[124:127], v[176:179], a[112:127]
ds_read_b128 v[92:95], v7 offset:15360
s_waitcnt lgkmcnt(7)
v_mfma_f32_32x32x16_bf16 a[128:143], v[64:67], v[176:179], a[128:143]
ds_read_b128 v[96:99], v7 offset:16384
s_waitcnt lgkmcnt(7)
v_mfma_f32_32x32x16_bf16 a[144:159], v[68:71], v[176:179], a[144:159]
ds_read_b128 v[100:103], v7 offset:17408
s_add_u32 m0, s25, 6144
s_add_u32 s26, s24, s82
buffer_load_dwordx4 v4, s[8:11], s26 offen sc1 lds
s_add_u32 s24, s24, 1024
s_waitcnt lgkmcnt(7)
v_mfma_f32_32x32x16_bf16 a[160:175], v[72:75], v[176:179], a[160:175]
ds_read_b128 v[104:107], v7 offset:18432
s_waitcnt lgkmcnt(7)
v_mfma_f32_32x32x16_bf16 a[176:191], v[76:79], v[176:179], a[176:191]
ds_read_b128 v[108:111], v7 offset:19456
s_waitcnt lgkmcnt(7)
v_mfma_f32_32x32x16_bf16 a[192:207], v[80:83], v[176:179], a[192:207]
ds_read_b128 v[112:115], v7 offset:20480
s_waitcnt lgkmcnt(7)
v_mfma_f32_32x32x16_bf16 a[208:223], v[84:87], v[176:179], a[208:223]
ds_read_b128 v[116:119], v7 offset:21504
s_waitcnt lgkmcnt(7)
v_mfma_f32_32x32x16_bf16 a[0:15], v[88:91], v[180:183], a[0:15]
ds_read_b128 v[120:123], v7 offset:22528
s_waitcnt lgkmcnt(7)
v_mfma_f32_32x32x16_bf16 a[16:31], v[92:95], v[180:183], a[16:31]
ds_read_b128 v[124:127], v7 offset:23552
s_waitcnt lgkmcnt(7)
v_mfma_f32_32x32x16_bf16 a[32:47], v[96:99], v[180:183], a[32:47]
ds_read_b128 v[64:67], v7 offset:24576
s_waitcnt lgkmcnt(7)
v_mfma_f32_32x32x16_bf16 a[48:63], v[100:103], v[180:183], a[48:63]
ds_read_b128 v[68:71], v7 offset:25600
s_waitcnt lgkmcnt(7)
v_mfma_f32_32x32x16_bf16 a[64:79], v[104:107], v[180:183], a[64:79]
ds_read_b128 v[72:75], v7 offset:26624
s_waitcnt lgkmcnt(7)
v_mfma_f32_32x32x16_bf16 a[80:95], v[108:111], v[180:183], a[80:95]
s_waitcnt vmcnt(7)
s_barrier
ds_read_b128 v[76:79], v7 offset:27648
s_waitcnt lgkmcnt(7)
v_mfma_f32_32x32x16_bf16 a[96:111], v[112:115], v[180:183], a[96:111]
ds_read_b128 v[80:83], v8 offset:0
s_waitcnt lgkmcnt(7)
v_mfma_f32_32x32x16_bf16 a[112:127], v[116:119], v[180:183], a[112:127]
ds_read_b128 v[84:87], v8 offset:1024
s_add_u32 m0, s25, 28672
s_add_u32 s26, s24, s76
buffer_load_dwordx4 v3, s[8:11], s26 offen sc1 lds
s_waitcnt lgkmcnt(7)
v_mfma_f32_32x32x16_bf16 a[128:143], v[120:123], v[180:183], a[128:143]
ds_read_b128 v[88:91], v8 offset:2048
s_waitcnt lgkmcnt(7)
v_mfma_f32_32x32x16_bf16 a[144:159], v[124:127], v[180:183], a[144:159]
ds_read_b128 v[92:95], v8 offset:3072
s_waitcnt lgkmcnt(7)
v_mfma_f32_32x32x16_bf16 a[160:175], v[64:67], v[180:183], a[160:175]
ds_read_b128 v[96:99], v8 offset:4096
s_add_u32 m0, s25, 29696
s_add_u32 s26, s24, s77
buffer_load_dwordx4 v3, s[8:11], s26 offen sc1 lds
s_waitcnt lgkmcnt(7)
v_mfma_f32_32x32x16_bf16 a[176:191], v[68:71], v[180:183], a[176:191]
ds_read_b128 v[100:103], v8 offset:5120
s_waitcnt lgkmcnt(7)
v_mfma_f32_32x32x16_bf16 a[192:207], v[72:75], v[180:183], a[192:207]
ds_read_b128 v[104:107], v8 offset:6144
s_waitcnt lgkmcnt(7)
v_mfma_f32_32x32x16_bf16 a[208:223], v[76:79], v[180:183], a[208:223]
ds_read_b128 v[108:111], v8 offset:7168
s_add_u32 m0, s25, 30720
s_add_u32 s26, s24, s78
buffer_load_dwordx4 v3, s[8:11], s26 offen sc1 lds
s_waitcnt lgkmcnt(7)
v_mfma_f32_32x32x16_bf16 a[0:15], v[80:83], v[184:187], a[0:15]
ds_read_b128 v[112:115], v8 offset:8192
s_waitcnt lgkmcnt(7)
v_mfma_f32_32x32x16_bf16 a[16:31], v[84:87], v[184:187], a[16:31]
ds_read_b128 v[116:119], v8 offset:9216
s_waitcnt lgkmcnt(7)
v_mfma_f32_32x32x16_bf16 a[32:47], v[88:91], v[184:187], a[32:47]
ds_read_b128 v[120:123], v8 offset:10240
s_add_u32 m0, s25, 31744
s_add_u32 s26, s24, s79
buffer_load_dwordx4 v3, s[8:11], s26 offen sc1 lds
s_waitcnt lgkmcnt(7)
v_mfma_f32_32x32x16_bf16 a[48:63], v[92:95], v[184:187], a[48:63]
ds_read_b128 v[124:127], v8 offset:11264
s_waitcnt lgkmcnt(7)
v_mfma_f32_32x32x16_bf16 a[64:79], v[96:99], v[184:187], a[64:79]
ds_read_b128 v[64:67], v8 offset:12288
s_waitcnt lgkmcnt(7)
v_mfma_f32_32x32x16_bf16 a[80:95], v[100:103], v[184:187], a[80:95]
ds_read_b128 v[68:71], v8 offset:13312
s_add_u32 m0, s25, 32768
s_add_u32 s26, s24, s80
buffer_load_dwordx4 v3, s[8:11], s26 offen sc1 lds
s_waitcnt lgkmcnt(7)
v_mfma_f32_32x32x16_bf16 a[96:111], v[104:107], v[184:187], a[96:111]
ds_read_b128 v[72:75], v8 offset:14336
s_waitcnt lgkmcnt(7)
v_mfma_f32_32x32x16_bf16 a[112:127], v[108:111], v[184:187], a[112:127]
ds_read_b128 v[76:79], v8 offset:15360
s_waitcnt lgkmcnt(7)
v_mfma_f32_32x32x16_bf16 a[128:143], v[112:115], v[184:187], a[128:143]
ds_read_b128 v[80:83], v8 offset:16384
s_add_u32 m0, s25, 33792
s_add_u32 s26, s24, s81
buffer_load_dwordx4 v4, s[8:11], s26 offen sc1 lds
s_waitcnt lgkmcnt(7)
v_mfma_f32_32x32x16_bf16 a[144:159], v[116:119], v[184:187], a[144:159]
ds_read_b128 v[84:87], v8 offset:17408
s_waitcnt lgkmcnt(7)
v_mfma_f32_32x32x16_bf16 a[160:175], v[120:123], v[184:187], a[160:175]
ds_read_b128 v[88:91], v8 offset:18432
s_waitcnt lgkmcnt(7)
v_mfma_f32_32x32x16_bf16 a[176:191], v[124:127], v[184:187], a[176:191]
ds_read_b128 v[92:95], v8 offset:19456
s_add_u32 m0, s25, 34816
s_add_u32 s26, s24, s82
buffer_load_dwordx4 v4, s[8:11], s26 offen sc1 lds
s_add_u32 s24, s24, 1024
s_waitcnt lgkmcnt(7)
v_mfma_f32_32x32x16_bf16 a[192:207], v[64:67], v[184:187], a[192:207]
ds_read_b128 v[96:99], v8 offset:20480
s_waitcnt lgkmcnt(7)
v_mfma_f32_32x32x16_bf16 a[208:223], v[68:71], v[184:187], a[208:223]
ds_read_b128 v[100:103], v8 offset:21504
s_waitcnt lgkmcnt(7)
v_mfma_f32_32x32x16_bf16 a[0:15], v[72:75], v[188:191], a[0:15]
ds_read_b128 v[104:107], v8 offset:22528
s_waitcnt lgkmcnt(7)
v_mfma_f32_32x32x16_bf16 a[16:31], v[76:79], v[188:191], a[16:31]
ds_read_b128 v[108:111], v8 offset:23552
s_waitcnt lgkmcnt(7)
v_mfma_f32_32x32x16_bf16 a[32:47], v[80:83], v[188:191], a[32:47]
ds_read_b128 v[112:115], v8 offset:24576
s_waitcnt lgkmcnt(7)
v_mfma_f32_32x32x16_bf16 a[48:63], v[84:87], v[188:191], a[48:63]
ds_read_b128 v[116:119], v8 offset:25600
s_waitcnt lgkmcnt(7)
v_mfma_f32_32x32x16_bf16 a[64:79], v[88:91], v[188:191], a[64:79]
ds_read_b128 v[120:123], v8 offset:26624
s_waitcnt lgkmcnt(7)
v_mfma_f32_32x32x16_bf16 a[80:95], v[92:95], v[188:191], a[80:95]
s_waitcnt vmcnt(7)
s_barrier
ds_read_b128 v[124:127], v8 offset:27648
s_waitcnt lgkmcnt(7)
v_mfma_f32_32x32x16_bf16 a[96:111], v[96:99], v[188:191], a[96:111]
ds_read_b128 v[64:67], v5 offset:0
s_add_u32 m0, s25, 57344
s_add_u32 s26, s24, s76
buffer_load_dwordx4 v3, s[8:11], s26 offen sc1 lds
s_waitcnt lgkmcnt(7)
v_mfma_f32_32x32x16_bf16 a[112:127], v[100:103], v[188:191], a[112:127]
ds_read_b128 v[68:71], v5 offset:1024
s_waitcnt lgkmcnt(7)
v_mfma_f32_32x32x16_bf16 a[128:143], v[104:107], v[188:191], a[128:143]
ds_read_b128 v[72:75], v5 offset:2048
s_waitcnt lgkmcnt(7)
v_mfma_f32_32x32x16_bf16 a[144:159], v[108:111], v[188:191], a[144:159]
ds_read_b128 v[76:79], v5 offset:3072
s_add_u32 m0, s25, 58368
s_add_u32 s26, s24, s77
buffer_load_dwordx4 v3, s[8:11], s26 offen sc1 lds
s_waitcnt lgkmcnt(7)
v_mfma_f32_32x32x16_bf16 a[160:175], v[112:115], v[188:191], a[160:175]
ds_read_b128 v[80:83], v5 offset:4096
s_waitcnt lgkmcnt(7)
v_mfma_f32_32x32x16_bf16 a[176:191], v[116:119], v[188:191], a[176:191]
ds_read_b128 v[84:87], v5 offset:5120
s_waitcnt lgkmcnt(7)
v_mfma_f32_32x32x16_bf16 a[192:207], v[120:123], v[188:191], a[192:207]
ds_read_b128 v[88:91], v5 offset:6144
s_add_u32 m0, s25, 59392
s_add_u32 s26, s24, s78
buffer_load_dwordx4 v3, s[8:11], s26 offen sc1 lds
s_waitcnt lgkmcnt(7)
v_mfma_f32_32x32x16_bf16 a[208:223], v[124:127], v[188:191], a[208:223]
ds_read_b128 v[92:95], v5 offset:7168
s_waitcnt lgkmcnt(7)
v_mfma_f32_32x32x16_bf16 a[0:15], v[64:67], v[192:195], a[0:15]
ds_read_b128 v[96:99], v5 offset:8192
s_waitcnt lgkmcnt(7)
v_mfma_f32_32x32x16_bf16 a[16:31], v[68:71], v[192:195], a[16:31]
ds_read_b128 v[100:103], v5 offset:9216
s_add_u32 m0, s25, 60416
s_add_u32 s26, s24, s79
buffer_load_dwordx4 v3, s[8:11], s26 offen sc1 lds
s_waitcnt lgkmcnt(7)
v_mfma_f32_32x32x16_bf16 a[32:47], v[72:75], v[192:195], a[32:47]
ds_read_b128 v[104:107], v5 offset:10240
s_waitcnt lgkmcnt(7)
v_mfma_f32_32x32x16_bf16 a[48:63], v[76:79], v[192:195], a[48:63]
ds_read_b128 v[108:111], v5 offset:11264
s_waitcnt lgkmcnt(7)
v_mfma_f32_32x32x16_bf16 a[64:79], v[80:83], v[192:195], a[64:79]
ds_read_b128 v[112:115], v5 offset:12288
s_add_u32 m0, s25, 61440
s_add_u32 s26, s24, s80
buffer_load_dwordx4 v3, s[8:11], s26 offen sc1 lds
s_waitcnt lgkmcnt(7)
v_mfma_f32_32x32x16_bf16 a[80:95], v[84:87], v[192:195], a[80:95]
ds_read_b128 v[116:119], v5 offset:13312
s_waitcnt lgkmcnt(7)
v_mfma_f32_32x32x16_bf16 a[96:111], v[88:91], v[192:195], a[96:111]
ds_read_b128 v[120:123], v5 offset:14336
s_waitcnt lgkmcnt(7)
v_mfma_f32_32x32x16_bf16 a[112:127], v[92:95], v[192:195], a[112:127]
ds_read_b128 v[124:127], v5 offset:15360
s_add_u32 m0, s25, 62464
s_add_u32 s26, s24, s81
buffer_load_dwordx4 v4, s[8:11], s26 offen sc1 lds
s_waitcnt lgkmcnt(7)
v_mfma_f32_32x32x16_bf16 a[128:143], v[96:99], v[192:195], a[128:143]
ds_read_b128 v[64:67], v5 offset:16384
s_waitcnt lgkmcnt(7)
v_mfma_f32_32x32x16_bf16 a[144:159], v[100:103], v[192:195], a[144:159]
ds_read_b128 v[68:71], v5 offset:17408
s_waitcnt lgkmcnt(7)
v_mfma_f32_32x32x16_bf16 a[160:175], v[104:107], v[192:195], a[160:175]
ds_read_b128 v[72:75], v5 offset:18432
s_add_u32 m0, s25, 63488
s_add_u32 s26, s24, s82
buffer_load_dwordx4 v4, s[8:11], s26 offen sc1 lds
s_add_u32 s24, s24, 1024
s_waitcnt lgkmcnt(7)
v_mfma_f32_32x32x16_bf16 a[176:191], v[108:111], v[192:195], a[176:191]
ds_read_b128 v[76:79], v5 offset:19456
s_waitcnt lgkmcnt(7)
v_mfma_f32_32x32x16_bf16 a[192:207], v[112:115], v[192:195], a[192:207]
ds_read_b128 v[80:83], v5 offset:20480
s_waitcnt lgkmcnt(7)
v_mfma_f32_32x32x16_bf16 a[208:223], v[116:119], v[192:195], a[208:223]
ds_read_b128 v[84:87], v5 offset:21504
s_waitcnt lgkmcnt(7)
v_mfma_f32_32x32x16_bf16 a[0:15], v[120:123], v[196:199], a[0:15]
ds_read_b128 v[88:91], v5 offset:22528
s_waitcnt lgkmcnt(7)
v_mfma_f32_32x32x16_bf16 a[16:31], v[124:127], v[196:199], a[16:31]
ds_read_b128 v[92:95], v5 offset:23552
s_waitcnt lgkmcnt(7)
v_mfma_f32_32x32x16_bf16 a[32:47], v[64:67], v[196:199], a[32:47]
ds_read_b128 v[96:99], v5 offset:24576
s_waitcnt lgkmcnt(7)
v_mfma_f32_32x32x16_bf16 a[48:63], v[68:71], v[196:199], a[48:63]
ds_read_b128 v[100:103], v5 offset:25600
s_waitcnt lgkmcnt(7)
v_mfma_f32_32x32x16_bf16 a[64:79], v[72:75], v[196:199], a[64:79]
ds_read_b128 v[104:107], v5 offset:26624
s_waitcnt lgkmcnt(7)
v_mfma_f32_32x32x16_bf16 a[80:95], v[76:79], v[196:199], a[80:95]
s_waitcnt vmcnt(7)
s_barrier
ds_read_b128 v[108:111], v5 offset:27648
s_add_u32 m0, s25, 86016
s_add_u32 s26, s24, s76
buffer_load_dwordx4 v3, s[8:11], s26 offen sc1 lds
s_waitcnt lgkmcnt(7)
v_mfma_f32_32x32x16_bf16 a[96:111], v[80:83], v[196:199], a[96:111]
ds_read_b128 v[112:115], v6 offset:0
s_waitcnt lgkmcnt(7)
v_mfma_f32_32x32x16_bf16 a[112:127], v[84:87], v[196:199], a[112:127]
ds_read_b128 v[116:119], v6 offset:1024
s_waitcnt lgkmcnt(7)
v_mfma_f32_32x32x16_bf16 a[128:143], v[88:91], v[196:199], a[128:143]
ds_read_b128 v[120:123], v6 offset:2048
s_add_u32 m0, s25, 87040
s_add_u32 s26, s24, s77
buffer_load_dwordx4 v3, s[8:11], s26 offen sc1 lds
s_waitcnt lgkmcnt(7)
v_mfma_f32_32x32x16_bf16 a[144:159], v[92:95], v[196:199], a[144:159]
ds_read_b128 v[124:127], v6 offset:3072
s_waitcnt lgkmcnt(7)
v_mfma_f32_32x32x16_bf16 a[160:175], v[96:99], v[196:199], a[160:175]
ds_read_b128 v[64:67], v6 offset:4096
s_waitcnt lgkmcnt(7)
v_mfma_f32_32x32x16_bf16 a[176:191], v[100:103], v[196:199], a[176:191]
ds_read_b128 v[68:71], v6 offset:5120
s_add_u32 m0, s25, 88064
s_add_u32 s26, s24, s78
buffer_load_dwordx4 v3, s[8:11], s26 offen sc1 lds
s_waitcnt lgkmcnt(7)
v_mfma_f32_32x32x16_bf16 a[192:207], v[104:107], v[196:199], a[192:207]
ds_read_b128 v[72:75], v6 offset:6144
s_waitcnt lgkmcnt(7)
v_mfma_f32_32x32x16_bf16 a[208:223], v[108:111], v[196:199], a[208:223]
ds_read_b128 v[76:79], v6 offset:7168
s_waitcnt lgkmcnt(7)
v_mfma_f32_32x32x16_bf16 a[0:15], v[112:115], v[200:203], a[0:15]
ds_read_b128 v[80:83], v6 offset:8192
s_add_u32 m0, s25, 89088
s_add_u32 s26, s24, s79
buffer_load_dwordx4 v3, s[8:11], s26 offen sc1 lds
s_waitcnt lgkmcnt(7)
v_mfma_f32_32x32x16_bf16 a[16:31], v[116:119], v[200:203], a[16:31]
ds_read_b128 v[84:87], v6 offset:9216
s_waitcnt lgkmcnt(7)
v_mfma_f32_32x32x16_bf16 a[32:47], v[120:123], v[200:203], a[32:47]
ds_read_b128 v[88:91], v6 offset:10240
s_waitcnt lgkmcnt(7)
v_mfma_f32_32x32x16_bf16 a[48:63], v[124:127], v[200:203], a[48:63]
ds_read_b128 v[92:95], v6 offset:11264
s_add_u32 m0, s25, 90112
s_add_u32 s26, s24, s80
buffer_load_dwordx4 v3, s[8:11], s26 offen sc1 lds
s_waitcnt lgkmcnt(7)
v_mfma_f32_32x32x16_bf16 a[64:79], v[64:67], v[200:203], a[64:79]
ds_read_b128 v[96:99], v6 offset:12288
s_waitcnt lgkmcnt(7)
v_mfma_f32_32x32x16_bf16 a[80:95], v[68:71], v[200:203], a[80:95]
ds_read_b128 v[100:103], v6 offset:13312
s_waitcnt lgkmcnt(7)
v_mfma_f32_32x32x16_bf16 a[96:111], v[72:75], v[200:203], a[96:111]
ds_read_b128 v[104:107], v6 offset:14336
s_add_u32 m0, s25, 91136
s_add_u32 s26, s24, s81
buffer_load_dwordx4 v4, s[8:11], s26 offen sc1 lds
s_waitcnt lgkmcnt(7)
v_mfma_f32_32x32x16_bf16 a[112:127], v[76:79], v[200:203], a[112:127]
ds_read_b128 v[108:111], v6 offset:15360
s_waitcnt lgkmcnt(7)
v_mfma_f32_32x32x16_bf16 a[128:143], v[80:83], v[200:203], a[128:143]
ds_read_b128 v[112:115], v6 offset:16384
s_waitcnt lgkmcnt(7)
v_mfma_f32_32x32x16_bf16 a[144:159], v[84:87], v[200:203], a[144:159]
ds_read_b128 v[116:119], v6 offset:17408
s_add_u32 m0, s25, 92160
s_add_u32 s26, s24, s82
buffer_load_dwordx4 v4, s[8:11], s26 offen sc1 lds
s_add_u32 s24, s24, 1024
s_waitcnt lgkmcnt(7)
v_mfma_f32_32x32x16_bf16 a[160:175], v[88:91], v[200:203], a[160:175]
ds_read_b128 v[120:123], v6 offset:18432
s_waitcnt lgkmcnt(7)
v_mfma_f32_32x32x16_bf16 a[176:191], v[92:95], v[200:203], a[176:191]
ds_read_b128 v[124:127], v6 offset:19456
s_waitcnt lgkmcnt(7)
v_mfma_f32_32x32x16_bf16 a[192:207], v[96:99], v[200:203], a[192:207]
ds_read_b128 v[64:67], v6 offset:20480
s_waitcnt lgkmcnt(7)
v_mfma_f32_32x32x16_bf16 a[208:223], v[100:103], v[200:203], a[208:223]
ds_read_b128 v[68:71], v6 offset:21504
s_waitcnt lgkmcnt(7)
v_mfma_f32_32x32x16_bf16 a[0:15], v[104:107], v[204:207], a[0:15]
ds_read_b128 v[72:75], v6 offset:22528
s_waitcnt lgkmcnt(7)
v_mfma_f32_32x32x16_bf16 a[16:31], v[108:111], v[204:207], a[16:31]
ds_read_b128 v[76:79], v6 offset:23552
s_waitcnt lgkmcnt(7)
v_mfma_f32_32x32x16_bf16 a[32:47], v[112:115], v[204:207], a[32:47]
ds_read_b128 v[80:83], v6 offset:24576
s_waitcnt lgkmcnt(7)
v_mfma_f32_32x32x16_bf16 a[48:63], v[116:119], v[204:207], a[48:63]
ds_read_b128 v[84:87], v6 offset:25600
s_waitcnt lgkmcnt(7)
v_mfma_f32_32x32x16_bf16 a[64:79], v[120:123], v[204:207], a[64:79]
ds_read_b128 v[88:91], v6 offset:26624
s_waitcnt lgkmcnt(7)
v_mfma_f32_32x32x16_bf16 a[80:95], v[124:127], v[204:207], a[80:95]
s_waitcnt vmcnt(7)
s_barrier
ds_read_b128 v[92:95], v6 offset:27648
s_waitcnt lgkmcnt(7)
v_mfma_f32_32x32x16_bf16 a[96:111], v[64:67], v[204:207], a[96:111]
ds_read_b128 v[96:99], v7 offset:0
s_waitcnt lgkmcnt(7)
v_mfma_f32_32x32x16_bf16 a[112:127], v[68:71], v[204:207], a[112:127]
ds_read_b128 v[100:103], v7 offset:1024
s_add_u32 m0, s25, 0
s_add_u32 s26, s24, s76
buffer_load_dwordx4 v3, s[8:11], s26 offen sc1 lds
s_waitcnt lgkmcnt(7)
v_mfma_f32_32x32x16_bf16 a[128:143], v[72:75], v[204:207], a[128:143]
ds_read_b128 v[104:107], v7 offset:2048
s_waitcnt lgkmcnt(7)
v_mfma_f32_32x32x16_bf16 a[144:159], v[76:79], v[204:207], a[144:159]
ds_read_b128 v[108:111], v7 offset:3072
s_waitcnt lgkmcnt(7)
v_mfma_f32_32x32x16_bf16 a[160:175], v[80:83], v[204:207], a[160:175]
ds_read_b128 v[112:115], v7 offset:4096
s_add_u32 m0, s25, 1024
s_add_u32 s26, s24, s77
buffer_load_dwordx4 v3, s[8:11], s26 offen sc1 lds
s_waitcnt lgkmcnt(7)
v_mfma_f32_32x32x16_bf16 a[176:191], v[84:87], v[204:207], a[176:191]
ds_read_b128 v[116:119], v7 offset:5120
s_waitcnt lgkmcnt(7)
v_mfma_f32_32x32x16_bf16 a[192:207], v[88:91], v[204:207], a[192:207]
ds_read_b128 v[120:123], v7 offset:6144
s_waitcnt lgkmcnt(7)
v_mfma_f32_32x32x16_bf16 a[208:223], v[92:95], v[204:207], a[208:223]
ds_read_b128 v[124:127], v7 offset:7168
s_add_u32 m0, s25, 2048
s_add_u32 s26, s24, s78
buffer_load_dwordx4 v3, s[8:11], s26 offen sc1 lds
s_waitcnt lgkmcnt(7)
v_mfma_f32_32x32x16_bf16 a[0:15], v[96:99], v[208:211], a[0:15]
ds_read_b128 v[64:67], v7 offset:8192
s_waitcnt lgkmcnt(7)
v_mfma_f32_32x32x16_bf16 a[16:31], v[100:103], v[208:211], a[16:31]
ds_read_b128 v[68:71], v7 offset:9216
s_waitcnt lgkmcnt(7)
v_mfma_f32_32x32x16_bf16 a[32:47], v[104:107], v[208:211], a[32:47]
ds_read_b128 v[72:75], v7 offset:10240
s_add_u32 m0, s25, 3072
s_add_u32 s26, s24, s79
buffer_load_dwordx4 v3, s[8:11], s26 offen sc1 lds
s_waitcnt lgkmcnt(7)
v_mfma_f32_32x32x16_bf16 a[48:63], v[108:111], v[208:211], a[48:63]
ds_read_b128 v[76:79], v7 offset:11264
s_waitcnt lgkmcnt(7)
v_mfma_f32_32x32x16_bf16 a[64:79], v[112:115], v[208:211], a[64:79]
ds_read_b128 v[80:83], v7 offset:12288
s_waitcnt lgkmcnt(7)
v_mfma_f32_32x32x16_bf16 a[80:95], v[116:119], v[208:211], a[80:95]
ds_read_b128 v[84:87], v7 offset:13312
s_add_u32 m0, s25, 4096
s_add_u32 s26, s24, s80
buffer_load_dwordx4 v3, s[8:11], s26 offen sc1 lds
s_waitcnt lgkmcnt(7)
v_mfma_f32_32x32x16_bf16 a[96:111], v[120:123], v[208:211], a[96:111]
ds_read_b128 v[88:91], v7 offset:14336
s_waitcnt lgkmcnt(7)
v_mfma_f32_32x32x16_bf16 a[112:127], v[124:127], v[208:211], a[112:127]
ds_read_b128 v[92:95], v7 offset:15360
s_waitcnt lgkmcnt(7)
v_mfma_f32_32x32x16_bf16 a[128:143], v[64:67], v[208:211], a[128:143]
ds_read_b128 v[96:99], v7 offset:16384
s_add_u32 m0, s25, 5120
s_add_u32 s26, s24, s81
buffer_load_dwordx4 v4, s[8:11], s26 offen sc1 lds
s_waitcnt lgkmcnt(7)
v_mfma_f32_32x32x16_bf16 a[144:159], v[68:71], v[208:211], a[144:159]
ds_read_b128 v[100:103], v7 offset:17408
s_waitcnt lgkmcnt(7)
v_mfma_f32_32x32x16_bf16 a[160:175], v[72:75], v[208:211], a[160:175]
ds_read_b128 v[104:107], v7 offset:18432
s_waitcnt lgkmcnt(7)
v_mfma_f32_32x32x16_bf16 a[176:191], v[76:79], v[208:211], a[176:191]
ds_read_b128 v[108:111], v7 offset:19456
s_add_u32 m0, s25, 6144
s_add_u32 s26, s24, s82
buffer_load_dwordx4 v4, s[8:11], s26 offen sc1 lds
s_add_u32 s24, s24, 1024
s_waitcnt lgkmcnt(7)
v_mfma_f32_32x32x16_bf16 a[192:207], v[80:83], v[208:211], a[192:207]
ds_read_b128 v[112:115], v7 offset:20480
s_waitcnt lgkmcnt(7)
v_mfma_f32_32x32x16_bf16 a[208:223], v[84:87], v[208:211], a[208:223]
ds_read_b128 v[116:119], v7 offset:21504
s_waitcnt lgkmcnt(7)
v_mfma_f32_32x32x16_bf16 a[0:15], v[88:91], v[212:215], a[0:15]
ds_read_b128 v[120:123], v7 offset:22528
s_waitcnt lgkmcnt(7)
v_mfma_f32_32x32x16_bf16 a[16:31], v[92:95], v[212:215], a[16:31]
ds_read_b128 v[124:127], v7 offset:23552
s_waitcnt lgkmcnt(7)
v_mfma_f32_32x32x16_bf16 a[32:47], v[96:99], v[212:215], a[32:47]
ds_read_b128 v[64:67], v7 offset:24576
s_waitcnt lgkmcnt(7)
v_mfma_f32_32x32x16_bf16 a[48:63], v[100:103], v[212:215], a[48:63]
ds_read_b128 v[68:71], v7 offset:25600
s_waitcnt lgkmcnt(7)
v_mfma_f32_32x32x16_bf16 a[64:79], v[104:107], v[212:215], a[64:79]
ds_read_b128 v[72:75], v7 offset:26624
s_waitcnt lgkmcnt(7)
v_mfma_f32_32x32x16_bf16 a[80:95], v[108:111], v[212:215], a[80:95]
s_waitcnt vmcnt(7)
s_barrier
ds_read_b128 v[76:79], v7 offset:27648
s_waitcnt lgkmcnt(7)
v_mfma_f32_32x32x16_bf16 a[96:111], v[112:115], v[212:215], a[96:111]
ds_read_b128 v[80:83], v8 offset:0
s_add_u32 m0, s25, 28672
s_add_u32 s26, s24, s76
buffer_load_dwordx4 v3, s[8:11], s26 offen sc1 lds
s_waitcnt lgkmcnt(7)
v_mfma_f32_32x32x16_bf16 a[112:127], v[116:119], v[212:215], a[112:127]
ds_read_b128 v[84:87], v8 offset:1024
s_waitcnt lgkmcnt(7)
v_mfma_f32_32x32x16_bf16 a[128:143], v[120:123], v[212:215], a[128:143]
ds_read_b128 v[88:91], v8 offset:2048
s_waitcnt lgkmcnt(7)
v_mfma_f32_32x32x16_bf16 a[144:159], v[124:127], v[212:215], a[144:159]
ds_read_b128 v[92:95], v8 offset:3072
s_add_u32 m0, s25, 29696
s_add_u32 s26, s24, s77
buffer_load_dwordx4 v3, s[8:11], s26 offen sc1 lds
s_waitcnt lgkmcnt(7)
v_mfma_f32_32x32x16_bf16 a[160:175], v[64:67], v[212:215], a[160:175]
ds_read_b128 v[96:99], v8 offset:4096
s_waitcnt lgkmcnt(7)
v_mfma_f32_32x32x16_bf16 a[176:191], v[68:71], v[212:215], a[176:191]
ds_read_b128 v[100:103], v8 offset:5120
s_waitcnt lgkmcnt(7)
v_mfma_f32_32x32x16_bf16 a[192:207], v[72:75], v[212:215], a[192:207]
ds_read_b128 v[104:107], v8 offset:6144
s_add_u32 m0, s25, 30720
s_add_u32 s26, s24, s78
buffer_load_dwordx4 v3, s[8:11], s26 offen sc1 lds
s_waitcnt lgkmcnt(7)
v_mfma_f32_32x32x16_bf16 a[208:223], v[76:79], v[212:215], a[208:223]
ds_read_b128 v[108:111], v8 offset:7168
s_waitcnt lgkmcnt(7)
v_mfma_f32_32x32x16_bf16 a[0:15], v[80:83], v[216:219], a[0:15]
ds_read_b128 v[112:115], v8 offset:8192
s_waitcnt lgkmcnt(7)
v_mfma_f32_32x32x16_bf16 a[16:31], v[84:87], v[216:219], a[16:31]
ds_read_b128 v[116:119], v8 offset:9216
s_add_u32 m0, s25, 31744
s_add_u32 s26, s24, s79
buffer_load_dwordx4 v3, s[8:11], s26 offen sc1 lds
s_waitcnt lgkmcnt(7)
v_mfma_f32_32x32x16_bf16 a[32:47], v[88:91], v[216:219], a[32:47]
ds_read_b128 v[120:123], v8 offset:10240
s_waitcnt lgkmcnt(7)
v_mfma_f32_32x32x16_bf16 a[48:63], v[92:95], v[216:219], a[48:63]
ds_read_b128 v[124:127], v8 offset:11264
s_waitcnt lgkmcnt(7)
v_mfma_f32_32x32x16_bf16 a[64:79], v[96:99], v[216:219], a[64:79]
ds_read_b128 v[64:67], v8 offset:12288
s_add_u32 m0, s25, 32768
s_add_u32 s26, s24, s80
buffer_load_dwordx4 v3, s[8:11], s26 offen sc1 lds
s_waitcnt lgkmcnt(7)
v_mfma_f32_32x32x16_bf16 a[80:95], v[100:103], v[216:219], a[80:95]
ds_read_b128 v[68:71], v8 offset:13312
s_waitcnt lgkmcnt(7)
v_mfma_f32_32x32x16_bf16 a[96:111], v[104:107], v[216:219], a[96:111]
ds_read_b128 v[72:75], v8 offset:14336
s_waitcnt lgkmcnt(7)
v_mfma_f32_32x32x16_bf16 a[112:127], v[108:111], v[216:219], a[112:127]
ds_read_b128 v[76:79], v8 offset:15360
s_add_u32 m0, s25, 33792
s_add_u32 s26, s24, s81
buffer_load_dwordx4 v4, s[8:11], s26 offen sc1 lds
s_waitcnt lgkmcnt(7)
v_mfma_f32_32x32x16_bf16 a[128:143], v[112:115], v[216:219], a[128:143]
ds_read_b128 v[80:83], v8 offset:16384
s_waitcnt lgkmcnt(7)
v_mfma_f32_32x32x16_bf16 a[144:159], v[116:119], v[216:219], a[144:159]
ds_read_b128 v[84:87], v8 offset:17408
s_waitcnt lgkmcnt(7)
v_mfma_f32_32x32x16_bf16 a[160:175], v[120:123], v[216:219], a[160:175]
ds_read_b128 v[88:91], v8 offset:18432
s_add_u32 m0, s25, 34816
s_add_u32 s26, s24, s82
buffer_load_dwordx4 v4, s[8:11], s26 offen sc1 lds
s_add_u32 s24, s24, 1024
s_waitcnt lgkmcnt(7)
v_mfma_f32_32x32x16_bf16 a[176:191], v[124:127], v[216:219], a[176:191]
ds_read_b128 v[92:95], v8 offset:19456
s_waitcnt lgkmcnt(7)
v_mfma_f32_32x32x16_bf16 a[192:207], v[64:67], v[216:219], a[192:207]
ds_read_b128 v[96:99], v8 offset:20480
s_waitcnt lgkmcnt(7)
v_mfma_f32_32x32x16_bf16 a[208:223], v[68:71], v[216:219], a[208:223]
ds_read_b128 v[100:103], v8 offset:21504
s_waitcnt lgkmcnt(7)
v_mfma_f32_32x32x16_bf16 a[0:15], v[72:75], v[220:223], a[0:15]
ds_read_b128 v[104:107], v8 offset:22528
s_waitcnt lgkmcnt(7)
v_mfma_f32_32x32x16_bf16 a[16:31], v[76:79], v[220:223], a[16:31]
ds_read_b128 v[108:111], v8 offset:23552
s_waitcnt lgkmcnt(7)
v_mfma_f32_32x32x16_bf16 a[32:47], v[80:83], v[220:223], a[32:47]
ds_read_b128 v[112:115], v8 offset:24576
s_waitcnt lgkmcnt(7)
v_mfma_f32_32x32x16_bf16 a[48:63], v[84:87], v[220:223], a[48:63]
ds_read_b128 v[116:119], v8 offset:25600
s_waitcnt lgkmcnt(7)
v_mfma_f32_32x32x16_bf16 a[64:79], v[88:91], v[220:223], a[64:79]
ds_read_b128 v[120:123], v8 offset:26624
s_waitcnt lgkmcnt(7)
v_mfma_f32_32x32x16_bf16 a[80:95], v[92:95], v[220:223], a[80:95]
s_waitcnt vmcnt(7)
s_barrier
ds_read_b128 v[124:127], v8 offset:27648
s_waitcnt lgkmcnt(7)
v_mfma_f32_32x32x16_bf16 a[96:111], v[96:99], v[220:223], a[96:111]
ds_read_b128 v[64:67], v5 offset:0
s_waitcnt lgkmcnt(7)
v_mfma_f32_32x32x16_bf16 a[112:127], v[100:103], v[220:223], a[112:127]
ds_read_b128 v[68:71], v5 offset:1024
s_waitcnt lgkmcnt(7)
v_mfma_f32_32x32x16_bf16 a[128:143], v[104:107], v[220:223], a[128:143]
ds_read_b128 v[72:75], v5 offset:2048
s_waitcnt lgkmcnt(7)
v_mfma_f32_32x32x16_bf16 a[144:159], v[108:111], v[220:223], a[144:159]
ds_read_b128 v[76:79], v5 offset:3072
s_waitcnt lgkmcnt(7)
v_mfma_f32_32x32x16_bf16 a[160:175], v[112:115], v[220:223], a[160:175]
ds_read_b128 v[80:83], v5 offset:4096
s_waitcnt lgkmcnt(7)
v_mfma_f32_32x32x16_bf16 a[176:191], v[116:119], v[220:223], a[176:191]
ds_read_b128 v[84:87], v5 offset:5120
s_waitcnt lgkmcnt(7)
v_mfma_f32_32x32x16_bf16 a[192:207], v[120:123], v[220:223], a[192:207]
ds_read_b128 v[88:91], v5 offset:6144
s_waitcnt lgkmcnt(7)
v_mfma_f32_32x32x16_bf16 a[208:223], v[124:127], v[220:223], a[208:223]
ds_read_b128 v[92:95], v5 offset:7168
s_waitcnt lgkmcnt(7)
v_mfma_f32_32x32x16_bf16 a[0:15], v[64:67], v[224:227], a[0:15]
ds_read_b128 v[96:99], v5 offset:8192
s_waitcnt lgkmcnt(7)
v_mfma_f32_32x32x16_bf16 a[16:31], v[68:71], v[224:227], a[16:31]
ds_read_b128 v[100:103], v5 offset:9216
s_waitcnt lgkmcnt(7)
v_mfma_f32_32x32x16_bf16 a[32:47], v[72:75], v[224:227], a[32:47]
ds_read_b128 v[104:107], v5 offset:10240
s_waitcnt lgkmcnt(7)
v_mfma_f32_32x32x16_bf16 a[48:63], v[76:79], v[224:227], a[48:63]
ds_read_b128 v[108:111], v5 offset:11264
s_waitcnt lgkmcnt(7)
v_mfma_f32_32x32x16_bf16 a[64:79], v[80:83], v[224:227], a[64:79]
ds_read_b128 v[112:115], v5 offset:12288
s_waitcnt lgkmcnt(7)
v_mfma_f32_32x32x16_bf16 a[80:95], v[84:87], v[224:227], a[80:95]
ds_read_b128 v[116:119], v5 offset:13312
s_waitcnt lgkmcnt(7)
v_mfma_f32_32x32x16_bf16 a[96:111], v[88:91], v[224:227], a[96:111]
ds_read_b128 v[120:123], v5 offset:14336
s_waitcnt lgkmcnt(7)
v_mfma_f32_32x32x16_bf16 a[112:127], v[92:95], v[224:227], a[112:127]
ds_read_b128 v[124:127], v5 offset:15360
s_waitcnt lgkmcnt(7)
v_mfma_f32_32x32x16_bf16 a[128:143], v[96:99], v[224:227], a[128:143]
ds_read_b128 v[64:67], v5 offset:16384
s_waitcnt lgkmcnt(7)
v_mfma_f32_32x32x16_bf16 a[144:159], v[100:103], v[224:227], a[144:159]
ds_read_b128 v[68:71], v5 offset:17408
s_waitcnt lgkmcnt(7)
v_mfma_f32_32x32x16_bf16 a[160:175], v[104:107], v[224:227], a[160:175]
ds_read_b128 v[72:75], v5 offset:18432
s_waitcnt lgkmcnt(7)
v_mfma_f32_32x32x16_bf16 a[176:191], v[108:111], v[224:227], a[176:191]
ds_read_b128 v[76:79], v5 offset:19456
s_waitcnt lgkmcnt(7)
v_mfma_f32_32x32x16_bf16 a[192:207], v[112:115], v[224:227], a[192:207]
ds_read_b128 v[80:83], v5 offset:20480
s_waitcnt lgkmcnt(7)
v_mfma_f32_32x32x16_bf16 a[208:223], v[116:119], v[224:227], a[208:223]
ds_read_b128 v[84:87], v5 offset:21504
s_waitcnt lgkmcnt(7)
v_mfma_f32_32x32x16_bf16 a[0:15], v[120:123], v[228:231], a[0:15]
ds_read_b128 v[88:91], v5 offset:22528
s_waitcnt lgkmcnt(7)
v_mfma_f32_32x32x16_bf16 a[16:31], v[124:127], v[228:231], a[16:31]
ds_read_b128 v[92:95], v5 offset:23552
s_waitcnt lgkmcnt(7)
v_mfma_f32_32x32x16_bf16 a[32:47], v[64:67], v[228:231], a[32:47]
ds_read_b128 v[96:99], v5 offset:24576
s_waitcnt lgkmcnt(7)
v_mfma_f32_32x32x16_bf16 a[48:63], v[68:71], v[228:231], a[48:63]
ds_read_b128 v[100:103], v5 offset:25600
s_waitcnt lgkmcnt(7)
v_mfma_f32_32x32x16_bf16 a[64:79], v[72:75], v[228:231], a[64:79]
ds_read_b128 v[104:107], v5 offset:26624
s_waitcnt lgkmcnt(7)
v_mfma_f32_32x32x16_bf16 a[80:95], v[76:79], v[228:231], a[80:95]
s_waitcnt vmcnt(0)
s_barrier
ds_read_b128 v[108:111], v5 offset:27648
s_waitcnt lgkmcnt(7)
v_mfma_f32_32x32x16_bf16 a[96:111], v[80:83], v[228:231], a[96:111]
ds_read_b128 v[112:115], v6 offset:0
s_waitcnt lgkmcnt(7)
v_mfma_f32_32x32x16_bf16 a[112:127], v[84:87], v[228:231], a[112:127]
ds_read_b128 v[116:119], v6 offset:1024
s_waitcnt lgkmcnt(7)
v_mfma_f32_32x32x16_bf16 a[128:143], v[88:91], v[228:231], a[128:143]
ds_read_b128 v[120:123], v6 offset:2048
s_waitcnt lgkmcnt(7)
v_mfma_f32_32x32x16_bf16 a[144:159], v[92:95], v[228:231], a[144:159]
ds_read_b128 v[124:127], v6 offset:3072
s_waitcnt lgkmcnt(7)
v_mfma_f32_32x32x16_bf16 a[160:175], v[96:99], v[228:231], a[160:175]
ds_read_b128 v[64:67], v6 offset:4096
s_waitcnt lgkmcnt(7)
v_mfma_f32_32x32x16_bf16 a[176:191], v[100:103], v[228:231], a[176:191]
ds_read_b128 v[68:71], v6 offset:5120
s_waitcnt lgkmcnt(7)
v_mfma_f32_32x32x16_bf16 a[192:207], v[104:107], v[228:231], a[192:207]
ds_read_b128 v[72:75], v6 offset:6144
s_waitcnt lgkmcnt(7)
v_mfma_f32_32x32x16_bf16 a[208:223], v[108:111], v[228:231], a[208:223]
ds_read_b128 v[76:79], v6 offset:7168
s_waitcnt lgkmcnt(7)
v_mfma_f32_32x32x16_bf16 a[0:15], v[112:115], v[232:235], a[0:15]
ds_read_b128 v[80:83], v6 offset:8192
s_waitcnt lgkmcnt(7)
v_mfma_f32_32x32x16_bf16 a[16:31], v[116:119], v[232:235], a[16:31]
ds_read_b128 v[84:87], v6 offset:9216
s_waitcnt lgkmcnt(7)
v_mfma_f32_32x32x16_bf16 a[32:47], v[120:123], v[232:235], a[32:47]
ds_read_b128 v[88:91], v6 offset:10240
s_waitcnt lgkmcnt(7)
v_mfma_f32_32x32x16_bf16 a[48:63], v[124:127], v[232:235], a[48:63]
ds_read_b128 v[92:95], v6 offset:11264
s_waitcnt lgkmcnt(7)
v_mfma_f32_32x32x16_bf16 a[64:79], v[64:67], v[232:235], a[64:79]
ds_read_b128 v[96:99], v6 offset:12288
s_waitcnt lgkmcnt(7)
v_mfma_f32_32x32x16_bf16 a[80:95], v[68:71], v[232:235], a[80:95]
ds_read_b128 v[100:103], v6 offset:13312
s_waitcnt lgkmcnt(7)
v_mfma_f32_32x32x16_bf16 a[96:111], v[72:75], v[232:235], a[96:111]
ds_read_b128 v[104:107], v6 offset:14336
s_waitcnt lgkmcnt(7)
v_mfma_f32_32x32x16_bf16 a[112:127], v[76:79], v[232:235], a[112:127]
ds_read_b128 v[108:111], v6 offset:15360
s_waitcnt lgkmcnt(7)
v_mfma_f32_32x32x16_bf16 a[128:143], v[80:83], v[232:235], a[128:143]
ds_read_b128 v[112:115], v6 offset:16384
s_waitcnt lgkmcnt(7)
v_mfma_f32_32x32x16_bf16 a[144:159], v[84:87], v[232:235], a[144:159]
ds_read_b128 v[116:119], v6 offset:17408
s_waitcnt lgkmcnt(7)
v_mfma_f32_32x32x16_bf16 a[160:175], v[88:91], v[232:235], a[160:175]
ds_read_b128 v[120:123], v6 offset:18432
s_waitcnt lgkmcnt(7)
v_mfma_f32_32x32x16_bf16 a[176:191], v[92:95], v[232:235], a[176:191]
ds_read_b128 v[124:127], v6 offset:19456
s_waitcnt lgkmcnt(7)
v_mfma_f32_32x32x16_bf16 a[192:207], v[96:99], v[232:235], a[192:207]
ds_read_b128 v[64:67], v6 offset:20480
s_waitcnt lgkmcnt(7)
v_mfma_f32_32x32x16_bf16 a[208:223], v[100:103], v[232:235], a[208:223]
ds_read_b128 v[68:71], v6 offset:21504
s_waitcnt lgkmcnt(7)
v_mfma_f32_32x32x16_bf16 a[0:15], v[104:107], v[236:239], a[0:15]
ds_read_b128 v[72:75], v6 offset:22528
s_waitcnt lgkmcnt(7)
v_mfma_f32_32x32x16_bf16 a[16:31], v[108:111], v[236:239], a[16:31]
ds_read_b128 v[76:79], v6 offset:23552
s_waitcnt lgkmcnt(7)
v_mfma_f32_32x32x16_bf16 a[32:47], v[112:115], v[236:239], a[32:47]
ds_read_b128 v[80:83], v6 offset:24576
s_waitcnt lgkmcnt(7)
v_mfma_f32_32x32x16_bf16 a[48:63], v[116:119], v[236:239], a[48:63]
ds_read_b128 v[84:87], v6 offset:25600
s_waitcnt lgkmcnt(7)
v_mfma_f32_32x32x16_bf16 a[64:79], v[120:123], v[236:239], a[64:79]
ds_read_b128 v[88:91], v6 offset:26624
s_waitcnt lgkmcnt(7)
v_mfma_f32_32x32x16_bf16 a[80:95], v[124:127], v[236:239], a[80:95]
ds_read_b128 v[92:95], v6 offset:27648
s_waitcnt lgkmcnt(7)
v_mfma_f32_32x32x16_bf16 a[96:111], v[64:67], v[236:239], a[96:111]
s_waitcnt lgkmcnt(6)
v_mfma_f32_32x32x16_bf16 a[112:127], v[68:71], v[236:239], a[112:127]
s_waitcnt lgkmcnt(5)
v_mfma_f32_32x32x16_bf16 a[128:143], v[72:75], v[236:239], a[128:143]
s_waitcnt lgkmcnt(4)
v_mfma_f32_32x32x16_bf16 a[144:159], v[76:79], v[236:239], a[144:159]
s_waitcnt lgkmcnt(3)
v_mfma_f32_32x32x16_bf16 a[160:175], v[80:83], v[236:239], a[160:175]
s_waitcnt lgkmcnt(2)
v_mfma_f32_32x32x16_bf16 a[176:191], v[84:87], v[236:239], a[176:191]
s_waitcnt lgkmcnt(1)
v_mfma_f32_32x32x16_bf16 a[192:207], v[88:91], v[236:239], a[192:207]
s_waitcnt lgkmcnt(0)
v_mfma_f32_32x32x16_bf16 a[208:223], v[92:95], v[236:239], a[208:223]
s_nop 15
s_waitcnt vmcnt(0)
s_barrier
s_cmp_lg_u32 s17, 0
s_cbranch_scc1 Lsig_70
s_lshl_b32 s26, s21, 7
s_add_u32 s26, s26, 54870016
v_mov_b32 v26, 1
v_mov_b32 v27, 1073741824
v_cmp_eq_u32 vcc, 0, v1
s_nop 1
v_cndmask_b32 v27, v27, v25, vcc
buffer_atomic_add v26, v27, s[8:11], s26 offen
Lsig_70:
v_accvgpr_read_b32 v32, a0
v_accvgpr_read_b32 v33, a1
v_accvgpr_read_b32 v34, a2
v_accvgpr_read_b32 v35, a3
v_accvgpr_read_b32 v36, a4
v_accvgpr_read_b32 v37, a5
v_accvgpr_read_b32 v38, a6
v_accvgpr_read_b32 v39, a7
v_accvgpr_read_b32 v40, a8
v_accvgpr_read_b32 v41, a9
v_accvgpr_read_b32 v42, a10
v_accvgpr_read_b32 v43, a11
v_accvgpr_read_b32 v44, a12
v_accvgpr_read_b32 v45, a13
v_accvgpr_read_b32 v46, a14
v_accvgpr_read_b32 v47, a15
v_cvt_pk_bf16_f32 v128, v32, v33
v_cvt_pk_bf16_f32 v129, v34, v35
v_cvt_pk_bf16_f32 v130, v36, v37
v_cvt_pk_bf16_f32 v131, v38, v39
v_cvt_pk_bf16_f32 v132, v40, v41
v_cvt_pk_bf16_f32 v133, v42, v43
v_cvt_pk_bf16_f32 v134, v44, v45
v_cvt_pk_bf16_f32 v135, v46, v47
v_accvgpr_read_b32 v32, a16
v_accvgpr_read_b32 v33, a17
v_accvgpr_read_b32 v34, a18
v_accvgpr_read_b32 v35, a19
v_accvgpr_read_b32 v36, a20
v_accvgpr_read_b32 v37, a21
v_accvgpr_read_b32 v38, a22
v_accvgpr_read_b32 v39, a23
v_accvgpr_read_b32 v40, a24
v_accvgpr_read_b32 v41, a25
v_accvgpr_read_b32 v42, a26
v_accvgpr_read_b32 v43, a27
v_accvgpr_read_b32 v44, a28
v_accvgpr_read_b32 v45, a29
v_accvgpr_read_b32 v46, a30
v_accvgpr_read_b32 v47, a31
v_cvt_pk_bf16_f32 v136, v32, v33
v_cvt_pk_bf16_f32 v137, v34, v35
v_cvt_pk_bf16_f32 v138, v36, v37
v_cvt_pk_bf16_f32 v139, v38, v39
v_cvt_pk_bf16_f32 v140, v40, v41
v_cvt_pk_bf16_f32 v141, v42, v43
v_cvt_pk_bf16_f32 v142, v44, v45
v_cvt_pk_bf16_f32 v143, v46, v47
v_accvgpr_read_b32 v32, a32
v_accvgpr_read_b32 v33, a33
v_accvgpr_read_b32 v34, a34
v_accvgpr_read_b32 v35, a35
v_accvgpr_read_b32 v36, a36
v_accvgpr_read_b32 v37, a37
v_accvgpr_read_b32 v38, a38
v_accvgpr_read_b32 v39, a39
v_accvgpr_read_b32 v40, a40
v_accvgpr_read_b32 v41, a41
v_accvgpr_read_b32 v42, a42
v_accvgpr_read_b32 v43, a43
v_accvgpr_read_b32 v44, a44
v_accvgpr_read_b32 v45, a45
v_accvgpr_read_b32 v46, a46
v_accvgpr_read_b32 v47, a47
v_cvt_pk_bf16_f32 v144, v32, v33
v_cvt_pk_bf16_f32 v145, v34, v35
v_cvt_pk_bf16_f32 v146, v36, v37
v_cvt_pk_bf16_f32 v147, v38, v39
v_cvt_pk_bf16_f32 v148, v40, v41
v_cvt_pk_bf16_f32 v149, v42, v43
v_cvt_pk_bf16_f32 v150, v44, v45
v_cvt_pk_bf16_f32 v151, v46, v47
v_accvgpr_read_b32 v32, a48
v_accvgpr_read_b32 v33, a49
v_accvgpr_read_b32 v34, a50
v_accvgpr_read_b32 v35, a51
v_accvgpr_read_b32 v36, a52
v_accvgpr_read_b32 v37, a53
v_accvgpr_read_b32 v38, a54
v_accvgpr_read_b32 v39, a55
v_accvgpr_read_b32 v40, a56
v_accvgpr_read_b32 v41, a57
v_accvgpr_read_b32 v42, a58
v_accvgpr_read_b32 v43, a59
v_accvgpr_read_b32 v44, a60
v_accvgpr_read_b32 v45, a61
v_accvgpr_read_b32 v46, a62
v_accvgpr_read_b32 v47, a63
v_cvt_pk_bf16_f32 v152, v32, v33
v_cvt_pk_bf16_f32 v153, v34, v35
v_cvt_pk_bf16_f32 v154, v36, v37
v_cvt_pk_bf16_f32 v155, v38, v39
v_cvt_pk_bf16_f32 v156, v40, v41
v_cvt_pk_bf16_f32 v157, v42, v43
v_cvt_pk_bf16_f32 v158, v44, v45
v_cvt_pk_bf16_f32 v159, v46, v47
v_accvgpr_read_b32 v32, a64
v_accvgpr_read_b32 v33, a65
v_accvgpr_read_b32 v34, a66
v_accvgpr_read_b32 v35, a67
v_accvgpr_read_b32 v36, a68
v_accvgpr_read_b32 v37, a69
v_accvgpr_read_b32 v38, a70
v_accvgpr_read_b32 v39, a71
v_accvgpr_read_b32 v40, a72
v_accvgpr_read_b32 v41, a73
v_accvgpr_read_b32 v42, a74
v_accvgpr_read_b32 v43, a75
v_accvgpr_read_b32 v44, a76
v_accvgpr_read_b32 v45, a77
v_accvgpr_read_b32 v46, a78
v_accvgpr_read_b32 v47, a79
v_cvt_pk_bf16_f32 v160, v32, v33
v_cvt_pk_bf16_f32 v161, v34, v35
v_cvt_pk_bf16_f32 v162, v36, v37
v_cvt_pk_bf16_f32 v163, v38, v39
v_cvt_pk_bf16_f32 v164, v40, v41
v_cvt_pk_bf16_f32 v165, v42, v43
v_cvt_pk_bf16_f32 v166, v44, v45
v_cvt_pk_bf16_f32 v167, v46, v47
v_accvgpr_read_b32 v32, a80
v_accvgpr_read_b32 v33, a81
v_accvgpr_read_b32 v34, a82
v_accvgpr_read_b32 v35, a83
v_accvgpr_read_b32 v36, a84
v_accvgpr_read_b32 v37, a85
v_accvgpr_read_b32 v38, a86
v_accvgpr_read_b32 v39, a87
v_accvgpr_read_b32 v40, a88
v_accvgpr_read_b32 v41, a89
v_accvgpr_read_b32 v42, a90
v_accvgpr_read_b32 v43, a91
v_accvgpr_read_b32 v44, a92
v_accvgpr_read_b32 v45, a93
v_accvgpr_read_b32 v46, a94
v_accvgpr_read_b32 v47, a95
v_cvt_pk_bf16_f32 v168, v32, v33
v_cvt_pk_bf16_f32 v169, v34, v35
v_cvt_pk_bf16_f32 v170, v36, v37
v_cvt_pk_bf16_f32 v171, v38, v39
v_cvt_pk_bf16_f32 v172, v40, v41
v_cvt_pk_bf16_f32 v173, v42, v43
v_cvt_pk_bf16_f32 v174, v44, v45
v_cvt_pk_bf16_f32 v175, v46, v47
v_accvgpr_read_b32 v32, a96
v_accvgpr_read_b32 v33, a97
v_accvgpr_read_b32 v34, a98
v_accvgpr_read_b32 v35, a99
v_accvgpr_read_b32 v36, a100
v_accvgpr_read_b32 v37, a101
v_accvgpr_read_b32 v38, a102
v_accvgpr_read_b32 v39, a103
v_accvgpr_read_b32 v40, a104
v_accvgpr_read_b32 v41, a105
v_accvgpr_read_b32 v42, a106
v_accvgpr_read_b32 v43, a107
v_accvgpr_read_b32 v44, a108
v_accvgpr_read_b32 v45, a109
v_accvgpr_read_b32 v46, a110
v_accvgpr_read_b32 v47, a111
v_cvt_pk_bf16_f32 v176, v32, v33
v_cvt_pk_bf16_f32 v177, v34, v35
v_cvt_pk_bf16_f32 v178, v36, v37
v_cvt_pk_bf16_f32 v179, v38, v39
v_cvt_pk_bf16_f32 v180, v40, v41
v_cvt_pk_bf16_f32 v181, v42, v43
v_cvt_pk_bf16_f32 v182, v44, v45
v_cvt_pk_bf16_f32 v183, v46, v47
v_accvgpr_read_b32 v32, a112
v_accvgpr_read_b32 v33, a113
v_accvgpr_read_b32 v34, a114
v_accvgpr_read_b32 v35, a115
v_accvgpr_read_b32 v36, a116
v_accvgpr_read_b32 v37, a117
v_accvgpr_read_b32 v38, a118
v_accvgpr_read_b32 v39, a119
v_accvgpr_read_b32 v40, a120
v_accvgpr_read_b32 v41, a121
v_accvgpr_read_b32 v42, a122
v_accvgpr_read_b32 v43, a123
v_accvgpr_read_b32 v44, a124
v_accvgpr_read_b32 v45, a125
v_accvgpr_read_b32 v46, a126
v_accvgpr_read_b32 v47, a127
v_cvt_pk_bf16_f32 v184, v32, v33
v_cvt_pk_bf16_f32 v185, v34, v35
v_cvt_pk_bf16_f32 v186, v36, v37
v_cvt_pk_bf16_f32 v187, v38, v39
v_cvt_pk_bf16_f32 v188, v40, v41
v_cvt_pk_bf16_f32 v189, v42, v43
v_cvt_pk_bf16_f32 v190, v44, v45
v_cvt_pk_bf16_f32 v191, v46, v47
v_accvgpr_read_b32 v32, a128
v_accvgpr_read_b32 v33, a129
v_accvgpr_read_b32 v34, a130
v_accvgpr_read_b32 v35, a131
v_accvgpr_read_b32 v36, a132
v_accvgpr_read_b32 v37, a133
v_accvgpr_read_b32 v38, a134
v_accvgpr_read_b32 v39, a135
v_accvgpr_read_b32 v40, a136
v_accvgpr_read_b32 v41, a137
v_accvgpr_read_b32 v42, a138
v_accvgpr_read_b32 v43, a139
v_accvgpr_read_b32 v44, a140
v_accvgpr_read_b32 v45, a141
v_accvgpr_read_b32 v46, a142
v_accvgpr_read_b32 v47, a143
v_cvt_pk_bf16_f32 v192, v32, v33
v_cvt_pk_bf16_f32 v193, v34, v35
v_cvt_pk_bf16_f32 v194, v36, v37
v_cvt_pk_bf16_f32 v195, v38, v39
v_cvt_pk_bf16_f32 v196, v40, v41
v_cvt_pk_bf16_f32 v197, v42, v43
v_cvt_pk_bf16_f32 v198, v44, v45
v_cvt_pk_bf16_f32 v199, v46, v47
v_accvgpr_read_b32 v32, a144
v_accvgpr_read_b32 v33, a145
v_accvgpr_read_b32 v34, a146
v_accvgpr_read_b32 v35, a147
v_accvgpr_read_b32 v36, a148
v_accvgpr_read_b32 v37, a149
v_accvgpr_read_b32 v38, a150
v_accvgpr_read_b32 v39, a151
v_accvgpr_read_b32 v40, a152
v_accvgpr_read_b32 v41, a153
v_accvgpr_read_b32 v42, a154
v_accvgpr_read_b32 v43, a155
v_accvgpr_read_b32 v44, a156
v_accvgpr_read_b32 v45, a157
v_accvgpr_read_b32 v46, a158
v_accvgpr_read_b32 v47, a159
v_cvt_pk_bf16_f32 v200, v32, v33
v_cvt_pk_bf16_f32 v201, v34, v35
v_cvt_pk_bf16_f32 v202, v36, v37
v_cvt_pk_bf16_f32 v203, v38, v39
v_cvt_pk_bf16_f32 v204, v40, v41
v_cvt_pk_bf16_f32 v205, v42, v43
v_cvt_pk_bf16_f32 v206, v44, v45
v_cvt_pk_bf16_f32 v207, v46, v47
v_accvgpr_read_b32 v32, a160
v_accvgpr_read_b32 v33, a161
v_accvgpr_read_b32 v34, a162
v_accvgpr_read_b32 v35, a163
v_accvgpr_read_b32 v36, a164
v_accvgpr_read_b32 v37, a165
v_accvgpr_read_b32 v38, a166
v_accvgpr_read_b32 v39, a167
v_accvgpr_read_b32 v40, a168
v_accvgpr_read_b32 v41, a169
v_accvgpr_read_b32 v42, a170
v_accvgpr_read_b32 v43, a171
v_accvgpr_read_b32 v44, a172
v_accvgpr_read_b32 v45, a173
v_accvgpr_read_b32 v46, a174
v_accvgpr_read_b32 v47, a175
v_cvt_pk_bf16_f32 v208, v32, v33
v_cvt_pk_bf16_f32 v209, v34, v35
v_cvt_pk_bf16_f32 v210, v36, v37
v_cvt_pk_bf16_f32 v211, v38, v39
v_cvt_pk_bf16_f32 v212, v40, v41
v_cvt_pk_bf16_f32 v213, v42, v43
v_cvt_pk_bf16_f32 v214, v44, v45
v_cvt_pk_bf16_f32 v215, v46, v47
v_accvgpr_read_b32 v32, a176
v_accvgpr_read_b32 v33, a177
v_accvgpr_read_b32 v34, a178
v_accvgpr_read_b32 v35, a179
v_accvgpr_read_b32 v36, a180
v_accvgpr_read_b32 v37, a181
v_accvgpr_read_b32 v38, a182
v_accvgpr_read_b32 v39, a183
v_accvgpr_read_b32 v40, a184
v_accvgpr_read_b32 v41, a185
v_accvgpr_read_b32 v42, a186
v_accvgpr_read_b32 v43, a187
v_accvgpr_read_b32 v44, a188
v_accvgpr_read_b32 v45, a189
v_accvgpr_read_b32 v46, a190
v_accvgpr_read_b32 v47, a191
v_cvt_pk_bf16_f32 v216, v32, v33
v_cvt_pk_bf16_f32 v217, v34, v35
v_cvt_pk_bf16_f32 v218, v36, v37
v_cvt_pk_bf16_f32 v219, v38, v39
v_cvt_pk_bf16_f32 v220, v40, v41
v_cvt_pk_bf16_f32 v221, v42, v43
v_cvt_pk_bf16_f32 v222, v44, v45
v_cvt_pk_bf16_f32 v223, v46, v47
v_accvgpr_read_b32 v32, a192
v_accvgpr_read_b32 v33, a193
v_accvgpr_read_b32 v34, a194
v_accvgpr_read_b32 v35, a195
v_accvgpr_read_b32 v36, a196
v_accvgpr_read_b32 v37, a197
v_accvgpr_read_b32 v38, a198
v_accvgpr_read_b32 v39, a199
v_accvgpr_read_b32 v40, a200
v_accvgpr_read_b32 v41, a201
v_accvgpr_read_b32 v42, a202
v_accvgpr_read_b32 v43, a203
v_accvgpr_read_b32 v44, a204
v_accvgpr_read_b32 v45, a205
v_accvgpr_read_b32 v46, a206
v_accvgpr_read_b32 v47, a207
v_cvt_pk_bf16_f32 v224, v32, v33
v_cvt_pk_bf16_f32 v225, v34, v35
v_cvt_pk_bf16_f32 v226, v36, v37
v_cvt_pk_bf16_f32 v227, v38, v39
v_cvt_pk_bf16_f32 v228, v40, v41
v_cvt_pk_bf16_f32 v229, v42, v43
v_cvt_pk_bf16_f32 v230, v44, v45
v_cvt_pk_bf16_f32 v231, v46, v47
v_accvgpr_read_b32 v32, a208
v_accvgpr_read_b32 v33, a209
v_accvgpr_read_b32 v34, a210
v_accvgpr_read_b32 v35, a211
v_accvgpr_read_b32 v36, a212
v_accvgpr_read_b32 v37, a213
v_accvgpr_read_b32 v38, a214
v_accvgpr_read_b32 v39, a215
v_accvgpr_read_b32 v40, a216
v_accvgpr_read_b32 v41, a217
v_accvgpr_read_b32 v42, a218
v_accvgpr_read_b32 v43, a219
v_accvgpr_read_b32 v44, a220
v_accvgpr_read_b32 v45, a221
v_accvgpr_read_b32 v46, a222
v_accvgpr_read_b32 v47, a223
v_cvt_pk_bf16_f32 v232, v32, v33
v_cvt_pk_bf16_f32 v233, v34, v35
v_cvt_pk_bf16_f32 v234, v36, v37
v_cvt_pk_bf16_f32 v235, v38, v39
v_cvt_pk_bf16_f32 v236, v40, v41
v_cvt_pk_bf16_f32 v237, v42, v43
v_cvt_pk_bf16_f32 v238, v44, v45
v_cvt_pk_bf16_f32 v239, v46, v47
v_bfe_u32 v26, v1, 4, 1
v_mul_u32_u24 v26, 14336, v26
v_lshrrev_b32 v27, 5, v1
v_lshl_add_u32 v26, v27, 8, v26
v_and_b32 v28, 15, v1
v_lshl_add_u32 v26, v28, 4, v26
s_mul_i32 s26, s23, 28672
s_add_u32 s26, s26, 14680064
v_bfe_u32 v28, v1, 1, 2
v_lshlrev_b32 v28, 6, v28
v_lshl_add_u32 v28, v27, 5, v28
v_and_b32 v29, 1, v1
v_lshl_add_u32 v28, v29, 4, v28
v_and_b32 v29, 31, v1
v_lshlrev_b32 v27, 2, v27
v_sub_u32 v29, v29, v27
s_add_u32 s27, s26, 0
buffer_load_dwordx4 a[0:3], v26, s[8:11], s27 offen offset:0 sc1
s_add_u32 s27, s26, 0
buffer_load_dwordx4 a[4:7], v26, s[8:11], s27 offen offset:512 sc1
s_add_u32 s27, s26, 0
buffer_load_dwordx4 a[8:11], v26, s[8:11], s27 offen offset:1024 sc1
s_add_u32 s27, s26, 0
buffer_load_dwordx4 a[12:15], v26, s[8:11], s27 offen offset:1536 sc1
s_add_u32 s27, s26, 0
buffer_load_dwordx4 a[16:19], v26, s[8:11], s27 offen offset:2048 sc1
s_add_u32 s27, s26, 0
buffer_load_dwordx4 a[20:23], v26, s[8:11], s27 offen offset:2560 sc1
s_add_u32 s27, s26, 0
buffer_load_dwordx4 a[24:27], v26, s[8:11], s27 offen offset:3584 sc1
s_add_u32 s27, s26, 4096
buffer_load_dwordx4 a[28:31], v26, s[8:11], s27 offen offset:0 sc1
s_add_u32 s27, s26, 4096
buffer_load_dwordx4 a[32:35], v26, s[8:11], s27 offen offset:512 sc1
s_add_u32 s27, s26, 4096
buffer_load_dwordx4 a[36:39], v26, s[8:11], s27 offen offset:1024 sc1
s_add_u32 s27, s26, 4096
buffer_load_dwordx4 a[40:43], v26, s[8:11], s27 offen offset:1536 sc1
s_add_u32 s27, s26, 4096
buffer_load_dwordx4 a[44:47], v26, s[8:11], s27 offen offset:2048 sc1
s_add_u32 s27, s26, 4096
buffer_load_dwordx4 a[48:51], v26, s[8:11], s27 offen offset:3072 sc1
s_add_u32 s27, s26, 4096
buffer_load_dwordx4 a[52:55], v26, s[8:11], s27 offen offset:3584 sc1
s_add_u32 s27, s26, 8192
buffer_load_dwordx4 a[56:59], v26, s[8:11], s27 offen offset:0 sc1
s_add_u32 s27, s26, 8192
buffer_load_dwordx4 a[60:63], v26, s[8:11], s27 offen offset:512 sc1
s_add_u32 s27, s26, 8192
buffer_load_dwordx4 a[64:67], v26, s[8:11], s27 offen offset:1024 sc1
s_add_u32 s27, s26, 8192
buffer_load_dwordx4 a[68:71], v26, s[8:11], s27 offen offset:1536 sc1
s_add_u32 s27, s26, 8192
buffer_load_dwordx4 a[72:75], v26, s[8:11], s27 offen offset:2560 sc1
s_add_u32 s27, s26, 8192
buffer_load_dwordx4 a[76:79], v26, s[8:11], s27 offen offset:3072 sc1
s_add_u32 s27, s26, 8192
buffer_load_dwordx4 a[80:83], v26, s[8:11], s27 offen offset:3584 sc1
s_add_u32 s27, s26, 12288
buffer_load_dwordx4 a[84:87], v26, s[8:11], s27 offen offset:0 sc1
s_add_u32 s27, s26, 12288
buffer_load_dwordx4 a[88:91], v26, s[8:11], s27 offen offset:512 sc1
s_add_u32 s27, s26, 12288
buffer_load_dwordx4 a[92:95], v26, s[8:11], s27 offen offset:1024 sc1
s_add_u32 s27, s26, 0
buffer_load_dwordx4 a[96:99], v26, s[8:11], s27 offen offset:3072 sc1
s_add_u32 s27, s26, 4096
buffer_load_dwordx4 a[100:103], v26, s[8:11], s27 offen offset:2560 sc1
s_add_u32 s27, s26, 8192
buffer_load_dwordx4 a[104:107], v26, s[8:11], s27 offen offset:2048 sc1
s_add_u32 s27, s26, 12288
buffer_load_dwordx4 a[108:111], v26, s[8:11], s27 offen offset:1536 sc1
s_waitcnt vmcnt(27)
v_mfma_f32_32x32x16_bf16 v[64:79], a[0:3], v[128:131], 0
s_waitcnt vmcnt(26)
v_mfma_f32_32x32x16_bf16 v[64:79], a[4:7], v[132:135], v[64:79]
s_waitcnt vmcnt(25)
v_mfma_f32_32x32x16_bf16 v[64:79], a[8:11], v[136:139], v[64:79]
s_waitcnt vmcnt(24)
v_mfma_f32_32x32x16_bf16 v[64:79], a[12:15], v[140:143], v[64:79]
s_waitcnt vmcnt(23)
v_mfma_f32_32x32x16_bf16 v[64:79], a[16:19], v[144:147], v[64:79]
s_waitcnt vmcnt(22)
v_mfma_f32_32x32x16_bf16 v[64:79], a[20:23], v[148:151], v[64:79]
s_waitcnt vmcnt(21)
v_mfma_f32_32x32x16_bf16 v[64:79], a[24:27], v[152:155], v[64:79]
s_waitcnt vmcnt(20)
v_mfma_f32_32x32x16_bf16 v[64:79], a[28:31], v[156:159], v[64:79]
s_waitcnt vmcnt(19)
v_mfma_f32_32x32x16_bf16 v[64:79], a[32:35], v[160:163], v[64:79]
s_waitcnt vmcnt(18)
v_mfma_f32_32x32x16_bf16 v[64:79], a[36:39], v[164:167], v[64:79]
s_waitcnt vmcnt(17)
v_mfma_f32_32x32x16_bf16 v[64:79], a[40:43], v[168:171], v[64:79]
s_waitcnt vmcnt(16)
v_mfma_f32_32x32x16_bf16 v[64:79], a[44:47], v[172:175], v[64:79]
s_waitcnt vmcnt(15)
v_mfma_f32_32x32x16_bf16 v[64:79], a[48:51], v[176:179], v[64:79]
s_waitcnt vmcnt(14)
v_mfma_f32_32x32x16_bf16 v[64:79], a[52:55], v[180:183], v[64:79]
s_waitcnt vmcnt(13)
v_mfma_f32_32x32x16_bf16 v[64:79], a[56:59], v[184:187], v[64:79]
s_waitcnt vmcnt(12)
v_mfma_f32_32x32x16_bf16 v[64:79], a[60:63], v[188:191], v[64:79]
s_waitcnt vmcnt(11)
v_mfma_f32_32x32x16_bf16 v[64:79], a[64:67], v[192:195], v[64:79]
s_waitcnt vmcnt(10)
v_mfma_f32_32x32x16_bf16 v[64:79], a[68:71], v[196:199], v[64:79]
s_waitcnt vmcnt(9)
v_mfma_f32_32x32x16_bf16 v[64:79], a[72:75], v[200:203], v[64:79]
s_waitcnt vmcnt(8)
v_mfma_f32_32x32x16_bf16 v[64:79], a[76:79], v[204:207], v[64:79]
s_waitcnt vmcnt(7)
v_mfma_f32_32x32x16_bf16 v[64:79], a[80:83], v[208:211], v[64:79]
s_waitcnt vmcnt(6)
v_mfma_f32_32x32x16_bf16 v[64:79], a[84:87], v[212:215], v[64:79]
s_waitcnt vmcnt(5)
v_mfma_f32_32x32x16_bf16 v[64:79], a[88:91], v[216:219], v[64:79]
s_waitcnt vmcnt(4)
v_mfma_f32_32x32x16_bf16 v[64:79], a[92:95], v[220:223], v[64:79]
s_waitcnt vmcnt(3)
v_mfma_f32_32x32x16_bf16 v[64:79], a[96:99], v[224:227], v[64:79]
s_waitcnt vmcnt(2)
v_mfma_f32_32x32x16_bf16 v[64:79], a[100:103], v[228:231], v[64:79]
s_waitcnt vmcnt(1)
v_mfma_f32_32x32x16_bf16 v[64:79], a[104:107], v[232:235], v[64:79]
s_waitcnt vmcnt(0)
v_mfma_f32_32x32x16_bf16 v[64:79], a[108:111], v[236:239], v[64:79]
s_nop 15
v_mov_b32 v31, 0xff800000
v_cmp_le_i32 vcc, 0, v29
s_nop 1
v_cndmask_b32 v64, v31, v64, vcc
v_cmp_le_i32 vcc, 1, v29
s_nop 1
v_cndmask_b32 v65, v31, v65, vcc
v_cmp_le_i32 vcc, 2, v29
s_nop 1
v_cndmask_b32 v66, v31, v66, vcc
v_cmp_le_i32 vcc, 3, v29
s_nop 1
v_cndmask_b32 v67, v31, v67, vcc
v_cmp_le_i32 vcc, 8, v29
s_nop 1
v_cndmask_b32 v68, v31, v68, vcc
v_cmp_le_i32 vcc, 9, v29
s_nop 1
v_cndmask_b32 v69, v31, v69, vcc
v_cmp_le_i32 vcc, 10, v29
s_nop 1
v_cndmask_b32 v70, v31, v70, vcc
v_cmp_le_i32 vcc, 11, v29
s_nop 1
v_cndmask_b32 v71, v31, v71, vcc
v_cmp_le_i32 vcc, 16, v29
s_nop 1
v_cndmask_b32 v72, v31, v72, vcc
v_cmp_le_i32 vcc, 17, v29
s_nop 1
v_cndmask_b32 v73, v31, v73, vcc
v_cmp_le_i32 vcc, 18, v29
s_nop 1
v_cndmask_b32 v74, v31, v74, vcc
v_cmp_le_i32 vcc, 19, v29
s_nop 1
v_cndmask_b32 v75, v31, v75, vcc
v_cmp_le_i32 vcc, 24, v29
s_nop 1
v_cndmask_b32 v76, v31, v76, vcc
v_cmp_le_i32 vcc, 25, v29
s_nop 1
v_cndmask_b32 v77, v31, v77, vcc
v_cmp_le_i32 vcc, 26, v29
s_nop 1
v_cndmask_b32 v78, v31, v78, vcc
v_cmp_le_i32 vcc, 27, v29
s_nop 1
v_cndmask_b32 v79, v31, v79, vcc
v_max3_f32 v32, v64, v65, v66
v_max3_f32 v32, v32, v67, v68
v_max3_f32 v32, v32, v69, v70
v_max3_f32 v32, v32, v71, v72
v_max3_f32 v32, v32, v73, v74
v_max3_f32 v32, v32, v75, v76
v_max3_f32 v32, v32, v77, v78
v_max_f32 v32, v32, v79
v_mov_b32 v33, v32
s_nop 1
v_permlane32_swap_b32 v33, v32
v_max_f32 v32, v32, v33
v_sub_f32 v64, v64, v32
v_sub_f32 v65, v65, v32
v_sub_f32 v66, v66, v32
v_sub_f32 v67, v67, v32
v_sub_f32 v68, v68, v32
v_sub_f32 v69, v69, v32
v_sub_f32 v70, v70, v32
v_sub_f32 v71, v71, v32
v_sub_f32 v72, v72, v32
v_sub_f32 v73, v73, v32
v_sub_f32 v74, v74, v32
v_sub_f32 v75, v75, v32
v_sub_f32 v76, v76, v32
v_sub_f32 v77, v77, v32
v_sub_f32 v78, v78, v32
v_sub_f32 v79, v79, v32
v_exp_f32 v64, v64
v_exp_f32 v65, v65
v_exp_f32 v66, v66
v_exp_f32 v67, v67
v_exp_f32 v68, v68
v_exp_f32 v69, v69
v_exp_f32 v70, v70
v_exp_f32 v71, v71
v_exp_f32 v72, v72
v_exp_f32 v73, v73
v_exp_f32 v74, v74
v_exp_f32 v75, v75
v_exp_f32 v76, v76
v_exp_f32 v77, v77
v_exp_f32 v78, v78
v_exp_f32 v79, v79
v_add_f32 v34, v64, v65
v_add_f32 v34, v34, v66
v_add_f32 v34, v34, v67
v_add_f32 v34, v34, v68
v_add_f32 v34, v34, v69
v_add_f32 v34, v34, v70
v_add_f32 v34, v34, v71
v_add_f32 v34, v34, v72
v_add_f32 v34, v34, v73
v_add_f32 v34, v34, v74
v_add_f32 v34, v34, v75
v_add_f32 v34, v34, v76
v_add_f32 v34, v34, v77
v_add_f32 v34, v34, v78
v_add_f32 v34, v34, v79
s_mov_b32 s27, 54857856
s_lshl_b32 s26, s23, 13
s_add_u32 s26, s26, 53477376
s_add_u32 s35, s23, 1
s_min_u32 s35, s35, 63
Lsp_71:
buffer_load_dword v30, v25, s[8:11], s27 offen sc1
s_waitcnt vmcnt(0)
v_readfirstlane_b32 s28, v30
s_cmp_ge_u32 s28, s35
s_cbranch_scc1 Lsn2_76
s_sub_u32 s19, s19, 1
s_cbranch_scc1 Lsn_75
s_sleep 16
s_add_u32 s28, s28, 3
s_cmp_gt_u32 s28, s23
s_cbranch_scc1 Lsp_71
s_sleep 112
s_branch Lsp_71
Lsn2_76:
v_min_u32 v35, 6, v1
v_lshlrev_b32 v35, 10, v35
Lsn2_76p:
buffer_load_dword v30, v35, s[8:11], s26 offen offset:1020 sc1
s_waitcnt vmcnt(0)
v_cmp_eq_u32 vcc, -1, v30
s_cbranch_vccz Lsg_72

s_sub_u32 s19, s19, 1
s_cbranch_scc0 Lsn2_76p
Lsn_75:
s_mov_b32 s19, 0
Lsg_72:
s_add_u32 s27, s26, 4096
Lsm_73:
buffer_load_dwordx4 a[112:115], v28, s[8:11], s26 offen offset:0 sc1
buffer_load_dwordx4 a[116:119], v28, s[8:11], s26 offen offset:256 sc1
buffer_load_dwordx4 a[120:123], v28, s[8:11], s26 offen offset:512 sc1
buffer_load_dwordx4 a[124:127], v28, s[8:11], s26 offen offset:768 sc1
buffer_load_dwordx4 a[128:131], v28, s[8:11], s26 offen offset:1024 sc1
buffer_load_dwordx4 a[132:135], v28, s[8:11], s26 offen offset:1280 sc1
buffer_load_dwordx4 a[136:139], v28, s[8:11], s26 offen offset:1792 sc1
buffer_load_dwordx4 a[140:143], v28, s[8:11], s26 offen offset:2048 sc1
buffer_load_dwordx4 a[144:147], v28, s[8:11], s26 offen offset:2304 sc1
buffer_load_dwordx4 a[148:151], v28, s[8:11], s26 offen offset:2560 sc1
buffer_load_dwordx4 a[152:155], v28, s[8:11], s26 offen offset:2816 sc1
buffer_load_dwordx4 a[156:159], v28, s[8:11], s26 offen offset:3072 sc1
buffer_load_dwordx4 a[160:163], v28, s[8:11], s26 offen offset:3584 sc1
buffer_load_dwordx4 a[164:167], v28, s[8:11], s26 offen offset:3840 sc1
buffer_load_dwordx4 a[168:171], v28, s[8:11], s27 offen offset:0 sc1
buffer_load_dwordx4 a[172:175], v28, s[8:11], s27 offen offset:256 sc1
buffer_load_dwordx4 a[176:179], v28, s[8:11], s27 offen offset:512 sc1
buffer_load_dwordx4 a[180:183], v28, s[8:11], s27 offen offset:768 sc1
buffer_load_dwordx4 a[184:187], v28, s[8:11], s27 offen offset:1280 sc1
buffer_load_dwordx4 a[188:191], v28, s[8:11], s27 offen offset:1536 sc1
buffer_load_dwordx4 a[192:195], v28, s[8:11], s27 offen offset:1792 sc1
buffer_load_dwordx4 a[196:199], v28, s[8:11], s27 offen offset:2048 sc1
buffer_load_dwordx4 a[200:203], v28, s[8:11], s27 offen offset:2304 sc1
buffer_load_dwordx4 a[204:207], v28, s[8:11], s27 offen offset:2560 sc1
buffer_load_dwordx4 a[208:211], v28, s[8:11], s26 offen offset:1536 sc1
buffer_load_dwordx4 a[212:215], v28, s[8:11], s26 offen offset:3328 sc1
buffer_load_dwordx4 a[216:219], v28, s[8:11], s27 offen offset:1024 sc1
buffer_load_dwordx4 a[220:223], v28, s[8:11], s27 offen offset:2816 sc1
s_waitcnt vmcnt(27)
v_mfma_f32_32x32x16_bf16 v[80:95], a[112:115], v[128:131], 0
s_waitcnt vmcnt(26)
v_mfma_f32_32x32x16_bf16 v[80:95], a[116:119], v[132:135], v[80:95]
s_waitcnt vmcnt(25)
v_mfma_f32_32x32x16_bf16 v[80:95], a[120:123], v[136:139], v[80:95]
s_waitcnt vmcnt(24)
v_mfma_f32_32x32x16_bf16 v[80:95], a[124:127], v[140:143], v[80:95]
s_waitcnt vmcnt(23)
v_mfma_f32_32x32x16_bf16 v[80:95], a[128:131], v[144:147], v[80:95]
s_waitcnt vmcnt(22)
v_mfma_f32_32x32x16_bf16 v[80:95], a[132:135], v[148:151], v[80:95]
s_waitcnt vmcnt(21)
v_mfma_f32_32x32x16_bf16 v[80:95], a[136:139], v[152:155], v[80:95]
s_waitcnt vmcnt(20)
v_mfma_f32_32x32x16_bf16 v[80:95], a[140:143], v[156:159], v[80:95]
s_waitcnt vmcnt(19)
v_mfma_f32_32x32x16_bf16 v[80:95], a[144:147], v[160:163], v[80:95]
s_waitcnt vmcnt(18)
v_mfma_f32_32x32x16_bf16 v[80:95], a[148:151], v[164:167], v[80:95]
s_waitcnt vmcnt(17)
v_mfma_f32_32x32x16_bf16 v[80:95], a[152:155], v[168:171], v[80:95]
s_waitcnt vmcnt(16)
v_mfma_f32_32x32x16_bf16 v[80:95], a[156:159], v[172:175], v[80:95]
s_waitcnt vmcnt(15)
v_mfma_f32_32x32x16_bf16 v[80:95], a[160:163], v[176:179], v[80:95]
s_waitcnt vmcnt(14)
v_mfma_f32_32x32x16_bf16 v[80:95], a[164:167], v[180:183], v[80:95]
s_waitcnt vmcnt(13)
v_mfma_f32_32x32x16_bf16 v[80:95], a[168:171], v[184:187], v[80:95]
s_waitcnt vmcnt(12)
v_mfma_f32_32x32x16_bf16 v[80:95], a[172:175], v[188:191], v[80:95]
s_waitcnt vmcnt(11)
v_mfma_f32_32x32x16_bf16 v[80:95], a[176:179], v[192:195], v[80:95]
s_waitcnt vmcnt(10)
v_mfma_f32_32x32x16_bf16 v[80:95], a[180:183], v[196:199], v[80:95]
s_waitcnt vmcnt(9)
v_mfma_f32_32x32x16_bf16 v[80:95], a[184:187], v[200:203], v[80:95]
s_waitcnt vmcnt(8)
v_mfma_f32_32x32x16_bf16 v[80:95], a[188:191], v[204:207], v[80:95]
s_waitcnt vmcnt(7)
v_mfma_f32_32x32x16_bf16 v[80:95], a[192:195], v[208:211], v[80:95]
s_waitcnt vmcnt(6)
v_mfma_f32_32x32x16_bf16 v[80:95], a[196:199], v[212:215], v[80:95]
s_waitcnt vmcnt(5)
v_mfma_f32_32x32x16_bf16 v[80:95], a[200:203], v[216:219], v[80:95]
s_waitcnt vmcnt(4)
v_mfma_f32_32x32x16_bf16 v[80:95], a[204:207], v[220:223], v[80:95]
s_waitcnt vmcnt(3)
v_mfma_f32_32x32x16_bf16 v[80:95], a[208:211], v[224:227], v[80:95]
s_waitcnt vmcnt(2)
v_mfma_f32_32x32x16_bf16 v[80:95], a[212:215], v[228:231], v[80:95]
s_waitcnt vmcnt(1)
v_mfma_f32_32x32x16_bf16 v[80:95], a[216:219], v[232:235], v[80:95]
s_waitcnt vmcnt(0)
v_mfma_f32_32x32x16_bf16 v[80:95], a[220:223], v[236:239], v[80:95]
s_nop 11
v_cmp_u_f32 vcc, v80, v81
v_cmp_u_f32 s[62:63], v82, v83
v_max3_f32 v33, v80, v81, v82
v_max3_f32 v33, v33, v83, v32
s_nop 1
s_or_b64 vcc, vcc, s[62:63]
s_cbranch_scc0 Lso_74
s_sleep 1
s_sub_u32 s19, s19, 1
s_cbranch_scc0 Lsm_73
s_mov_b32 s19, 0
Lso_74:
v_mov_b32 v35, v33
s_nop 1
v_permlane32_swap_b32 v35, v33
v_max_f32 v33, v33, v35
v_sub_f32 v32, v32, v33
v_sub_f32 v80, v80, v33
v_sub_f32 v81, v81, v33
v_sub_f32 v82, v82, v33
v_sub_f32 v83, v83, v33
v_exp_f32 v32, v32
v_exp_f32 v80, v80
v_exp_f32 v81, v81
v_exp_f32 v82, v82
v_exp_f32 v83, v83
v_add_f32 v35, v80, v81
v_fmac_f32 v35, v34, v32
v_add_f32 v33, v82, v83
v_add_f32 v33, v33, v35
v_mov_b32 v35, v33
s_nop 1
v_permlane32_swap_b32 v35, v33
v_add_f32 v33, v33, v35
v_rcp_f32 v33, v33
s_nop 0
v_mul_f32 v32, v32, v33
v_pk_mul_f32 v[64:65], v[64:65], v[32:33] op_sel_hi:[1,0]
v_pk_mul_f32 v[66:67], v[66:67], v[32:33] op_sel_hi:[1,0]
v_pk_mul_f32 v[68:69], v[68:69], v[32:33] op_sel_hi:[1,0]
v_pk_mul_f32 v[70:71], v[70:71], v[32:33] op_sel_hi:[1,0]
v_pk_mul_f32 v[72:73], v[72:73], v[32:33] op_sel_hi:[1,0]
v_pk_mul_f32 v[74:75], v[74:75], v[32:33] op_sel_hi:[1,0]
v_pk_mul_f32 v[76:77], v[76:77], v[32:33] op_sel_hi:[1,0]
v_pk_mul_f32 v[78:79], v[78:79], v[32:33] op_sel_hi:[1,0]
v_pk_mul_f32 v[80:81], v[80:81], v[32:33] op_sel:[0,1] op_sel_hi:[1,1]
v_pk_mul_f32 v[82:83], v[82:83], v[32:33] op_sel:[0,1] op_sel_hi:[1,1]
v_cvt_pk_bf16_f32 v64, v64, v65
v_cvt_pk_bf16_f32 v65, v66, v67
v_cvt_pk_bf16_f32 v66, v68, v69
v_cvt_pk_bf16_f32 v67, v70, v71
v_cvt_pk_bf16_f32 v68, v72, v73
v_cvt_pk_bf16_f32 v69, v74, v75
v_cvt_pk_bf16_f32 v70, v76, v77
v_cvt_pk_bf16_f32 v71, v78, v79
v_cvt_pk_bf16_f32 v72, v80, v81
v_cvt_pk_bf16_f32 v73, v82, v83
buffer_store_dwordx4 v[64:67], v60, s[8:11], s33 offen sc1
buffer_store_dwordx4 v[68:71], v60, s[8:11], s33 offen offset:512 sc1
buffer_store_dwordx2 v[72:73], v61, s[8:11], s34 offen sc1
s_barrier
s_branch Lnext_23
Lend2:
s_endpgm
Lteam:

v_lshrrev_b32 v1, 6, v0
s_nop 0
v_readfirstlane_b32 s17, v1
v_and_b32 v1, 63, v0
v_lshlrev_b32 v2, 4, v1
s_lshl_b32 s30, s17, 1
s_add_u32 s31, s30, 0
s_cmp_ge_u32 s31, 7
s_cselect_b32 s32, 7, 0
s_sub_u32 s31, s31, s32
s_lshl_b32 s31, s31, 10
v_add_u32 v3, s31, v2
s_add_u32 s31, s30, 1
s_cmp_ge_u32 s31, 7
s_cselect_b32 s32, 7, 0
s_sub_u32 s31, s31, s32
s_lshl_b32 s31, s31, 10
v_add_u32 v4, s31, v2
s_add_u32 s31, s30, 2
s_cmp_ge_u32 s31, 7
s_cselect_b32 s32, 7, 0
s_sub_u32 s31, s31, s32
s_lshl_b32 s31, s31, 10
v_add_u32 v5, s31, v2
s_add_u32 s31, s30, 3
s_cmp_ge_u32 s31, 7
s_cselect_b32 s32, 7, 0
s_sub_u32 s31, s31, s32
s_lshl_b32 s31, s31, 10
v_add_u32 v6, s31, v2
s_add_u32 s31, s30, 4
s_cmp_ge_u32 s31, 7
s_cselect_b32 s32, 7, 0
s_sub_u32 s31, s31, s32
s_lshl_b32 s31, s31, 10
v_add_u32 v7, s31, v2
s_add_u32 s31, s30, 5
s_cmp_ge_u32 s31, 7
s_cselect_b32 s32, 7, 0
s_sub_u32 s31, s31, s32
s_lshl_b32 s31, s31, 10
v_add_u32 v8, s31, v2
s_add_u32 s31, s30, 6
s_cmp_ge_u32 s31, 7
s_cselect_b32 s32, 7, 0
s_sub_u32 s31, s31, s32
s_lshl_b32 s31, s31, 10
v_add_u32 v9, s31, v2

v_lshrrev_b32 v40, 4, v1
v_and_b32 v41, 15, v1
v_lshrrev_b32 v42, 3, v1
v_and_b32 v43, 7, v1
v_mov_b32 v10, 0x44444444
v_mov_b32 v44, 0xeeeeeeee
v_and_b32 v45, 2, v1
v_cmp_ne_u32 vcc, 0, v45
s_nop 1
v_cndmask_b32 v10, v10, v44, vcc
v_mov_b32 v13, 0
v_mov_b32 v14, 1
v_mov_b32 v20, -1
v_lshrrev_b32 v44, 1, v42
v_lshlrev_b32 v46, 6, v44
v_and_b32 v45, 1, v42
v_lshl_add_u32 v46, v45, 4, v46
v_and_b32 v45, 1, v43
v_lshl_add_u32 v47, v45, 5, v46
s_lshl_b32 s31, s17, 2
v_lshrrev_b32 v44, 0, v41
v_add_u32 v44, s31, v44
v_subrev_u32 v45, 14, v44
v_cmp_gt_u32 vcc, 14, v44
s_nop 1
v_cndmask_b32 v44, v45, v44, vcc
v_lshlrev_b32 v44, 7, v44
v_and_b32 v45, 0, v1
v_lshl_add_u32 v15, v45, 2, v44
v_add_u32 v15, 2048, v15
s_mov_b32 s18, 0
s_mov_b32 s19, 0x40000
s_mov_b32 s20, 54525952
s_mov_b32 s21, 54534144
s_mov_b32 s22, 54788096
s_mov_b32 s23, 54804480
s_mov_b32 s34, 54886400
s_mov_b32 s35, 54894592
s_mov_b32 s28, 53477376
s_sub_u32 s33, s16, 16
v_lshlrev_b32 v48, 1, v3
v_sub_u32 v48, v48, v2
v_lshlrev_b32 v49, 1, v4
v_sub_u32 v49, v49, v2
v_lshlrev_b32 v50, 1, v5
v_sub_u32 v50, v50, v2
v_lshlrev_b32 v51, 1, v6
v_sub_u32 v51, v51, v2
v_lshlrev_b32 v52, 1, v7
v_sub_u32 v52, v52, v2
v_lshlrev_b32 v53, 1, v8
v_sub_u32 v53, v53, v2
v_lshlrev_b32 v54, 1, v9
v_sub_u32 v54, v54, v2
s_cmp_ge_u32 s16, 30
s_cbranch_scc1 LPF_90
s_cmp_ge_u32 s16, 16
s_cbranch_scc1 LB_89

v_lshlrev_b32 v44, 6, v40
v_bfe_u32 v45, v41, 2, 1
v_lshl_add_u32 v44, v45, 5, v44
v_bfe_u32 v45, v41, 3, 1
v_lshl_add_u32 v44, v45, 2, v44
v_bfe_u32 v45, v41, 1, 1
v_lshl_add_u32 v44, v45, 3, v44
v_and_b32 v45, 1, v41
v_lshl_add_u32 v44, v45, 1, v44
s_lshl_b32 s31, s17, 11
s_add_u32 s31, s31, 8192
v_add_u32 v21, s31, v44
v_add_u32 v26, s31, v2
v_lshrrev_b32 v44, 3, v41
v_lshlrev_b32 v44, 8, v44
v_lshl_add_u32 v44, v40, 6, v44
v_bfe_u32 v45, v41, 1, 1
v_lshl_add_u32 v44, v45, 5, v44
v_bfe_u32 v45, v41, 2, 1
v_lshl_add_u32 v44, v45, 2, v44
v_and_b32 v45, 1, v41
v_lshl_add_u32 v44, v45, 3, v44
v_add_u32 v172, s31, v44
v_add_u32 v31, 1024, v172
v_lshlrev_b32 v44, 2, v1
v_add_u32 v44, s31, v44
ds_write_b32 v44, v13 offset:1792
v_lshlrev_b32 v44, 8, v40
v_and_b32 v45, 1, v41
v_lshl_add_u32 v44, v45, 2, v44
s_lshr_b32 s31, s17, 1
s_mul_i32 s31, s31, 1056
s_and_b32 s32, s17, 1
s_lshl_b32 s32, s32, 3
s_add_u32 s31, s31, s32
s_add_u32 s31, s31, 16384
v_add_u32 v44, s31, v44
v_lshrrev_b32 v45, 1, v41
v_lshl_add_u32 v173, v45, 4, v44
v_add_u32 v173, 4224, v173
v_bfe_u32 v45, v41, 1, 2
v_lshl_add_u32 v44, v45, 4, v44
v_lshrrev_b32 v45, 3, v41
v_mul_u32_u24 v45, 2112, v45
v_add_u32 v22, v44, v45
v_add_u32 v25, 16384, v2
v_bfe_u32 v45, v41, 1, 2
v_lshlrev_b32 v44, 6, v45
v_and_b32 v45, 1, v40
v_lshl_add_u32 v44, v45, 5, v44
v_and_b32 v45, 1, v41
v_lshl_add_u32 v44, v45, 4, v44
s_mul_i32 s31, s17, 1792
v_add_u32 v44, s31, v44
v_add_u32 v30, 1536, v44
v_lshrrev_b32 v45, 1, v40
v_lshl_add_u32 v23, v45, 8, v44
s_mul_i32 s31, s17, 14336
s_add_u32 s31, s31, 24576
v_add_u32 v24, s31, v2
v_mov_b32 v174, -1
v_mov_b32 v175, -1
v_bfe_u32 v45, v43, 1, 1
v_lshl_add_u32 v44, v45, 3, v47
v_lshrrev_b32 v45, 2, v43
v_lshl_add_u32 v44, v45, 8, v44
s_lshr_b32 s31, s16, 2
s_lshl_b32 s31, s31, 12
s_and_b32 s30, s16, 3
s_lshl_b32 s32, s30, 9
s_add_u32 s32, s32, s31
v_add_u32 v27, s32, v44
v_lshrrev_b32 v45, 1, v43
v_lshl_add_u32 v44, v45, 8, v46
v_and_b32 v45, 1, v43
v_lshl_add_u32 v44, v45, 3, v44
s_and_b32 s32, s30, 1
s_lshl_b32 s32, s32, 5
s_add_u32 s31, s31, s32
s_lshr_b32 s32, s30, 1
s_lshl_b32 s32, s32, 2
s_add_u32 s31, s31, s32
s_add_u32 s31, s31, 2048
v_add_u32 v44, s31, v44
v_mov_b32 v45, 1073741824
v_cmp_gt_u32 vcc, 4, v43
s_nop 1
v_cndmask_b32 v28, v45, v44, vcc
v_cndmask_b32 v29, 0, 1.0, vcc
s_lshl_b32 s31, s16, 7
v_mov_b32 v44, s31
v_mov_b32 v45, 1073741824
v_cmp_gt_u32 vcc, 1, v1
s_nop 1
v_cndmask_b32 v16, v45, v44, vcc
s_mul_i32 s31, s17, 3584
s_add_u32 s25, s31, 14680064
s_add_u32 s36, s25, 14336
s_lshr_b32 s30, s16, 1
s_and_b32 s31, s16, 1
s_add_u32 s31, s31, 1
s_cmp_eq_u32 s16, 6
s_cselect_b32 s31, 3, s31
s_cselect_b32 s30, 2, s30
s_cmp_eq_u32 s30, s17
s_cselect_b32 s37, s31, 0
s_lshl_b32 s30, s16, 15
s_add_u32 s38, s30, 17252352
s_mov_b32 s42, 458752
s_sub_u32 s30, s16, 14
s_mul_i32 s30, s30, 14336
s_add_u32 s30, s30, 14708736
s_cmp_ge_u32 s16, 14
s_cselect_b32 s38, s30, s38
s_cselect_b32 s42, 28672, s42
s_lshl_b32 s30, s17, 12
v_lshlrev_b32 v44, 7, v1
v_add_u32 v20, s30, v44
v_lshlrev_b32 v63, 7, v41
s_mov_b32 s31, 54865920
buffer_load_dword v64, v13, s[12:15], 0 offen offset:4 sc1
buffer_load_dword v65, v63, s[8:11], s31 offen sc1
s_lshl_b32 s30, s16, 6
s_lshl_b32 s31, s17, 2
s_add_u32 s30, s30, s31
v_and_b32 v44, 1, v1
v_lshlrev_b32 v44, 4, v44
v_add_u32 v44, s30, v44
s_mov_b32 s32, 54878208
Lpw_91:
buffer_load_dword v45, v44, s[8:11], s32 offen sc1
s_waitcnt vmcnt(0)
v_cmp_gt_u32 vcc, 1, v45
s_cbranch_vccz Lpo_92
s_sleep 1
s_sub_u32 s19, s19, 1
s_cbranch_scc0 Lpw_91
s_mov_b32 s19, 0
Lpo_92:
v_readfirstlane_b32 s41, v64
v_cmp_gt_u32 vcc, 16, v65
s_mov_b32 s43, 0
s_cbranch_vccnz Lxe_93
s_mov_b32 s43, 1
buffer_load_dwordx4 v[88:91], v2, s[8:11], s25 offen offset:0 sc1
buffer_load_dwordx4 v[92:95], v2, s[8:11], s25 offen offset:1024 sc1
buffer_load_dwordx4 v[96:99], v2, s[8:11], s25 offen offset:2048 sc1
buffer_load_dwordx4 v[100:103], v2, s[8:11], s25 offen offset:3072 sc1
buffer_load_dwordx4 v[104:107], v2, s[8:11], s36 offen offset:0 sc1
buffer_load_dwordx4 v[108:111], v2, s[8:11], s36 offen offset:1024 sc1
buffer_load_dwordx4 v[112:115], v2, s[8:11], s36 offen offset:2048 sc1
buffer_load_dwordx4 v[116:119], v2, s[8:11], s36 offen offset:3072 sc1
Lxe_93:
s_mul_i32 s30, s16, 401408
s_mul_i32 s31, s17, 100352
s_add_u32 s30, s30, s31
s_add_u32 s30, s30, 0
s_mul_i32 s32, s17, 14336
s_add_u32 s32, s32, 24576
s_add_u32 s31, s30, 0
buffer_load_dwordx4 a[0:3], v48, s[8:11], s31 offen sc1
buffer_load_dwordx4 a[4:7], v48, s[8:11], s31 offen offset:1024 sc1
buffer_load_dwordx4 a[8:11], v49, s[8:11], s31 offen sc1
buffer_load_dwordx4 a[12:15], v49, s[8:11], s31 offen offset:1024 sc1
buffer_load_dwordx4 a[16:19], v50, s[8:11], s31 offen sc1
buffer_load_dwordx4 a[20:23], v50, s[8:11], s31 offen offset:1024 sc1
buffer_load_dwordx4 a[24:27], v51, s[8:11], s31 offen sc1
buffer_load_dwordx4 a[28:31], v51, s[8:11], s31 offen offset:1024 sc1
buffer_load_dwordx4 a[32:35], v52, s[8:11], s31 offen sc1
buffer_load_dwordx4 a[36:39], v52, s[8:11], s31 offen offset:1024 sc1
buffer_load_dwordx4 a[40:43], v53, s[8:11], s31 offen sc1
buffer_load_dwordx4 a[44:47], v53, s[8:11], s31 offen offset:1024 sc1
buffer_load_dwordx4 a[48:51], v54, s[8:11], s31 offen sc1
buffer_load_dwordx4 a[52:55], v54, s[8:11], s31 offen offset:1024 sc1
s_waitcnt vmcnt(30)
s_add_u32 s31, s30, 14336
buffer_load_dwordx4 a[56:59], v48, s[8:11], s31 offen sc1
buffer_load_dwordx4 a[60:63], v48, s[8:11], s31 offen offset:1024 sc1
buffer_load_dwordx4 a[64:67], v49, s[8:11], s31 offen sc1
buffer_load_dwordx4 a[68:71], v49, s[8:11], s31 offen offset:1024 sc1
buffer_load_dwordx4 a[72:75], v50, s[8:11], s31 offen sc1
buffer_load_dwordx4 a[76:79], v50, s[8:11], s31 offen offset:1024 sc1
buffer_load_dwordx4 a[80:83], v51, s[8:11], s31 offen sc1
buffer_load_dwordx4 a[84:87], v51, s[8:11], s31 offen offset:1024 sc1
buffer_load_dwordx4 a[88:91], v52, s[8:11], s31 offen sc1
buffer_load_dwordx4 a[92:95], v52, s[8:11], s31 offen offset:1024 sc1
buffer_load_dwordx4 a[96:99], v53, s[8:11], s31 offen sc1
buffer_load_dwordx4 a[100:103], v53, s[8:11], s31 offen offset:1024 sc1
buffer_load_dwordx4 a[104:107], v54, s[8:11], s31 offen sc1
buffer_load_dwordx4 a[108:111], v54, s[8:11], s31 offen offset:1024 sc1
s_waitcnt vmcnt(30)
s_add_u32 s31, s30, 28672
buffer_load_dwordx4 a[112:115], v48, s[8:11], s31 offen sc1
buffer_load_dwordx4 a[116:119], v48, s[8:11], s31 offen offset:1024 sc1
buffer_load_dwordx4 a[120:123], v49, s[8:11], s31 offen sc1
buffer_load_dwordx4 a[124:127], v49, s[8:11], s31 offen offset:1024 sc1
buffer_load_dwordx4 a[128:131], v50, s[8:11], s31 offen sc1
buffer_load_dwordx4 a[132:135], v50, s[8:11], s31 offen offset:1024 sc1
buffer_load_dwordx4 a[136:139], v51, s[8:11], s31 offen sc1
buffer_load_dwordx4 a[140:143], v51, s[8:11], s31 offen offset:1024 sc1
buffer_load_dwordx4 a[144:147], v52, s[8:11], s31 offen sc1
buffer_load_dwordx4 a[148:151], v52, s[8:11], s31 offen offset:1024 sc1
buffer_load_dwordx4 a[152:155], v53, s[8:11], s31 offen sc1
buffer_load_dwordx4 a[156:159], v53, s[8:11], s31 offen offset:1024 sc1
buffer_load_dwordx4 a[160:163], v54, s[8:11], s31 offen sc1
buffer_load_dwordx4 a[164:167], v54, s[8:11], s31 offen offset:1024 sc1
s_waitcnt vmcnt(30)
s_add_u32 s31, s30, 43008
buffer_load_dwordx4 a[168:171], v48, s[8:11], s31 offen sc1
buffer_load_dwordx4 a[172:175], v48, s[8:11], s31 offen offset:1024 sc1
buffer_load_dwordx4 a[176:179], v49, s[8:11], s31 offen sc1
buffer_load_dwordx4 a[180:183], v49, s[8:11], s31 offen offset:1024 sc1
buffer_load_dwordx4 a[184:187], v50, s[8:11], s31 offen sc1
buffer_load_dwordx4 a[188:191], v50, s[8:11], s31 offen offset:1024 sc1
buffer_load_dwordx4 a[192:195], v51, s[8:11], s31 offen sc1
buffer_load_dwordx4 a[196:199], v51, s[8:11], s31 offen offset:1024 sc1
buffer_load_dwordx4 a[200:203], v52, s[8:11], s31 offen sc1
buffer_load_dwordx4 a[204:207], v52, s[8:11], s31 offen offset:1024 sc1
buffer_load_dwordx4 a[208:211], v53, s[8:11], s31 offen sc1
buffer_load_dwordx4 a[212:215], v53, s[8:11], s31 offen offset:1024 sc1
buffer_load_dwordx4 a[216:219], v54, s[8:11], s31 offen sc1
buffer_load_dwordx4 a[220:223], v54, s[8:11], s31 offen offset:1024 sc1
s_waitcnt vmcnt(30)
s_add_u32 s31, s30, 57344
buffer_load_dwordx4 a[224:227], v48, s[8:11], s31 offen sc1
buffer_load_dwordx4 a[228:231], v48, s[8:11], s31 offen offset:1024 sc1
buffer_load_dwordx4 a[232:235], v49, s[8:11], s31 offen sc1
buffer_load_dwordx4 a[236:239], v49, s[8:11], s31 offen offset:1024 sc1
buffer_load_dwordx4 a[240:243], v50, s[8:11], s31 offen sc1
buffer_load_dwordx4 a[244:247], v50, s[8:11], s31 offen offset:1024 sc1
buffer_load_dwordx4 a[248:251], v51, s[8:11], s31 offen sc1
buffer_load_dwordx4 a[252:255], v51, s[8:11], s31 offen offset:1024 sc1
buffer_load_dwordx4 v[176:179], v52, s[8:11], s31 offen sc1
buffer_load_dwordx4 v[180:183], v52, s[8:11], s31 offen offset:1024 sc1
buffer_load_dwordx4 v[184:187], v53, s[8:11], s31 offen sc1
buffer_load_dwordx4 v[188:191], v53, s[8:11], s31 offen offset:1024 sc1
buffer_load_dwordx4 v[192:195], v54, s[8:11], s31 offen sc1
buffer_load_dwordx4 v[196:199], v54, s[8:11], s31 offen offset:1024 sc1
s_waitcnt vmcnt(30)
s_add_u32 s31, s30, 71680
s_add_u32 m0, s32, 0
s_nop 0
buffer_load_dwordx4 v48, s[8:11], s31 offen sc1 lds
buffer_load_dwordx4 v48, s[8:11], s31 offen offset:1024 sc1 lds
s_add_u32 m0, s32, 2048
s_nop 0
buffer_load_dwordx4 v49, s[8:11], s31 offen sc1 lds
buffer_load_dwordx4 v49, s[8:11], s31 offen offset:1024 sc1 lds
s_add_u32 m0, s32, 4096
s_nop 0
buffer_load_dwordx4 v50, s[8:11], s31 offen sc1 lds
buffer_load_dwordx4 v50, s[8:11], s31 offen offset:1024 sc1 lds
s_add_u32 m0, s32, 6144
s_nop 0
buffer_load_dwordx4 v51, s[8:11], s31 offen sc1 lds
buffer_load_dwordx4 v51, s[8:11], s31 offen offset:1024 sc1 lds
s_add_u32 m0, s32, 8192
s_nop 0
buffer_load_dwordx4 v52, s[8:11], s31 offen sc1 lds
buffer_load_dwordx4 v52, s[8:11], s31 offen offset:1024 sc1 lds
s_add_u32 m0, s32, 10240
s_nop 0
buffer_load_dwordx4 v53, s[8:11], s31 offen sc1 lds
buffer_load_dwordx4 v53, s[8:11], s31 offen offset:1024 sc1 lds
s_add_u32 m0, s32, 12288
s_nop 0
buffer_load_dwordx4 v54, s[8:11], s31 offen sc1 lds
buffer_load_dwordx4 v54, s[8:11], s31 offen offset:1024 sc1 lds
s_waitcnt vmcnt(30)
s_add_u32 s31, s30, 86016
buffer_load_dwordx4 v[200:203], v48, s[8:11], s31 offen sc1
buffer_load_dwordx4 v[204:207], v48, s[8:11], s31 offen offset:1024 sc1
buffer_load_dwordx4 v[208:211], v49, s[8:11], s31 offen sc1
buffer_load_dwordx4 v[212:215], v49, s[8:11], s31 offen offset:1024 sc1
buffer_load_dwordx4 v[216:219], v50, s[8:11], s31 offen sc1
buffer_load_dwordx4 v[220:223], v50, s[8:11], s31 offen offset:1024 sc1
buffer_load_dwordx4 v[224:227], v51, s[8:11], s31 offen sc1
buffer_load_dwordx4 v[228:231], v51, s[8:11], s31 offen offset:1024 sc1
buffer_load_dwordx4 v[232:235], v52, s[8:11], s31 offen sc1
buffer_load_dwordx4 v[236:239], v52, s[8:11], s31 offen offset:1024 sc1
buffer_load_dwordx4 v[240:243], v53, s[8:11], s31 offen sc1
buffer_load_dwordx4 v[244:247], v53, s[8:11], s31 offen offset:1024 sc1
buffer_load_dwordx4 v[248:251], v54, s[8:11], s31 offen sc1
buffer_load_dwordx4 v[252:255], v54, s[8:11], s31 offen offset:1024 sc1
s_waitcnt vmcnt(30)
v_mov_b32 v60, 0
v_mov_b32 v61, 0
v_mov_b32 v62, 0
v_mov_b32 v63, 0
v_mov_b32 v64, 0
v_mov_b32 v65, 0
v_mov_b32 v66, 0
v_mov_b32 v67, 0
v_mov_b32 v68, 0
v_mov_b32 v69, 0
v_mov_b32 v70, 0
v_mov_b32 v71, 0
v_mov_b32 v72, 0
v_mov_b32 v73, 0
v_mov_b32 v74, 0
v_mov_b32 v75, 0
v_mov_b32 v76, 0
v_mov_b32 v77, 0
v_mov_b32 v78, 0
v_mov_b32 v79, 0
v_mov_b32 v80, 0
v_mov_b32 v81, 0
v_mov_b32 v82, 0
v_mov_b32 v83, 0
v_mov_b32 v84, 0
v_mov_b32 v85, 0
v_mov_b32 v86, 0
v_mov_b32 v87, 0
v_mov_b32 v160, 0
v_mov_b32 v161, 0
v_mov_b32 v162, 0
v_mov_b32 v163, 0
v_mov_b32 v164, 0
v_mov_b32 v165, 0
v_mov_b32 v166, 0
v_mov_b32 v167, 0
v_mov_b32 v168, 0
v_mov_b32 v169, 0
v_mov_b32 v170, 0
v_mov_b32 v171, 0
s_waitcnt vmcnt(0)
s_cmp_eq_u32 s43, 1
s_cbranch_scc1 Lxl_94
v_lshlrev_b32 v44, 7, v41
s_mov_b32 s32, 54865920
Lpw_95:
buffer_load_dword v45, v44, s[8:11], s32 offen sc1
s_waitcnt vmcnt(0)
v_cmp_gt_u32 vcc, 16, v45
s_cbranch_vccz Lpo_96
s_sleep 1
s_sub_u32 s19, s19, 1
s_cbranch_scc0 Lpw_95
s_mov_b32 s19, 0
Lpo_96:
buffer_load_dwordx4 v[88:91], v2, s[8:11], s25 offen offset:0 sc1
buffer_load_dwordx4 v[92:95], v2, s[8:11], s25 offen offset:1024 sc1
buffer_load_dwordx4 v[96:99], v2, s[8:11], s25 offen offset:2048 sc1
buffer_load_dwordx4 v[100:103], v2, s[8:11], s25 offen offset:3072 sc1
buffer_load_dwordx4 v[104:107], v2, s[8:11], s36 offen offset:0 sc1
buffer_load_dwordx4 v[108:111], v2, s[8:11], s36 offen offset:1024 sc1
buffer_load_dwordx4 v[112:115], v2, s[8:11], s36 offen offset:2048 sc1
buffer_load_dwordx4 v[116:119], v2, s[8:11], s36 offen offset:3072 sc1
Lxl_94:
s_cmp_lg_u32 s41, 0
s_cbranch_scc1 Lmk_97
s_mov_b32 s40, 20000
v_mov_b32 v40, 0
Lmw_98:
buffer_load_dword v42, v40, s[12:15], 0 offen offset:4 sc1
s_waitcnt vmcnt(0)
v_readfirstlane_b32 s41, v42
s_cmp_lg_u32 s41, 0
s_cbranch_scc1 Lmg_99
s_sleep 1
s_sub_u32 s40, s40, 1
s_cbranch_scc0 Lmw_98
v_mov_b32 v42, 2
v_mov_b32 v43, 0
buffer_atomic_cmpswap v[42:43], v40, s[12:15], 0 offen offset:4
s_waitcnt vmcnt(0)
s_mov_b32 s40, 20000
s_branch Lmw_98
Lmg_99:
Lmk_97:
s_barrier

s_cmp_eq_u32 s41, 1
s_cbranch_scc0 Lnx_100
s_cmp_eq_u32 s17, 3
s_cbranch_scc1 Lrole_79
s_branch Lrole_77
Lnx_100:
s_cmp_eq_u32 s17, 3
s_cbranch_scc1 Lrole_80
s_branch Lrole_78
Lnx_101:
LB_89:

s_lshl_b32 s31, s17, 12
v_add_u32 v21, s31, v2
v_and_b32 v44, 511, v2
s_add_u32 s31, s31, 2048
v_add_u32 v22, s31, v44
v_lshlrev_b32 v44, 7, v40
v_lshl_add_u32 v44, v41, 2, v44
s_lshl_b32 s31, s17, 9
s_add_u32 s31, s31, 8192
v_add_u32 v23, s31, v44
v_add_u32 v29, 2048, v23
s_and_b32 s30, s17, 1
s_lshl_b32 s31, s30, 11
s_add_u32 s31, s31, 8192
v_lshlrev_b32 v44, 3, v1
v_add_u32 v24, s31, v44
v_lshrrev_b32 v45, 1, v43
v_lshl_add_u32 v44, v45, 2, v47
s_lshl_b32 s31, s33, 1
s_add_u32 s31, s31, s30
s_lshl_b32 s31, s31, 8
v_add_u32 v25, s31, v44
s_lshl_b32 s31, s17, 15
s_add_u32 s31, s31, 16384
v_add_u32 v26, s31, v2
v_lshlrev_b32 v44, 7, v1
s_lshl_b32 s31, s33, 11
v_add_u32 v44, s31, v44
v_mov_b32 v45, 1073741824
v_cmp_gt_u32 vcc, 16, v1
s_nop 1
v_cndmask_b32 v27, v45, v44, vcc
s_cmp_eq_u32 s33, 0
s_cselect_b32 s31, 0, 1073741824
s_lshl_b32 s31, s33, 7
s_lshl_b32 s32, s17, 2
s_add_u32 s31, s31, s32
v_mov_b32 v44, s31
v_mov_b32 v45, 1073741824
v_cmp_gt_u32 vcc, 1, v1
s_nop 1
v_cndmask_b32 v16, v45, v44, vcc
v_lshrrev_b32 v44, 0, v1
s_xor_b32 s32, s33, 1
v_mov_b32 v45, s32
v_cmp_eq_u32 vcc, s33, v44
s_nop 1
v_cndmask_b32 v44, v44, v45, vcc
v_lshlrev_b32 v44, 7, v44
v_and_b32 v45, 0, v1
v_lshl_add_u32 v44, v45, 2, v44
s_cmp_eq_u32 s17, 0
s_cselect_b64 vcc, -1, 0
v_cndmask_b32 v15, v15, v44, vcc
v_and_b32 v44, 3, v1
s_lshl_b32 s32, s17, 2
v_add_u32 v44, s32, v44
v_lshlrev_b32 v31, 7, v44
s_lshl_b32 s30, s33, 15
s_add_u32 s24, s30, 16777216
s_add_u32 s39, s24, 16384
s_lshl_b32 s30, s33, 13
s_lshl_b32 s31, s17, 10
s_add_u32 s30, s30, s31
s_add_u32 s26, s30, 46137344
s_mov_b32 s27, 1073741824
s_mov_b32 s28, 1073741824
s_mov_b32 s29, 54853632
s_nop 0
s_lshl_b32 s30, s33, 1
s_mul_i32 s31, s30, 37
s_lshr_b32 s31, s31, 8
s_add_u32 s30, s30, 1
s_mul_i32 s30, s30, 37
s_lshr_b32 s30, s30, 8
s_sub_u32 s30, s30, s31
v_bfe_u32 v44, v1, 3, 1
v_mul_u32_u24 v44, s30, v44
v_add_u32 v44, s31, v44
v_and_b32 v45, 1, v1
v_lshl_add_u32 v44, v45, 2, v44
v_bfe_u32 v45, v1, 1, 2
v_lshl_add_u32 v44, v45, 4, v44
s_lshl_b32 s30, s17, 6
s_add_u32 s30, s30, 8
v_add_u32 v44, s30, v44
v_lshlrev_b32 v55, 2, v44
s_mov_b32 s43, 0
buffer_load_dword v64, v13, s[12:15], 0 offen offset:4 sc1
s_lshl_b32 s32, s17, 15
s_add_u32 s32, s32, 16384
v_mov_b32 v45, 1073741824
v_cmp_eq_u32 vcc, 0, v1
s_nop 1
v_cndmask_b32 v28, v45, v13, vcc
Ltw_102:
s_and_b32 s30, s43, 3
s_cmp_eq_u32 s30, 3
s_cbranch_scc1 Lto_103
s_mov_b32 s31, 54878208
buffer_load_dword v45, v55, s[8:11], s31 offen sc1
s_waitcnt vmcnt(0)
v_cmp_ne_u32 vcc, 0, v45
s_sub_u32 s19, s19, 1
s_cselect_b32 s30, -1, 0
s_max_i32 s19, s19, 0
s_nop 1
s_or_b32 s43, vcc_lo, s30
s_branch Ltw_102
Lto_103:
s_mul_i32 s30, s33, 458752
s_mul_i32 s31, s17, 57344
s_add_u32 s30, s30, s31
s_add_u32 s30, s30, 7340032
buffer_load_dwordx4 a[0:3], v48, s[8:11], s30 offen sc1
buffer_load_dwordx4 a[4:7], v48, s[8:11], s30 offen offset:1024 sc1
buffer_load_dwordx4 a[64:67], v49, s[8:11], s30 offen sc1
buffer_load_dwordx4 a[68:71], v49, s[8:11], s30 offen offset:1024 sc1
buffer_load_dwordx4 a[128:131], v50, s[8:11], s30 offen sc1
buffer_load_dwordx4 a[132:135], v50, s[8:11], s30 offen offset:1024 sc1
buffer_load_dwordx4 a[192:195], v51, s[8:11], s30 offen sc1
buffer_load_dwordx4 a[196:199], v51, s[8:11], s30 offen offset:1024 sc1
buffer_load_dwordx4 v[192:195], v52, s[8:11], s30 offen sc1
buffer_load_dwordx4 v[196:199], v52, s[8:11], s30 offen offset:1024 sc1
s_add_u32 m0, s32, 0
s_nop 0
buffer_load_dwordx4 v53, s[8:11], s30 offen sc1 lds
buffer_load_dwordx4 v53, s[8:11], s30 offen offset:1024 sc1 lds
s_add_u32 m0, s32, 16384
s_nop 0
buffer_load_dwordx4 v54, s[8:11], s30 offen sc1 lds
buffer_load_dwordx4 v54, s[8:11], s30 offen offset:1024 sc1 lds
s_waitcnt vmcnt(30)
Ltw_104:
s_and_b32 s30, s43, 12
s_cmp_eq_u32 s30, 12
s_cbranch_scc1 Lto_105
s_mov_b32 s31, 54878208
buffer_load_dword v45, v55, s[8:11], s31 offen sc1
s_waitcnt vmcnt(0)
v_cmp_ne_u32 vcc, 0, v45
s_sub_u32 s19, s19, 1
s_cselect_b32 s30, -1, 0
s_max_i32 s19, s19, 0
s_nop 1
s_or_b32 s43, vcc_lo, s30
s_branch Ltw_104
Lto_105:
s_mul_i32 s30, s33, 458752
s_mul_i32 s31, s17, 57344
s_add_u32 s30, s30, s31
s_add_u32 s30, s30, 7354368
buffer_load_dwordx4 a[8:11], v48, s[8:11], s30 offen sc1
buffer_load_dwordx4 a[12:15], v48, s[8:11], s30 offen offset:1024 sc1
buffer_load_dwordx4 a[72:75], v49, s[8:11], s30 offen sc1
buffer_load_dwordx4 a[76:79], v49, s[8:11], s30 offen offset:1024 sc1
buffer_load_dwordx4 a[136:139], v50, s[8:11], s30 offen sc1
buffer_load_dwordx4 a[140:143], v50, s[8:11], s30 offen offset:1024 sc1
buffer_load_dwordx4 a[200:203], v51, s[8:11], s30 offen sc1
buffer_load_dwordx4 a[204:207], v51, s[8:11], s30 offen offset:1024 sc1
buffer_load_dwordx4 v[200:203], v52, s[8:11], s30 offen sc1
buffer_load_dwordx4 v[204:207], v52, s[8:11], s30 offen offset:1024 sc1
s_add_u32 m0, s32, 2048
s_nop 0
buffer_load_dwordx4 v53, s[8:11], s30 offen sc1 lds
buffer_load_dwordx4 v53, s[8:11], s30 offen offset:1024 sc1 lds
s_add_u32 m0, s32, 18432
s_nop 0
buffer_load_dwordx4 v54, s[8:11], s30 offen sc1 lds
buffer_load_dwordx4 v54, s[8:11], s30 offen offset:1024 sc1 lds
s_waitcnt vmcnt(30)
Ltw_106:
s_and_b32 s30, s43, 48
s_cmp_eq_u32 s30, 48
s_cbranch_scc1 Lto_107
s_mov_b32 s31, 54878208
buffer_load_dword v45, v55, s[8:11], s31 offen sc1
s_waitcnt vmcnt(0)
v_cmp_ne_u32 vcc, 0, v45
s_sub_u32 s19, s19, 1
s_cselect_b32 s30, -1, 0
s_max_i32 s19, s19, 0
s_nop 1
s_or_b32 s43, vcc_lo, s30
s_branch Ltw_106
Lto_107:
s_mul_i32 s30, s33, 458752
s_mul_i32 s31, s17, 57344
s_add_u32 s30, s30, s31
s_add_u32 s30, s30, 7368704
buffer_load_dwordx4 a[16:19], v48, s[8:11], s30 offen sc1
buffer_load_dwordx4 a[20:23], v48, s[8:11], s30 offen offset:1024 sc1
buffer_load_dwordx4 a[80:83], v49, s[8:11], s30 offen sc1
buffer_load_dwordx4 a[84:87], v49, s[8:11], s30 offen offset:1024 sc1
buffer_load_dwordx4 a[144:147], v50, s[8:11], s30 offen sc1
buffer_load_dwordx4 a[148:151], v50, s[8:11], s30 offen offset:1024 sc1
buffer_load_dwordx4 a[208:211], v51, s[8:11], s30 offen sc1
buffer_load_dwordx4 a[212:215], v51, s[8:11], s30 offen offset:1024 sc1
buffer_load_dwordx4 v[208:211], v52, s[8:11], s30 offen sc1
buffer_load_dwordx4 v[212:215], v52, s[8:11], s30 offen offset:1024 sc1
s_add_u32 m0, s32, 4096
s_nop 0
buffer_load_dwordx4 v53, s[8:11], s30 offen sc1 lds
buffer_load_dwordx4 v53, s[8:11], s30 offen offset:1024 sc1 lds
s_add_u32 m0, s32, 20480
s_nop 0
buffer_load_dwordx4 v54, s[8:11], s30 offen sc1 lds
buffer_load_dwordx4 v54, s[8:11], s30 offen offset:1024 sc1 lds
s_waitcnt vmcnt(30)
Ltw_108:
s_and_b32 s30, s43, 192
s_cmp_eq_u32 s30, 192
s_cbranch_scc1 Lto_109
s_mov_b32 s31, 54878208
buffer_load_dword v45, v55, s[8:11], s31 offen sc1
s_waitcnt vmcnt(0)
v_cmp_ne_u32 vcc, 0, v45
s_sub_u32 s19, s19, 1
s_cselect_b32 s30, -1, 0
s_max_i32 s19, s19, 0
s_nop 1
s_or_b32 s43, vcc_lo, s30
s_branch Ltw_108
Lto_109:
s_mul_i32 s30, s33, 458752
s_mul_i32 s31, s17, 57344
s_add_u32 s30, s30, s31
s_add_u32 s30, s30, 7383040
buffer_load_dwordx4 a[24:27], v48, s[8:11], s30 offen sc1
buffer_load_dwordx4 a[28:31], v48, s[8:11], s30 offen offset:1024 sc1
buffer_load_dwordx4 a[88:91], v49, s[8:11], s30 offen sc1
buffer_load_dwordx4 a[92:95], v49, s[8:11], s30 offen offset:1024 sc1
buffer_load_dwordx4 a[152:155], v50, s[8:11], s30 offen sc1
buffer_load_dwordx4 a[156:159], v50, s[8:11], s30 offen offset:1024 sc1
buffer_load_dwordx4 a[216:219], v51, s[8:11], s30 offen sc1
buffer_load_dwordx4 a[220:223], v51, s[8:11], s30 offen offset:1024 sc1
buffer_load_dwordx4 v[216:219], v52, s[8:11], s30 offen sc1
buffer_load_dwordx4 v[220:223], v52, s[8:11], s30 offen offset:1024 sc1
s_add_u32 m0, s32, 6144
s_nop 0
buffer_load_dwordx4 v53, s[8:11], s30 offen sc1 lds
buffer_load_dwordx4 v53, s[8:11], s30 offen offset:1024 sc1 lds
s_add_u32 m0, s32, 22528
s_nop 0
buffer_load_dwordx4 v54, s[8:11], s30 offen sc1 lds
buffer_load_dwordx4 v54, s[8:11], s30 offen offset:1024 sc1 lds
s_waitcnt vmcnt(30)
Ltw_110:
s_and_b32 s30, s43, 768
s_cmp_eq_u32 s30, 768
s_cbranch_scc1 Lto_111
s_mov_b32 s31, 54878208
buffer_load_dword v45, v55, s[8:11], s31 offen sc1
s_waitcnt vmcnt(0)
v_cmp_ne_u32 vcc, 0, v45
s_sub_u32 s19, s19, 1
s_cselect_b32 s30, -1, 0
s_max_i32 s19, s19, 0
s_nop 1
s_or_b32 s43, vcc_lo, s30
s_branch Ltw_110
Lto_111:
s_mul_i32 s30, s33, 458752
s_mul_i32 s31, s17, 57344
s_add_u32 s30, s30, s31
s_add_u32 s30, s30, 7569408
buffer_load_dwordx4 a[32:35], v48, s[8:11], s30 offen sc1
buffer_load_dwordx4 a[36:39], v48, s[8:11], s30 offen offset:1024 sc1
buffer_load_dwordx4 a[96:99], v49, s[8:11], s30 offen sc1
buffer_load_dwordx4 a[100:103], v49, s[8:11], s30 offen offset:1024 sc1
buffer_load_dwordx4 a[160:163], v50, s[8:11], s30 offen sc1
buffer_load_dwordx4 a[164:167], v50, s[8:11], s30 offen offset:1024 sc1
buffer_load_dwordx4 a[224:227], v51, s[8:11], s30 offen sc1
buffer_load_dwordx4 a[228:231], v51, s[8:11], s30 offen offset:1024 sc1
buffer_load_dwordx4 v[224:227], v52, s[8:11], s30 offen sc1
buffer_load_dwordx4 v[228:231], v52, s[8:11], s30 offen offset:1024 sc1
s_add_u32 m0, s32, 8192
s_nop 0
buffer_load_dwordx4 v53, s[8:11], s30 offen sc1 lds
buffer_load_dwordx4 v53, s[8:11], s30 offen offset:1024 sc1 lds
s_add_u32 m0, s32, 24576
s_nop 0
buffer_load_dwordx4 v54, s[8:11], s30 offen sc1 lds
buffer_load_dwordx4 v54, s[8:11], s30 offen offset:1024 sc1 lds
s_waitcnt vmcnt(30)
Ltw_112:
s_and_b32 s30, s43, 3072
s_cmp_eq_u32 s30, 3072
s_cbranch_scc1 Lto_113
s_mov_b32 s31, 54878208
buffer_load_dword v45, v55, s[8:11], s31 offen sc1
s_waitcnt vmcnt(0)
v_cmp_ne_u32 vcc, 0, v45
s_sub_u32 s19, s19, 1
s_cselect_b32 s30, -1, 0
s_max_i32 s19, s19, 0
s_nop 1
s_or_b32 s43, vcc_lo, s30
s_branch Ltw_112
Lto_113:
s_mul_i32 s30, s33, 458752
s_mul_i32 s31, s17, 57344
s_add_u32 s30, s30, s31
s_add_u32 s30, s30, 7583744
buffer_load_dwordx4 a[40:43], v48, s[8:11], s30 offen sc1
buffer_load_dwordx4 a[44:47], v48, s[8:11], s30 offen offset:1024 sc1
buffer_load_dwordx4 a[104:107], v49, s[8:11], s30 offen sc1
buffer_load_dwordx4 a[108:111], v49, s[8:11], s30 offen offset:1024 sc1
buffer_load_dwordx4 a[168:171], v50, s[8:11], s30 offen sc1
buffer_load_dwordx4 a[172:175], v50, s[8:11], s30 offen offset:1024 sc1
buffer_load_dwordx4 a[232:235], v51, s[8:11], s30 offen sc1
buffer_load_dwordx4 a[236:239], v51, s[8:11], s30 offen offset:1024 sc1
buffer_load_dwordx4 v[232:235], v52, s[8:11], s30 offen sc1
buffer_load_dwordx4 v[236:239], v52, s[8:11], s30 offen offset:1024 sc1
s_add_u32 m0, s32, 10240
s_nop 0
buffer_load_dwordx4 v53, s[8:11], s30 offen sc1 lds
buffer_load_dwordx4 v53, s[8:11], s30 offen offset:1024 sc1 lds
s_add_u32 m0, s32, 26624
s_nop 0
buffer_load_dwordx4 v54, s[8:11], s30 offen sc1 lds
buffer_load_dwordx4 v54, s[8:11], s30 offen offset:1024 sc1 lds
s_waitcnt vmcnt(30)
Ltw_114:
s_and_b32 s30, s43, 12288
s_cmp_eq_u32 s30, 12288
s_cbranch_scc1 Lto_115
s_mov_b32 s31, 54878208
buffer_load_dword v45, v55, s[8:11], s31 offen sc1
s_waitcnt vmcnt(0)
v_cmp_ne_u32 vcc, 0, v45
s_sub_u32 s19, s19, 1
s_cselect_b32 s30, -1, 0
s_max_i32 s19, s19, 0
s_nop 1
s_or_b32 s43, vcc_lo, s30
s_branch Ltw_114
Lto_115:
s_mul_i32 s30, s33, 458752
s_mul_i32 s31, s17, 57344
s_add_u32 s30, s30, s31
s_add_u32 s30, s30, 7598080
buffer_load_dwordx4 a[48:51], v48, s[8:11], s30 offen sc1
buffer_load_dwordx4 a[52:55], v48, s[8:11], s30 offen offset:1024 sc1
buffer_load_dwordx4 a[112:115], v49, s[8:11], s30 offen sc1
buffer_load_dwordx4 a[116:119], v49, s[8:11], s30 offen offset:1024 sc1
buffer_load_dwordx4 a[176:179], v50, s[8:11], s30 offen sc1
buffer_load_dwordx4 a[180:183], v50, s[8:11], s30 offen offset:1024 sc1
buffer_load_dwordx4 a[240:243], v51, s[8:11], s30 offen sc1
buffer_load_dwordx4 a[244:247], v51, s[8:11], s30 offen offset:1024 sc1
buffer_load_dwordx4 v[240:243], v52, s[8:11], s30 offen sc1
buffer_load_dwordx4 v[244:247], v52, s[8:11], s30 offen offset:1024 sc1
s_add_u32 m0, s32, 12288
s_nop 0
buffer_load_dwordx4 v53, s[8:11], s30 offen sc1 lds
buffer_load_dwordx4 v53, s[8:11], s30 offen offset:1024 sc1 lds
s_add_u32 m0, s32, 28672
s_nop 0
buffer_load_dwordx4 v54, s[8:11], s30 offen sc1 lds
buffer_load_dwordx4 v54, s[8:11], s30 offen offset:1024 sc1 lds
s_waitcnt vmcnt(30)
Ltw_116:
s_and_b32 s30, s43, 49152
s_cmp_eq_u32 s30, 49152
s_cbranch_scc1 Lto_117
s_mov_b32 s31, 54878208
buffer_load_dword v45, v55, s[8:11], s31 offen sc1
s_waitcnt vmcnt(0)
v_cmp_ne_u32 vcc, 0, v45
s_sub_u32 s19, s19, 1
s_cselect_b32 s30, -1, 0
s_max_i32 s19, s19, 0
s_nop 1
s_or_b32 s43, vcc_lo, s30
s_branch Ltw_116
Lto_117:
s_mul_i32 s30, s33, 458752
s_mul_i32 s31, s17, 57344
s_add_u32 s30, s30, s31
s_add_u32 s30, s30, 7612416
buffer_load_dwordx4 a[56:59], v48, s[8:11], s30 offen sc1
buffer_load_dwordx4 a[60:63], v48, s[8:11], s30 offen offset:1024 sc1
buffer_load_dwordx4 a[120:123], v49, s[8:11], s30 offen sc1
buffer_load_dwordx4 a[124:127], v49, s[8:11], s30 offen offset:1024 sc1
buffer_load_dwordx4 a[184:187], v50, s[8:11], s30 offen sc1
buffer_load_dwordx4 a[188:191], v50, s[8:11], s30 offen offset:1024 sc1
buffer_load_dwordx4 a[248:251], v51, s[8:11], s30 offen sc1
buffer_load_dwordx4 a[252:255], v51, s[8:11], s30 offen offset:1024 sc1
buffer_load_dwordx4 v[248:251], v52, s[8:11], s30 offen sc1
buffer_load_dwordx4 v[252:255], v52, s[8:11], s30 offen offset:1024 sc1
s_add_u32 m0, s32, 14336
s_nop 0
buffer_load_dwordx4 v53, s[8:11], s30 offen sc1 lds
buffer_load_dwordx4 v53, s[8:11], s30 offen offset:1024 sc1 lds
s_add_u32 m0, s32, 30720
s_nop 0
buffer_load_dwordx4 v54, s[8:11], s30 offen sc1 lds
buffer_load_dwordx4 v54, s[8:11], s30 offen offset:1024 sc1 lds
s_waitcnt vmcnt(30)
v_readfirstlane_b32 s41, v64
buffer_load_dword v30, v13, s[8:11], s29 offen sc1
v_mov_b32 v140, -1
v_mov_b32 v141, -1
v_mov_b32 v142, -1
v_mov_b32 v143, -1
s_add_u32 s30, s26, 7110656
buffer_store_dwordx4 v[140:143], v2, s[8:11], s30 offen sc1
s_add_u32 s30, s26, 7114752
buffer_store_dwordx4 v[140:143], v2, s[8:11], s30 offen sc1
s_add_u32 s30, s26, 7225344
buffer_store_dwordx4 v[140:143], v2, s[8:11], s30 offen sc1
s_add_u32 s30, s26, 7229440
buffer_store_dwordx4 v[140:143], v2, s[8:11], s30 offen sc1
v_mov_b32 v60, 0
v_mov_b32 v61, 0
v_mov_b32 v62, 0
v_mov_b32 v63, 0
v_mov_b32 v64, 0
v_mov_b32 v65, 0
v_mov_b32 v66, 0
v_mov_b32 v67, 0
v_mov_b32 v68, 0
v_mov_b32 v69, 0
v_mov_b32 v70, 0
v_mov_b32 v71, 0
v_mov_b32 v72, 0
v_mov_b32 v73, 0
v_mov_b32 v74, 0
v_mov_b32 v75, 0
v_mov_b32 v76, 0
v_mov_b32 v77, 0
v_mov_b32 v78, 0
v_mov_b32 v79, 0
v_mov_b32 v80, 0
v_mov_b32 v81, 0
v_mov_b32 v82, 0
v_mov_b32 v83, 0
v_mov_b32 v84, 0
v_mov_b32 v85, 0
v_mov_b32 v86, 0
v_mov_b32 v87, 0
v_mov_b32 v88, 0
v_mov_b32 v89, 0
v_mov_b32 v90, 0
v_mov_b32 v91, 0
v_mov_b32 v124, 0
v_mov_b32 v125, 0
v_mov_b32 v126, 0
v_mov_b32 v127, 0
v_mov_b32 v128, 0
v_mov_b32 v129, 0
v_mov_b32 v130, 0
v_mov_b32 v131, 0
v_mov_b32 v132, 0
v_mov_b32 v133, 0
v_mov_b32 v134, 0
v_mov_b32 v135, 0
v_mov_b32 v136, 0
v_mov_b32 v137, 0
v_mov_b32 v138, 0
v_mov_b32 v139, 0
v_mov_b32 v152, 0
v_mov_b32 v153, 0
v_mov_b32 v154, 0
v_mov_b32 v155, 0
v_mov_b32 v156, 0
v_mov_b32 v157, 0
v_mov_b32 v158, 0
v_mov_b32 v159, 0
v_mov_b32 v148, 0
v_mov_b32 v149, 0
v_mov_b32 v150, 0
v_mov_b32 v151, 0
s_waitcnt vmcnt(0)
s_cmp_lg_u32 s41, 0
s_cbranch_scc1 Lmk_118
s_mov_b32 s40, 20000
v_mov_b32 v40, 0
Lmw_119:
buffer_load_dword v42, v40, s[12:15], 0 offen offset:4 sc1
s_waitcnt vmcnt(0)
v_readfirstlane_b32 s41, v42
s_cmp_lg_u32 s41, 0
s_cbranch_scc1 Lmg_120
s_sleep 1
s_sub_u32 s40, s40, 1
s_cbranch_scc0 Lmw_119
v_mov_b32 v42, 2
v_mov_b32 v43, 0
buffer_atomic_cmpswap v[42:43], v40, s[12:15], 0 offen offset:4
s_waitcnt vmcnt(0)
s_mov_b32 s40, 20000
s_branch Lmw_119
Lmg_120:
Lmk_118:
s_barrier

s_cmp_eq_u32 s41, 1
s_cbranch_scc0 Lnx_121
s_cmp_eq_u32 s17, 1
s_cbranch_scc1 Lrole_83
s_cmp_eq_u32 s17, 2
s_cbranch_scc1 Lrole_85
s_cmp_eq_u32 s17, 3
s_cbranch_scc1 Lrole_87
s_branch Lrole_81
Lnx_121:
s_cmp_eq_u32 s17, 1
s_cbranch_scc1 Lrole_84
s_cmp_eq_u32 s17, 2
s_cbranch_scc1 Lrole_86
s_cmp_eq_u32 s17, 3
s_cbranch_scc1 Lrole_88
s_branch Lrole_82
Lnx_122:
LPF_90:
s_sub_u32 s30, s16, 30
s_lshl_b32 s30, s30, 2
s_add_u32 s30, s30, s17
s_cmp_eq_u32 s30, 0
s_cbranch_scc1 Lpub_1280
s_cmp_eq_u32 s30, 1
s_cbranch_scc1 Lpub_1281
s_cmp_lt_u32 s30, 7
s_cbranch_scc1 Lcode_129
s_mul_i32 s25, s30, 7
s_sub_u32 s25, s25, 14
s_add_u32 s36, s25, 7
s_mul_i32 s31, s30, 5
s_sub_u32 s31, s31, 6
s_add_u32 s32, s31, 5
s_min_u32 s32, s32, 28
s_cmp_ge_u32 s30, 4
s_cselect_b32 s25, s31, s25
s_cselect_b32 s36, s32, s36
s_mov_b32 s24, 16793600
s_mov_b32 s39, 458752
s_mov_b32 s28, 32768
s_cmp_eq_u32 s30, 7
s_cselect_b32 s24, 14680064, s24
s_cselect_b32 s39, 28672, s39
s_cselect_b32 s28, 16384, s28
s_cselect_b32 s25, 0, s25
s_cselect_b32 s36, 4, s36
v_lshlrev_b32 v21, 7, v1
s_mov_b32 s29, 54853632
Lpf_123:
s_cmp_lt_u32 s18, 3
s_cbranch_scc1 Lpfg_126
s_sub_u32 s30, s18, 2
Lpfw_124:
buffer_load_dword v25, v13, s[8:11], s34 offen sc1
s_waitcnt vmcnt(0)
v_cmp_gt_u32 vcc, s30, v25
s_cbranch_vccz Lpfg_126
s_sleep 1
s_sub_u32 s19, s19, 1
s_cbranch_scc0 Lpfw_124
s_mov_b32 s19, 0
Lpfg_126:
s_sleep 0
s_and_b32 s30, s18, 3
s_cbranch_scc1 Lpfg2_127
Lpfc_125:
buffer_load_dword v25, v13, s[8:11], s29 offen sc1
s_waitcnt vmcnt(0)
v_cmp_gt_u32 vcc, 32, v25
s_cbranch_vccz Lpfc_125x
s_sleep 4
s_sub_u32 s19, s19, 1
s_cbranch_scc0 Lpfc_125
s_mov_b32 s19, 0
Lpfc_125x:
s_add_u32 s29, s29, 128
Lpfg2_127:
s_mov_b32 s30, s25
Lpfg2_127l:
s_lshr_b32 s31, s30, 1
s_mul_i32 s31, s31, s28
s_and_b32 s32, s30, 1
s_lshl_b32 s32, s32, 13
s_add_u32 s31, s31, s32
s_add_u32 s31, s31, s24
buffer_load_dword v26, v21, s[8:11], s31 offen
s_add_u32 s30, s30, 1
s_cmp_lt_u32 s30, s36
s_cbranch_scc1 Lpfg2_127l
s_add_u32 s24, s24, s39
s_add_u32 s18, s18, 1
s_cmp_lt_u32 s18, 63
s_cbranch_scc1 Lpf_123
s_branch Lend
Lcode_129:
s_getpc_b64 s[44:45]
Lcode_129pc:
s_add_u32 s44, s44, Lteamcode-Lcode_129pc
s_addc_u32 s45, s45, 0
s_sub_u32 s30, s30, 2
s_lshl_b32 s30, s30, 13
v_lshlrev_b32 v21, 7, v1
v_add_u32 v21, s30, v21
v_min_u32 v21, Lteamend-Lteamcode-4, v21
global_load_dword v22, v21, s[44:45]
s_waitcnt vmcnt(0)
s_branch Lend
Lpub_1280:
v_lshrrev_b32 v21, 2, v1
v_lshlrev_b32 v21, 7, v21
v_and_b32 v22, 3, v1
v_lshl_add_u32 v21, v22, 2, v21
v_mov_b32 v24, 1073741824
v_cmp_eq_u32 vcc, 0, v1
s_nop 1
v_cndmask_b32 v24, v24, v13, vcc
s_mov_b32 s31, 54858880
s_mov_b32 s18, 2
s_mov_b32 exec_lo, 4294967295
s_mov_b32 exec_hi, 16777215
Lpub_1280p:
buffer_load_dword v22, v21, s[8:11], s34 offen sc1
s_waitcnt vmcnt(0)
v_cmp_gt_u32 vcc, s18, v22
s_cbranch_vccz Lpub_1280g
s_sleep 1
s_sub_u32 s19, s19, 1
s_cbranch_scc0 Lpub_1280p
s_mov_b32 s19, 0
Lpub_1280g:
s_add_u32 s18, s18, 1
s_cmp_gt_u32 s18, 65
s_cbranch_scc1 Lpub_1280h
v_cmp_gt_u32 vcc, s18, v22
s_cbranch_vccz Lpub_1280g
Lpub_1280h:
s_sub_u32 s32, s18, 2
v_mov_b32 v23, s32
buffer_atomic_umax v23, v24, s[8:11], s31 offen
s_cmp_le_u32 s18, 65
s_cbranch_scc1 Lpub_1280p
s_branch Lend
Lpub_1281:
v_lshrrev_b32 v21, 0, v1
v_lshlrev_b32 v21, 7, v21
v_and_b32 v22, 0, v1
v_lshl_add_u32 v21, v22, 2, v21
v_mov_b32 v24, 1073741824
v_cmp_eq_u32 vcc, 0, v1
s_nop 1
v_cndmask_b32 v24, v24, v13, vcc
s_mov_b32 s31, 54857856
s_mov_b32 s18, 1
s_mov_b32 exec_lo, 65535
s_mov_b32 exec_hi, 0
Lpub_1281p:
buffer_load_dword v22, v21, s[8:11], s35 offen sc1
s_waitcnt vmcnt(0)
v_cmp_gt_u32 vcc, s18, v22
s_cbranch_vccz Lpub_1281g
s_sleep 1
s_sub_u32 s19, s19, 1
s_cbranch_scc0 Lpub_1281p
s_mov_b32 s19, 0
Lpub_1281g:
s_add_u32 s18, s18, 1
s_cmp_gt_u32 s18, 63
s_cbranch_scc1 Lpub_1281h
v_cmp_gt_u32 vcc, s18, v22
s_cbranch_vccz Lpub_1281g
Lpub_1281h:
s_sub_u32 s32, s18, 1
v_mov_b32 v23, s32
buffer_atomic_umax v23, v24, s[8:11], s31 offen
s_cmp_le_u32 s18, 63
s_cbranch_scc1 Lpub_1281p
s_branch Lend
.p2align 6
Lteamcode:
.p2align 6
Lrole_77:
ds_read_b128 v[144:147], v24 offset:0
ds_read_b128 v[148:151], v24 offset:1024
ds_read_b128 v[152:155], v24 offset:2048
ds_read_b128 v[156:159], v24 offset:3072
s_waitcnt lgkmcnt(0)
Ltop_130:
Lmp_131:
buffer_load_dwordx4 v[32:35], v3, s[8:11], s20 offen sc1
buffer_load_dwordx4 v[36:39], v4, s[8:11], s20 offen sc1
s_nop 15
s_nop 15
buffer_load_dwordx4 v[136:139], v3, s[8:11], s20 offen sc1
buffer_load_dwordx4 v[140:143], v4, s[8:11], s20 offen sc1
s_waitcnt vmcnt(2)
v_max_u32 v11, v35, v39
v_cmp_eq_u32 vcc, -1, v11
s_cbranch_vccnz Lmp_131b
Lma_133:
ds_write_b128 v3, v[32:35] offset:0
ds_write_b128 v4, v[36:39] offset:0
v_smfmac_f32_16x16x64_bf16 v[84:87], v[32:35], v[144:151], v10
v_max3_u32 v11, v32, v33, v34
v_smfmac_f32_16x16x64_bf16 v[60:63], v[32:35], a[0:7], v10
v_max3_u32 v11, v11, v36, v37
v_smfmac_f32_16x16x64_bf16 v[64:67], v[32:35], a[56:63], v10
v_max_u32 v11, v11, v38
v_cmp_eq_u32 vcc, -1, v11
v_smfmac_f32_16x16x64_bf16 v[68:71], v[32:35], a[112:119], v10
v_smfmac_f32_16x16x64_bf16 v[72:75], v[32:35], a[168:175], v10
s_cbranch_vccnz Lmr2_134
Lma2_135:
s_waitcnt lgkmcnt(0)
s_barrier
ds_read_b128 v[40:43], v5 offset:0
ds_read_b128 v[44:47], v6 offset:0
v_smfmac_f32_16x16x64_bf16 v[76:79], v[32:35], a[224:231], v10
ds_read_b128 v[48:51], v7 offset:0
v_smfmac_f32_16x16x64_bf16 v[80:83], v[32:35], v[200:207], v10
ds_read_b128 v[52:55], v8 offset:0
v_smfmac_f32_16x16x64_bf16 v[84:87], v[36:39], v[152:159], v10
ds_read_b128 v[56:59], v9 offset:0
v_smfmac_f32_16x16x64_bf16 v[60:63], v[36:39], a[8:15], v10
ds_read_b128 v[144:147], v24 offset:4096
v_smfmac_f32_16x16x64_bf16 v[64:67], v[36:39], a[64:71], v10
ds_read_b128 v[148:151], v24 offset:5120
v_smfmac_f32_16x16x64_bf16 v[68:71], v[36:39], a[120:127], v10
ds_read_b128 v[152:155], v24 offset:6144
v_smfmac_f32_16x16x64_bf16 v[72:75], v[36:39], a[176:183], v10
ds_read_b128 v[156:159], v24 offset:7168
v_smfmac_f32_16x16x64_bf16 v[76:79], v[36:39], a[232:239], v10
v_smfmac_f32_16x16x64_bf16 v[80:83], v[36:39], v[208:215], v10
s_waitcnt lgkmcnt(4)
v_smfmac_f32_16x16x64_bf16 v[60:63], v[40:43], a[16:23], v10
ds_read_b128 v[120:123], v23 offset:0
v_smfmac_f32_16x16x64_bf16 v[60:63], v[44:47], a[24:31], v10
ds_read_b128 v[124:127], v23 offset:512
v_smfmac_f32_16x16x64_bf16 v[60:63], v[48:51], a[32:39], v10
ds_read_b128 v[128:131], v23 offset:1024
v_smfmac_f32_16x16x64_bf16 v[60:63], v[52:55], a[40:47], v10
ds_read_b128 v[132:135], v30 offset:0
v_smfmac_f32_16x16x64_bf16 v[60:63], v[56:59], a[48:55], v10
s_waitcnt lgkmcnt(6)
v_smfmac_f32_16x16x64_bf16 v[84:87], v[40:43], v[144:151], v10
v_smfmac_f32_16x16x64_bf16 v[64:67], v[40:43], a[72:79], v10
ds_read_b128 v[144:147], v24 offset:8192
s_nop 0
v_smfmac_f32_16x16x64_bf16 v[64:67], v[44:47], a[80:87], v10
ds_read_b128 v[148:151], v24 offset:9216
v_smfmac_f32_16x16x64_bf16 v[64:67], v[48:51], a[88:95], v10
v_add_f32 v60, v60, v62
v_smfmac_f32_16x16x64_bf16 v[64:67], v[52:55], a[96:103], v10
v_add_f32 v61, v61, v63
v_smfmac_f32_16x16x64_bf16 v[64:67], v[56:59], a[104:111], v10
s_waitcnt lgkmcnt(6)
v_smfmac_f32_16x16x64_bf16 v[84:87], v[44:47], v[152:159], v10
v_smfmac_f32_16x16x64_bf16 v[68:71], v[40:43], a[128:135], v10
ds_read_b128 v[152:155], v24 offset:10240
s_nop 0
v_smfmac_f32_16x16x64_bf16 v[68:71], v[44:47], a[136:143], v10
ds_read_b128 v[156:159], v24 offset:11264
v_smfmac_f32_16x16x64_bf16 v[68:71], v[48:51], a[144:151], v10
v_add_f32 v64, v64, v66
v_smfmac_f32_16x16x64_bf16 v[68:71], v[52:55], a[152:159], v10
v_add_f32 v65, v65, v67
v_smfmac_f32_16x16x64_bf16 v[68:71], v[56:59], a[160:167], v10
v_cvt_pk_bf16_f32 v62, v60, v64
s_waitcnt lgkmcnt(2)
v_smfmac_f32_16x16x64_bf16 v[84:87], v[48:51], v[144:151], v10
v_cvt_pk_bf16_f32 v63, v61, v65
v_smfmac_f32_16x16x64_bf16 v[72:75], v[40:43], a[184:191], v10
ds_read_b128 v[144:147], v24 offset:12288
ds_write2_b32 v172, v62, v63 offset0:0 offset1:4
v_smfmac_f32_16x16x64_bf16 v[72:75], v[44:47], a[192:199], v10
ds_read_b128 v[148:151], v24 offset:13312
v_smfmac_f32_16x16x64_bf16 v[72:75], v[48:51], a[200:207], v10
v_add_f32 v68, v68, v70
v_smfmac_f32_16x16x64_bf16 v[72:75], v[52:55], a[208:215], v10
v_add_f32 v69, v69, v71
v_smfmac_f32_16x16x64_bf16 v[72:75], v[56:59], a[216:223], v10
s_waitcnt lgkmcnt(3)
v_smfmac_f32_16x16x64_bf16 v[84:87], v[52:55], v[152:159], v10
v_smfmac_f32_16x16x64_bf16 v[76:79], v[40:43], a[240:247], v10
s_nop 0
s_nop 0
v_smfmac_f32_16x16x64_bf16 v[76:79], v[44:47], a[248:255], v10
s_nop 0
v_smfmac_f32_16x16x64_bf16 v[76:79], v[48:51], v[176:183], v10
v_add_f32 v72, v72, v74
v_smfmac_f32_16x16x64_bf16 v[76:79], v[52:55], v[184:191], v10
v_add_f32 v73, v73, v75
v_smfmac_f32_16x16x64_bf16 v[76:79], v[56:59], v[192:199], v10
v_cvt_pk_bf16_f32 v70, v68, v72
s_waitcnt lgkmcnt(0)
v_smfmac_f32_16x16x64_bf16 v[84:87], v[56:59], v[144:151], v10
v_cvt_pk_bf16_f32 v71, v69, v73
v_smfmac_f32_16x16x64_bf16 v[80:83], v[40:43], v[216:223], v10
ds_write2_b32 v172, v70, v71 offset0:128 offset1:132
v_smfmac_f32_16x16x64_bf16 v[80:83], v[44:47], v[224:231], v10
s_nop 0
ds_read_b128 v[136:139], v26
v_smfmac_f32_16x16x64_bf16 v[80:83], v[48:51], v[232:239], v10
v_add_f32 v76, v76, v78
v_add_f32 v77, v77, v79
v_smfmac_f32_16x16x64_bf16 v[80:83], v[52:55], v[240:247], v10
v_add_f32 v84, v84, v86
v_add_f32 v85, v85, v87
v_smfmac_f32_16x16x64_bf16 v[80:83], v[56:59], v[248:255], v10
v_cvt_pk_bf16_f32 v78, v76, v84
v_cvt_pk_bf16_f32 v79, v77, v85
s_waitcnt lgkmcnt(0)
v_smfmac_f32_16x16x64_bf16 v[160:163], v[136:139], v[88:95], v10
ds_write2_b32 v31, v78, v79 offset0:0 offset1:4
v_smfmac_f32_16x16x64_bf16 v[164:167], v[136:139], v[104:111], v10
s_nop 0
v_smfmac_f32_16x16x64_bf16 v[168:171], v[136:139], v[120:127], v10
s_nop 0
v_add_f32 v80, v80, v82
v_add_f32 v81, v81, v83
v_cvt_pk_bf16_f32 v82, v80, v81
ds_write_b16 v21, v82 offset:1536
ds_write_b16_d16_hi v21, v82 offset:1552
ds_read_b128 v[140:143], v26 offset:1024
s_waitcnt lgkmcnt(0)
v_smfmac_f32_16x16x64_bf16 v[160:163], v[140:143], v[96:103], v10
v_smfmac_f32_16x16x64_bf16 v[164:167], v[140:143], v[112:119], v10
v_smfmac_f32_16x16x64_bf16 v[168:171], v[140:143], v[128:135], v10
s_nop 5
v_pk_add_f32 v[160:161], v[160:161], v[162:163]
ds_write2_b32 v22, v160, v161 offset0:0 offset1:32
v_pk_add_f32 v[164:165], v[164:165], v[166:167]
ds_write2_b32 v22, v164, v165 offset0:16 offset1:48
v_pk_add_f32 v[168:169], v[168:169], v[170:171]
ds_write2_b32 v173, v168, v169 offset0:0 offset1:32
s_waitcnt lgkmcnt(0)
s_barrier
v_mov_b32 v60, 0
v_mov_b32 v61, 0
v_mov_b32 v62, 0
v_mov_b32 v63, 0
v_mov_b32 v64, 0
v_mov_b32 v65, 0
v_mov_b32 v66, 0
v_mov_b32 v67, 0
v_mov_b32 v68, 0
v_mov_b32 v69, 0
v_mov_b32 v70, 0
v_mov_b32 v71, 0
v_mov_b32 v72, 0
v_mov_b32 v73, 0
v_mov_b32 v74, 0
v_mov_b32 v75, 0
v_mov_b32 v76, 0
v_mov_b32 v77, 0
s_cmp_eq_u32 s17, 0
s_cbranch_scc0 Lfl_138
buffer_store_dword v14, v16, s[8:11], s35 offen
Lfl_138:
v_mov_b32 v60, 0
v_mov_b32 v61, 0
v_mov_b32 v62, 0
v_mov_b32 v63, 0
v_mov_b32 v64, 0
v_mov_b32 v65, 0
v_mov_b32 v66, 0
v_mov_b32 v67, 0
v_mov_b32 v68, 0
v_mov_b32 v69, 0
v_mov_b32 v70, 0
v_mov_b32 v71, 0
v_mov_b32 v72, 0
v_mov_b32 v73, 0
v_mov_b32 v74, 0
v_mov_b32 v75, 0
v_mov_b32 v76, 0
v_mov_b32 v77, 0
v_mov_b32 v78, 0
v_mov_b32 v79, 0
v_mov_b32 v80, 0
v_mov_b32 v81, 0
v_mov_b32 v82, 0
v_mov_b32 v83, 0
v_mov_b32 v84, 0
v_mov_b32 v85, 0
v_mov_b32 v86, 0
v_mov_b32 v87, 0
v_mov_b32 v160, 0
v_mov_b32 v161, 0
v_mov_b32 v162, 0
v_mov_b32 v163, 0
v_mov_b32 v164, 0
v_mov_b32 v165, 0
v_mov_b32 v166, 0
v_mov_b32 v167, 0
v_mov_b32 v168, 0
v_mov_b32 v169, 0
v_mov_b32 v170, 0
v_mov_b32 v171, 0
ds_read_b128 v[144:147], v24 offset:0
ds_read_b128 v[148:151], v24 offset:1024
ds_read_b128 v[152:155], v24 offset:2048
ds_read_b128 v[156:159], v24 offset:3072
s_waitcnt lgkmcnt(0)
s_add_u32 s25, s25, 28672
s_add_u32 s36, s36, 28672
s_barrier
s_cmp_eq_u32 s18, 62
s_cbranch_scc1 Lrec_done
buffer_load_dwordx4 v[88:91], v2, s[8:11], s25 offen offset:0 sc1
buffer_load_dwordx4 v[92:95], v2, s[8:11], s25 offen offset:1024 sc1
buffer_load_dwordx4 v[96:99], v2, s[8:11], s25 offen offset:2048 sc1
buffer_load_dwordx4 v[100:103], v2, s[8:11], s25 offen offset:3072 sc1
buffer_load_dwordx4 v[104:107], v2, s[8:11], s36 offen offset:0 sc1
buffer_load_dwordx4 v[108:111], v2, s[8:11], s36 offen offset:1024 sc1
buffer_load_dwordx4 v[112:115], v2, s[8:11], s36 offen offset:2048 sc1
buffer_load_dwordx4 v[116:119], v2, s[8:11], s36 offen offset:3072 sc1
s_add_u32 s18, s18, 1
s_xor_b32 s20, s20, 8192
s_xor_b32 s22, s22, 16384
s_xor_b32 s23, s23, 16384
s_add_u32 s28, s28, 8192
s_add_u32 s38, s38, s42
s_mov_b64 exec, 15
buffer_load_dwordx4 v[40:43], v15, s[8:11], s34 offen sc1
s_nop 15
buffer_load_dwordx4 v[44:47], v15, s[8:11], s34 offen sc1
s_nop 15
buffer_load_dwordx4 v[48:51], v15, s[8:11], s34 offen sc1
Lfp_139:
s_waitcnt vmcnt(2)
v_min3_u32 v11, v40, v41, v42
v_min_u32 v11, v11, v43
v_cmp_gt_u32 vcc, v14, v11
s_cbranch_vccz Lfg_140
buffer_load_dwordx4 v[40:43], v15, s[8:11], s34 offen sc1
s_waitcnt vmcnt(2)
v_min3_u32 v11, v44, v45, v46
v_min_u32 v11, v11, v47
v_cmp_gt_u32 vcc, v14, v11
s_cbranch_vccz Lfg_140
buffer_load_dwordx4 v[44:47], v15, s[8:11], s34 offen sc1
s_waitcnt vmcnt(2)
v_min3_u32 v11, v48, v49, v50
v_min_u32 v11, v11, v51
v_cmp_gt_u32 vcc, v14, v11
s_cbranch_vccz Lfg_140
buffer_load_dwordx4 v[48:51], v15, s[8:11], s34 offen sc1
s_sub_u32 s19, s19, 1
s_cbranch_scc0 Lfp_139
s_mov_b32 s19, 0
Lfg_140:
s_mov_b64 exec, -1
v_add_u32 v14, 1, v14
s_branch Ltop_130
Lmp_131b:
s_waitcnt vmcnt(0)
v_max_u32 v11, v139, v143
v_cmp_eq_u32 vcc, -1, v11
s_cbranch_vccnz Lmr_132
v_mov_b32 v32, v136
v_mov_b32 v33, v137
v_mov_b32 v34, v138
v_mov_b32 v35, v139
v_mov_b32 v36, v140
v_mov_b32 v37, v141
v_mov_b32 v38, v142
v_mov_b32 v39, v143
s_nop 0
s_branch Lma_133
Lmr_132:

s_sub_u32 s19, s19, 1
s_cbranch_scc0 Lmp_131
s_mov_b32 s19, 0
s_branch Lma_133
Lmr2_134:

s_sub_u32 s19, s19, 1
s_cbranch_scc1 Lmr2_134x
s_nop 15
v_mov_b32 v60, 0
v_mov_b32 v61, 0
v_mov_b32 v62, 0
v_mov_b32 v63, 0
v_mov_b32 v64, 0
v_mov_b32 v65, 0
v_mov_b32 v66, 0
v_mov_b32 v67, 0
v_mov_b32 v68, 0
v_mov_b32 v69, 0
v_mov_b32 v70, 0
v_mov_b32 v71, 0
v_mov_b32 v72, 0
v_mov_b32 v73, 0
v_mov_b32 v74, 0
v_mov_b32 v75, 0
v_mov_b32 v76, 0
v_mov_b32 v77, 0
v_mov_b32 v78, 0
v_mov_b32 v79, 0
v_mov_b32 v80, 0
v_mov_b32 v81, 0
v_mov_b32 v82, 0
v_mov_b32 v83, 0
v_mov_b32 v84, 0
v_mov_b32 v85, 0
v_mov_b32 v86, 0
v_mov_b32 v87, 0
s_branch Lmp_131
Lmr2_134x:
s_mov_b32 s19, 0
s_branch Lma2_135
.p2align 6
Lrole_79:
ds_read_b128 v[144:147], v24 offset:0
ds_read_b128 v[148:151], v24 offset:1024
ds_read_b128 v[152:155], v24 offset:2048
ds_read_b128 v[156:159], v24 offset:3072
s_waitcnt lgkmcnt(0)
Ltop_141:
Lmp_142:
buffer_load_dwordx4 v[32:35], v3, s[8:11], s20 offen sc1
buffer_load_dwordx4 v[36:39], v4, s[8:11], s20 offen sc1
s_nop 15
s_nop 15
buffer_load_dwordx4 v[136:139], v3, s[8:11], s20 offen sc1
buffer_load_dwordx4 v[140:143], v4, s[8:11], s20 offen sc1
s_waitcnt vmcnt(2)
v_max_u32 v11, v35, v39
v_cmp_eq_u32 vcc, -1, v11
s_cbranch_vccnz Lmp_142b
Lma_144:
ds_write_b128 v3, v[32:35] offset:0
ds_write_b128 v4, v[36:39] offset:0
v_smfmac_f32_16x16x64_bf16 v[84:87], v[32:35], v[144:151], v10
v_max3_u32 v11, v32, v33, v34
v_smfmac_f32_16x16x64_bf16 v[60:63], v[32:35], a[0:7], v10
v_max3_u32 v11, v11, v36, v37
v_smfmac_f32_16x16x64_bf16 v[64:67], v[32:35], a[56:63], v10
v_max_u32 v11, v11, v38
v_cmp_eq_u32 vcc, -1, v11
v_smfmac_f32_16x16x64_bf16 v[68:71], v[32:35], a[112:119], v10
v_smfmac_f32_16x16x64_bf16 v[72:75], v[32:35], a[168:175], v10
s_cbranch_vccnz Lmr2_145
Lma2_146:
s_waitcnt lgkmcnt(0)
s_barrier
ds_read_b128 v[40:43], v5 offset:0
ds_read_b128 v[44:47], v6 offset:0
v_smfmac_f32_16x16x64_bf16 v[76:79], v[32:35], a[224:231], v10
ds_read_b128 v[48:51], v7 offset:0
v_smfmac_f32_16x16x64_bf16 v[80:83], v[32:35], v[200:207], v10
ds_read_b128 v[52:55], v8 offset:0
v_smfmac_f32_16x16x64_bf16 v[84:87], v[36:39], v[152:159], v10
ds_read_b128 v[56:59], v9 offset:0
v_smfmac_f32_16x16x64_bf16 v[60:63], v[36:39], a[8:15], v10
ds_read_b128 v[144:147], v24 offset:4096
v_smfmac_f32_16x16x64_bf16 v[64:67], v[36:39], a[64:71], v10
ds_read_b128 v[148:151], v24 offset:5120
v_smfmac_f32_16x16x64_bf16 v[68:71], v[36:39], a[120:127], v10
ds_read_b128 v[152:155], v24 offset:6144
v_smfmac_f32_16x16x64_bf16 v[72:75], v[36:39], a[176:183], v10
ds_read_b128 v[156:159], v24 offset:7168
v_smfmac_f32_16x16x64_bf16 v[76:79], v[36:39], a[232:239], v10
v_smfmac_f32_16x16x64_bf16 v[80:83], v[36:39], v[208:215], v10
s_waitcnt lgkmcnt(4)
v_smfmac_f32_16x16x64_bf16 v[60:63], v[40:43], a[16:23], v10
ds_read_b128 v[120:123], v23 offset:0
v_smfmac_f32_16x16x64_bf16 v[60:63], v[44:47], a[24:31], v10
ds_read_b128 v[124:127], v23 offset:512
v_smfmac_f32_16x16x64_bf16 v[60:63], v[48:51], a[32:39], v10
ds_read_b128 v[128:131], v23 offset:1024
v_smfmac_f32_16x16x64_bf16 v[60:63], v[52:55], a[40:47], v10
ds_read_b128 v[132:135], v30 offset:0
v_smfmac_f32_16x16x64_bf16 v[60:63], v[56:59], a[48:55], v10
buffer_store_dwordx2 v[174:175], v27, s[8:11], s23 offen
s_waitcnt lgkmcnt(6)
v_smfmac_f32_16x16x64_bf16 v[84:87], v[40:43], v[144:151], v10
v_smfmac_f32_16x16x64_bf16 v[64:67], v[40:43], a[72:79], v10
ds_read_b128 v[144:147], v24 offset:8192
s_nop 0
v_smfmac_f32_16x16x64_bf16 v[64:67], v[44:47], a[80:87], v10
ds_read_b128 v[148:151], v24 offset:9216
buffer_store_dword v174, v28, s[8:11], s23 offen
v_smfmac_f32_16x16x64_bf16 v[64:67], v[48:51], a[88:95], v10
v_add_f32 v60, v60, v62
v_smfmac_f32_16x16x64_bf16 v[64:67], v[52:55], a[96:103], v10
v_add_f32 v61, v61, v63
v_smfmac_f32_16x16x64_bf16 v[64:67], v[56:59], a[104:111], v10
s_waitcnt lgkmcnt(6)
v_smfmac_f32_16x16x64_bf16 v[84:87], v[44:47], v[152:159], v10
v_smfmac_f32_16x16x64_bf16 v[68:71], v[40:43], a[128:135], v10
ds_read_b128 v[152:155], v24 offset:10240
s_nop 0
v_smfmac_f32_16x16x64_bf16 v[68:71], v[44:47], a[136:143], v10
ds_read_b128 v[156:159], v24 offset:11264
v_smfmac_f32_16x16x64_bf16 v[68:71], v[48:51], a[144:151], v10
v_add_f32 v64, v64, v66
v_smfmac_f32_16x16x64_bf16 v[68:71], v[52:55], a[152:159], v10
v_add_f32 v65, v65, v67
v_smfmac_f32_16x16x64_bf16 v[68:71], v[56:59], a[160:167], v10
v_cvt_pk_bf16_f32 v62, v60, v64
s_waitcnt lgkmcnt(2)
v_smfmac_f32_16x16x64_bf16 v[84:87], v[48:51], v[144:151], v10
v_cvt_pk_bf16_f32 v63, v61, v65
v_smfmac_f32_16x16x64_bf16 v[72:75], v[40:43], a[184:191], v10
ds_read_b128 v[144:147], v24 offset:12288
ds_write2_b32 v172, v62, v63 offset0:0 offset1:4
v_smfmac_f32_16x16x64_bf16 v[72:75], v[44:47], a[192:199], v10
ds_read_b128 v[148:151], v24 offset:13312
v_smfmac_f32_16x16x64_bf16 v[72:75], v[48:51], a[200:207], v10
v_add_f32 v68, v68, v70
v_smfmac_f32_16x16x64_bf16 v[72:75], v[52:55], a[208:215], v10
v_add_f32 v69, v69, v71
v_smfmac_f32_16x16x64_bf16 v[72:75], v[56:59], a[216:223], v10
s_waitcnt lgkmcnt(3)
v_smfmac_f32_16x16x64_bf16 v[84:87], v[52:55], v[152:159], v10
v_smfmac_f32_16x16x64_bf16 v[76:79], v[40:43], a[240:247], v10
s_nop 0
s_nop 0
v_smfmac_f32_16x16x64_bf16 v[76:79], v[44:47], a[248:255], v10
s_nop 0
v_smfmac_f32_16x16x64_bf16 v[76:79], v[48:51], v[176:183], v10
v_add_f32 v72, v72, v74
v_smfmac_f32_16x16x64_bf16 v[76:79], v[52:55], v[184:191], v10
v_add_f32 v73, v73, v75
v_smfmac_f32_16x16x64_bf16 v[76:79], v[56:59], v[192:199], v10
v_cvt_pk_bf16_f32 v70, v68, v72
s_waitcnt lgkmcnt(0)
v_smfmac_f32_16x16x64_bf16 v[84:87], v[56:59], v[144:151], v10
v_cvt_pk_bf16_f32 v71, v69, v73
v_smfmac_f32_16x16x64_bf16 v[80:83], v[40:43], v[216:223], v10
ds_write2_b32 v172, v70, v71 offset0:128 offset1:132
v_smfmac_f32_16x16x64_bf16 v[80:83], v[44:47], v[224:231], v10
s_nop 0
ds_read_b128 v[136:139], v26
v_smfmac_f32_16x16x64_bf16 v[80:83], v[48:51], v[232:239], v10
v_add_f32 v76, v76, v78
v_add_f32 v77, v77, v79
v_smfmac_f32_16x16x64_bf16 v[80:83], v[52:55], v[240:247], v10
v_add_f32 v84, v84, v86
v_add_f32 v85, v85, v87
v_smfmac_f32_16x16x64_bf16 v[80:83], v[56:59], v[248:255], v10
v_cvt_pk_bf16_f32 v78, v76, v84
v_cvt_pk_bf16_f32 v79, v77, v85
s_waitcnt lgkmcnt(0)
v_smfmac_f32_16x16x64_bf16 v[160:163], v[136:139], v[88:95], v10
ds_write2_b32 v31, v78, v79 offset0:0 offset1:4
v_smfmac_f32_16x16x64_bf16 v[164:167], v[136:139], v[104:111], v10
s_nop 0
v_smfmac_f32_16x16x64_bf16 v[168:171], v[136:139], v[120:127], v10
s_nop 0
v_add_f32 v80, v80, v82
v_add_f32 v81, v81, v83
v_cvt_pk_bf16_f32 v82, v80, v81
ds_write_b16 v21, v82 offset:1536
ds_write_b16_d16_hi v21, v82 offset:1552
ds_read_b128 v[140:143], v26 offset:1024
s_waitcnt lgkmcnt(0)
v_smfmac_f32_16x16x64_bf16 v[160:163], v[140:143], v[96:103], v10
v_smfmac_f32_16x16x64_bf16 v[164:167], v[140:143], v[112:119], v10
v_smfmac_f32_16x16x64_bf16 v[168:171], v[140:143], v[128:135], v10
s_nop 5
v_pk_add_f32 v[160:161], v[160:161], v[162:163]
ds_write2_b32 v22, v160, v161 offset0:0 offset1:32
v_pk_add_f32 v[164:165], v[164:165], v[166:167]
ds_write2_b32 v22, v164, v165 offset0:16 offset1:48
v_pk_add_f32 v[168:169], v[168:169], v[170:171]
ds_write2_b32 v173, v168, v169 offset0:0 offset1:32
s_waitcnt lgkmcnt(0)
s_barrier
ds_read_b128 v[32:35], v25 offset:0
ds_read_b128 v[36:39], v25 offset:1056
ds_read_b128 v[40:43], v25 offset:2112
ds_read_b128 v[44:47], v25 offset:3168
ds_read_b128 v[48:51], v25 offset:4224
ds_read_b128 v[52:55], v25 offset:5280
s_waitcnt lgkmcnt(4)
v_pk_add_f32 v[32:33], v[32:33], v[34:35]
v_pk_add_f32 v[36:37], v[36:37], v[38:39]
v_pk_add_f32 v[32:33], v[32:33], v[36:37]
s_waitcnt lgkmcnt(2)
v_pk_add_f32 v[40:41], v[40:41], v[42:43]
v_pk_add_f32 v[44:45], v[44:45], v[46:47]
v_pk_add_f32 v[34:35], v[40:41], v[44:45]
v_max3_f32 v38, v32, v33, v34
s_waitcnt lgkmcnt(0)
v_pk_add_f32 v[48:49], v[48:49], v[50:51]
v_pk_add_f32 v[52:53], v[52:53], v[54:55]
v_pk_add_f32 v[36:37], v[48:49], v[52:53]
v_max3_f32 v38, v38, v35, v36
v_max_f32 v38, v38, v37
v_pk_add_f32 v[32:33], v[32:33], v[38:39] op_sel_hi:[1,0] neg_lo:[0,1] neg_hi:[0,1]
v_pk_add_f32 v[34:35], v[34:35], v[38:39] op_sel_hi:[1,0] neg_lo:[0,1] neg_hi:[0,1]
v_max_f32_dpp v44, v38, v38 quad_perm:[1,0,3,2] row_mask:0xf bank_mask:0xf
v_pk_add_f32 v[36:37], v[36:37], v[38:39] op_sel_hi:[1,0] neg_lo:[0,1] neg_hi:[0,1]
v_exp_f32 v32, v32
v_max_f32_dpp v44, v44, v44 quad_perm:[2,3,0,1] row_mask:0xf bank_mask:0xf
v_exp_f32 v33, v33
v_exp_f32 v34, v34
v_max_f32_dpp v44, v44, v44 row_half_mirror row_mask:0xf bank_mask:0xf
v_exp_f32 v35, v35
v_sub_f32 v44, v38, v44
v_exp_f32 v36, v36
v_exp_f32 v37, v37
v_exp_f32 v44, v44
v_pk_add_f32 v[40:41], v[32:33], v[34:35]
v_add_f32 v42, v36, v37
v_add_f32 v40, v40, v41
v_fma_f32 v40, v42, v29, v40
v_mul_f32 v40, v40, v44
s_nop 1
v_add_f32_dpp v40, v40, v40 quad_perm:[1,0,3,2] row_mask:0xf bank_mask:0xf
s_nop 1
v_add_f32_dpp v40, v40, v40 quad_perm:[2,3,0,1] row_mask:0xf bank_mask:0xf
s_nop 1
v_add_f32_dpp v40, v40, v40 row_half_mirror row_mask:0xf bank_mask:0xf
v_rcp_f32 v40, v40
s_nop 0
v_mul_f32 v40, v40, v44
v_pk_mul_f32 v[32:33], v[32:33], v[40:41] op_sel_hi:[1,0]
v_pk_mul_f32 v[34:35], v[34:35], v[40:41] op_sel_hi:[1,0]
v_pk_mul_f32 v[36:37], v[36:37], v[40:41] op_sel_hi:[1,0]
v_cvt_pk_bf16_f32 v32, v32, v33
v_cvt_pk_bf16_f32 v33, v34, v35
buffer_store_dwordx2 v[32:33], v27, s[8:11], s22 offen
v_cvt_pk_bf16_f32 v36, v36, v37
buffer_store_dword v36, v28, s[8:11], s22 offen
s_barrier
v_mov_b32 v60, 0
v_mov_b32 v61, 0
v_mov_b32 v62, 0
v_mov_b32 v63, 0
v_mov_b32 v64, 0
v_mov_b32 v65, 0
v_mov_b32 v66, 0
v_mov_b32 v67, 0
v_mov_b32 v68, 0
v_mov_b32 v69, 0
v_mov_b32 v70, 0
v_mov_b32 v71, 0
v_mov_b32 v72, 0
v_mov_b32 v73, 0
v_mov_b32 v74, 0
v_mov_b32 v75, 0
v_mov_b32 v76, 0
v_mov_b32 v77, 0
v_mov_b32 v78, 0
v_mov_b32 v79, 0
v_mov_b32 v80, 0
v_mov_b32 v81, 0
v_mov_b32 v82, 0
v_mov_b32 v83, 0
v_mov_b32 v84, 0
v_mov_b32 v85, 0
v_mov_b32 v86, 0
v_mov_b32 v87, 0
v_mov_b32 v160, 0
v_mov_b32 v161, 0
v_mov_b32 v162, 0
v_mov_b32 v163, 0
v_mov_b32 v164, 0
v_mov_b32 v165, 0
v_mov_b32 v166, 0
v_mov_b32 v167, 0
v_mov_b32 v168, 0
v_mov_b32 v169, 0
v_mov_b32 v170, 0
v_mov_b32 v171, 0
ds_read_b128 v[144:147], v24 offset:0
ds_read_b128 v[148:151], v24 offset:1024
ds_read_b128 v[152:155], v24 offset:2048
ds_read_b128 v[156:159], v24 offset:3072
s_waitcnt lgkmcnt(0)
s_add_u32 s25, s25, 28672
s_add_u32 s36, s36, 28672
s_cmp_eq_u32 s18, 62
s_cbranch_scc1 Lrec_done
buffer_load_dwordx4 v[88:91], v2, s[8:11], s25 offen offset:0 sc1
buffer_load_dwordx4 v[92:95], v2, s[8:11], s25 offen offset:1024 sc1
buffer_load_dwordx4 v[96:99], v2, s[8:11], s25 offen offset:2048 sc1
buffer_load_dwordx4 v[100:103], v2, s[8:11], s25 offen offset:3072 sc1
buffer_load_dwordx4 v[104:107], v2, s[8:11], s36 offen offset:0 sc1
buffer_load_dwordx4 v[108:111], v2, s[8:11], s36 offen offset:1024 sc1
buffer_load_dwordx4 v[112:115], v2, s[8:11], s36 offen offset:2048 sc1
buffer_load_dwordx4 v[116:119], v2, s[8:11], s36 offen offset:3072 sc1
s_add_u32 s18, s18, 1
s_xor_b32 s20, s20, 8192
s_xor_b32 s22, s22, 16384
s_xor_b32 s23, s23, 16384
s_add_u32 s28, s28, 8192
s_add_u32 s38, s38, s42
s_mov_b64 exec, 15
buffer_load_dwordx4 v[40:43], v15, s[8:11], s34 offen sc1
s_nop 15
buffer_load_dwordx4 v[44:47], v15, s[8:11], s34 offen sc1
s_nop 15
buffer_load_dwordx4 v[48:51], v15, s[8:11], s34 offen sc1
Lfp_149:
s_waitcnt vmcnt(2)
v_min3_u32 v11, v40, v41, v42
v_min_u32 v11, v11, v43
v_cmp_gt_u32 vcc, v14, v11
s_cbranch_vccz Lfg_150
buffer_load_dwordx4 v[40:43], v15, s[8:11], s34 offen sc1
s_waitcnt vmcnt(2)
v_min3_u32 v11, v44, v45, v46
v_min_u32 v11, v11, v47
v_cmp_gt_u32 vcc, v14, v11
s_cbranch_vccz Lfg_150
buffer_load_dwordx4 v[44:47], v15, s[8:11], s34 offen sc1
s_waitcnt vmcnt(2)
v_min3_u32 v11, v48, v49, v50
v_min_u32 v11, v11, v51
v_cmp_gt_u32 vcc, v14, v11
s_cbranch_vccz Lfg_150
buffer_load_dwordx4 v[48:51], v15, s[8:11], s34 offen sc1
s_sub_u32 s19, s19, 1
s_cbranch_scc0 Lfp_149
s_mov_b32 s19, 0
Lfg_150:
s_mov_b64 exec, -1
v_add_u32 v14, 1, v14
s_branch Ltop_141
Lmp_142b:
s_waitcnt vmcnt(0)
v_max_u32 v11, v139, v143
v_cmp_eq_u32 vcc, -1, v11
s_cbranch_vccnz Lmr_143
v_mov_b32 v32, v136
v_mov_b32 v33, v137
v_mov_b32 v34, v138
v_mov_b32 v35, v139
v_mov_b32 v36, v140
v_mov_b32 v37, v141
v_mov_b32 v38, v142
v_mov_b32 v39, v143
s_nop 0
s_branch Lma_144
Lmr_143:

s_sub_u32 s19, s19, 1
s_cbranch_scc0 Lmp_142
s_mov_b32 s19, 0
s_branch Lma_144
Lmr2_145:

s_sub_u32 s19, s19, 1
s_cbranch_scc1 Lmr2_145x
s_nop 15
v_mov_b32 v60, 0
v_mov_b32 v61, 0
v_mov_b32 v62, 0
v_mov_b32 v63, 0
v_mov_b32 v64, 0
v_mov_b32 v65, 0
v_mov_b32 v66, 0
v_mov_b32 v67, 0
v_mov_b32 v68, 0
v_mov_b32 v69, 0
v_mov_b32 v70, 0
v_mov_b32 v71, 0
v_mov_b32 v72, 0
v_mov_b32 v73, 0
v_mov_b32 v74, 0
v_mov_b32 v75, 0
v_mov_b32 v76, 0
v_mov_b32 v77, 0
v_mov_b32 v78, 0
v_mov_b32 v79, 0
v_mov_b32 v80, 0
v_mov_b32 v81, 0
v_mov_b32 v82, 0
v_mov_b32 v83, 0
v_mov_b32 v84, 0
v_mov_b32 v85, 0
v_mov_b32 v86, 0
v_mov_b32 v87, 0
s_branch Lmp_142
Lmr2_145x:
s_mov_b32 s19, 0
s_branch Lma2_146
.p2align 6
Lrole_81:
v_cmp_gt_u32 vcc, 32, v30
s_cbranch_vccnz Lcr_153
Lco_152:
Ltop_151:
buffer_load_dwordx4 v[32:35], v3, s[8:11], s20 offen sc1
buffer_load_dwordx4 v[36:39], v4, s[8:11], s20 offen sc1
buffer_load_dwordx4 v[40:43], v5, s[8:11], s20 offen sc1
buffer_load_dwordx4 v[44:47], v6, s[8:11], s20 offen sc1
buffer_load_dwordx4 v[48:51], v7, s[8:11], s20 offen sc1
buffer_load_dwordx4 v[52:55], v8, s[8:11], s20 offen sc1
buffer_load_dwordx4 v[56:59], v9, s[8:11], s20 offen sc1
buffer_store_dwordx4 v[124:127], v2, s[8:11], s27 offen sc1
s_add_u32 s30, s27, 4096
buffer_store_dwordx4 v[132:135], v2, s[8:11], s30 offen sc1
buffer_load_dwordx4 v[92:95], v21, s[8:11], s24 offen offset:0 sc1
buffer_load_dwordx4 v[96:99], v21, s[8:11], s24 offen offset:1024 sc1
buffer_load_dwordx4 v[100:103], v21, s[8:11], s24 offen offset:2048 sc1
buffer_load_dwordx4 v[104:107], v21, s[8:11], s24 offen offset:3072 sc1
s_barrier
v_mov_b32 v152, 0
v_mov_b32 v153, 0
v_mov_b32 v154, 0
v_mov_b32 v155, 0
v_mov_b32 v156, 0
v_mov_b32 v157, 0
v_mov_b32 v158, 0
v_mov_b32 v159, 0
v_mov_b32 v60, 0
v_mov_b32 v61, 0
v_mov_b32 v62, 0
v_mov_b32 v63, 0
v_mov_b32 v64, 0
v_mov_b32 v65, 0
v_mov_b32 v66, 0
v_mov_b32 v67, 0
v_mov_b32 v68, 0
v_mov_b32 v69, 0
v_mov_b32 v70, 0
v_mov_b32 v71, 0
v_mov_b32 v72, 0
v_mov_b32 v73, 0
v_mov_b32 v74, 0
v_mov_b32 v75, 0
v_mov_b32 v76, 0
v_mov_b32 v77, 0
v_mov_b32 v78, 0
v_mov_b32 v79, 0
v_mov_b32 v80, 0
v_mov_b32 v81, 0
v_mov_b32 v82, 0
v_mov_b32 v83, 0
v_mov_b32 v84, 0
v_mov_b32 v85, 0
v_mov_b32 v86, 0
v_mov_b32 v87, 0
v_mov_b32 v88, 0
v_mov_b32 v89, 0
v_mov_b32 v90, 0
v_mov_b32 v91, 0
s_waitcnt vmcnt(12)
Lmp_154w:
ds_write_b128 v3, v[32:35] offset:0
v_max3_u32 v11, v32, v33, v34
v_max_u32 v11, v11, v35
s_waitcnt vmcnt(11)
ds_write_b128 v4, v[36:39] offset:0
v_max3_u32 v11, v11, v36, v37
v_max3_u32 v11, v11, v38, v39
s_waitcnt vmcnt(10)
ds_write_b128 v5, v[40:43] offset:0
v_max3_u32 v11, v11, v40, v41
v_max3_u32 v11, v11, v42, v43
s_waitcnt vmcnt(9)
ds_write_b128 v6, v[44:47] offset:0
v_max3_u32 v11, v11, v44, v45
v_max3_u32 v11, v11, v46, v47
s_waitcnt vmcnt(8)
ds_write_b128 v7, v[48:51] offset:0
v_max3_u32 v11, v11, v48, v49
v_max3_u32 v11, v11, v50, v51
s_waitcnt vmcnt(7)
ds_write_b128 v8, v[52:55] offset:0
v_max3_u32 v11, v11, v52, v53
v_max3_u32 v11, v11, v54, v55
s_waitcnt vmcnt(6)
ds_write_b128 v9, v[56:59] offset:0
v_max3_u32 v11, v11, v56, v57
v_max3_u32 v11, v11, v58, v59
v_cmp_eq_u32 vcc, -1, v11
s_cbranch_vccnz Lmr_155
Lma_156:
s_waitcnt lgkmcnt(0)
s_barrier
v_smfmac_f32_16x16x64_bf16 v[60:63], v[32:35], a[0:7], v10
ds_read_b128 v[160:163], v26 offset:0
buffer_load_dwordx4 v[108:111], v21, s[8:11], s39 offen offset:0 sc1
buffer_load_dwordx4 v[112:115], v21, s[8:11], s39 offen offset:1024 sc1
buffer_load_dwordx4 v[116:119], v21, s[8:11], s39 offen offset:2048 sc1
buffer_load_dwordx4 v[120:123], v21, s[8:11], s39 offen offset:3072 sc1
v_smfmac_f32_16x16x64_bf16 v[64:67], v[32:35], a[8:15], v10
ds_read_b128 v[164:167], v26 offset:1024
v_smfmac_f32_16x16x64_bf16 v[68:71], v[32:35], a[16:23], v10
ds_read_b128 v[168:171], v26 offset:2048
v_smfmac_f32_16x16x64_bf16 v[72:75], v[32:35], a[24:31], v10
ds_read_b128 v[172:175], v26 offset:3072
v_smfmac_f32_16x16x64_bf16 v[76:79], v[32:35], a[32:39], v10
ds_read_b128 v[176:179], v26 offset:4096
v_smfmac_f32_16x16x64_bf16 v[80:83], v[32:35], a[40:47], v10
ds_read_b128 v[180:183], v26 offset:5120
v_smfmac_f32_16x16x64_bf16 v[84:87], v[32:35], a[48:55], v10
ds_read_b128 v[184:187], v26 offset:6144
v_smfmac_f32_16x16x64_bf16 v[88:91], v[32:35], a[56:63], v10
ds_read_b128 v[188:191], v26 offset:7168
v_smfmac_f32_16x16x64_bf16 v[60:63], v[36:39], a[64:71], v10
v_smfmac_f32_16x16x64_bf16 v[64:67], v[36:39], a[72:79], v10
s_waitcnt lgkmcnt(6)
v_smfmac_f32_16x16x64_bf16 v[60:63], v[52:55], v[160:167], v10
ds_read_b128 v[160:163], v26 offset:8192
v_smfmac_f32_16x16x64_bf16 v[68:71], v[36:39], a[80:87], v10
ds_read_b128 v[164:167], v26 offset:9216
v_smfmac_f32_16x16x64_bf16 v[72:75], v[36:39], a[88:95], v10
s_waitcnt lgkmcnt(6)
v_smfmac_f32_16x16x64_bf16 v[64:67], v[52:55], v[168:175], v10
ds_read_b128 v[168:171], v26 offset:10240
v_smfmac_f32_16x16x64_bf16 v[76:79], v[36:39], a[96:103], v10
ds_read_b128 v[172:175], v26 offset:11264
v_smfmac_f32_16x16x64_bf16 v[80:83], v[36:39], a[104:111], v10
s_waitcnt lgkmcnt(6)
v_smfmac_f32_16x16x64_bf16 v[68:71], v[52:55], v[176:183], v10
ds_read_b128 v[176:179], v26 offset:12288
v_smfmac_f32_16x16x64_bf16 v[84:87], v[36:39], a[112:119], v10
ds_read_b128 v[180:183], v26 offset:13312
v_smfmac_f32_16x16x64_bf16 v[88:91], v[36:39], a[120:127], v10
s_waitcnt lgkmcnt(6)
v_smfmac_f32_16x16x64_bf16 v[72:75], v[52:55], v[184:191], v10
ds_read_b128 v[184:187], v26 offset:14336
v_smfmac_f32_16x16x64_bf16 v[60:63], v[40:43], a[128:135], v10
ds_read_b128 v[188:191], v26 offset:15360
s_and_b32 s30, s18, 3
s_cmp_eq_u32 s30, 3
s_cbranch_scc0 Lsu_158
s_add_u32 s29, s29, 128
buffer_load_dword v30, v13, s[8:11], s29 offen sc1
Lsu_158:
v_smfmac_f32_16x16x64_bf16 v[64:67], v[40:43], a[136:143], v10
s_waitcnt lgkmcnt(6)
v_smfmac_f32_16x16x64_bf16 v[76:79], v[52:55], v[160:167], v10
ds_read_b128 v[160:163], v26 offset:16384
v_smfmac_f32_16x16x64_bf16 v[68:71], v[40:43], a[144:151], v10
ds_read_b128 v[164:167], v26 offset:17408
v_smfmac_f32_16x16x64_bf16 v[72:75], v[40:43], a[152:159], v10
s_waitcnt lgkmcnt(6)
v_smfmac_f32_16x16x64_bf16 v[80:83], v[52:55], v[168:175], v10
ds_read_b128 v[168:171], v26 offset:18432
v_smfmac_f32_16x16x64_bf16 v[76:79], v[40:43], a[160:167], v10
ds_read_b128 v[172:175], v26 offset:19456
v_smfmac_f32_16x16x64_bf16 v[80:83], v[40:43], a[168:175], v10
s_waitcnt lgkmcnt(6)
v_smfmac_f32_16x16x64_bf16 v[84:87], v[52:55], v[176:183], v10
ds_read_b128 v[176:179], v26 offset:20480
v_smfmac_f32_16x16x64_bf16 v[84:87], v[40:43], a[176:183], v10
ds_read_b128 v[180:183], v26 offset:21504
v_smfmac_f32_16x16x64_bf16 v[88:91], v[40:43], a[184:191], v10
s_waitcnt lgkmcnt(6)
v_smfmac_f32_16x16x64_bf16 v[88:91], v[52:55], v[184:191], v10
ds_read_b128 v[184:187], v26 offset:22528
v_smfmac_f32_16x16x64_bf16 v[60:63], v[44:47], a[192:199], v10
ds_read_b128 v[188:191], v26 offset:23552
v_smfmac_f32_16x16x64_bf16 v[64:67], v[44:47], a[200:207], v10
s_waitcnt lgkmcnt(6)
v_smfmac_f32_16x16x64_bf16 v[60:63], v[56:59], v[160:167], v10
ds_read_b128 v[160:163], v26 offset:24576
v_smfmac_f32_16x16x64_bf16 v[68:71], v[44:47], a[208:215], v10
ds_read_b128 v[164:167], v26 offset:25600
v_smfmac_f32_16x16x64_bf16 v[72:75], v[44:47], a[216:223], v10
s_waitcnt lgkmcnt(6)
v_smfmac_f32_16x16x64_bf16 v[64:67], v[56:59], v[168:175], v10
ds_read_b128 v[168:171], v26 offset:26624
v_smfmac_f32_16x16x64_bf16 v[76:79], v[44:47], a[224:231], v10
ds_read_b128 v[172:175], v26 offset:27648
v_smfmac_f32_16x16x64_bf16 v[80:83], v[44:47], a[232:239], v10
s_waitcnt lgkmcnt(6)
v_smfmac_f32_16x16x64_bf16 v[68:71], v[56:59], v[176:183], v10
ds_read_b128 v[176:179], v26 offset:28672
v_smfmac_f32_16x16x64_bf16 v[84:87], v[44:47], a[240:247], v10
ds_read_b128 v[180:183], v26 offset:29696
v_smfmac_f32_16x16x64_bf16 v[88:91], v[44:47], a[248:255], v10
s_waitcnt lgkmcnt(6)
v_smfmac_f32_16x16x64_bf16 v[72:75], v[56:59], v[184:191], v10
ds_read_b128 v[184:187], v26 offset:30720
v_smfmac_f32_16x16x64_bf16 v[60:63], v[48:51], v[192:199], v10
ds_read_b128 v[188:191], v26 offset:31744
v_smfmac_f32_16x16x64_bf16 v[64:67], v[48:51], v[200:207], v10
s_waitcnt lgkmcnt(6)
v_smfmac_f32_16x16x64_bf16 v[76:79], v[56:59], v[160:167], v10
v_smfmac_f32_16x16x64_bf16 v[68:71], v[48:51], v[208:215], v10
v_smfmac_f32_16x16x64_bf16 v[72:75], v[48:51], v[216:223], v10
s_waitcnt lgkmcnt(4)
v_smfmac_f32_16x16x64_bf16 v[80:83], v[56:59], v[168:175], v10
v_smfmac_f32_16x16x64_bf16 v[76:79], v[48:51], v[224:231], v10
v_smfmac_f32_16x16x64_bf16 v[80:83], v[48:51], v[232:239], v10
s_waitcnt lgkmcnt(2)
v_smfmac_f32_16x16x64_bf16 v[84:87], v[56:59], v[176:183], v10
v_smfmac_f32_16x16x64_bf16 v[84:87], v[48:51], v[240:247], v10
v_smfmac_f32_16x16x64_bf16 v[88:91], v[48:51], v[248:255], v10
s_waitcnt lgkmcnt(0)
v_smfmac_f32_16x16x64_bf16 v[88:91], v[56:59], v[184:191], v10
s_nop 7
v_pk_add_f32 v[60:61], v[60:61], v[62:63]
v_pk_add_f32 v[64:65], v[64:65], v[66:67]
v_pk_add_f32 v[68:69], v[68:69], v[70:71]
v_pk_add_f32 v[72:73], v[72:73], v[74:75]
v_pk_add_f32 v[76:77], v[76:77], v[78:79]
v_pk_add_f32 v[80:81], v[80:81], v[82:83]
v_pk_add_f32 v[84:85], v[84:85], v[86:87]
v_pk_add_f32 v[88:89], v[88:89], v[90:91]
v_cvt_pk_bf16_f32 v124, v60, v61
v_cvt_pk_bf16_f32 v125, v64, v65
v_cvt_pk_bf16_f32 v126, v68, v69
v_cvt_pk_bf16_f32 v127, v72, v73
v_cvt_pk_bf16_f32 v132, v76, v77
v_cvt_pk_bf16_f32 v133, v80, v81
v_cvt_pk_bf16_f32 v134, v84, v85
v_cvt_pk_bf16_f32 v135, v88, v89
s_mov_b64 exec, 15
buffer_load_dword v17, v31, s[8:11], s35 offen sc1
s_nop 15
buffer_load_dword v18, v31, s[8:11], s35 offen sc1
s_nop 15
buffer_load_dword v19, v31, s[8:11], s35 offen sc1
Lfp_159:
s_waitcnt vmcnt(2)
v_cmp_gt_u32 vcc, v14, v17
s_cbranch_vccz Lfg_160
buffer_load_dword v17, v31, s[8:11], s35 offen sc1
s_waitcnt vmcnt(2)
v_cmp_gt_u32 vcc, v14, v18
s_cbranch_vccz Lfg_160
buffer_load_dword v18, v31, s[8:11], s35 offen sc1
s_waitcnt vmcnt(2)
v_cmp_gt_u32 vcc, v14, v19
s_cbranch_vccz Lfg_160
buffer_load_dword v19, v31, s[8:11], s35 offen sc1

s_sub_u32 s19, s19, 1
s_cbranch_scc0 Lfp_159
s_mov_b32 s19, 0
Lfg_160:
s_mov_b64 exec, -1
Lpp_161:
buffer_load_dwordx4 v[140:143], v21, s[8:11], s22 offen sc1
buffer_load_dwordx4 v[144:147], v21, s[8:11], s22 offen offset:1024 sc1

buffer_load_dwordx4 v[148:151], v22, s[8:11], s22 offen sc1

s_waitcnt vmcnt(2)
v_smfmac_f32_16x16x64_bf16 v[152:155], v[140:143], v[92:99], v10
v_smfmac_f32_16x16x64_bf16 v[156:159], v[140:143], v[108:115], v10
s_waitcnt vmcnt(1)
buffer_store_dword v14, v16, s[8:11], s34 offen offset:2048
v_smfmac_f32_16x16x64_bf16 v[152:155], v[144:147], v[100:107], v10
v_smfmac_f32_16x16x64_bf16 v[156:159], v[144:147], v[116:123], v10
s_waitcnt vmcnt(1)
v_smfmac_f32_16x16x64_bf16 v[152:155], v[148:151], v[124:131], v10
v_smfmac_f32_16x16x64_bf16 v[156:159], v[148:151], v[132:139], v10
s_nop 6
v_pk_add_f32 v[152:153], v[152:153], v[154:155]
v_pk_add_f32 v[156:157], v[156:157], v[158:159]
ds_write2_b32 v23, v152, v153 offset0:0 offset1:16
ds_write2_b32 v29, v156, v157 offset0:0 offset1:16
v_cmp_u_f32 vcc, v152, v153
s_cbranch_vccnz Lpr2_164
Lpa2_165:
buffer_store_dword v14, v16, s[8:11], s34 offen
s_waitcnt lgkmcnt(0)
s_barrier
s_add_u32 s18, s18, 1
s_xor_b32 s20, s20, 8192
s_xor_b32 s21, s21, 8192
s_xor_b32 s22, s22, 16384
s_add_u32 s24, s24, 458752
s_add_u32 s39, s39, 458752
s_mov_b32 s27, s26
s_add_u32 s26, s26, 114688
s_lshl_b32 s28, s18, 13
s_add_u32 s28, s28, 53469184

v_cmp_gt_u32 vcc, 32, v30
s_cbranch_vccnz Lcr_167
Lco_166:
s_mov_b64 exec, 16383
buffer_load_dwordx4 v[168:171], v15, s[8:11], s34 offen sc1
s_nop 15
buffer_load_dwordx4 v[172:175], v15, s[8:11], s34 offen sc1
s_nop 15
buffer_load_dwordx4 v[176:179], v15, s[8:11], s34 offen sc1
Lfp_168:
s_waitcnt vmcnt(2)
v_min3_u32 v11, v168, v169, v170
v_min_u32 v11, v11, v171
v_cmp_gt_u32 vcc, v14, v11
s_cbranch_vccz Lfg_169
buffer_load_dwordx4 v[168:171], v15, s[8:11], s34 offen sc1
s_waitcnt vmcnt(2)
v_min3_u32 v11, v172, v173, v174
v_min_u32 v11, v11, v175
v_cmp_gt_u32 vcc, v14, v11
s_cbranch_vccz Lfg_169
buffer_load_dwordx4 v[172:175], v15, s[8:11], s34 offen sc1
s_waitcnt vmcnt(2)
v_min3_u32 v11, v176, v177, v178
v_min_u32 v11, v11, v179
v_cmp_gt_u32 vcc, v14, v11
s_cbranch_vccz Lfg_169
buffer_load_dwordx4 v[176:179], v15, s[8:11], s34 offen sc1
s_sub_u32 s19, s19, 1
s_cbranch_scc0 Lfp_168
s_mov_b32 s19, 0
Lfg_169:
s_mov_b64 exec, -1
v_add_u32 v14, 1, v14
s_cmp_lt_u32 s18, 63
s_cbranch_scc1 Ltop_151
v_mov_b32 v60, 0
v_mov_b32 v61, 0
v_mov_b32 v62, 0
v_mov_b32 v63, 0
v_mov_b32 v64, 0
v_mov_b32 v65, 0
v_mov_b32 v66, 0
v_mov_b32 v67, 0
v_mov_b32 v68, 0
v_mov_b32 v69, 0
v_mov_b32 v70, 0
v_mov_b32 v71, 0
v_mov_b32 v72, 0
v_mov_b32 v73, 0
v_mov_b32 v74, 0
v_mov_b32 v75, 0
v_mov_b32 v76, 0
v_mov_b32 v77, 0
v_mov_b32 v78, 0
v_mov_b32 v79, 0
v_mov_b32 v80, 0
v_mov_b32 v81, 0
v_mov_b32 v82, 0
v_mov_b32 v83, 0
v_mov_b32 v84, 0
v_mov_b32 v85, 0
v_mov_b32 v86, 0
v_mov_b32 v87, 0
v_mov_b32 v88, 0
v_mov_b32 v89, 0
v_mov_b32 v90, 0
v_mov_b32 v91, 0
buffer_load_dwordx4 v[32:35], v3, s[8:11], s20 offen sc1
buffer_load_dwordx4 v[36:39], v4, s[8:11], s20 offen sc1
buffer_load_dwordx4 v[40:43], v5, s[8:11], s20 offen sc1
buffer_load_dwordx4 v[44:47], v6, s[8:11], s20 offen sc1
buffer_load_dwordx4 v[48:51], v7, s[8:11], s20 offen sc1
buffer_load_dwordx4 v[52:55], v8, s[8:11], s20 offen sc1
buffer_load_dwordx4 v[56:59], v9, s[8:11], s20 offen sc1
s_barrier
buffer_store_dwordx4 v[124:127], v2, s[8:11], s27 offen sc1
s_add_u32 s30, s27, 4096
buffer_store_dwordx4 v[132:135], v2, s[8:11], s30 offen sc1
s_waitcnt vmcnt(8)
Lmp_170w:
ds_write_b128 v3, v[32:35] offset:0
v_max3_u32 v11, v32, v33, v34
v_max_u32 v11, v11, v35
s_waitcnt vmcnt(7)
ds_write_b128 v4, v[36:39] offset:0
v_max3_u32 v11, v11, v36, v37
v_max3_u32 v11, v11, v38, v39
s_waitcnt vmcnt(6)
ds_write_b128 v5, v[40:43] offset:0
v_max3_u32 v11, v11, v40, v41
v_max3_u32 v11, v11, v42, v43
s_waitcnt vmcnt(5)
ds_write_b128 v6, v[44:47] offset:0
v_max3_u32 v11, v11, v44, v45
v_max3_u32 v11, v11, v46, v47
s_waitcnt vmcnt(4)
ds_write_b128 v7, v[48:51] offset:0
v_max3_u32 v11, v11, v48, v49
v_max3_u32 v11, v11, v50, v51
s_waitcnt vmcnt(3)
ds_write_b128 v8, v[52:55] offset:0
v_max3_u32 v11, v11, v52, v53
v_max3_u32 v11, v11, v54, v55
s_waitcnt vmcnt(2)
ds_write_b128 v9, v[56:59] offset:0
v_max3_u32 v11, v11, v56, v57
v_max3_u32 v11, v11, v58, v59
v_cmp_eq_u32 vcc, -1, v11
s_cbranch_vccnz Lmr_171
Lma_172:
s_waitcnt lgkmcnt(0)
s_barrier
v_smfmac_f32_16x16x64_bf16 v[60:63], v[32:35], a[0:7], v10
ds_read_b128 v[160:163], v26 offset:0
s_cmp_eq_u32 s33, 0
s_cbranch_scc0 Lsu_173
s_mov_b32 s30, 54857856
buffer_atomic_umax v14, v28, s[8:11], s30 offen
Lsu_173:
v_smfmac_f32_16x16x64_bf16 v[64:67], v[32:35], a[8:15], v10
ds_read_b128 v[164:167], v26 offset:1024
v_smfmac_f32_16x16x64_bf16 v[68:71], v[32:35], a[16:23], v10
ds_read_b128 v[168:171], v26 offset:2048
v_smfmac_f32_16x16x64_bf16 v[72:75], v[32:35], a[24:31], v10
ds_read_b128 v[172:175], v26 offset:3072
v_smfmac_f32_16x16x64_bf16 v[76:79], v[32:35], a[32:39], v10
ds_read_b128 v[176:179], v26 offset:4096
v_smfmac_f32_16x16x64_bf16 v[80:83], v[32:35], a[40:47], v10
ds_read_b128 v[180:183], v26 offset:5120
v_smfmac_f32_16x16x64_bf16 v[84:87], v[32:35], a[48:55], v10
ds_read_b128 v[184:187], v26 offset:6144
v_smfmac_f32_16x16x64_bf16 v[88:91], v[32:35], a[56:63], v10
ds_read_b128 v[188:191], v26 offset:7168
v_smfmac_f32_16x16x64_bf16 v[60:63], v[36:39], a[64:71], v10
v_smfmac_f32_16x16x64_bf16 v[64:67], v[36:39], a[72:79], v10
s_waitcnt lgkmcnt(6)
v_smfmac_f32_16x16x64_bf16 v[60:63], v[52:55], v[160:167], v10
ds_read_b128 v[160:163], v26 offset:8192
v_smfmac_f32_16x16x64_bf16 v[68:71], v[36:39], a[80:87], v10
ds_read_b128 v[164:167], v26 offset:9216
v_smfmac_f32_16x16x64_bf16 v[72:75], v[36:39], a[88:95], v10
s_waitcnt lgkmcnt(6)
v_smfmac_f32_16x16x64_bf16 v[64:67], v[52:55], v[168:175], v10
ds_read_b128 v[168:171], v26 offset:10240
v_smfmac_f32_16x16x64_bf16 v[76:79], v[36:39], a[96:103], v10
ds_read_b128 v[172:175], v26 offset:11264
v_smfmac_f32_16x16x64_bf16 v[80:83], v[36:39], a[104:111], v10
s_waitcnt lgkmcnt(6)
v_smfmac_f32_16x16x64_bf16 v[68:71], v[52:55], v[176:183], v10
ds_read_b128 v[176:179], v26 offset:12288
v_smfmac_f32_16x16x64_bf16 v[84:87], v[36:39], a[112:119], v10
ds_read_b128 v[180:183], v26 offset:13312
v_smfmac_f32_16x16x64_bf16 v[88:91], v[36:39], a[120:127], v10
s_waitcnt lgkmcnt(6)
v_smfmac_f32_16x16x64_bf16 v[72:75], v[52:55], v[184:191], v10
ds_read_b128 v[184:187], v26 offset:14336
v_smfmac_f32_16x16x64_bf16 v[60:63], v[40:43], a[128:135], v10
ds_read_b128 v[188:191], v26 offset:15360
v_smfmac_f32_16x16x64_bf16 v[64:67], v[40:43], a[136:143], v10
s_waitcnt lgkmcnt(6)
v_smfmac_f32_16x16x64_bf16 v[76:79], v[52:55], v[160:167], v10
ds_read_b128 v[160:163], v26 offset:16384
v_smfmac_f32_16x16x64_bf16 v[68:71], v[40:43], a[144:151], v10
ds_read_b128 v[164:167], v26 offset:17408
v_smfmac_f32_16x16x64_bf16 v[72:75], v[40:43], a[152:159], v10
s_waitcnt lgkmcnt(6)
v_smfmac_f32_16x16x64_bf16 v[80:83], v[52:55], v[168:175], v10
ds_read_b128 v[168:171], v26 offset:18432
v_smfmac_f32_16x16x64_bf16 v[76:79], v[40:43], a[160:167], v10
ds_read_b128 v[172:175], v26 offset:19456
v_smfmac_f32_16x16x64_bf16 v[80:83], v[40:43], a[168:175], v10
s_waitcnt lgkmcnt(6)
v_smfmac_f32_16x16x64_bf16 v[84:87], v[52:55], v[176:183], v10
ds_read_b128 v[176:179], v26 offset:20480
v_smfmac_f32_16x16x64_bf16 v[84:87], v[40:43], a[176:183], v10
ds_read_b128 v[180:183], v26 offset:21504
v_smfmac_f32_16x16x64_bf16 v[88:91], v[40:43], a[184:191], v10
s_waitcnt lgkmcnt(6)
v_smfmac_f32_16x16x64_bf16 v[88:91], v[52:55], v[184:191], v10
ds_read_b128 v[184:187], v26 offset:22528
v_smfmac_f32_16x16x64_bf16 v[60:63], v[44:47], a[192:199], v10
ds_read_b128 v[188:191], v26 offset:23552
v_smfmac_f32_16x16x64_bf16 v[64:67], v[44:47], a[200:207], v10
s_waitcnt lgkmcnt(6)
v_smfmac_f32_16x16x64_bf16 v[60:63], v[56:59], v[160:167], v10
ds_read_b128 v[160:163], v26 offset:24576
v_smfmac_f32_16x16x64_bf16 v[68:71], v[44:47], a[208:215], v10
ds_read_b128 v[164:167], v26 offset:25600
v_smfmac_f32_16x16x64_bf16 v[72:75], v[44:47], a[216:223], v10
s_waitcnt lgkmcnt(6)
v_smfmac_f32_16x16x64_bf16 v[64:67], v[56:59], v[168:175], v10
ds_read_b128 v[168:171], v26 offset:26624
v_smfmac_f32_16x16x64_bf16 v[76:79], v[44:47], a[224:231], v10
ds_read_b128 v[172:175], v26 offset:27648
v_smfmac_f32_16x16x64_bf16 v[80:83], v[44:47], a[232:239], v10
s_waitcnt lgkmcnt(6)
v_smfmac_f32_16x16x64_bf16 v[68:71], v[56:59], v[176:183], v10
ds_read_b128 v[176:179], v26 offset:28672
v_smfmac_f32_16x16x64_bf16 v[84:87], v[44:47], a[240:247], v10
ds_read_b128 v[180:183], v26 offset:29696
v_smfmac_f32_16x16x64_bf16 v[88:91], v[44:47], a[248:255], v10
s_waitcnt lgkmcnt(6)
v_smfmac_f32_16x16x64_bf16 v[72:75], v[56:59], v[184:191], v10
ds_read_b128 v[184:187], v26 offset:30720
v_smfmac_f32_16x16x64_bf16 v[60:63], v[48:51], v[192:199], v10
ds_read_b128 v[188:191], v26 offset:31744
v_smfmac_f32_16x16x64_bf16 v[64:67], v[48:51], v[200:207], v10
s_waitcnt lgkmcnt(6)
v_smfmac_f32_16x16x64_bf16 v[76:79], v[56:59], v[160:167], v10
v_smfmac_f32_16x16x64_bf16 v[68:71], v[48:51], v[208:215], v10
v_smfmac_f32_16x16x64_bf16 v[72:75], v[48:51], v[216:223], v10
s_waitcnt lgkmcnt(4)
v_smfmac_f32_16x16x64_bf16 v[80:83], v[56:59], v[168:175], v10
v_smfmac_f32_16x16x64_bf16 v[76:79], v[48:51], v[224:231], v10
v_smfmac_f32_16x16x64_bf16 v[80:83], v[48:51], v[232:239], v10
s_waitcnt lgkmcnt(2)
v_smfmac_f32_16x16x64_bf16 v[84:87], v[56:59], v[176:183], v10
v_smfmac_f32_16x16x64_bf16 v[84:87], v[48:51], v[240:247], v10
v_smfmac_f32_16x16x64_bf16 v[88:91], v[48:51], v[248:255], v10
s_waitcnt lgkmcnt(0)
v_smfmac_f32_16x16x64_bf16 v[88:91], v[56:59], v[184:191], v10
s_nop 7
v_pk_add_f32 v[60:61], v[60:61], v[62:63]
v_pk_add_f32 v[64:65], v[64:65], v[66:67]
v_pk_add_f32 v[68:69], v[68:69], v[70:71]
v_pk_add_f32 v[72:73], v[72:73], v[74:75]
v_pk_add_f32 v[76:77], v[76:77], v[78:79]
v_pk_add_f32 v[80:81], v[80:81], v[82:83]
v_pk_add_f32 v[84:85], v[84:85], v[86:87]
v_pk_add_f32 v[88:89], v[88:89], v[90:91]
v_cvt_pk_bf16_f32 v124, v60, v61
v_cvt_pk_bf16_f32 v125, v64, v65
v_cvt_pk_bf16_f32 v126, v68, v69
v_cvt_pk_bf16_f32 v127, v72, v73
v_cvt_pk_bf16_f32 v132, v76, v77
v_cvt_pk_bf16_f32 v133, v80, v81
v_cvt_pk_bf16_f32 v134, v84, v85
v_cvt_pk_bf16_f32 v135, v88, v89
buffer_store_dwordx4 v[124:127], v2, s[8:11], s26 offen sc1
s_add_u32 s30, s26, 4096
buffer_store_dwordx4 v[132:135], v2, s[8:11], s30 offen sc1
v_mov_b32 v14, 65
s_waitcnt vmcnt(0)
buffer_store_dword v14, v16, s[8:11], s34 offen
s_branch Lrec_done
Lcr_153:
buffer_load_dword v30, v13, s[8:11], s29 offen sc1
s_waitcnt vmcnt(0)
v_cmp_gt_u32 vcc, 32, v30
s_cbranch_vccz Lco_152
s_sleep 4

s_sub_u32 s19, s19, 1
s_cbranch_scc0 Lcr_153
s_mov_b32 s19, 0
s_branch Lco_152
Lmp_154:
buffer_load_dwordx4 v[32:35], v3, s[8:11], s20 offen sc1
buffer_load_dwordx4 v[36:39], v4, s[8:11], s20 offen sc1
buffer_load_dwordx4 v[40:43], v5, s[8:11], s20 offen sc1
buffer_load_dwordx4 v[44:47], v6, s[8:11], s20 offen sc1
buffer_load_dwordx4 v[48:51], v7, s[8:11], s20 offen sc1
buffer_load_dwordx4 v[52:55], v8, s[8:11], s20 offen sc1
buffer_load_dwordx4 v[56:59], v9, s[8:11], s20 offen sc1
s_waitcnt vmcnt(0)
s_branch Lmp_154w
Lmr_155:

s_sub_u32 s19, s19, 1
s_cbranch_scc0 Lmp_154
s_mov_b32 s19, 0
s_branch Lma_156
Lpr2_164:
s_sub_u32 s19, s19, 1
s_cbranch_scc1 Lpr2_164x
s_waitcnt lgkmcnt(0)

v_mov_b32 v152, 0
v_mov_b32 v153, 0
v_mov_b32 v154, 0
v_mov_b32 v155, 0
v_mov_b32 v156, 0
v_mov_b32 v157, 0
v_mov_b32 v158, 0
v_mov_b32 v159, 0
s_branch Lpp_161
Lpr2_164x:
s_mov_b32 s19, 0
s_branch Lpa2_165
Lcr_167:
buffer_load_dword v30, v13, s[8:11], s29 offen sc1
s_waitcnt vmcnt(0)
v_cmp_gt_u32 vcc, 32, v30
s_cbranch_vccz Lco_166
s_sleep 4

s_sub_u32 s19, s19, 1
s_cbranch_scc0 Lcr_167
s_mov_b32 s19, 0
s_branch Lco_166
Lmp_170:
buffer_load_dwordx4 v[32:35], v3, s[8:11], s20 offen sc1
buffer_load_dwordx4 v[36:39], v4, s[8:11], s20 offen sc1
buffer_load_dwordx4 v[40:43], v5, s[8:11], s20 offen sc1
buffer_load_dwordx4 v[44:47], v6, s[8:11], s20 offen sc1
buffer_load_dwordx4 v[48:51], v7, s[8:11], s20 offen sc1
buffer_load_dwordx4 v[52:55], v8, s[8:11], s20 offen sc1
buffer_load_dwordx4 v[56:59], v9, s[8:11], s20 offen sc1
s_waitcnt vmcnt(0)
s_branch Lmp_170w
Lmr_171:

s_sub_u32 s19, s19, 1
s_cbranch_scc0 Lmp_170
s_mov_b32 s19, 0
s_branch Lma_172
.p2align 6
Lrole_83:
v_cmp_gt_u32 vcc, 32, v30
s_cbranch_vccnz Lcr_176
Lco_175:
Ltop_174:
s_barrier
buffer_store_dwordx4 v[124:127], v2, s[8:11], s27 offen sc1
s_add_u32 s30, s27, 4096
buffer_store_dwordx4 v[132:135], v2, s[8:11], s30 offen sc1
s_cmp_lt_u32 s33, 7
s_cbranch_scc1 Lpub_177
Lpubb_178:
buffer_load_dwordx4 v[92:95], v21, s[8:11], s24 offen offset:0 sc1
v_mov_b32 v152, 0
v_mov_b32 v153, 0
v_mov_b32 v154, 0
v_mov_b32 v155, 0
v_mov_b32 v156, 0
buffer_load_dwordx4 v[96:99], v21, s[8:11], s24 offen offset:1024 sc1
v_mov_b32 v157, 0
v_mov_b32 v158, 0
v_mov_b32 v159, 0
v_mov_b32 v60, 0
v_mov_b32 v61, 0
buffer_load_dwordx4 v[100:103], v21, s[8:11], s24 offen offset:2048 sc1
v_mov_b32 v62, 0
v_mov_b32 v63, 0
v_mov_b32 v64, 0
v_mov_b32 v65, 0
v_mov_b32 v66, 0
buffer_load_dwordx4 v[104:107], v21, s[8:11], s24 offen offset:3072 sc1
v_mov_b32 v67, 0
v_mov_b32 v68, 0
v_mov_b32 v69, 0
v_mov_b32 v70, 0
v_mov_b32 v71, 0
buffer_load_dwordx4 v[108:111], v21, s[8:11], s39 offen offset:0 sc1
v_mov_b32 v72, 0
v_mov_b32 v73, 0
v_mov_b32 v74, 0
v_mov_b32 v75, 0
v_mov_b32 v76, 0
buffer_load_dwordx4 v[112:115], v21, s[8:11], s39 offen offset:1024 sc1
v_mov_b32 v77, 0
v_mov_b32 v78, 0
v_mov_b32 v79, 0
v_mov_b32 v80, 0
v_mov_b32 v81, 0
buffer_load_dwordx4 v[116:119], v21, s[8:11], s39 offen offset:2048 sc1
v_mov_b32 v82, 0
v_mov_b32 v83, 0
v_mov_b32 v84, 0
v_mov_b32 v85, 0
v_mov_b32 v86, 0
buffer_load_dwordx4 v[120:123], v21, s[8:11], s39 offen offset:3072 sc1
v_mov_b32 v87, 0
v_mov_b32 v88, 0
v_mov_b32 v89, 0
v_mov_b32 v90, 0
v_mov_b32 v91, 0
s_barrier
ds_read_b128 v[32:35], v3 offset:0
ds_read_b128 v[36:39], v4 offset:0
ds_read_b128 v[52:55], v8 offset:0
ds_read_b128 v[40:43], v5 offset:0
ds_read_b128 v[44:47], v6 offset:0
ds_read_b128 v[48:51], v7 offset:0
ds_read_b128 v[56:59], v9 offset:0
s_waitcnt lgkmcnt(6)
v_smfmac_f32_16x16x64_bf16 v[60:63], v[32:35], a[0:7], v10
ds_read_b128 v[160:163], v26 offset:0
v_smfmac_f32_16x16x64_bf16 v[64:67], v[32:35], a[8:15], v10
ds_read_b128 v[164:167], v26 offset:1024
v_smfmac_f32_16x16x64_bf16 v[68:71], v[32:35], a[16:23], v10
ds_read_b128 v[168:171], v26 offset:2048
v_smfmac_f32_16x16x64_bf16 v[72:75], v[32:35], a[24:31], v10
ds_read_b128 v[172:175], v26 offset:3072
v_smfmac_f32_16x16x64_bf16 v[76:79], v[32:35], a[32:39], v10
ds_read_b128 v[176:179], v26 offset:4096
v_smfmac_f32_16x16x64_bf16 v[80:83], v[32:35], a[40:47], v10
ds_read_b128 v[180:183], v26 offset:5120
v_smfmac_f32_16x16x64_bf16 v[84:87], v[32:35], a[48:55], v10
ds_read_b128 v[184:187], v26 offset:6144
v_smfmac_f32_16x16x64_bf16 v[88:91], v[32:35], a[56:63], v10
ds_read_b128 v[188:191], v26 offset:7168
s_waitcnt lgkmcnt(13)
v_smfmac_f32_16x16x64_bf16 v[60:63], v[36:39], a[64:71], v10
v_smfmac_f32_16x16x64_bf16 v[64:67], v[36:39], a[72:79], v10
s_waitcnt lgkmcnt(12)
s_waitcnt lgkmcnt(6)
v_smfmac_f32_16x16x64_bf16 v[60:63], v[52:55], v[160:167], v10
ds_read_b128 v[160:163], v26 offset:8192
v_smfmac_f32_16x16x64_bf16 v[68:71], v[36:39], a[80:87], v10
ds_read_b128 v[164:167], v26 offset:9216
v_smfmac_f32_16x16x64_bf16 v[72:75], v[36:39], a[88:95], v10
s_waitcnt lgkmcnt(6)
v_smfmac_f32_16x16x64_bf16 v[64:67], v[52:55], v[168:175], v10
ds_read_b128 v[168:171], v26 offset:10240
v_smfmac_f32_16x16x64_bf16 v[76:79], v[36:39], a[96:103], v10
ds_read_b128 v[172:175], v26 offset:11264
v_smfmac_f32_16x16x64_bf16 v[80:83], v[36:39], a[104:111], v10
s_waitcnt lgkmcnt(6)
v_smfmac_f32_16x16x64_bf16 v[68:71], v[52:55], v[176:183], v10
ds_read_b128 v[176:179], v26 offset:12288
v_smfmac_f32_16x16x64_bf16 v[84:87], v[36:39], a[112:119], v10
ds_read_b128 v[180:183], v26 offset:13312
v_smfmac_f32_16x16x64_bf16 v[88:91], v[36:39], a[120:127], v10
s_waitcnt lgkmcnt(6)
v_smfmac_f32_16x16x64_bf16 v[72:75], v[52:55], v[184:191], v10
ds_read_b128 v[184:187], v26 offset:14336
v_smfmac_f32_16x16x64_bf16 v[60:63], v[40:43], a[128:135], v10
ds_read_b128 v[188:191], v26 offset:15360
v_smfmac_f32_16x16x64_bf16 v[64:67], v[40:43], a[136:143], v10
s_waitcnt lgkmcnt(6)
v_smfmac_f32_16x16x64_bf16 v[76:79], v[52:55], v[160:167], v10
ds_read_b128 v[160:163], v26 offset:16384
v_smfmac_f32_16x16x64_bf16 v[68:71], v[40:43], a[144:151], v10
ds_read_b128 v[164:167], v26 offset:17408
v_smfmac_f32_16x16x64_bf16 v[72:75], v[40:43], a[152:159], v10
s_and_b32 s30, s18, 3
s_cmp_eq_u32 s30, 3
s_cbranch_scc0 Lsu_182
s_add_u32 s29, s29, 128
buffer_load_dword v30, v13, s[8:11], s29 offen sc1
Lsu_182:
s_waitcnt lgkmcnt(6)
v_smfmac_f32_16x16x64_bf16 v[80:83], v[52:55], v[168:175], v10
ds_read_b128 v[168:171], v26 offset:18432
v_smfmac_f32_16x16x64_bf16 v[76:79], v[40:43], a[160:167], v10
ds_read_b128 v[172:175], v26 offset:19456
v_smfmac_f32_16x16x64_bf16 v[80:83], v[40:43], a[168:175], v10
s_waitcnt lgkmcnt(6)
v_smfmac_f32_16x16x64_bf16 v[84:87], v[52:55], v[176:183], v10
ds_read_b128 v[176:179], v26 offset:20480
v_smfmac_f32_16x16x64_bf16 v[84:87], v[40:43], a[176:183], v10
ds_read_b128 v[180:183], v26 offset:21504
v_smfmac_f32_16x16x64_bf16 v[88:91], v[40:43], a[184:191], v10
s_waitcnt lgkmcnt(6)
v_smfmac_f32_16x16x64_bf16 v[88:91], v[52:55], v[184:191], v10
ds_read_b128 v[184:187], v26 offset:22528
v_smfmac_f32_16x16x64_bf16 v[60:63], v[44:47], a[192:199], v10
ds_read_b128 v[188:191], v26 offset:23552
v_smfmac_f32_16x16x64_bf16 v[64:67], v[44:47], a[200:207], v10
s_waitcnt lgkmcnt(6)
v_smfmac_f32_16x16x64_bf16 v[60:63], v[56:59], v[160:167], v10
ds_read_b128 v[160:163], v26 offset:24576
v_smfmac_f32_16x16x64_bf16 v[68:71], v[44:47], a[208:215], v10
ds_read_b128 v[164:167], v26 offset:25600
v_smfmac_f32_16x16x64_bf16 v[72:75], v[44:47], a[216:223], v10
s_waitcnt lgkmcnt(6)
v_smfmac_f32_16x16x64_bf16 v[64:67], v[56:59], v[168:175], v10
ds_read_b128 v[168:171], v26 offset:26624
v_smfmac_f32_16x16x64_bf16 v[76:79], v[44:47], a[224:231], v10
ds_read_b128 v[172:175], v26 offset:27648
v_smfmac_f32_16x16x64_bf16 v[80:83], v[44:47], a[232:239], v10
s_waitcnt lgkmcnt(6)
v_smfmac_f32_16x16x64_bf16 v[68:71], v[56:59], v[176:183], v10
ds_read_b128 v[176:179], v26 offset:28672
v_smfmac_f32_16x16x64_bf16 v[84:87], v[44:47], a[240:247], v10
ds_read_b128 v[180:183], v26 offset:29696
v_smfmac_f32_16x16x64_bf16 v[88:91], v[44:47], a[248:255], v10
s_waitcnt lgkmcnt(6)
v_smfmac_f32_16x16x64_bf16 v[72:75], v[56:59], v[184:191], v10
ds_read_b128 v[184:187], v26 offset:30720
v_smfmac_f32_16x16x64_bf16 v[60:63], v[48:51], v[192:199], v10
ds_read_b128 v[188:191], v26 offset:31744
v_smfmac_f32_16x16x64_bf16 v[64:67], v[48:51], v[200:207], v10
s_waitcnt lgkmcnt(6)
v_smfmac_f32_16x16x64_bf16 v[76:79], v[56:59], v[160:167], v10
v_smfmac_f32_16x16x64_bf16 v[68:71], v[48:51], v[208:215], v10
v_smfmac_f32_16x16x64_bf16 v[72:75], v[48:51], v[216:223], v10
s_waitcnt lgkmcnt(4)
v_smfmac_f32_16x16x64_bf16 v[80:83], v[56:59], v[168:175], v10
v_smfmac_f32_16x16x64_bf16 v[76:79], v[48:51], v[224:231], v10
v_smfmac_f32_16x16x64_bf16 v[80:83], v[48:51], v[232:239], v10
s_waitcnt lgkmcnt(2)
v_smfmac_f32_16x16x64_bf16 v[84:87], v[56:59], v[176:183], v10
v_smfmac_f32_16x16x64_bf16 v[84:87], v[48:51], v[240:247], v10
v_smfmac_f32_16x16x64_bf16 v[88:91], v[48:51], v[248:255], v10
s_waitcnt lgkmcnt(0)
v_smfmac_f32_16x16x64_bf16 v[88:91], v[56:59], v[184:191], v10
s_nop 7
v_pk_add_f32 v[60:61], v[60:61], v[62:63]
v_pk_add_f32 v[64:65], v[64:65], v[66:67]
v_pk_add_f32 v[68:69], v[68:69], v[70:71]
v_pk_add_f32 v[72:73], v[72:73], v[74:75]
v_pk_add_f32 v[76:77], v[76:77], v[78:79]
v_pk_add_f32 v[80:81], v[80:81], v[82:83]
v_pk_add_f32 v[84:85], v[84:85], v[86:87]
v_pk_add_f32 v[88:89], v[88:89], v[90:91]
v_cvt_pk_bf16_f32 v124, v60, v61
v_cvt_pk_bf16_f32 v125, v64, v65
v_cvt_pk_bf16_f32 v126, v68, v69
v_cvt_pk_bf16_f32 v127, v72, v73
v_cvt_pk_bf16_f32 v132, v76, v77
v_cvt_pk_bf16_f32 v133, v80, v81
v_cvt_pk_bf16_f32 v134, v84, v85
v_cvt_pk_bf16_f32 v135, v88, v89
s_mov_b64 exec, 15
buffer_load_dword v17, v31, s[8:11], s35 offen sc1
s_nop 15
buffer_load_dword v18, v31, s[8:11], s35 offen sc1
s_nop 15
buffer_load_dword v19, v31, s[8:11], s35 offen sc1
Lfp_183:
s_waitcnt vmcnt(2)
v_cmp_gt_u32 vcc, v14, v17
s_cbranch_vccz Lfg_184
buffer_load_dword v17, v31, s[8:11], s35 offen sc1
s_waitcnt vmcnt(2)
v_cmp_gt_u32 vcc, v14, v18
s_cbranch_vccz Lfg_184
buffer_load_dword v18, v31, s[8:11], s35 offen sc1
s_waitcnt vmcnt(2)
v_cmp_gt_u32 vcc, v14, v19
s_cbranch_vccz Lfg_184
buffer_load_dword v19, v31, s[8:11], s35 offen sc1

s_sub_u32 s19, s19, 1
s_cbranch_scc0 Lfp_183
s_mov_b32 s19, 0
Lfg_184:
s_mov_b64 exec, -1
Lpp_185:
buffer_load_dwordx4 v[140:143], v21, s[8:11], s22 offen sc1
buffer_load_dwordx4 v[144:147], v21, s[8:11], s22 offen offset:1024 sc1

buffer_load_dwordx4 v[148:151], v22, s[8:11], s22 offen sc1

s_waitcnt vmcnt(2)
v_smfmac_f32_16x16x64_bf16 v[152:155], v[140:143], v[92:99], v10
v_smfmac_f32_16x16x64_bf16 v[156:159], v[140:143], v[108:115], v10
s_waitcnt vmcnt(1)
buffer_store_dword v14, v16, s[8:11], s34 offen offset:2048
v_smfmac_f32_16x16x64_bf16 v[152:155], v[144:147], v[100:107], v10
v_smfmac_f32_16x16x64_bf16 v[156:159], v[144:147], v[116:123], v10
s_waitcnt vmcnt(1)
v_smfmac_f32_16x16x64_bf16 v[152:155], v[148:151], v[124:131], v10
v_smfmac_f32_16x16x64_bf16 v[156:159], v[148:151], v[132:139], v10
s_nop 6
v_pk_add_f32 v[152:153], v[152:153], v[154:155]
v_pk_add_f32 v[156:157], v[156:157], v[158:159]
ds_write2_b32 v23, v152, v153 offset0:0 offset1:16
ds_write2_b32 v29, v156, v157 offset0:0 offset1:16
v_cmp_u_f32 vcc, v152, v153
s_cbranch_vccnz Lpr2_188
Lpa2_189:
buffer_store_dword v14, v16, s[8:11], s34 offen
s_waitcnt lgkmcnt(0)
s_barrier
s_add_u32 s18, s18, 1
s_xor_b32 s20, s20, 8192
s_xor_b32 s21, s21, 8192
s_xor_b32 s22, s22, 16384
s_add_u32 s24, s24, 458752
s_add_u32 s39, s39, 458752
s_mov_b32 s27, s26
s_add_u32 s26, s26, 114688
s_lshl_b32 s28, s18, 13
s_add_u32 s28, s28, 53469184

v_cmp_gt_u32 vcc, 32, v30
s_cbranch_vccnz Lcr_191
Lco_190:
v_add_u32 v14, 1, v14
s_cmp_lt_u32 s18, 63
s_cbranch_scc1 Ltop_174
v_mov_b32 v60, 0
v_mov_b32 v61, 0
v_mov_b32 v62, 0
v_mov_b32 v63, 0
v_mov_b32 v64, 0
v_mov_b32 v65, 0
v_mov_b32 v66, 0
v_mov_b32 v67, 0
v_mov_b32 v68, 0
v_mov_b32 v69, 0
v_mov_b32 v70, 0
v_mov_b32 v71, 0
v_mov_b32 v72, 0
v_mov_b32 v73, 0
v_mov_b32 v74, 0
v_mov_b32 v75, 0
v_mov_b32 v76, 0
v_mov_b32 v77, 0
v_mov_b32 v78, 0
v_mov_b32 v79, 0
v_mov_b32 v80, 0
v_mov_b32 v81, 0
v_mov_b32 v82, 0
v_mov_b32 v83, 0
v_mov_b32 v84, 0
v_mov_b32 v85, 0
v_mov_b32 v86, 0
v_mov_b32 v87, 0
v_mov_b32 v88, 0
v_mov_b32 v89, 0
v_mov_b32 v90, 0
v_mov_b32 v91, 0
s_barrier
buffer_store_dwordx4 v[124:127], v2, s[8:11], s27 offen sc1
s_add_u32 s30, s27, 4096
buffer_store_dwordx4 v[132:135], v2, s[8:11], s30 offen sc1
s_cmp_lt_u32 s33, 7
s_cbranch_scc1 Lpub_192
Lpubb_193:
s_barrier
ds_read_b128 v[32:35], v3 offset:0
ds_read_b128 v[36:39], v4 offset:0
ds_read_b128 v[52:55], v8 offset:0
ds_read_b128 v[40:43], v5 offset:0
ds_read_b128 v[44:47], v6 offset:0
ds_read_b128 v[48:51], v7 offset:0
ds_read_b128 v[56:59], v9 offset:0
s_waitcnt lgkmcnt(6)
v_smfmac_f32_16x16x64_bf16 v[60:63], v[32:35], a[0:7], v10
ds_read_b128 v[160:163], v26 offset:0
v_smfmac_f32_16x16x64_bf16 v[64:67], v[32:35], a[8:15], v10
ds_read_b128 v[164:167], v26 offset:1024
v_smfmac_f32_16x16x64_bf16 v[68:71], v[32:35], a[16:23], v10
ds_read_b128 v[168:171], v26 offset:2048
v_smfmac_f32_16x16x64_bf16 v[72:75], v[32:35], a[24:31], v10
ds_read_b128 v[172:175], v26 offset:3072
v_smfmac_f32_16x16x64_bf16 v[76:79], v[32:35], a[32:39], v10
ds_read_b128 v[176:179], v26 offset:4096
v_smfmac_f32_16x16x64_bf16 v[80:83], v[32:35], a[40:47], v10
ds_read_b128 v[180:183], v26 offset:5120
v_smfmac_f32_16x16x64_bf16 v[84:87], v[32:35], a[48:55], v10
ds_read_b128 v[184:187], v26 offset:6144
v_smfmac_f32_16x16x64_bf16 v[88:91], v[32:35], a[56:63], v10
ds_read_b128 v[188:191], v26 offset:7168
s_waitcnt lgkmcnt(13)
v_smfmac_f32_16x16x64_bf16 v[60:63], v[36:39], a[64:71], v10
v_smfmac_f32_16x16x64_bf16 v[64:67], v[36:39], a[72:79], v10
s_waitcnt lgkmcnt(12)
s_waitcnt lgkmcnt(6)
v_smfmac_f32_16x16x64_bf16 v[60:63], v[52:55], v[160:167], v10
ds_read_b128 v[160:163], v26 offset:8192
v_smfmac_f32_16x16x64_bf16 v[68:71], v[36:39], a[80:87], v10
ds_read_b128 v[164:167], v26 offset:9216
v_smfmac_f32_16x16x64_bf16 v[72:75], v[36:39], a[88:95], v10
s_waitcnt lgkmcnt(6)
v_smfmac_f32_16x16x64_bf16 v[64:67], v[52:55], v[168:175], v10
ds_read_b128 v[168:171], v26 offset:10240
v_smfmac_f32_16x16x64_bf16 v[76:79], v[36:39], a[96:103], v10
ds_read_b128 v[172:175], v26 offset:11264
v_smfmac_f32_16x16x64_bf16 v[80:83], v[36:39], a[104:111], v10
s_waitcnt lgkmcnt(6)
v_smfmac_f32_16x16x64_bf16 v[68:71], v[52:55], v[176:183], v10
ds_read_b128 v[176:179], v26 offset:12288
v_smfmac_f32_16x16x64_bf16 v[84:87], v[36:39], a[112:119], v10
ds_read_b128 v[180:183], v26 offset:13312
v_smfmac_f32_16x16x64_bf16 v[88:91], v[36:39], a[120:127], v10
s_waitcnt lgkmcnt(6)
v_smfmac_f32_16x16x64_bf16 v[72:75], v[52:55], v[184:191], v10
ds_read_b128 v[184:187], v26 offset:14336
v_smfmac_f32_16x16x64_bf16 v[60:63], v[40:43], a[128:135], v10
ds_read_b128 v[188:191], v26 offset:15360
v_smfmac_f32_16x16x64_bf16 v[64:67], v[40:43], a[136:143], v10
s_waitcnt lgkmcnt(6)
v_smfmac_f32_16x16x64_bf16 v[76:79], v[52:55], v[160:167], v10
ds_read_b128 v[160:163], v26 offset:16384
v_smfmac_f32_16x16x64_bf16 v[68:71], v[40:43], a[144:151], v10
ds_read_b128 v[164:167], v26 offset:17408
v_smfmac_f32_16x16x64_bf16 v[72:75], v[40:43], a[152:159], v10
s_waitcnt lgkmcnt(6)
v_smfmac_f32_16x16x64_bf16 v[80:83], v[52:55], v[168:175], v10
ds_read_b128 v[168:171], v26 offset:18432
v_smfmac_f32_16x16x64_bf16 v[76:79], v[40:43], a[160:167], v10
ds_read_b128 v[172:175], v26 offset:19456
v_smfmac_f32_16x16x64_bf16 v[80:83], v[40:43], a[168:175], v10
s_waitcnt lgkmcnt(6)
v_smfmac_f32_16x16x64_bf16 v[84:87], v[52:55], v[176:183], v10
ds_read_b128 v[176:179], v26 offset:20480
v_smfmac_f32_16x16x64_bf16 v[84:87], v[40:43], a[176:183], v10
ds_read_b128 v[180:183], v26 offset:21504
v_smfmac_f32_16x16x64_bf16 v[88:91], v[40:43], a[184:191], v10
s_waitcnt lgkmcnt(6)
v_smfmac_f32_16x16x64_bf16 v[88:91], v[52:55], v[184:191], v10
ds_read_b128 v[184:187], v26 offset:22528
v_smfmac_f32_16x16x64_bf16 v[60:63], v[44:47], a[192:199], v10
ds_read_b128 v[188:191], v26 offset:23552
v_smfmac_f32_16x16x64_bf16 v[64:67], v[44:47], a[200:207], v10
s_waitcnt lgkmcnt(6)
v_smfmac_f32_16x16x64_bf16 v[60:63], v[56:59], v[160:167], v10
ds_read_b128 v[160:163], v26 offset:24576
v_smfmac_f32_16x16x64_bf16 v[68:71], v[44:47], a[208:215], v10
ds_read_b128 v[164:167], v26 offset:25600
v_smfmac_f32_16x16x64_bf16 v[72:75], v[44:47], a[216:223], v10
s_waitcnt lgkmcnt(6)
v_smfmac_f32_16x16x64_bf16 v[64:67], v[56:59], v[168:175], v10
ds_read_b128 v[168:171], v26 offset:26624
v_smfmac_f32_16x16x64_bf16 v[76:79], v[44:47], a[224:231], v10
ds_read_b128 v[172:175], v26 offset:27648
v_smfmac_f32_16x16x64_bf16 v[80:83], v[44:47], a[232:239], v10
s_waitcnt lgkmcnt(6)
v_smfmac_f32_16x16x64_bf16 v[68:71], v[56:59], v[176:183], v10
ds_read_b128 v[176:179], v26 offset:28672
v_smfmac_f32_16x16x64_bf16 v[84:87], v[44:47], a[240:247], v10
ds_read_b128 v[180:183], v26 offset:29696
v_smfmac_f32_16x16x64_bf16 v[88:91], v[44:47], a[248:255], v10
s_waitcnt lgkmcnt(6)
v_smfmac_f32_16x16x64_bf16 v[72:75], v[56:59], v[184:191], v10
ds_read_b128 v[184:187], v26 offset:30720
v_smfmac_f32_16x16x64_bf16 v[60:63], v[48:51], v[192:199], v10
ds_read_b128 v[188:191], v26 offset:31744
v_smfmac_f32_16x16x64_bf16 v[64:67], v[48:51], v[200:207], v10
s_waitcnt lgkmcnt(6)
v_smfmac_f32_16x16x64_bf16 v[76:79], v[56:59], v[160:167], v10
v_smfmac_f32_16x16x64_bf16 v[68:71], v[48:51], v[208:215], v10
v_smfmac_f32_16x16x64_bf16 v[72:75], v[48:51], v[216:223], v10
s_waitcnt lgkmcnt(4)
v_smfmac_f32_16x16x64_bf16 v[80:83], v[56:59], v[168:175], v10
v_smfmac_f32_16x16x64_bf16 v[76:79], v[48:51], v[224:231], v10
v_smfmac_f32_16x16x64_bf16 v[80:83], v[48:51], v[232:239], v10
s_waitcnt lgkmcnt(2)
v_smfmac_f32_16x16x64_bf16 v[84:87], v[56:59], v[176:183], v10
v_smfmac_f32_16x16x64_bf16 v[84:87], v[48:51], v[240:247], v10
v_smfmac_f32_16x16x64_bf16 v[88:91], v[48:51], v[248:255], v10
s_waitcnt lgkmcnt(0)
v_smfmac_f32_16x16x64_bf16 v[88:91], v[56:59], v[184:191], v10
s_nop 7
v_pk_add_f32 v[60:61], v[60:61], v[62:63]
v_pk_add_f32 v[64:65], v[64:65], v[66:67]
v_pk_add_f32 v[68:69], v[68:69], v[70:71]
v_pk_add_f32 v[72:73], v[72:73], v[74:75]
v_pk_add_f32 v[76:77], v[76:77], v[78:79]
v_pk_add_f32 v[80:81], v[80:81], v[82:83]
v_pk_add_f32 v[84:85], v[84:85], v[86:87]
v_pk_add_f32 v[88:89], v[88:89], v[90:91]
v_cvt_pk_bf16_f32 v124, v60, v61
v_cvt_pk_bf16_f32 v125, v64, v65
v_cvt_pk_bf16_f32 v126, v68, v69
v_cvt_pk_bf16_f32 v127, v72, v73
v_cvt_pk_bf16_f32 v132, v76, v77
v_cvt_pk_bf16_f32 v133, v80, v81
v_cvt_pk_bf16_f32 v134, v84, v85
v_cvt_pk_bf16_f32 v135, v88, v89
buffer_store_dwordx4 v[124:127], v2, s[8:11], s26 offen sc1
s_add_u32 s30, s26, 4096
buffer_store_dwordx4 v[132:135], v2, s[8:11], s30 offen sc1
v_mov_b32 v14, 65
s_waitcnt vmcnt(0)
buffer_store_dword v14, v16, s[8:11], s34 offen
s_branch Lrec_done
Lcr_176:
buffer_load_dword v30, v13, s[8:11], s29 offen sc1
s_waitcnt vmcnt(0)
v_cmp_gt_u32 vcc, 32, v30
s_cbranch_vccz Lco_175
s_sleep 4

s_sub_u32 s19, s19, 1
s_cbranch_scc0 Lcr_176
s_mov_b32 s19, 0
s_branch Lco_175
Lpub_177:
s_cmp_eq_u32 s33, 0
s_cbranch_scc0 Lpub_177_0
buffer_store_dwordx4 v[52:55], v8, s[8:11], s28 offen sc1
s_branch Lpubb_178
Lpub_177_0:
s_cmp_eq_u32 s33, 1
s_cbranch_scc0 Lpub_177_1
buffer_store_dwordx4 v[56:59], v9, s[8:11], s28 offen sc1
s_branch Lpubb_178
Lpub_177_1:
s_cmp_eq_u32 s33, 2
s_cbranch_scc0 Lpub_177_2
buffer_store_dwordx4 v[32:35], v3, s[8:11], s28 offen sc1
s_branch Lpubb_178
Lpub_177_2:
s_cmp_eq_u32 s33, 3
s_cbranch_scc0 Lpub_177_3
buffer_store_dwordx4 v[36:39], v4, s[8:11], s28 offen sc1
s_branch Lpubb_178
Lpub_177_3:
s_cmp_eq_u32 s33, 4
s_cbranch_scc0 Lpub_177_4
buffer_store_dwordx4 v[40:43], v5, s[8:11], s28 offen sc1
s_branch Lpubb_178
Lpub_177_4:
s_cmp_eq_u32 s33, 5
s_cbranch_scc0 Lpub_177_5
buffer_store_dwordx4 v[44:47], v6, s[8:11], s28 offen sc1
s_branch Lpubb_178
Lpub_177_5:
buffer_store_dwordx4 v[48:51], v7, s[8:11], s28 offen sc1
s_branch Lpubb_178
Lpub_177_6:
Lpr2_188:
s_sub_u32 s19, s19, 1
s_cbranch_scc1 Lpr2_188x
s_waitcnt lgkmcnt(0)

v_mov_b32 v152, 0
v_mov_b32 v153, 0
v_mov_b32 v154, 0
v_mov_b32 v155, 0
v_mov_b32 v156, 0
v_mov_b32 v157, 0
v_mov_b32 v158, 0
v_mov_b32 v159, 0
s_branch Lpp_185
Lpr2_188x:
s_mov_b32 s19, 0
s_branch Lpa2_189
Lcr_191:
buffer_load_dword v30, v13, s[8:11], s29 offen sc1
s_waitcnt vmcnt(0)
v_cmp_gt_u32 vcc, 32, v30
s_cbranch_vccz Lco_190
s_sleep 4

s_sub_u32 s19, s19, 1
s_cbranch_scc0 Lcr_191
s_mov_b32 s19, 0
s_branch Lco_190
Lpub_192:
s_cmp_eq_u32 s33, 0
s_cbranch_scc0 Lpub_192_0
buffer_store_dwordx4 v[52:55], v8, s[8:11], s28 offen sc1
s_branch Lpubb_193
Lpub_192_0:
s_cmp_eq_u32 s33, 1
s_cbranch_scc0 Lpub_192_1
buffer_store_dwordx4 v[56:59], v9, s[8:11], s28 offen sc1
s_branch Lpubb_193
Lpub_192_1:
s_cmp_eq_u32 s33, 2
s_cbranch_scc0 Lpub_192_2
buffer_store_dwordx4 v[32:35], v3, s[8:11], s28 offen sc1
s_branch Lpubb_193
Lpub_192_2:
s_cmp_eq_u32 s33, 3
s_cbranch_scc0 Lpub_192_3
buffer_store_dwordx4 v[36:39], v4, s[8:11], s28 offen sc1
s_branch Lpubb_193
Lpub_192_3:
s_cmp_eq_u32 s33, 4
s_cbranch_scc0 Lpub_192_4
buffer_store_dwordx4 v[40:43], v5, s[8:11], s28 offen sc1
s_branch Lpubb_193
Lpub_192_4:
s_cmp_eq_u32 s33, 5
s_cbranch_scc0 Lpub_192_5
buffer_store_dwordx4 v[44:47], v6, s[8:11], s28 offen sc1
s_branch Lpubb_193
Lpub_192_5:
buffer_store_dwordx4 v[48:51], v7, s[8:11], s28 offen sc1
s_branch Lpubb_193
Lpub_192_6:
.p2align 6
Lrole_85:
v_cmp_gt_u32 vcc, 32, v30
s_cbranch_vccnz Lcr_199
Lco_198:
Ltop_197:
s_barrier
buffer_store_dwordx4 v[124:127], v2, s[8:11], s27 offen sc1
s_add_u32 s30, s27, 4096
buffer_store_dwordx4 v[132:135], v2, s[8:11], s30 offen sc1
buffer_store_dword v20, v25, s[8:11], s21 offen
buffer_load_dwordx4 v[92:95], v21, s[8:11], s24 offen offset:0 sc1
v_mov_b32 v152, 0
v_mov_b32 v153, 0
v_mov_b32 v154, 0
v_mov_b32 v155, 0
v_mov_b32 v156, 0
buffer_load_dwordx4 v[96:99], v21, s[8:11], s24 offen offset:1024 sc1
v_mov_b32 v157, 0
v_mov_b32 v158, 0
v_mov_b32 v159, 0
v_mov_b32 v60, 0
v_mov_b32 v61, 0
buffer_load_dwordx4 v[100:103], v21, s[8:11], s24 offen offset:2048 sc1
v_mov_b32 v62, 0
v_mov_b32 v63, 0
v_mov_b32 v64, 0
v_mov_b32 v65, 0
v_mov_b32 v66, 0
buffer_load_dwordx4 v[104:107], v21, s[8:11], s24 offen offset:3072 sc1
v_mov_b32 v67, 0
v_mov_b32 v68, 0
v_mov_b32 v69, 0
v_mov_b32 v70, 0
v_mov_b32 v71, 0
buffer_load_dwordx4 v[108:111], v21, s[8:11], s39 offen offset:0 sc1
v_mov_b32 v72, 0
v_mov_b32 v73, 0
v_mov_b32 v74, 0
v_mov_b32 v75, 0
v_mov_b32 v76, 0
buffer_load_dwordx4 v[112:115], v21, s[8:11], s39 offen offset:1024 sc1
v_mov_b32 v77, 0
v_mov_b32 v78, 0
v_mov_b32 v79, 0
v_mov_b32 v80, 0
v_mov_b32 v81, 0
buffer_load_dwordx4 v[116:119], v21, s[8:11], s39 offen offset:2048 sc1
v_mov_b32 v82, 0
v_mov_b32 v83, 0
v_mov_b32 v84, 0
v_mov_b32 v85, 0
v_mov_b32 v86, 0
buffer_load_dwordx4 v[120:123], v21, s[8:11], s39 offen offset:3072 sc1
v_mov_b32 v87, 0
v_mov_b32 v88, 0
v_mov_b32 v89, 0
v_mov_b32 v90, 0
v_mov_b32 v91, 0
s_barrier
ds_read_b128 v[32:35], v3 offset:0
ds_read_b128 v[36:39], v4 offset:0
ds_read_b128 v[52:55], v8 offset:0
ds_read_b128 v[40:43], v5 offset:0
ds_read_b128 v[44:47], v6 offset:0
ds_read_b128 v[48:51], v7 offset:0
ds_read_b128 v[56:59], v9 offset:0
s_waitcnt lgkmcnt(6)
v_smfmac_f32_16x16x64_bf16 v[60:63], v[32:35], a[0:7], v10
ds_read_b128 v[160:163], v26 offset:0
v_smfmac_f32_16x16x64_bf16 v[64:67], v[32:35], a[8:15], v10
ds_read_b128 v[164:167], v26 offset:1024
v_smfmac_f32_16x16x64_bf16 v[68:71], v[32:35], a[16:23], v10
ds_read_b128 v[168:171], v26 offset:2048
v_smfmac_f32_16x16x64_bf16 v[72:75], v[32:35], a[24:31], v10
ds_read_b128 v[172:175], v26 offset:3072
v_smfmac_f32_16x16x64_bf16 v[76:79], v[32:35], a[32:39], v10
ds_read_b128 v[176:179], v26 offset:4096
v_smfmac_f32_16x16x64_bf16 v[80:83], v[32:35], a[40:47], v10
ds_read_b128 v[180:183], v26 offset:5120
v_smfmac_f32_16x16x64_bf16 v[84:87], v[32:35], a[48:55], v10
ds_read_b128 v[184:187], v26 offset:6144
v_smfmac_f32_16x16x64_bf16 v[88:91], v[32:35], a[56:63], v10
ds_read_b128 v[188:191], v26 offset:7168
s_waitcnt lgkmcnt(13)
v_smfmac_f32_16x16x64_bf16 v[60:63], v[36:39], a[64:71], v10
v_smfmac_f32_16x16x64_bf16 v[64:67], v[36:39], a[72:79], v10
s_waitcnt lgkmcnt(12)
s_waitcnt lgkmcnt(6)
v_smfmac_f32_16x16x64_bf16 v[60:63], v[52:55], v[160:167], v10
ds_read_b128 v[160:163], v26 offset:8192
v_smfmac_f32_16x16x64_bf16 v[68:71], v[36:39], a[80:87], v10
ds_read_b128 v[164:167], v26 offset:9216
v_smfmac_f32_16x16x64_bf16 v[72:75], v[36:39], a[88:95], v10
s_waitcnt lgkmcnt(6)
v_smfmac_f32_16x16x64_bf16 v[64:67], v[52:55], v[168:175], v10
ds_read_b128 v[168:171], v26 offset:10240
v_smfmac_f32_16x16x64_bf16 v[76:79], v[36:39], a[96:103], v10
ds_read_b128 v[172:175], v26 offset:11264
v_smfmac_f32_16x16x64_bf16 v[80:83], v[36:39], a[104:111], v10
s_waitcnt lgkmcnt(6)
v_smfmac_f32_16x16x64_bf16 v[68:71], v[52:55], v[176:183], v10
ds_read_b128 v[176:179], v26 offset:12288
v_smfmac_f32_16x16x64_bf16 v[84:87], v[36:39], a[112:119], v10
ds_read_b128 v[180:183], v26 offset:13312
v_smfmac_f32_16x16x64_bf16 v[88:91], v[36:39], a[120:127], v10
s_waitcnt lgkmcnt(6)
v_smfmac_f32_16x16x64_bf16 v[72:75], v[52:55], v[184:191], v10
ds_read_b128 v[184:187], v26 offset:14336
v_smfmac_f32_16x16x64_bf16 v[60:63], v[40:43], a[128:135], v10
ds_read_b128 v[188:191], v26 offset:15360
v_smfmac_f32_16x16x64_bf16 v[64:67], v[40:43], a[136:143], v10
s_waitcnt lgkmcnt(6)
v_smfmac_f32_16x16x64_bf16 v[76:79], v[52:55], v[160:167], v10
ds_read_b128 v[160:163], v26 offset:16384
v_smfmac_f32_16x16x64_bf16 v[68:71], v[40:43], a[144:151], v10
ds_read_b128 v[164:167], v26 offset:17408
v_smfmac_f32_16x16x64_bf16 v[72:75], v[40:43], a[152:159], v10
s_waitcnt lgkmcnt(6)
v_smfmac_f32_16x16x64_bf16 v[80:83], v[52:55], v[168:175], v10
ds_read_b128 v[168:171], v26 offset:18432
v_smfmac_f32_16x16x64_bf16 v[76:79], v[40:43], a[160:167], v10
ds_read_b128 v[172:175], v26 offset:19456
v_smfmac_f32_16x16x64_bf16 v[80:83], v[40:43], a[168:175], v10
s_waitcnt lgkmcnt(6)
v_smfmac_f32_16x16x64_bf16 v[84:87], v[52:55], v[176:183], v10
ds_read_b128 v[176:179], v26 offset:20480
s_and_b32 s30, s18, 3
s_cmp_eq_u32 s30, 3
s_cbranch_scc0 Lsu_203
s_add_u32 s29, s29, 128
buffer_load_dword v30, v13, s[8:11], s29 offen sc1
Lsu_203:
v_smfmac_f32_16x16x64_bf16 v[84:87], v[40:43], a[176:183], v10
ds_read_b128 v[180:183], v26 offset:21504
v_smfmac_f32_16x16x64_bf16 v[88:91], v[40:43], a[184:191], v10
s_waitcnt lgkmcnt(6)
v_smfmac_f32_16x16x64_bf16 v[88:91], v[52:55], v[184:191], v10
ds_read_b128 v[184:187], v26 offset:22528
v_smfmac_f32_16x16x64_bf16 v[60:63], v[44:47], a[192:199], v10
ds_read_b128 v[188:191], v26 offset:23552
v_smfmac_f32_16x16x64_bf16 v[64:67], v[44:47], a[200:207], v10
s_waitcnt lgkmcnt(6)
v_smfmac_f32_16x16x64_bf16 v[60:63], v[56:59], v[160:167], v10
ds_read_b128 v[160:163], v26 offset:24576
v_smfmac_f32_16x16x64_bf16 v[68:71], v[44:47], a[208:215], v10
ds_read_b128 v[164:167], v26 offset:25600
v_smfmac_f32_16x16x64_bf16 v[72:75], v[44:47], a[216:223], v10
s_waitcnt lgkmcnt(6)
v_smfmac_f32_16x16x64_bf16 v[64:67], v[56:59], v[168:175], v10
ds_read_b128 v[168:171], v26 offset:26624
v_smfmac_f32_16x16x64_bf16 v[76:79], v[44:47], a[224:231], v10
ds_read_b128 v[172:175], v26 offset:27648
v_smfmac_f32_16x16x64_bf16 v[80:83], v[44:47], a[232:239], v10
s_waitcnt lgkmcnt(6)
v_smfmac_f32_16x16x64_bf16 v[68:71], v[56:59], v[176:183], v10
ds_read_b128 v[176:179], v26 offset:28672
v_smfmac_f32_16x16x64_bf16 v[84:87], v[44:47], a[240:247], v10
ds_read_b128 v[180:183], v26 offset:29696
v_smfmac_f32_16x16x64_bf16 v[88:91], v[44:47], a[248:255], v10
s_waitcnt lgkmcnt(6)
v_smfmac_f32_16x16x64_bf16 v[72:75], v[56:59], v[184:191], v10
ds_read_b128 v[184:187], v26 offset:30720
v_smfmac_f32_16x16x64_bf16 v[60:63], v[48:51], v[192:199], v10
ds_read_b128 v[188:191], v26 offset:31744
v_smfmac_f32_16x16x64_bf16 v[64:67], v[48:51], v[200:207], v10
s_waitcnt lgkmcnt(6)
v_smfmac_f32_16x16x64_bf16 v[76:79], v[56:59], v[160:167], v10
v_smfmac_f32_16x16x64_bf16 v[68:71], v[48:51], v[208:215], v10
v_smfmac_f32_16x16x64_bf16 v[72:75], v[48:51], v[216:223], v10
s_waitcnt lgkmcnt(4)
v_smfmac_f32_16x16x64_bf16 v[80:83], v[56:59], v[168:175], v10
v_smfmac_f32_16x16x64_bf16 v[76:79], v[48:51], v[224:231], v10
v_smfmac_f32_16x16x64_bf16 v[80:83], v[48:51], v[232:239], v10
s_waitcnt lgkmcnt(2)
v_smfmac_f32_16x16x64_bf16 v[84:87], v[56:59], v[176:183], v10
v_smfmac_f32_16x16x64_bf16 v[84:87], v[48:51], v[240:247], v10
v_smfmac_f32_16x16x64_bf16 v[88:91], v[48:51], v[248:255], v10
s_waitcnt lgkmcnt(0)
v_smfmac_f32_16x16x64_bf16 v[88:91], v[56:59], v[184:191], v10
s_nop 7
v_pk_add_f32 v[60:61], v[60:61], v[62:63]
v_pk_add_f32 v[64:65], v[64:65], v[66:67]
v_pk_add_f32 v[68:69], v[68:69], v[70:71]
v_pk_add_f32 v[72:73], v[72:73], v[74:75]
v_pk_add_f32 v[76:77], v[76:77], v[78:79]
v_pk_add_f32 v[80:81], v[80:81], v[82:83]
v_pk_add_f32 v[84:85], v[84:85], v[86:87]
v_pk_add_f32 v[88:89], v[88:89], v[90:91]
v_cvt_pk_bf16_f32 v124, v60, v61
v_cvt_pk_bf16_f32 v125, v64, v65
v_cvt_pk_bf16_f32 v126, v68, v69
v_cvt_pk_bf16_f32 v127, v72, v73
v_cvt_pk_bf16_f32 v132, v76, v77
v_cvt_pk_bf16_f32 v133, v80, v81
v_cvt_pk_bf16_f32 v134, v84, v85
v_cvt_pk_bf16_f32 v135, v88, v89
s_mov_b64 exec, 15
buffer_load_dword v17, v31, s[8:11], s35 offen sc1
s_nop 15
buffer_load_dword v18, v31, s[8:11], s35 offen sc1
s_nop 15
buffer_load_dword v19, v31, s[8:11], s35 offen sc1
Lfp_204:
s_waitcnt vmcnt(2)
v_cmp_gt_u32 vcc, v14, v17
s_cbranch_vccz Lfg_205
buffer_load_dword v17, v31, s[8:11], s35 offen sc1
s_waitcnt vmcnt(2)
v_cmp_gt_u32 vcc, v14, v18
s_cbranch_vccz Lfg_205
buffer_load_dword v18, v31, s[8:11], s35 offen sc1
s_waitcnt vmcnt(2)
v_cmp_gt_u32 vcc, v14, v19
s_cbranch_vccz Lfg_205
buffer_load_dword v19, v31, s[8:11], s35 offen sc1

s_sub_u32 s19, s19, 1
s_cbranch_scc0 Lfp_204
s_mov_b32 s19, 0
Lfg_205:
s_mov_b64 exec, -1
Lpp_206:
buffer_load_dwordx4 v[140:143], v21, s[8:11], s22 offen sc1
buffer_load_dwordx4 v[144:147], v21, s[8:11], s22 offen offset:1024 sc1

buffer_load_dwordx4 v[148:151], v22, s[8:11], s22 offen sc1

s_waitcnt vmcnt(2)
v_smfmac_f32_16x16x64_bf16 v[152:155], v[140:143], v[92:99], v10
v_smfmac_f32_16x16x64_bf16 v[156:159], v[140:143], v[108:115], v10
s_waitcnt vmcnt(1)
buffer_store_dword v14, v16, s[8:11], s34 offen offset:2048
v_smfmac_f32_16x16x64_bf16 v[152:155], v[144:147], v[100:107], v10
v_smfmac_f32_16x16x64_bf16 v[156:159], v[144:147], v[116:123], v10
s_waitcnt vmcnt(1)
v_smfmac_f32_16x16x64_bf16 v[152:155], v[148:151], v[124:131], v10
v_smfmac_f32_16x16x64_bf16 v[156:159], v[148:151], v[132:139], v10
s_nop 6
v_pk_add_f32 v[152:153], v[152:153], v[154:155]
v_pk_add_f32 v[156:157], v[156:157], v[158:159]
ds_write2_b32 v23, v152, v153 offset0:0 offset1:16
ds_write2_b32 v29, v156, v157 offset0:0 offset1:16
v_cmp_u_f32 vcc, v152, v153
s_cbranch_vccnz Lpr2_209
Lpa2_210:
buffer_store_dword v14, v16, s[8:11], s34 offen
s_waitcnt lgkmcnt(0)
s_barrier
ds_read2st64_b64 v[160:163], v24 offset0:0 offset1:1
ds_read2st64_b64 v[164:167], v24 offset0:2 offset1:3
s_waitcnt lgkmcnt(1)
v_pk_add_f32 v[160:161], v[160:161], v[162:163]
s_waitcnt lgkmcnt(0)
v_pk_add_f32 v[164:165], v[164:165], v[166:167]
v_pk_add_f32 v[160:161], v[160:161], v[164:165]
v_cvt_pk_bf16_f32 v160, v160, v161
buffer_store_dword v160, v25, s[8:11], s21 offen
s_cmp_eq_u32 s18, 62
s_mov_b32 s30, 53993472
s_cselect_b32 s30, s30, 1073741824
s_cbranch_scc0 Llast_211
buffer_store_dword v160, v25, s[8:11], s30 offen sc1
Llast_211:
s_add_u32 s18, s18, 1
s_xor_b32 s20, s20, 8192
s_xor_b32 s21, s21, 8192
s_xor_b32 s22, s22, 16384
s_add_u32 s24, s24, 458752
s_add_u32 s39, s39, 458752
s_mov_b32 s27, s26
s_add_u32 s26, s26, 114688
s_lshl_b32 s28, s18, 13
s_add_u32 s28, s28, 53469184

v_cmp_gt_u32 vcc, 32, v30
s_cbranch_vccnz Lcr_213
Lco_212:
v_add_u32 v14, 1, v14
s_cmp_lt_u32 s18, 63
s_cbranch_scc1 Ltop_197
v_mov_b32 v60, 0
v_mov_b32 v61, 0
v_mov_b32 v62, 0
v_mov_b32 v63, 0
v_mov_b32 v64, 0
v_mov_b32 v65, 0
v_mov_b32 v66, 0
v_mov_b32 v67, 0
v_mov_b32 v68, 0
v_mov_b32 v69, 0
v_mov_b32 v70, 0
v_mov_b32 v71, 0
v_mov_b32 v72, 0
v_mov_b32 v73, 0
v_mov_b32 v74, 0
v_mov_b32 v75, 0
v_mov_b32 v76, 0
v_mov_b32 v77, 0
v_mov_b32 v78, 0
v_mov_b32 v79, 0
v_mov_b32 v80, 0
v_mov_b32 v81, 0
v_mov_b32 v82, 0
v_mov_b32 v83, 0
v_mov_b32 v84, 0
v_mov_b32 v85, 0
v_mov_b32 v86, 0
v_mov_b32 v87, 0
v_mov_b32 v88, 0
v_mov_b32 v89, 0
v_mov_b32 v90, 0
v_mov_b32 v91, 0
s_barrier
buffer_store_dwordx4 v[124:127], v2, s[8:11], s27 offen sc1
s_add_u32 s30, s27, 4096
buffer_store_dwordx4 v[132:135], v2, s[8:11], s30 offen sc1
s_barrier
ds_read_b128 v[32:35], v3 offset:0
ds_read_b128 v[36:39], v4 offset:0
ds_read_b128 v[52:55], v8 offset:0
ds_read_b128 v[40:43], v5 offset:0
ds_read_b128 v[44:47], v6 offset:0
ds_read_b128 v[48:51], v7 offset:0
ds_read_b128 v[56:59], v9 offset:0
s_waitcnt lgkmcnt(6)
v_smfmac_f32_16x16x64_bf16 v[60:63], v[32:35], a[0:7], v10
ds_read_b128 v[160:163], v26 offset:0
v_smfmac_f32_16x16x64_bf16 v[64:67], v[32:35], a[8:15], v10
ds_read_b128 v[164:167], v26 offset:1024
v_smfmac_f32_16x16x64_bf16 v[68:71], v[32:35], a[16:23], v10
ds_read_b128 v[168:171], v26 offset:2048
v_smfmac_f32_16x16x64_bf16 v[72:75], v[32:35], a[24:31], v10
ds_read_b128 v[172:175], v26 offset:3072
v_smfmac_f32_16x16x64_bf16 v[76:79], v[32:35], a[32:39], v10
ds_read_b128 v[176:179], v26 offset:4096
v_smfmac_f32_16x16x64_bf16 v[80:83], v[32:35], a[40:47], v10
ds_read_b128 v[180:183], v26 offset:5120
v_smfmac_f32_16x16x64_bf16 v[84:87], v[32:35], a[48:55], v10
ds_read_b128 v[184:187], v26 offset:6144
v_smfmac_f32_16x16x64_bf16 v[88:91], v[32:35], a[56:63], v10
ds_read_b128 v[188:191], v26 offset:7168
s_waitcnt lgkmcnt(13)
v_smfmac_f32_16x16x64_bf16 v[60:63], v[36:39], a[64:71], v10
v_smfmac_f32_16x16x64_bf16 v[64:67], v[36:39], a[72:79], v10
s_waitcnt lgkmcnt(12)
s_waitcnt lgkmcnt(6)
v_smfmac_f32_16x16x64_bf16 v[60:63], v[52:55], v[160:167], v10
ds_read_b128 v[160:163], v26 offset:8192
v_smfmac_f32_16x16x64_bf16 v[68:71], v[36:39], a[80:87], v10
ds_read_b128 v[164:167], v26 offset:9216
v_smfmac_f32_16x16x64_bf16 v[72:75], v[36:39], a[88:95], v10
s_waitcnt lgkmcnt(6)
v_smfmac_f32_16x16x64_bf16 v[64:67], v[52:55], v[168:175], v10
ds_read_b128 v[168:171], v26 offset:10240
v_smfmac_f32_16x16x64_bf16 v[76:79], v[36:39], a[96:103], v10
ds_read_b128 v[172:175], v26 offset:11264
v_smfmac_f32_16x16x64_bf16 v[80:83], v[36:39], a[104:111], v10
s_waitcnt lgkmcnt(6)
v_smfmac_f32_16x16x64_bf16 v[68:71], v[52:55], v[176:183], v10
ds_read_b128 v[176:179], v26 offset:12288
v_smfmac_f32_16x16x64_bf16 v[84:87], v[36:39], a[112:119], v10
ds_read_b128 v[180:183], v26 offset:13312
v_smfmac_f32_16x16x64_bf16 v[88:91], v[36:39], a[120:127], v10
s_waitcnt lgkmcnt(6)
v_smfmac_f32_16x16x64_bf16 v[72:75], v[52:55], v[184:191], v10
ds_read_b128 v[184:187], v26 offset:14336
v_smfmac_f32_16x16x64_bf16 v[60:63], v[40:43], a[128:135], v10
ds_read_b128 v[188:191], v26 offset:15360
v_smfmac_f32_16x16x64_bf16 v[64:67], v[40:43], a[136:143], v10
s_waitcnt lgkmcnt(6)
v_smfmac_f32_16x16x64_bf16 v[76:79], v[52:55], v[160:167], v10
ds_read_b128 v[160:163], v26 offset:16384
v_smfmac_f32_16x16x64_bf16 v[68:71], v[40:43], a[144:151], v10
ds_read_b128 v[164:167], v26 offset:17408
v_smfmac_f32_16x16x64_bf16 v[72:75], v[40:43], a[152:159], v10
s_waitcnt lgkmcnt(6)
v_smfmac_f32_16x16x64_bf16 v[80:83], v[52:55], v[168:175], v10
ds_read_b128 v[168:171], v26 offset:18432
v_smfmac_f32_16x16x64_bf16 v[76:79], v[40:43], a[160:167], v10
ds_read_b128 v[172:175], v26 offset:19456
v_smfmac_f32_16x16x64_bf16 v[80:83], v[40:43], a[168:175], v10
s_waitcnt lgkmcnt(6)
v_smfmac_f32_16x16x64_bf16 v[84:87], v[52:55], v[176:183], v10
ds_read_b128 v[176:179], v26 offset:20480
v_smfmac_f32_16x16x64_bf16 v[84:87], v[40:43], a[176:183], v10
ds_read_b128 v[180:183], v26 offset:21504
v_smfmac_f32_16x16x64_bf16 v[88:91], v[40:43], a[184:191], v10
s_waitcnt lgkmcnt(6)
v_smfmac_f32_16x16x64_bf16 v[88:91], v[52:55], v[184:191], v10
ds_read_b128 v[184:187], v26 offset:22528
v_smfmac_f32_16x16x64_bf16 v[60:63], v[44:47], a[192:199], v10
ds_read_b128 v[188:191], v26 offset:23552
v_smfmac_f32_16x16x64_bf16 v[64:67], v[44:47], a[200:207], v10
s_waitcnt lgkmcnt(6)
v_smfmac_f32_16x16x64_bf16 v[60:63], v[56:59], v[160:167], v10
ds_read_b128 v[160:163], v26 offset:24576
v_smfmac_f32_16x16x64_bf16 v[68:71], v[44:47], a[208:215], v10
ds_read_b128 v[164:167], v26 offset:25600
v_smfmac_f32_16x16x64_bf16 v[72:75], v[44:47], a[216:223], v10
s_waitcnt lgkmcnt(6)
v_smfmac_f32_16x16x64_bf16 v[64:67], v[56:59], v[168:175], v10
ds_read_b128 v[168:171], v26 offset:26624
v_smfmac_f32_16x16x64_bf16 v[76:79], v[44:47], a[224:231], v10
ds_read_b128 v[172:175], v26 offset:27648
v_smfmac_f32_16x16x64_bf16 v[80:83], v[44:47], a[232:239], v10
s_waitcnt lgkmcnt(6)
v_smfmac_f32_16x16x64_bf16 v[68:71], v[56:59], v[176:183], v10
ds_read_b128 v[176:179], v26 offset:28672
v_smfmac_f32_16x16x64_bf16 v[84:87], v[44:47], a[240:247], v10
ds_read_b128 v[180:183], v26 offset:29696
v_smfmac_f32_16x16x64_bf16 v[88:91], v[44:47], a[248:255], v10
s_waitcnt lgkmcnt(6)
v_smfmac_f32_16x16x64_bf16 v[72:75], v[56:59], v[184:191], v10
ds_read_b128 v[184:187], v26 offset:30720
v_smfmac_f32_16x16x64_bf16 v[60:63], v[48:51], v[192:199], v10
ds_read_b128 v[188:191], v26 offset:31744
v_smfmac_f32_16x16x64_bf16 v[64:67], v[48:51], v[200:207], v10
s_waitcnt lgkmcnt(6)
v_smfmac_f32_16x16x64_bf16 v[76:79], v[56:59], v[160:167], v10
v_smfmac_f32_16x16x64_bf16 v[68:71], v[48:51], v[208:215], v10
v_smfmac_f32_16x16x64_bf16 v[72:75], v[48:51], v[216:223], v10
s_waitcnt lgkmcnt(4)
v_smfmac_f32_16x16x64_bf16 v[80:83], v[56:59], v[168:175], v10
v_smfmac_f32_16x16x64_bf16 v[76:79], v[48:51], v[224:231], v10
v_smfmac_f32_16x16x64_bf16 v[80:83], v[48:51], v[232:239], v10
s_waitcnt lgkmcnt(2)
v_smfmac_f32_16x16x64_bf16 v[84:87], v[56:59], v[176:183], v10
v_smfmac_f32_16x16x64_bf16 v[84:87], v[48:51], v[240:247], v10
v_smfmac_f32_16x16x64_bf16 v[88:91], v[48:51], v[248:255], v10
s_waitcnt lgkmcnt(0)
v_smfmac_f32_16x16x64_bf16 v[88:91], v[56:59], v[184:191], v10
s_nop 7
v_pk_add_f32 v[60:61], v[60:61], v[62:63]
v_pk_add_f32 v[64:65], v[64:65], v[66:67]
v_pk_add_f32 v[68:69], v[68:69], v[70:71]
v_pk_add_f32 v[72:73], v[72:73], v[74:75]
v_pk_add_f32 v[76:77], v[76:77], v[78:79]
v_pk_add_f32 v[80:81], v[80:81], v[82:83]
v_pk_add_f32 v[84:85], v[84:85], v[86:87]
v_pk_add_f32 v[88:89], v[88:89], v[90:91]
v_cvt_pk_bf16_f32 v124, v60, v61
v_cvt_pk_bf16_f32 v125, v64, v65
v_cvt_pk_bf16_f32 v126, v68, v69
v_cvt_pk_bf16_f32 v127, v72, v73
v_cvt_pk_bf16_f32 v132, v76, v77
v_cvt_pk_bf16_f32 v133, v80, v81
v_cvt_pk_bf16_f32 v134, v84, v85
v_cvt_pk_bf16_f32 v135, v88, v89
buffer_store_dwordx4 v[124:127], v2, s[8:11], s26 offen sc1
s_add_u32 s30, s26, 4096
buffer_store_dwordx4 v[132:135], v2, s[8:11], s30 offen sc1
v_mov_b32 v14, 65
s_waitcnt vmcnt(0)
buffer_store_dword v14, v16, s[8:11], s34 offen
s_branch Lrec_done
Lcr_199:
buffer_load_dword v30, v13, s[8:11], s29 offen sc1
s_waitcnt vmcnt(0)
v_cmp_gt_u32 vcc, 32, v30
s_cbranch_vccz Lco_198
s_sleep 4

s_sub_u32 s19, s19, 1
s_cbranch_scc0 Lcr_199
s_mov_b32 s19, 0
s_branch Lco_198
Lpr2_209:
s_sub_u32 s19, s19, 1
s_cbranch_scc1 Lpr2_209x
s_waitcnt lgkmcnt(0)

v_mov_b32 v152, 0
v_mov_b32 v153, 0
v_mov_b32 v154, 0
v_mov_b32 v155, 0
v_mov_b32 v156, 0
v_mov_b32 v157, 0
v_mov_b32 v158, 0
v_mov_b32 v159, 0
s_branch Lpp_206
Lpr2_209x:
s_mov_b32 s19, 0
s_branch Lpa2_210
Lcr_213:
buffer_load_dword v30, v13, s[8:11], s29 offen sc1
s_waitcnt vmcnt(0)
v_cmp_gt_u32 vcc, 32, v30
s_cbranch_vccz Lco_212
s_sleep 4

s_sub_u32 s19, s19, 1
s_cbranch_scc0 Lcr_213
s_mov_b32 s19, 0
s_branch Lco_212
.p2align 6
Lrole_87:
v_cmp_gt_u32 vcc, 32, v30
s_cbranch_vccnz Lcr_219
Lco_218:
Ltop_217:
s_barrier
buffer_store_dwordx4 v[124:127], v2, s[8:11], s27 offen sc1
s_add_u32 s30, s27, 4096
buffer_store_dwordx4 v[132:135], v2, s[8:11], s30 offen sc1
buffer_store_dword v20, v25, s[8:11], s21 offen
buffer_load_dwordx4 v[92:95], v21, s[8:11], s24 offen offset:0 sc1
v_mov_b32 v152, 0
v_mov_b32 v153, 0
v_mov_b32 v154, 0
v_mov_b32 v155, 0
v_mov_b32 v156, 0
buffer_load_dwordx4 v[96:99], v21, s[8:11], s24 offen offset:1024 sc1
v_mov_b32 v157, 0
v_mov_b32 v158, 0
v_mov_b32 v159, 0
v_mov_b32 v60, 0
v_mov_b32 v61, 0
buffer_load_dwordx4 v[100:103], v21, s[8:11], s24 offen offset:2048 sc1
v_mov_b32 v62, 0
v_mov_b32 v63, 0
v_mov_b32 v64, 0
v_mov_b32 v65, 0
v_mov_b32 v66, 0
buffer_load_dwordx4 v[104:107], v21, s[8:11], s24 offen offset:3072 sc1
v_mov_b32 v67, 0
v_mov_b32 v68, 0
v_mov_b32 v69, 0
v_mov_b32 v70, 0
v_mov_b32 v71, 0
buffer_load_dwordx4 v[108:111], v21, s[8:11], s39 offen offset:0 sc1
v_mov_b32 v72, 0
v_mov_b32 v73, 0
v_mov_b32 v74, 0
v_mov_b32 v75, 0
v_mov_b32 v76, 0
buffer_load_dwordx4 v[112:115], v21, s[8:11], s39 offen offset:1024 sc1
v_mov_b32 v77, 0
v_mov_b32 v78, 0
v_mov_b32 v79, 0
v_mov_b32 v80, 0
v_mov_b32 v81, 0
buffer_load_dwordx4 v[116:119], v21, s[8:11], s39 offen offset:2048 sc1
v_mov_b32 v82, 0
v_mov_b32 v83, 0
v_mov_b32 v84, 0
v_mov_b32 v85, 0
v_mov_b32 v86, 0
buffer_load_dwordx4 v[120:123], v21, s[8:11], s39 offen offset:3072 sc1
v_mov_b32 v87, 0
v_mov_b32 v88, 0
v_mov_b32 v89, 0
v_mov_b32 v90, 0
v_mov_b32 v91, 0
s_barrier
ds_read_b128 v[32:35], v3 offset:0
ds_read_b128 v[36:39], v4 offset:0
ds_read_b128 v[52:55], v8 offset:0
ds_read_b128 v[40:43], v5 offset:0
ds_read_b128 v[44:47], v6 offset:0
ds_read_b128 v[48:51], v7 offset:0
ds_read_b128 v[56:59], v9 offset:0
s_waitcnt lgkmcnt(6)
v_smfmac_f32_16x16x64_bf16 v[60:63], v[32:35], a[0:7], v10
ds_read_b128 v[160:163], v26 offset:0
v_smfmac_f32_16x16x64_bf16 v[64:67], v[32:35], a[8:15], v10
ds_read_b128 v[164:167], v26 offset:1024
v_smfmac_f32_16x16x64_bf16 v[68:71], v[32:35], a[16:23], v10
ds_read_b128 v[168:171], v26 offset:2048
v_smfmac_f32_16x16x64_bf16 v[72:75], v[32:35], a[24:31], v10
ds_read_b128 v[172:175], v26 offset:3072
v_smfmac_f32_16x16x64_bf16 v[76:79], v[32:35], a[32:39], v10
ds_read_b128 v[176:179], v26 offset:4096
v_smfmac_f32_16x16x64_bf16 v[80:83], v[32:35], a[40:47], v10
ds_read_b128 v[180:183], v26 offset:5120
v_smfmac_f32_16x16x64_bf16 v[84:87], v[32:35], a[48:55], v10
ds_read_b128 v[184:187], v26 offset:6144
v_smfmac_f32_16x16x64_bf16 v[88:91], v[32:35], a[56:63], v10
ds_read_b128 v[188:191], v26 offset:7168
s_waitcnt lgkmcnt(13)
v_smfmac_f32_16x16x64_bf16 v[60:63], v[36:39], a[64:71], v10
v_smfmac_f32_16x16x64_bf16 v[64:67], v[36:39], a[72:79], v10
s_waitcnt lgkmcnt(12)
s_waitcnt lgkmcnt(6)
v_smfmac_f32_16x16x64_bf16 v[60:63], v[52:55], v[160:167], v10
ds_read_b128 v[160:163], v26 offset:8192
v_smfmac_f32_16x16x64_bf16 v[68:71], v[36:39], a[80:87], v10
ds_read_b128 v[164:167], v26 offset:9216
v_smfmac_f32_16x16x64_bf16 v[72:75], v[36:39], a[88:95], v10
s_waitcnt lgkmcnt(6)
v_smfmac_f32_16x16x64_bf16 v[64:67], v[52:55], v[168:175], v10
ds_read_b128 v[168:171], v26 offset:10240
v_smfmac_f32_16x16x64_bf16 v[76:79], v[36:39], a[96:103], v10
ds_read_b128 v[172:175], v26 offset:11264
v_smfmac_f32_16x16x64_bf16 v[80:83], v[36:39], a[104:111], v10
s_waitcnt lgkmcnt(6)
v_smfmac_f32_16x16x64_bf16 v[68:71], v[52:55], v[176:183], v10
ds_read_b128 v[176:179], v26 offset:12288
v_smfmac_f32_16x16x64_bf16 v[84:87], v[36:39], a[112:119], v10
ds_read_b128 v[180:183], v26 offset:13312
v_smfmac_f32_16x16x64_bf16 v[88:91], v[36:39], a[120:127], v10
s_waitcnt lgkmcnt(6)
v_smfmac_f32_16x16x64_bf16 v[72:75], v[52:55], v[184:191], v10
ds_read_b128 v[184:187], v26 offset:14336
v_smfmac_f32_16x16x64_bf16 v[60:63], v[40:43], a[128:135], v10
ds_read_b128 v[188:191], v26 offset:15360
v_smfmac_f32_16x16x64_bf16 v[64:67], v[40:43], a[136:143], v10
s_waitcnt lgkmcnt(6)
v_smfmac_f32_16x16x64_bf16 v[76:79], v[52:55], v[160:167], v10
ds_read_b128 v[160:163], v26 offset:16384
v_smfmac_f32_16x16x64_bf16 v[68:71], v[40:43], a[144:151], v10
ds_read_b128 v[164:167], v26 offset:17408
v_smfmac_f32_16x16x64_bf16 v[72:75], v[40:43], a[152:159], v10
s_waitcnt lgkmcnt(6)
v_smfmac_f32_16x16x64_bf16 v[80:83], v[52:55], v[168:175], v10
ds_read_b128 v[168:171], v26 offset:18432
v_smfmac_f32_16x16x64_bf16 v[76:79], v[40:43], a[160:167], v10
ds_read_b128 v[172:175], v26 offset:19456
v_smfmac_f32_16x16x64_bf16 v[80:83], v[40:43], a[168:175], v10
s_waitcnt lgkmcnt(6)
v_smfmac_f32_16x16x64_bf16 v[84:87], v[52:55], v[176:183], v10
ds_read_b128 v[176:179], v26 offset:20480
v_smfmac_f32_16x16x64_bf16 v[84:87], v[40:43], a[176:183], v10
ds_read_b128 v[180:183], v26 offset:21504
v_smfmac_f32_16x16x64_bf16 v[88:91], v[40:43], a[184:191], v10
s_waitcnt lgkmcnt(6)
v_smfmac_f32_16x16x64_bf16 v[88:91], v[52:55], v[184:191], v10
ds_read_b128 v[184:187], v26 offset:22528
v_smfmac_f32_16x16x64_bf16 v[60:63], v[44:47], a[192:199], v10
ds_read_b128 v[188:191], v26 offset:23552
s_and_b32 s30, s18, 3
s_cmp_eq_u32 s30, 3
s_cbranch_scc0 Lsu_223
s_add_u32 s29, s29, 128
buffer_load_dword v30, v13, s[8:11], s29 offen sc1
Lsu_223:
v_smfmac_f32_16x16x64_bf16 v[64:67], v[44:47], a[200:207], v10
s_waitcnt lgkmcnt(6)
v_smfmac_f32_16x16x64_bf16 v[60:63], v[56:59], v[160:167], v10
ds_read_b128 v[160:163], v26 offset:24576
v_smfmac_f32_16x16x64_bf16 v[68:71], v[44:47], a[208:215], v10
ds_read_b128 v[164:167], v26 offset:25600
v_smfmac_f32_16x16x64_bf16 v[72:75], v[44:47], a[216:223], v10
s_waitcnt lgkmcnt(6)
v_smfmac_f32_16x16x64_bf16 v[64:67], v[56:59], v[168:175], v10
ds_read_b128 v[168:171], v26 offset:26624
v_smfmac_f32_16x16x64_bf16 v[76:79], v[44:47], a[224:231], v10
ds_read_b128 v[172:175], v26 offset:27648
v_smfmac_f32_16x16x64_bf16 v[80:83], v[44:47], a[232:239], v10
s_waitcnt lgkmcnt(6)
v_smfmac_f32_16x16x64_bf16 v[68:71], v[56:59], v[176:183], v10
ds_read_b128 v[176:179], v26 offset:28672
v_smfmac_f32_16x16x64_bf16 v[84:87], v[44:47], a[240:247], v10
ds_read_b128 v[180:183], v26 offset:29696
v_smfmac_f32_16x16x64_bf16 v[88:91], v[44:47], a[248:255], v10
s_waitcnt lgkmcnt(6)
v_smfmac_f32_16x16x64_bf16 v[72:75], v[56:59], v[184:191], v10
ds_read_b128 v[184:187], v26 offset:30720
v_smfmac_f32_16x16x64_bf16 v[60:63], v[48:51], v[192:199], v10
ds_read_b128 v[188:191], v26 offset:31744
v_smfmac_f32_16x16x64_bf16 v[64:67], v[48:51], v[200:207], v10
s_waitcnt lgkmcnt(6)
v_smfmac_f32_16x16x64_bf16 v[76:79], v[56:59], v[160:167], v10
v_smfmac_f32_16x16x64_bf16 v[68:71], v[48:51], v[208:215], v10
v_smfmac_f32_16x16x64_bf16 v[72:75], v[48:51], v[216:223], v10
s_waitcnt lgkmcnt(4)
v_smfmac_f32_16x16x64_bf16 v[80:83], v[56:59], v[168:175], v10
v_smfmac_f32_16x16x64_bf16 v[76:79], v[48:51], v[224:231], v10
v_smfmac_f32_16x16x64_bf16 v[80:83], v[48:51], v[232:239], v10
s_waitcnt lgkmcnt(2)
v_smfmac_f32_16x16x64_bf16 v[84:87], v[56:59], v[176:183], v10
v_smfmac_f32_16x16x64_bf16 v[84:87], v[48:51], v[240:247], v10
v_smfmac_f32_16x16x64_bf16 v[88:91], v[48:51], v[248:255], v10
s_waitcnt lgkmcnt(0)
v_smfmac_f32_16x16x64_bf16 v[88:91], v[56:59], v[184:191], v10
s_nop 7
v_pk_add_f32 v[60:61], v[60:61], v[62:63]
v_pk_add_f32 v[64:65], v[64:65], v[66:67]
v_pk_add_f32 v[68:69], v[68:69], v[70:71]
v_pk_add_f32 v[72:73], v[72:73], v[74:75]
v_pk_add_f32 v[76:77], v[76:77], v[78:79]
v_pk_add_f32 v[80:81], v[80:81], v[82:83]
v_pk_add_f32 v[84:85], v[84:85], v[86:87]
v_pk_add_f32 v[88:89], v[88:89], v[90:91]
v_cvt_pk_bf16_f32 v124, v60, v61
v_cvt_pk_bf16_f32 v125, v64, v65
v_cvt_pk_bf16_f32 v126, v68, v69
v_cvt_pk_bf16_f32 v127, v72, v73
v_cvt_pk_bf16_f32 v132, v76, v77
v_cvt_pk_bf16_f32 v133, v80, v81
v_cvt_pk_bf16_f32 v134, v84, v85
v_cvt_pk_bf16_f32 v135, v88, v89
s_mov_b64 exec, 15
buffer_load_dword v17, v31, s[8:11], s35 offen sc1
s_nop 15
buffer_load_dword v18, v31, s[8:11], s35 offen sc1
s_nop 15
buffer_load_dword v19, v31, s[8:11], s35 offen sc1
Lfp_224:
s_waitcnt vmcnt(2)
v_cmp_gt_u32 vcc, v14, v17
s_cbranch_vccz Lfg_225
buffer_load_dword v17, v31, s[8:11], s35 offen sc1
s_waitcnt vmcnt(2)
v_cmp_gt_u32 vcc, v14, v18
s_cbranch_vccz Lfg_225
buffer_load_dword v18, v31, s[8:11], s35 offen sc1
s_waitcnt vmcnt(2)
v_cmp_gt_u32 vcc, v14, v19
s_cbranch_vccz Lfg_225
buffer_load_dword v19, v31, s[8:11], s35 offen sc1

s_sub_u32 s19, s19, 1
s_cbranch_scc0 Lfp_224
s_mov_b32 s19, 0
Lfg_225:
s_mov_b64 exec, -1
Lpp_226:
buffer_load_dwordx4 v[140:143], v21, s[8:11], s22 offen sc1
buffer_load_dwordx4 v[144:147], v21, s[8:11], s22 offen offset:1024 sc1

buffer_load_dwordx4 v[148:151], v22, s[8:11], s22 offen sc1

s_waitcnt vmcnt(2)
v_smfmac_f32_16x16x64_bf16 v[152:155], v[140:143], v[92:99], v10
v_smfmac_f32_16x16x64_bf16 v[156:159], v[140:143], v[108:115], v10
s_waitcnt vmcnt(1)
buffer_store_dword v14, v16, s[8:11], s34 offen offset:2048
v_smfmac_f32_16x16x64_bf16 v[152:155], v[144:147], v[100:107], v10
v_smfmac_f32_16x16x64_bf16 v[156:159], v[144:147], v[116:123], v10
s_waitcnt vmcnt(1)
v_smfmac_f32_16x16x64_bf16 v[152:155], v[148:151], v[124:131], v10
v_smfmac_f32_16x16x64_bf16 v[156:159], v[148:151], v[132:139], v10
s_nop 6
v_pk_add_f32 v[152:153], v[152:153], v[154:155]
v_pk_add_f32 v[156:157], v[156:157], v[158:159]
ds_write2_b32 v23, v152, v153 offset0:0 offset1:16
ds_write2_b32 v29, v156, v157 offset0:0 offset1:16
v_cmp_u_f32 vcc, v152, v153
s_cbranch_vccnz Lpr2_229
Lpa2_230:
buffer_store_dword v14, v16, s[8:11], s34 offen
s_waitcnt lgkmcnt(0)
s_barrier
ds_read2st64_b64 v[160:163], v24 offset0:0 offset1:1
ds_read2st64_b64 v[164:167], v24 offset0:2 offset1:3
s_waitcnt lgkmcnt(1)
v_pk_add_f32 v[160:161], v[160:161], v[162:163]
s_waitcnt lgkmcnt(0)
v_pk_add_f32 v[164:165], v[164:165], v[166:167]
v_pk_add_f32 v[160:161], v[160:161], v[164:165]
v_cvt_pk_bf16_f32 v160, v160, v161
buffer_store_dword v160, v25, s[8:11], s21 offen
s_cmp_eq_u32 s18, 62
s_mov_b32 s30, 53993472
s_cselect_b32 s30, s30, 1073741824
s_cbranch_scc0 Llast_231
buffer_store_dword v160, v25, s[8:11], s30 offen sc1
Llast_231:
s_add_u32 s18, s18, 1
s_xor_b32 s20, s20, 8192
s_xor_b32 s21, s21, 8192
s_xor_b32 s22, s22, 16384
s_add_u32 s24, s24, 458752
s_add_u32 s39, s39, 458752
s_mov_b32 s27, s26
s_add_u32 s26, s26, 114688
s_lshl_b32 s28, s18, 13
s_add_u32 s28, s28, 53469184

v_cmp_gt_u32 vcc, 32, v30
s_cbranch_vccnz Lcr_233
Lco_232:
v_add_u32 v14, 1, v14
s_cmp_lt_u32 s18, 63
s_cbranch_scc1 Ltop_217
v_mov_b32 v60, 0
v_mov_b32 v61, 0
v_mov_b32 v62, 0
v_mov_b32 v63, 0
v_mov_b32 v64, 0
v_mov_b32 v65, 0
v_mov_b32 v66, 0
v_mov_b32 v67, 0
v_mov_b32 v68, 0
v_mov_b32 v69, 0
v_mov_b32 v70, 0
v_mov_b32 v71, 0
v_mov_b32 v72, 0
v_mov_b32 v73, 0
v_mov_b32 v74, 0
v_mov_b32 v75, 0
v_mov_b32 v76, 0
v_mov_b32 v77, 0
v_mov_b32 v78, 0
v_mov_b32 v79, 0
v_mov_b32 v80, 0
v_mov_b32 v81, 0
v_mov_b32 v82, 0
v_mov_b32 v83, 0
v_mov_b32 v84, 0
v_mov_b32 v85, 0
v_mov_b32 v86, 0
v_mov_b32 v87, 0
v_mov_b32 v88, 0
v_mov_b32 v89, 0
v_mov_b32 v90, 0
v_mov_b32 v91, 0
s_barrier
buffer_store_dwordx4 v[124:127], v2, s[8:11], s27 offen sc1
s_add_u32 s30, s27, 4096
buffer_store_dwordx4 v[132:135], v2, s[8:11], s30 offen sc1
s_barrier
ds_read_b128 v[32:35], v3 offset:0
ds_read_b128 v[36:39], v4 offset:0
ds_read_b128 v[52:55], v8 offset:0
ds_read_b128 v[40:43], v5 offset:0
ds_read_b128 v[44:47], v6 offset:0
ds_read_b128 v[48:51], v7 offset:0
ds_read_b128 v[56:59], v9 offset:0
s_waitcnt lgkmcnt(6)
v_smfmac_f32_16x16x64_bf16 v[60:63], v[32:35], a[0:7], v10
ds_read_b128 v[160:163], v26 offset:0
v_smfmac_f32_16x16x64_bf16 v[64:67], v[32:35], a[8:15], v10
ds_read_b128 v[164:167], v26 offset:1024
v_smfmac_f32_16x16x64_bf16 v[68:71], v[32:35], a[16:23], v10
ds_read_b128 v[168:171], v26 offset:2048
v_smfmac_f32_16x16x64_bf16 v[72:75], v[32:35], a[24:31], v10
ds_read_b128 v[172:175], v26 offset:3072
v_smfmac_f32_16x16x64_bf16 v[76:79], v[32:35], a[32:39], v10
ds_read_b128 v[176:179], v26 offset:4096
v_smfmac_f32_16x16x64_bf16 v[80:83], v[32:35], a[40:47], v10
ds_read_b128 v[180:183], v26 offset:5120
v_smfmac_f32_16x16x64_bf16 v[84:87], v[32:35], a[48:55], v10
ds_read_b128 v[184:187], v26 offset:6144
v_smfmac_f32_16x16x64_bf16 v[88:91], v[32:35], a[56:63], v10
ds_read_b128 v[188:191], v26 offset:7168
s_waitcnt lgkmcnt(13)
v_smfmac_f32_16x16x64_bf16 v[60:63], v[36:39], a[64:71], v10
v_smfmac_f32_16x16x64_bf16 v[64:67], v[36:39], a[72:79], v10
s_waitcnt lgkmcnt(12)
s_waitcnt lgkmcnt(6)
v_smfmac_f32_16x16x64_bf16 v[60:63], v[52:55], v[160:167], v10
ds_read_b128 v[160:163], v26 offset:8192
v_smfmac_f32_16x16x64_bf16 v[68:71], v[36:39], a[80:87], v10
ds_read_b128 v[164:167], v26 offset:9216
v_smfmac_f32_16x16x64_bf16 v[72:75], v[36:39], a[88:95], v10
s_waitcnt lgkmcnt(6)
v_smfmac_f32_16x16x64_bf16 v[64:67], v[52:55], v[168:175], v10
ds_read_b128 v[168:171], v26 offset:10240
v_smfmac_f32_16x16x64_bf16 v[76:79], v[36:39], a[96:103], v10
ds_read_b128 v[172:175], v26 offset:11264
v_smfmac_f32_16x16x64_bf16 v[80:83], v[36:39], a[104:111], v10
s_waitcnt lgkmcnt(6)
v_smfmac_f32_16x16x64_bf16 v[68:71], v[52:55], v[176:183], v10
ds_read_b128 v[176:179], v26 offset:12288
v_smfmac_f32_16x16x64_bf16 v[84:87], v[36:39], a[112:119], v10
ds_read_b128 v[180:183], v26 offset:13312
v_smfmac_f32_16x16x64_bf16 v[88:91], v[36:39], a[120:127], v10
s_waitcnt lgkmcnt(6)
v_smfmac_f32_16x16x64_bf16 v[72:75], v[52:55], v[184:191], v10
ds_read_b128 v[184:187], v26 offset:14336
v_smfmac_f32_16x16x64_bf16 v[60:63], v[40:43], a[128:135], v10
ds_read_b128 v[188:191], v26 offset:15360
v_smfmac_f32_16x16x64_bf16 v[64:67], v[40:43], a[136:143], v10
s_waitcnt lgkmcnt(6)
v_smfmac_f32_16x16x64_bf16 v[76:79], v[52:55], v[160:167], v10
ds_read_b128 v[160:163], v26 offset:16384
v_smfmac_f32_16x16x64_bf16 v[68:71], v[40:43], a[144:151], v10
ds_read_b128 v[164:167], v26 offset:17408
v_smfmac_f32_16x16x64_bf16 v[72:75], v[40:43], a[152:159], v10
s_waitcnt lgkmcnt(6)
v_smfmac_f32_16x16x64_bf16 v[80:83], v[52:55], v[168:175], v10
ds_read_b128 v[168:171], v26 offset:18432
v_smfmac_f32_16x16x64_bf16 v[76:79], v[40:43], a[160:167], v10
ds_read_b128 v[172:175], v26 offset:19456
v_smfmac_f32_16x16x64_bf16 v[80:83], v[40:43], a[168:175], v10
s_waitcnt lgkmcnt(6)
v_smfmac_f32_16x16x64_bf16 v[84:87], v[52:55], v[176:183], v10
ds_read_b128 v[176:179], v26 offset:20480
v_smfmac_f32_16x16x64_bf16 v[84:87], v[40:43], a[176:183], v10
ds_read_b128 v[180:183], v26 offset:21504
v_smfmac_f32_16x16x64_bf16 v[88:91], v[40:43], a[184:191], v10
s_waitcnt lgkmcnt(6)
v_smfmac_f32_16x16x64_bf16 v[88:91], v[52:55], v[184:191], v10
ds_read_b128 v[184:187], v26 offset:22528
v_smfmac_f32_16x16x64_bf16 v[60:63], v[44:47], a[192:199], v10
ds_read_b128 v[188:191], v26 offset:23552
v_smfmac_f32_16x16x64_bf16 v[64:67], v[44:47], a[200:207], v10
s_waitcnt lgkmcnt(6)
v_smfmac_f32_16x16x64_bf16 v[60:63], v[56:59], v[160:167], v10
ds_read_b128 v[160:163], v26 offset:24576
v_smfmac_f32_16x16x64_bf16 v[68:71], v[44:47], a[208:215], v10
ds_read_b128 v[164:167], v26 offset:25600
v_smfmac_f32_16x16x64_bf16 v[72:75], v[44:47], a[216:223], v10
s_waitcnt lgkmcnt(6)
v_smfmac_f32_16x16x64_bf16 v[64:67], v[56:59], v[168:175], v10
ds_read_b128 v[168:171], v26 offset:26624
v_smfmac_f32_16x16x64_bf16 v[76:79], v[44:47], a[224:231], v10
ds_read_b128 v[172:175], v26 offset:27648
v_smfmac_f32_16x16x64_bf16 v[80:83], v[44:47], a[232:239], v10
s_waitcnt lgkmcnt(6)
v_smfmac_f32_16x16x64_bf16 v[68:71], v[56:59], v[176:183], v10
ds_read_b128 v[176:179], v26 offset:28672
v_smfmac_f32_16x16x64_bf16 v[84:87], v[44:47], a[240:247], v10
ds_read_b128 v[180:183], v26 offset:29696
v_smfmac_f32_16x16x64_bf16 v[88:91], v[44:47], a[248:255], v10
s_waitcnt lgkmcnt(6)
v_smfmac_f32_16x16x64_bf16 v[72:75], v[56:59], v[184:191], v10
ds_read_b128 v[184:187], v26 offset:30720
v_smfmac_f32_16x16x64_bf16 v[60:63], v[48:51], v[192:199], v10
ds_read_b128 v[188:191], v26 offset:31744
v_smfmac_f32_16x16x64_bf16 v[64:67], v[48:51], v[200:207], v10
s_waitcnt lgkmcnt(6)
v_smfmac_f32_16x16x64_bf16 v[76:79], v[56:59], v[160:167], v10
v_smfmac_f32_16x16x64_bf16 v[68:71], v[48:51], v[208:215], v10
v_smfmac_f32_16x16x64_bf16 v[72:75], v[48:51], v[216:223], v10
s_waitcnt lgkmcnt(4)
v_smfmac_f32_16x16x64_bf16 v[80:83], v[56:59], v[168:175], v10
v_smfmac_f32_16x16x64_bf16 v[76:79], v[48:51], v[224:231], v10
v_smfmac_f32_16x16x64_bf16 v[80:83], v[48:51], v[232:239], v10
s_waitcnt lgkmcnt(2)
v_smfmac_f32_16x16x64_bf16 v[84:87], v[56:59], v[176:183], v10
v_smfmac_f32_16x16x64_bf16 v[84:87], v[48:51], v[240:247], v10
v_smfmac_f32_16x16x64_bf16 v[88:91], v[48:51], v[248:255], v10
s_waitcnt lgkmcnt(0)
v_smfmac_f32_16x16x64_bf16 v[88:91], v[56:59], v[184:191], v10
s_nop 7
v_pk_add_f32 v[60:61], v[60:61], v[62:63]
v_pk_add_f32 v[64:65], v[64:65], v[66:67]
v_pk_add_f32 v[68:69], v[68:69], v[70:71]
v_pk_add_f32 v[72:73], v[72:73], v[74:75]
v_pk_add_f32 v[76:77], v[76:77], v[78:79]
v_pk_add_f32 v[80:81], v[80:81], v[82:83]
v_pk_add_f32 v[84:85], v[84:85], v[86:87]
v_pk_add_f32 v[88:89], v[88:89], v[90:91]
v_cvt_pk_bf16_f32 v124, v60, v61
v_cvt_pk_bf16_f32 v125, v64, v65
v_cvt_pk_bf16_f32 v126, v68, v69
v_cvt_pk_bf16_f32 v127, v72, v73
v_cvt_pk_bf16_f32 v132, v76, v77
v_cvt_pk_bf16_f32 v133, v80, v81
v_cvt_pk_bf16_f32 v134, v84, v85
v_cvt_pk_bf16_f32 v135, v88, v89
buffer_store_dwordx4 v[124:127], v2, s[8:11], s26 offen sc1
s_add_u32 s30, s26, 4096
buffer_store_dwordx4 v[132:135], v2, s[8:11], s30 offen sc1
v_mov_b32 v14, 65
s_waitcnt vmcnt(0)
buffer_store_dword v14, v16, s[8:11], s34 offen
s_branch Lrec_done
Lcr_219:
buffer_load_dword v30, v13, s[8:11], s29 offen sc1
s_waitcnt vmcnt(0)
v_cmp_gt_u32 vcc, 32, v30
s_cbranch_vccz Lco_218
s_sleep 4

s_sub_u32 s19, s19, 1
s_cbranch_scc0 Lcr_219
s_mov_b32 s19, 0
s_branch Lco_218
Lpr2_229:
s_sub_u32 s19, s19, 1
s_cbranch_scc1 Lpr2_229x
s_waitcnt lgkmcnt(0)

v_mov_b32 v152, 0
v_mov_b32 v153, 0
v_mov_b32 v154, 0
v_mov_b32 v155, 0
v_mov_b32 v156, 0
v_mov_b32 v157, 0
v_mov_b32 v158, 0
v_mov_b32 v159, 0
s_branch Lpp_226
Lpr2_229x:
s_mov_b32 s19, 0
s_branch Lpa2_230
Lcr_233:
buffer_load_dword v30, v13, s[8:11], s29 offen sc1
s_waitcnt vmcnt(0)
v_cmp_gt_u32 vcc, 32, v30
s_cbranch_vccz Lco_232
s_sleep 4

s_sub_u32 s19, s19, 1
s_cbranch_scc0 Lcr_233
s_mov_b32 s19, 0
s_branch Lco_232
Lteamend:
.p2align 6
Lrole_78:
ds_read_b128 v[144:147], v24 offset:0
ds_read_b128 v[148:151], v24 offset:1024
ds_read_b128 v[152:155], v24 offset:2048
ds_read_b128 v[156:159], v24 offset:3072
s_waitcnt lgkmcnt(0)
Ltop_237:
Lmp_238:
buffer_load_dwordx4 v[32:35], v3, s[8:11], s20 offen sc1
buffer_load_dwordx4 v[36:39], v4, s[8:11], s20 offen sc1
s_nop 15
s_nop 15
buffer_load_dwordx4 v[136:139], v3, s[8:11], s20 offen sc1
buffer_load_dwordx4 v[140:143], v4, s[8:11], s20 offen sc1
s_waitcnt vmcnt(2)
v_max_u32 v11, v35, v39
v_cmp_eq_u32 vcc, -1, v11
s_cbranch_vccnz Lmp_238b
Lma_240:
ds_write_b128 v3, v[32:35] offset:0
ds_write_b128 v4, v[36:39] offset:0
v_smfmac_f32_16x16x64_bf16 v[84:87], v[32:35], v[144:151], v10
v_max3_u32 v11, v32, v33, v34
v_smfmac_f32_16x16x64_bf16 v[60:63], v[32:35], a[0:7], v10
v_max3_u32 v11, v11, v36, v37
v_smfmac_f32_16x16x64_bf16 v[64:67], v[32:35], a[56:63], v10
v_max_u32 v11, v11, v38
v_cmp_eq_u32 vcc, -1, v11
v_smfmac_f32_16x16x64_bf16 v[68:71], v[32:35], a[112:119], v10
v_smfmac_f32_16x16x64_bf16 v[72:75], v[32:35], a[168:175], v10
s_cbranch_vccnz Lmr2_241
Lma2_242:
s_waitcnt lgkmcnt(0)
s_barrier
ds_read_b128 v[40:43], v5 offset:0
ds_read_b128 v[44:47], v6 offset:0
v_smfmac_f32_16x16x64_bf16 v[76:79], v[32:35], a[224:231], v10
ds_read_b128 v[48:51], v7 offset:0
v_smfmac_f32_16x16x64_bf16 v[80:83], v[32:35], v[200:207], v10
ds_read_b128 v[52:55], v8 offset:0
v_smfmac_f32_16x16x64_bf16 v[84:87], v[36:39], v[152:159], v10
ds_read_b128 v[56:59], v9 offset:0
v_smfmac_f32_16x16x64_bf16 v[60:63], v[36:39], a[8:15], v10
ds_read_b128 v[144:147], v24 offset:4096
v_smfmac_f32_16x16x64_bf16 v[64:67], v[36:39], a[64:71], v10
ds_read_b128 v[148:151], v24 offset:5120
v_smfmac_f32_16x16x64_bf16 v[68:71], v[36:39], a[120:127], v10
ds_read_b128 v[152:155], v24 offset:6144
v_smfmac_f32_16x16x64_bf16 v[72:75], v[36:39], a[176:183], v10
ds_read_b128 v[156:159], v24 offset:7168
v_smfmac_f32_16x16x64_bf16 v[76:79], v[36:39], a[232:239], v10
v_smfmac_f32_16x16x64_bf16 v[80:83], v[36:39], v[208:215], v10
s_waitcnt lgkmcnt(4)
v_smfmac_f32_16x16x64_bf16 v[60:63], v[40:43], a[16:23], v10
ds_read_b128 v[120:123], v23 offset:0
v_smfmac_f32_16x16x64_bf16 v[60:63], v[44:47], a[24:31], v10
ds_read_b128 v[124:127], v23 offset:512
v_smfmac_f32_16x16x64_bf16 v[60:63], v[48:51], a[32:39], v10
ds_read_b128 v[128:131], v23 offset:1024
v_smfmac_f32_16x16x64_bf16 v[60:63], v[52:55], a[40:47], v10
ds_read_b128 v[132:135], v30 offset:0
v_smfmac_f32_16x16x64_bf16 v[60:63], v[56:59], a[48:55], v10
s_waitcnt lgkmcnt(6)
v_smfmac_f32_16x16x64_bf16 v[84:87], v[40:43], v[144:151], v10
v_smfmac_f32_16x16x64_bf16 v[64:67], v[40:43], a[72:79], v10
ds_read_b128 v[144:147], v24 offset:8192
s_nop 0
v_smfmac_f32_16x16x64_bf16 v[64:67], v[44:47], a[80:87], v10
ds_read_b128 v[148:151], v24 offset:9216
v_smfmac_f32_16x16x64_bf16 v[64:67], v[48:51], a[88:95], v10
v_add_f32 v60, v60, v62
v_smfmac_f32_16x16x64_bf16 v[64:67], v[52:55], a[96:103], v10
v_add_f32 v61, v61, v63
v_smfmac_f32_16x16x64_bf16 v[64:67], v[56:59], a[104:111], v10
s_waitcnt lgkmcnt(6)
v_smfmac_f32_16x16x64_bf16 v[84:87], v[44:47], v[152:159], v10
v_smfmac_f32_16x16x64_bf16 v[68:71], v[40:43], a[128:135], v10
ds_read_b128 v[152:155], v24 offset:10240
s_nop 0
v_smfmac_f32_16x16x64_bf16 v[68:71], v[44:47], a[136:143], v10
ds_read_b128 v[156:159], v24 offset:11264
v_smfmac_f32_16x16x64_bf16 v[68:71], v[48:51], a[144:151], v10
v_add_f32 v64, v64, v66
v_smfmac_f32_16x16x64_bf16 v[68:71], v[52:55], a[152:159], v10
v_add_f32 v65, v65, v67
v_smfmac_f32_16x16x64_bf16 v[68:71], v[56:59], a[160:167], v10
v_cvt_pk_bf16_f32 v62, v60, v64
s_waitcnt lgkmcnt(2)
v_smfmac_f32_16x16x64_bf16 v[84:87], v[48:51], v[144:151], v10
v_cvt_pk_bf16_f32 v63, v61, v65
v_smfmac_f32_16x16x64_bf16 v[72:75], v[40:43], a[184:191], v10
ds_read_b128 v[144:147], v24 offset:12288
ds_write2_b32 v172, v62, v63 offset0:0 offset1:4
v_smfmac_f32_16x16x64_bf16 v[72:75], v[44:47], a[192:199], v10
ds_read_b128 v[148:151], v24 offset:13312
v_smfmac_f32_16x16x64_bf16 v[72:75], v[48:51], a[200:207], v10
v_add_f32 v68, v68, v70
v_smfmac_f32_16x16x64_bf16 v[72:75], v[52:55], a[208:215], v10
v_add_f32 v69, v69, v71
v_smfmac_f32_16x16x64_bf16 v[72:75], v[56:59], a[216:223], v10
s_waitcnt lgkmcnt(3)
v_smfmac_f32_16x16x64_bf16 v[84:87], v[52:55], v[152:159], v10
v_smfmac_f32_16x16x64_bf16 v[76:79], v[40:43], a[240:247], v10
s_nop 0
s_nop 0
v_smfmac_f32_16x16x64_bf16 v[76:79], v[44:47], a[248:255], v10
s_nop 0
v_smfmac_f32_16x16x64_bf16 v[76:79], v[48:51], v[176:183], v10
v_add_f32 v72, v72, v74
v_smfmac_f32_16x16x64_bf16 v[76:79], v[52:55], v[184:191], v10
v_add_f32 v73, v73, v75
v_smfmac_f32_16x16x64_bf16 v[76:79], v[56:59], v[192:199], v10
v_cvt_pk_bf16_f32 v70, v68, v72
s_waitcnt lgkmcnt(0)
v_smfmac_f32_16x16x64_bf16 v[84:87], v[56:59], v[144:151], v10
v_cvt_pk_bf16_f32 v71, v69, v73
v_smfmac_f32_16x16x64_bf16 v[80:83], v[40:43], v[216:223], v10
ds_write2_b32 v172, v70, v71 offset0:128 offset1:132
v_smfmac_f32_16x16x64_bf16 v[80:83], v[44:47], v[224:231], v10
s_nop 0
ds_read_b128 v[136:139], v26
v_smfmac_f32_16x16x64_bf16 v[80:83], v[48:51], v[232:239], v10
v_add_f32 v76, v76, v78
v_add_f32 v77, v77, v79
v_smfmac_f32_16x16x64_bf16 v[80:83], v[52:55], v[240:247], v10
v_add_f32 v84, v84, v86
v_add_f32 v85, v85, v87
v_smfmac_f32_16x16x64_bf16 v[80:83], v[56:59], v[248:255], v10
v_cvt_pk_bf16_f32 v78, v76, v84
v_cvt_pk_bf16_f32 v79, v77, v85
s_waitcnt lgkmcnt(0)
v_smfmac_f32_16x16x64_bf16 v[160:163], v[136:139], v[88:95], v10
ds_write2_b32 v31, v78, v79 offset0:0 offset1:4
v_smfmac_f32_16x16x64_bf16 v[164:167], v[136:139], v[104:111], v10
s_nop 0
v_smfmac_f32_16x16x64_bf16 v[168:171], v[136:139], v[120:127], v10
s_nop 0
v_add_f32 v80, v80, v82
v_add_f32 v81, v81, v83
v_cvt_pk_bf16_f32 v82, v80, v81
ds_write_b16 v21, v82 offset:1536
ds_write_b16_d16_hi v21, v82 offset:1552
ds_read_b128 v[140:143], v26 offset:1024
s_waitcnt lgkmcnt(0)
v_smfmac_f32_16x16x64_bf16 v[160:163], v[140:143], v[96:103], v10
v_smfmac_f32_16x16x64_bf16 v[164:167], v[140:143], v[112:119], v10
v_smfmac_f32_16x16x64_bf16 v[168:171], v[140:143], v[128:135], v10
s_nop 5
v_pk_add_f32 v[160:161], v[160:161], v[162:163]
ds_write2_b32 v22, v160, v161 offset0:0 offset1:32
v_pk_add_f32 v[164:165], v[164:165], v[166:167]
ds_write2_b32 v22, v164, v165 offset0:16 offset1:48
v_pk_add_f32 v[168:169], v[168:169], v[170:171]
ds_write2_b32 v173, v168, v169 offset0:0 offset1:32
s_waitcnt lgkmcnt(0)
s_barrier
v_mov_b32 v60, 0
v_mov_b32 v61, 0
v_mov_b32 v62, 0
v_mov_b32 v63, 0
v_mov_b32 v64, 0
v_mov_b32 v65, 0
v_mov_b32 v66, 0
v_mov_b32 v67, 0
v_mov_b32 v68, 0
v_mov_b32 v69, 0
v_mov_b32 v70, 0
v_mov_b32 v71, 0
v_mov_b32 v72, 0
v_mov_b32 v73, 0
v_mov_b32 v74, 0
v_mov_b32 v75, 0
v_mov_b32 v76, 0
v_mov_b32 v77, 0
s_cmp_eq_u32 s17, 0
s_cbranch_scc0 Lfl_245
buffer_store_dword v14, v16, s[8:11], s35 offen sc1
Lfl_245:
v_mov_b32 v60, 0
v_mov_b32 v61, 0
v_mov_b32 v62, 0
v_mov_b32 v63, 0
v_mov_b32 v64, 0
v_mov_b32 v65, 0
v_mov_b32 v66, 0
v_mov_b32 v67, 0
v_mov_b32 v68, 0
v_mov_b32 v69, 0
v_mov_b32 v70, 0
v_mov_b32 v71, 0
v_mov_b32 v72, 0
v_mov_b32 v73, 0
v_mov_b32 v74, 0
v_mov_b32 v75, 0
v_mov_b32 v76, 0
v_mov_b32 v77, 0
v_mov_b32 v78, 0
v_mov_b32 v79, 0
v_mov_b32 v80, 0
v_mov_b32 v81, 0
v_mov_b32 v82, 0
v_mov_b32 v83, 0
v_mov_b32 v84, 0
v_mov_b32 v85, 0
v_mov_b32 v86, 0
v_mov_b32 v87, 0
v_mov_b32 v160, 0
v_mov_b32 v161, 0
v_mov_b32 v162, 0
v_mov_b32 v163, 0
v_mov_b32 v164, 0
v_mov_b32 v165, 0
v_mov_b32 v166, 0
v_mov_b32 v167, 0
v_mov_b32 v168, 0
v_mov_b32 v169, 0
v_mov_b32 v170, 0
v_mov_b32 v171, 0
ds_read_b128 v[144:147], v24 offset:0
ds_read_b128 v[148:151], v24 offset:1024
ds_read_b128 v[152:155], v24 offset:2048
ds_read_b128 v[156:159], v24 offset:3072
s_waitcnt lgkmcnt(0)
s_add_u32 s25, s25, 28672
s_add_u32 s36, s36, 28672
s_barrier
s_cmp_eq_u32 s18, 62
s_cbranch_scc1 Lrec_done
buffer_load_dwordx4 v[88:91], v2, s[8:11], s25 offen offset:0 sc1
buffer_load_dwordx4 v[92:95], v2, s[8:11], s25 offen offset:1024 sc1
buffer_load_dwordx4 v[96:99], v2, s[8:11], s25 offen offset:2048 sc1
buffer_load_dwordx4 v[100:103], v2, s[8:11], s25 offen offset:3072 sc1
buffer_load_dwordx4 v[104:107], v2, s[8:11], s36 offen offset:0 sc1
buffer_load_dwordx4 v[108:111], v2, s[8:11], s36 offen offset:1024 sc1
buffer_load_dwordx4 v[112:115], v2, s[8:11], s36 offen offset:2048 sc1
buffer_load_dwordx4 v[116:119], v2, s[8:11], s36 offen offset:3072 sc1
s_add_u32 s18, s18, 1
s_xor_b32 s20, s20, 8192
s_xor_b32 s22, s22, 16384
s_xor_b32 s23, s23, 16384
s_add_u32 s28, s28, 8192
s_add_u32 s38, s38, s42
s_mov_b64 exec, 15
buffer_load_dwordx4 v[40:43], v15, s[8:11], s34 offen sc1
s_nop 15
buffer_load_dwordx4 v[44:47], v15, s[8:11], s34 offen sc1
s_nop 15
buffer_load_dwordx4 v[48:51], v15, s[8:11], s34 offen sc1
Lfp_246:
s_waitcnt vmcnt(2)
v_min3_u32 v11, v40, v41, v42
v_min_u32 v11, v11, v43
v_cmp_gt_u32 vcc, v14, v11
s_cbranch_vccz Lfg_247
buffer_load_dwordx4 v[40:43], v15, s[8:11], s34 offen sc1
s_waitcnt vmcnt(2)
v_min3_u32 v11, v44, v45, v46
v_min_u32 v11, v11, v47
v_cmp_gt_u32 vcc, v14, v11
s_cbranch_vccz Lfg_247
buffer_load_dwordx4 v[44:47], v15, s[8:11], s34 offen sc1
s_waitcnt vmcnt(2)
v_min3_u32 v11, v48, v49, v50
v_min_u32 v11, v11, v51
v_cmp_gt_u32 vcc, v14, v11
s_cbranch_vccz Lfg_247
buffer_load_dwordx4 v[48:51], v15, s[8:11], s34 offen sc1
s_sub_u32 s19, s19, 1
s_cbranch_scc0 Lfp_246
s_mov_b32 s19, 0
Lfg_247:
s_mov_b64 exec, -1
v_add_u32 v14, 1, v14
s_branch Ltop_237
Lmp_238b:
s_waitcnt vmcnt(0)
v_max_u32 v11, v139, v143
v_cmp_eq_u32 vcc, -1, v11
s_cbranch_vccnz Lmr_239
v_mov_b32 v32, v136
v_mov_b32 v33, v137
v_mov_b32 v34, v138
v_mov_b32 v35, v139
v_mov_b32 v36, v140
v_mov_b32 v37, v141
v_mov_b32 v38, v142
v_mov_b32 v39, v143
s_nop 0
s_branch Lma_240
Lmr_239:

s_sub_u32 s19, s19, 1
s_cbranch_scc0 Lmp_238
s_mov_b32 s19, 0
s_branch Lma_240
Lmr2_241:

s_sub_u32 s19, s19, 1
s_cbranch_scc1 Lmr2_241x
s_nop 15
v_mov_b32 v60, 0
v_mov_b32 v61, 0
v_mov_b32 v62, 0
v_mov_b32 v63, 0
v_mov_b32 v64, 0
v_mov_b32 v65, 0
v_mov_b32 v66, 0
v_mov_b32 v67, 0
v_mov_b32 v68, 0
v_mov_b32 v69, 0
v_mov_b32 v70, 0
v_mov_b32 v71, 0
v_mov_b32 v72, 0
v_mov_b32 v73, 0
v_mov_b32 v74, 0
v_mov_b32 v75, 0
v_mov_b32 v76, 0
v_mov_b32 v77, 0
v_mov_b32 v78, 0
v_mov_b32 v79, 0
v_mov_b32 v80, 0
v_mov_b32 v81, 0
v_mov_b32 v82, 0
v_mov_b32 v83, 0
v_mov_b32 v84, 0
v_mov_b32 v85, 0
v_mov_b32 v86, 0
v_mov_b32 v87, 0
s_branch Lmp_238
Lmr2_241x:
s_mov_b32 s19, 0
s_branch Lma2_242
.p2align 6
Lrole_80:
ds_read_b128 v[144:147], v24 offset:0
ds_read_b128 v[148:151], v24 offset:1024
ds_read_b128 v[152:155], v24 offset:2048
ds_read_b128 v[156:159], v24 offset:3072
s_waitcnt lgkmcnt(0)
Ltop_248:
Lmp_249:
buffer_load_dwordx4 v[32:35], v3, s[8:11], s20 offen sc1
buffer_load_dwordx4 v[36:39], v4, s[8:11], s20 offen sc1
s_nop 15
s_nop 15
buffer_load_dwordx4 v[136:139], v3, s[8:11], s20 offen sc1
buffer_load_dwordx4 v[140:143], v4, s[8:11], s20 offen sc1
s_waitcnt vmcnt(2)
v_max_u32 v11, v35, v39
v_cmp_eq_u32 vcc, -1, v11
s_cbranch_vccnz Lmp_249b
Lma_251:
ds_write_b128 v3, v[32:35] offset:0
ds_write_b128 v4, v[36:39] offset:0
v_smfmac_f32_16x16x64_bf16 v[84:87], v[32:35], v[144:151], v10
v_max3_u32 v11, v32, v33, v34
v_smfmac_f32_16x16x64_bf16 v[60:63], v[32:35], a[0:7], v10
v_max3_u32 v11, v11, v36, v37
v_smfmac_f32_16x16x64_bf16 v[64:67], v[32:35], a[56:63], v10
v_max_u32 v11, v11, v38
v_cmp_eq_u32 vcc, -1, v11
v_smfmac_f32_16x16x64_bf16 v[68:71], v[32:35], a[112:119], v10
v_smfmac_f32_16x16x64_bf16 v[72:75], v[32:35], a[168:175], v10
s_cbranch_vccnz Lmr2_252
Lma2_253:
s_waitcnt lgkmcnt(0)
s_barrier
ds_read_b128 v[40:43], v5 offset:0
ds_read_b128 v[44:47], v6 offset:0
v_smfmac_f32_16x16x64_bf16 v[76:79], v[32:35], a[224:231], v10
ds_read_b128 v[48:51], v7 offset:0
v_smfmac_f32_16x16x64_bf16 v[80:83], v[32:35], v[200:207], v10
ds_read_b128 v[52:55], v8 offset:0
v_smfmac_f32_16x16x64_bf16 v[84:87], v[36:39], v[152:159], v10
ds_read_b128 v[56:59], v9 offset:0
v_smfmac_f32_16x16x64_bf16 v[60:63], v[36:39], a[8:15], v10
ds_read_b128 v[144:147], v24 offset:4096
v_smfmac_f32_16x16x64_bf16 v[64:67], v[36:39], a[64:71], v10
ds_read_b128 v[148:151], v24 offset:5120
v_smfmac_f32_16x16x64_bf16 v[68:71], v[36:39], a[120:127], v10
ds_read_b128 v[152:155], v24 offset:6144
v_smfmac_f32_16x16x64_bf16 v[72:75], v[36:39], a[176:183], v10
ds_read_b128 v[156:159], v24 offset:7168
v_smfmac_f32_16x16x64_bf16 v[76:79], v[36:39], a[232:239], v10
v_smfmac_f32_16x16x64_bf16 v[80:83], v[36:39], v[208:215], v10
s_waitcnt lgkmcnt(4)
v_smfmac_f32_16x16x64_bf16 v[60:63], v[40:43], a[16:23], v10
ds_read_b128 v[120:123], v23 offset:0
v_smfmac_f32_16x16x64_bf16 v[60:63], v[44:47], a[24:31], v10
ds_read_b128 v[124:127], v23 offset:512
v_smfmac_f32_16x16x64_bf16 v[60:63], v[48:51], a[32:39], v10
ds_read_b128 v[128:131], v23 offset:1024
v_smfmac_f32_16x16x64_bf16 v[60:63], v[52:55], a[40:47], v10
ds_read_b128 v[132:135], v30 offset:0
v_smfmac_f32_16x16x64_bf16 v[60:63], v[56:59], a[48:55], v10
buffer_store_dwordx2 v[174:175], v27, s[8:11], s23 offen sc1
s_waitcnt lgkmcnt(6)
v_smfmac_f32_16x16x64_bf16 v[84:87], v[40:43], v[144:151], v10
v_smfmac_f32_16x16x64_bf16 v[64:67], v[40:43], a[72:79], v10
ds_read_b128 v[144:147], v24 offset:8192
s_nop 0
v_smfmac_f32_16x16x64_bf16 v[64:67], v[44:47], a[80:87], v10
ds_read_b128 v[148:151], v24 offset:9216
buffer_store_dword v174, v28, s[8:11], s23 offen sc1
v_smfmac_f32_16x16x64_bf16 v[64:67], v[48:51], a[88:95], v10
v_add_f32 v60, v60, v62
v_smfmac_f32_16x16x64_bf16 v[64:67], v[52:55], a[96:103], v10
v_add_f32 v61, v61, v63
v_smfmac_f32_16x16x64_bf16 v[64:67], v[56:59], a[104:111], v10
s_waitcnt lgkmcnt(6)
v_smfmac_f32_16x16x64_bf16 v[84:87], v[44:47], v[152:159], v10
v_smfmac_f32_16x16x64_bf16 v[68:71], v[40:43], a[128:135], v10
ds_read_b128 v[152:155], v24 offset:10240
s_nop 0
v_smfmac_f32_16x16x64_bf16 v[68:71], v[44:47], a[136:143], v10
ds_read_b128 v[156:159], v24 offset:11264
v_smfmac_f32_16x16x64_bf16 v[68:71], v[48:51], a[144:151], v10
v_add_f32 v64, v64, v66
v_smfmac_f32_16x16x64_bf16 v[68:71], v[52:55], a[152:159], v10
v_add_f32 v65, v65, v67
v_smfmac_f32_16x16x64_bf16 v[68:71], v[56:59], a[160:167], v10
v_cvt_pk_bf16_f32 v62, v60, v64
s_waitcnt lgkmcnt(2)
v_smfmac_f32_16x16x64_bf16 v[84:87], v[48:51], v[144:151], v10
v_cvt_pk_bf16_f32 v63, v61, v65
v_smfmac_f32_16x16x64_bf16 v[72:75], v[40:43], a[184:191], v10
ds_read_b128 v[144:147], v24 offset:12288
ds_write2_b32 v172, v62, v63 offset0:0 offset1:4
v_smfmac_f32_16x16x64_bf16 v[72:75], v[44:47], a[192:199], v10
ds_read_b128 v[148:151], v24 offset:13312
v_smfmac_f32_16x16x64_bf16 v[72:75], v[48:51], a[200:207], v10
v_add_f32 v68, v68, v70
v_smfmac_f32_16x16x64_bf16 v[72:75], v[52:55], a[208:215], v10
v_add_f32 v69, v69, v71
v_smfmac_f32_16x16x64_bf16 v[72:75], v[56:59], a[216:223], v10
s_waitcnt lgkmcnt(3)
v_smfmac_f32_16x16x64_bf16 v[84:87], v[52:55], v[152:159], v10
v_smfmac_f32_16x16x64_bf16 v[76:79], v[40:43], a[240:247], v10
s_nop 0
s_nop 0
v_smfmac_f32_16x16x64_bf16 v[76:79], v[44:47], a[248:255], v10
s_nop 0
v_smfmac_f32_16x16x64_bf16 v[76:79], v[48:51], v[176:183], v10
v_add_f32 v72, v72, v74
v_smfmac_f32_16x16x64_bf16 v[76:79], v[52:55], v[184:191], v10
v_add_f32 v73, v73, v75
v_smfmac_f32_16x16x64_bf16 v[76:79], v[56:59], v[192:199], v10
v_cvt_pk_bf16_f32 v70, v68, v72
s_waitcnt lgkmcnt(0)
v_smfmac_f32_16x16x64_bf16 v[84:87], v[56:59], v[144:151], v10
v_cvt_pk_bf16_f32 v71, v69, v73
v_smfmac_f32_16x16x64_bf16 v[80:83], v[40:43], v[216:223], v10
ds_write2_b32 v172, v70, v71 offset0:128 offset1:132
v_smfmac_f32_16x16x64_bf16 v[80:83], v[44:47], v[224:231], v10
s_nop 0
ds_read_b128 v[136:139], v26
v_smfmac_f32_16x16x64_bf16 v[80:83], v[48:51], v[232:239], v10
v_add_f32 v76, v76, v78
v_add_f32 v77, v77, v79
v_smfmac_f32_16x16x64_bf16 v[80:83], v[52:55], v[240:247], v10
v_add_f32 v84, v84, v86
v_add_f32 v85, v85, v87
v_smfmac_f32_16x16x64_bf16 v[80:83], v[56:59], v[248:255], v10
v_cvt_pk_bf16_f32 v78, v76, v84
v_cvt_pk_bf16_f32 v79, v77, v85
s_waitcnt lgkmcnt(0)
v_smfmac_f32_16x16x64_bf16 v[160:163], v[136:139], v[88:95], v10
ds_write2_b32 v31, v78, v79 offset0:0 offset1:4
v_smfmac_f32_16x16x64_bf16 v[164:167], v[136:139], v[104:111], v10
s_nop 0
v_smfmac_f32_16x16x64_bf16 v[168:171], v[136:139], v[120:127], v10
s_nop 0
v_add_f32 v80, v80, v82
v_add_f32 v81, v81, v83
v_cvt_pk_bf16_f32 v82, v80, v81
ds_write_b16 v21, v82 offset:1536
ds_write_b16_d16_hi v21, v82 offset:1552
ds_read_b128 v[140:143], v26 offset:1024
s_waitcnt lgkmcnt(0)
v_smfmac_f32_16x16x64_bf16 v[160:163], v[140:143], v[96:103], v10
v_smfmac_f32_16x16x64_bf16 v[164:167], v[140:143], v[112:119], v10
v_smfmac_f32_16x16x64_bf16 v[168:171], v[140:143], v[128:135], v10
s_nop 5
v_pk_add_f32 v[160:161], v[160:161], v[162:163]
ds_write2_b32 v22, v160, v161 offset0:0 offset1:32
v_pk_add_f32 v[164:165], v[164:165], v[166:167]
ds_write2_b32 v22, v164, v165 offset0:16 offset1:48
v_pk_add_f32 v[168:169], v[168:169], v[170:171]
ds_write2_b32 v173, v168, v169 offset0:0 offset1:32
s_waitcnt lgkmcnt(0)
s_barrier
ds_read_b128 v[32:35], v25 offset:0
ds_read_b128 v[36:39], v25 offset:1056
ds_read_b128 v[40:43], v25 offset:2112
ds_read_b128 v[44:47], v25 offset:3168
ds_read_b128 v[48:51], v25 offset:4224
ds_read_b128 v[52:55], v25 offset:5280
s_waitcnt lgkmcnt(4)
v_pk_add_f32 v[32:33], v[32:33], v[34:35]
v_pk_add_f32 v[36:37], v[36:37], v[38:39]
v_pk_add_f32 v[32:33], v[32:33], v[36:37]
s_waitcnt lgkmcnt(2)
v_pk_add_f32 v[40:41], v[40:41], v[42:43]
v_pk_add_f32 v[44:45], v[44:45], v[46:47]
v_pk_add_f32 v[34:35], v[40:41], v[44:45]
v_max3_f32 v38, v32, v33, v34
s_waitcnt lgkmcnt(0)
v_pk_add_f32 v[48:49], v[48:49], v[50:51]
v_pk_add_f32 v[52:53], v[52:53], v[54:55]
v_pk_add_f32 v[36:37], v[48:49], v[52:53]
v_max3_f32 v38, v38, v35, v36
v_max_f32 v38, v38, v37
v_pk_add_f32 v[32:33], v[32:33], v[38:39] op_sel_hi:[1,0] neg_lo:[0,1] neg_hi:[0,1]
v_pk_add_f32 v[34:35], v[34:35], v[38:39] op_sel_hi:[1,0] neg_lo:[0,1] neg_hi:[0,1]
v_max_f32_dpp v44, v38, v38 quad_perm:[1,0,3,2] row_mask:0xf bank_mask:0xf
v_pk_add_f32 v[36:37], v[36:37], v[38:39] op_sel_hi:[1,0] neg_lo:[0,1] neg_hi:[0,1]
v_exp_f32 v32, v32
v_max_f32_dpp v44, v44, v44 quad_perm:[2,3,0,1] row_mask:0xf bank_mask:0xf
v_exp_f32 v33, v33
v_exp_f32 v34, v34
v_max_f32_dpp v44, v44, v44 row_half_mirror row_mask:0xf bank_mask:0xf
v_exp_f32 v35, v35
v_sub_f32 v44, v38, v44
v_exp_f32 v36, v36
v_exp_f32 v37, v37
v_exp_f32 v44, v44
v_pk_add_f32 v[40:41], v[32:33], v[34:35]
v_add_f32 v42, v36, v37
v_add_f32 v40, v40, v41
v_fma_f32 v40, v42, v29, v40
v_mul_f32 v40, v40, v44
s_nop 1
v_add_f32_dpp v40, v40, v40 quad_perm:[1,0,3,2] row_mask:0xf bank_mask:0xf
s_nop 1
v_add_f32_dpp v40, v40, v40 quad_perm:[2,3,0,1] row_mask:0xf bank_mask:0xf
s_nop 1
v_add_f32_dpp v40, v40, v40 row_half_mirror row_mask:0xf bank_mask:0xf
v_rcp_f32 v40, v40
s_nop 0
v_mul_f32 v40, v40, v44
v_pk_mul_f32 v[32:33], v[32:33], v[40:41] op_sel_hi:[1,0]
v_pk_mul_f32 v[34:35], v[34:35], v[40:41] op_sel_hi:[1,0]
v_pk_mul_f32 v[36:37], v[36:37], v[40:41] op_sel_hi:[1,0]
v_cvt_pk_bf16_f32 v32, v32, v33
v_cvt_pk_bf16_f32 v33, v34, v35
buffer_store_dwordx2 v[32:33], v27, s[8:11], s22 offen sc1
v_cvt_pk_bf16_f32 v36, v36, v37
buffer_store_dword v36, v28, s[8:11], s22 offen sc1
s_barrier
v_mov_b32 v60, 0
v_mov_b32 v61, 0
v_mov_b32 v62, 0
v_mov_b32 v63, 0
v_mov_b32 v64, 0
v_mov_b32 v65, 0
v_mov_b32 v66, 0
v_mov_b32 v67, 0
v_mov_b32 v68, 0
v_mov_b32 v69, 0
v_mov_b32 v70, 0
v_mov_b32 v71, 0
v_mov_b32 v72, 0
v_mov_b32 v73, 0
v_mov_b32 v74, 0
v_mov_b32 v75, 0
v_mov_b32 v76, 0
v_mov_b32 v77, 0
v_mov_b32 v78, 0
v_mov_b32 v79, 0
v_mov_b32 v80, 0
v_mov_b32 v81, 0
v_mov_b32 v82, 0
v_mov_b32 v83, 0
v_mov_b32 v84, 0
v_mov_b32 v85, 0
v_mov_b32 v86, 0
v_mov_b32 v87, 0
v_mov_b32 v160, 0
v_mov_b32 v161, 0
v_mov_b32 v162, 0
v_mov_b32 v163, 0
v_mov_b32 v164, 0
v_mov_b32 v165, 0
v_mov_b32 v166, 0
v_mov_b32 v167, 0
v_mov_b32 v168, 0
v_mov_b32 v169, 0
v_mov_b32 v170, 0
v_mov_b32 v171, 0
ds_read_b128 v[144:147], v24 offset:0
ds_read_b128 v[148:151], v24 offset:1024
ds_read_b128 v[152:155], v24 offset:2048
ds_read_b128 v[156:159], v24 offset:3072
s_waitcnt lgkmcnt(0)
s_add_u32 s25, s25, 28672
s_add_u32 s36, s36, 28672
s_cmp_eq_u32 s18, 62
s_cbranch_scc1 Lrec_done
buffer_load_dwordx4 v[88:91], v2, s[8:11], s25 offen offset:0 sc1
buffer_load_dwordx4 v[92:95], v2, s[8:11], s25 offen offset:1024 sc1
buffer_load_dwordx4 v[96:99], v2, s[8:11], s25 offen offset:2048 sc1
buffer_load_dwordx4 v[100:103], v2, s[8:11], s25 offen offset:3072 sc1
buffer_load_dwordx4 v[104:107], v2, s[8:11], s36 offen offset:0 sc1
buffer_load_dwordx4 v[108:111], v2, s[8:11], s36 offen offset:1024 sc1
buffer_load_dwordx4 v[112:115], v2, s[8:11], s36 offen offset:2048 sc1
buffer_load_dwordx4 v[116:119], v2, s[8:11], s36 offen offset:3072 sc1
s_add_u32 s18, s18, 1
s_xor_b32 s20, s20, 8192
s_xor_b32 s22, s22, 16384
s_xor_b32 s23, s23, 16384
s_add_u32 s28, s28, 8192
s_add_u32 s38, s38, s42
s_mov_b64 exec, 15
buffer_load_dwordx4 v[40:43], v15, s[8:11], s34 offen sc1
s_nop 15
buffer_load_dwordx4 v[44:47], v15, s[8:11], s34 offen sc1
s_nop 15
buffer_load_dwordx4 v[48:51], v15, s[8:11], s34 offen sc1
Lfp_256:
s_waitcnt vmcnt(2)
v_min3_u32 v11, v40, v41, v42
v_min_u32 v11, v11, v43
v_cmp_gt_u32 vcc, v14, v11
s_cbranch_vccz Lfg_257
buffer_load_dwordx4 v[40:43], v15, s[8:11], s34 offen sc1
s_waitcnt vmcnt(2)
v_min3_u32 v11, v44, v45, v46
v_min_u32 v11, v11, v47
v_cmp_gt_u32 vcc, v14, v11
s_cbranch_vccz Lfg_257
buffer_load_dwordx4 v[44:47], v15, s[8:11], s34 offen sc1
s_waitcnt vmcnt(2)
v_min3_u32 v11, v48, v49, v50
v_min_u32 v11, v11, v51
v_cmp_gt_u32 vcc, v14, v11
s_cbranch_vccz Lfg_257
buffer_load_dwordx4 v[48:51], v15, s[8:11], s34 offen sc1
s_sub_u32 s19, s19, 1
s_cbranch_scc0 Lfp_256
s_mov_b32 s19, 0
Lfg_257:
s_mov_b64 exec, -1
v_add_u32 v14, 1, v14
s_branch Ltop_248
Lmp_249b:
s_waitcnt vmcnt(0)
v_max_u32 v11, v139, v143
v_cmp_eq_u32 vcc, -1, v11
s_cbranch_vccnz Lmr_250
v_mov_b32 v32, v136
v_mov_b32 v33, v137
v_mov_b32 v34, v138
v_mov_b32 v35, v139
v_mov_b32 v36, v140
v_mov_b32 v37, v141
v_mov_b32 v38, v142
v_mov_b32 v39, v143
s_nop 0
s_branch Lma_251
Lmr_250:

s_sub_u32 s19, s19, 1
s_cbranch_scc0 Lmp_249
s_mov_b32 s19, 0
s_branch Lma_251
Lmr2_252:

s_sub_u32 s19, s19, 1
s_cbranch_scc1 Lmr2_252x
s_nop 15
v_mov_b32 v60, 0
v_mov_b32 v61, 0
v_mov_b32 v62, 0
v_mov_b32 v63, 0
v_mov_b32 v64, 0
v_mov_b32 v65, 0
v_mov_b32 v66, 0
v_mov_b32 v67, 0
v_mov_b32 v68, 0
v_mov_b32 v69, 0
v_mov_b32 v70, 0
v_mov_b32 v71, 0
v_mov_b32 v72, 0
v_mov_b32 v73, 0
v_mov_b32 v74, 0
v_mov_b32 v75, 0
v_mov_b32 v76, 0
v_mov_b32 v77, 0
v_mov_b32 v78, 0
v_mov_b32 v79, 0
v_mov_b32 v80, 0
v_mov_b32 v81, 0
v_mov_b32 v82, 0
v_mov_b32 v83, 0
v_mov_b32 v84, 0
v_mov_b32 v85, 0
v_mov_b32 v86, 0
v_mov_b32 v87, 0
s_branch Lmp_249
Lmr2_252x:
s_mov_b32 s19, 0
s_branch Lma2_253
.p2align 6
Lrole_82:
v_cmp_gt_u32 vcc, 32, v30
s_cbranch_vccnz Lcr_260
Lco_259:
Ltop_258:
buffer_load_dwordx4 v[32:35], v3, s[8:11], s20 offen sc1
buffer_load_dwordx4 v[36:39], v4, s[8:11], s20 offen sc1
buffer_load_dwordx4 v[40:43], v5, s[8:11], s20 offen sc1
buffer_load_dwordx4 v[44:47], v6, s[8:11], s20 offen sc1
buffer_load_dwordx4 v[48:51], v7, s[8:11], s20 offen sc1
buffer_load_dwordx4 v[52:55], v8, s[8:11], s20 offen sc1
buffer_load_dwordx4 v[56:59], v9, s[8:11], s20 offen sc1
buffer_store_dwordx4 v[124:127], v2, s[8:11], s27 offen sc1
s_add_u32 s30, s27, 4096
buffer_store_dwordx4 v[132:135], v2, s[8:11], s30 offen sc1
buffer_load_dwordx4 v[92:95], v21, s[8:11], s24 offen offset:0 sc1
buffer_load_dwordx4 v[96:99], v21, s[8:11], s24 offen offset:1024 sc1
buffer_load_dwordx4 v[100:103], v21, s[8:11], s24 offen offset:2048 sc1
buffer_load_dwordx4 v[104:107], v21, s[8:11], s24 offen offset:3072 sc1
s_barrier
v_mov_b32 v152, 0
v_mov_b32 v153, 0
v_mov_b32 v154, 0
v_mov_b32 v155, 0
v_mov_b32 v156, 0
v_mov_b32 v157, 0
v_mov_b32 v158, 0
v_mov_b32 v159, 0
v_mov_b32 v60, 0
v_mov_b32 v61, 0
v_mov_b32 v62, 0
v_mov_b32 v63, 0
v_mov_b32 v64, 0
v_mov_b32 v65, 0
v_mov_b32 v66, 0
v_mov_b32 v67, 0
v_mov_b32 v68, 0
v_mov_b32 v69, 0
v_mov_b32 v70, 0
v_mov_b32 v71, 0
v_mov_b32 v72, 0
v_mov_b32 v73, 0
v_mov_b32 v74, 0
v_mov_b32 v75, 0
v_mov_b32 v76, 0
v_mov_b32 v77, 0
v_mov_b32 v78, 0
v_mov_b32 v79, 0
v_mov_b32 v80, 0
v_mov_b32 v81, 0
v_mov_b32 v82, 0
v_mov_b32 v83, 0
v_mov_b32 v84, 0
v_mov_b32 v85, 0
v_mov_b32 v86, 0
v_mov_b32 v87, 0
v_mov_b32 v88, 0
v_mov_b32 v89, 0
v_mov_b32 v90, 0
v_mov_b32 v91, 0
s_waitcnt vmcnt(12)
Lmp_261w:
ds_write_b128 v3, v[32:35] offset:0
v_max3_u32 v11, v32, v33, v34
v_max_u32 v11, v11, v35
s_waitcnt vmcnt(11)
ds_write_b128 v4, v[36:39] offset:0
v_max3_u32 v11, v11, v36, v37
v_max3_u32 v11, v11, v38, v39
s_waitcnt vmcnt(10)
ds_write_b128 v5, v[40:43] offset:0
v_max3_u32 v11, v11, v40, v41
v_max3_u32 v11, v11, v42, v43
s_waitcnt vmcnt(9)
ds_write_b128 v6, v[44:47] offset:0
v_max3_u32 v11, v11, v44, v45
v_max3_u32 v11, v11, v46, v47
s_waitcnt vmcnt(8)
ds_write_b128 v7, v[48:51] offset:0
v_max3_u32 v11, v11, v48, v49
v_max3_u32 v11, v11, v50, v51
s_waitcnt vmcnt(7)
ds_write_b128 v8, v[52:55] offset:0
v_max3_u32 v11, v11, v52, v53
v_max3_u32 v11, v11, v54, v55
s_waitcnt vmcnt(6)
ds_write_b128 v9, v[56:59] offset:0
v_max3_u32 v11, v11, v56, v57
v_max3_u32 v11, v11, v58, v59
v_cmp_eq_u32 vcc, -1, v11
s_cbranch_vccnz Lmr_262
Lma_263:
s_waitcnt lgkmcnt(0)
s_barrier
v_smfmac_f32_16x16x64_bf16 v[60:63], v[32:35], a[0:7], v10
ds_read_b128 v[160:163], v26 offset:0
buffer_load_dwordx4 v[108:111], v21, s[8:11], s39 offen offset:0 sc1
buffer_load_dwordx4 v[112:115], v21, s[8:11], s39 offen offset:1024 sc1
buffer_load_dwordx4 v[116:119], v21, s[8:11], s39 offen offset:2048 sc1
buffer_load_dwordx4 v[120:123], v21, s[8:11], s39 offen offset:3072 sc1
v_smfmac_f32_16x16x64_bf16 v[64:67], v[32:35], a[8:15], v10
ds_read_b128 v[164:167], v26 offset:1024
v_smfmac_f32_16x16x64_bf16 v[68:71], v[32:35], a[16:23], v10
ds_read_b128 v[168:171], v26 offset:2048
v_smfmac_f32_16x16x64_bf16 v[72:75], v[32:35], a[24:31], v10
ds_read_b128 v[172:175], v26 offset:3072
v_smfmac_f32_16x16x64_bf16 v[76:79], v[32:35], a[32:39], v10
ds_read_b128 v[176:179], v26 offset:4096
v_smfmac_f32_16x16x64_bf16 v[80:83], v[32:35], a[40:47], v10
ds_read_b128 v[180:183], v26 offset:5120
v_smfmac_f32_16x16x64_bf16 v[84:87], v[32:35], a[48:55], v10
ds_read_b128 v[184:187], v26 offset:6144
v_smfmac_f32_16x16x64_bf16 v[88:91], v[32:35], a[56:63], v10
ds_read_b128 v[188:191], v26 offset:7168
v_smfmac_f32_16x16x64_bf16 v[60:63], v[36:39], a[64:71], v10
v_smfmac_f32_16x16x64_bf16 v[64:67], v[36:39], a[72:79], v10
s_waitcnt lgkmcnt(6)
v_smfmac_f32_16x16x64_bf16 v[60:63], v[52:55], v[160:167], v10
ds_read_b128 v[160:163], v26 offset:8192
v_smfmac_f32_16x16x64_bf16 v[68:71], v[36:39], a[80:87], v10
ds_read_b128 v[164:167], v26 offset:9216
v_smfmac_f32_16x16x64_bf16 v[72:75], v[36:39], a[88:95], v10
s_waitcnt lgkmcnt(6)
v_smfmac_f32_16x16x64_bf16 v[64:67], v[52:55], v[168:175], v10
ds_read_b128 v[168:171], v26 offset:10240
v_smfmac_f32_16x16x64_bf16 v[76:79], v[36:39], a[96:103], v10
ds_read_b128 v[172:175], v26 offset:11264
v_smfmac_f32_16x16x64_bf16 v[80:83], v[36:39], a[104:111], v10
s_waitcnt lgkmcnt(6)
v_smfmac_f32_16x16x64_bf16 v[68:71], v[52:55], v[176:183], v10
ds_read_b128 v[176:179], v26 offset:12288
v_smfmac_f32_16x16x64_bf16 v[84:87], v[36:39], a[112:119], v10
ds_read_b128 v[180:183], v26 offset:13312
v_smfmac_f32_16x16x64_bf16 v[88:91], v[36:39], a[120:127], v10
s_waitcnt lgkmcnt(6)
v_smfmac_f32_16x16x64_bf16 v[72:75], v[52:55], v[184:191], v10
ds_read_b128 v[184:187], v26 offset:14336
v_smfmac_f32_16x16x64_bf16 v[60:63], v[40:43], a[128:135], v10
ds_read_b128 v[188:191], v26 offset:15360
s_and_b32 s30, s18, 3
s_cmp_eq_u32 s30, 3
s_cbranch_scc0 Lsu_265
s_add_u32 s29, s29, 128
buffer_load_dword v30, v13, s[8:11], s29 offen sc1
Lsu_265:
v_smfmac_f32_16x16x64_bf16 v[64:67], v[40:43], a[136:143], v10
s_waitcnt lgkmcnt(6)
v_smfmac_f32_16x16x64_bf16 v[76:79], v[52:55], v[160:167], v10
ds_read_b128 v[160:163], v26 offset:16384
v_smfmac_f32_16x16x64_bf16 v[68:71], v[40:43], a[144:151], v10
ds_read_b128 v[164:167], v26 offset:17408
v_smfmac_f32_16x16x64_bf16 v[72:75], v[40:43], a[152:159], v10
s_waitcnt lgkmcnt(6)
v_smfmac_f32_16x16x64_bf16 v[80:83], v[52:55], v[168:175], v10
ds_read_b128 v[168:171], v26 offset:18432
v_smfmac_f32_16x16x64_bf16 v[76:79], v[40:43], a[160:167], v10
ds_read_b128 v[172:175], v26 offset:19456
v_smfmac_f32_16x16x64_bf16 v[80:83], v[40:43], a[168:175], v10
s_waitcnt lgkmcnt(6)
v_smfmac_f32_16x16x64_bf16 v[84:87], v[52:55], v[176:183], v10
ds_read_b128 v[176:179], v26 offset:20480
v_smfmac_f32_16x16x64_bf16 v[84:87], v[40:43], a[176:183], v10
ds_read_b128 v[180:183], v26 offset:21504
v_smfmac_f32_16x16x64_bf16 v[88:91], v[40:43], a[184:191], v10
s_waitcnt lgkmcnt(6)
v_smfmac_f32_16x16x64_bf16 v[88:91], v[52:55], v[184:191], v10
ds_read_b128 v[184:187], v26 offset:22528
v_smfmac_f32_16x16x64_bf16 v[60:63], v[44:47], a[192:199], v10
ds_read_b128 v[188:191], v26 offset:23552
v_smfmac_f32_16x16x64_bf16 v[64:67], v[44:47], a[200:207], v10
s_waitcnt lgkmcnt(6)
v_smfmac_f32_16x16x64_bf16 v[60:63], v[56:59], v[160:167], v10
ds_read_b128 v[160:163], v26 offset:24576
v_smfmac_f32_16x16x64_bf16 v[68:71], v[44:47], a[208:215], v10
ds_read_b128 v[164:167], v26 offset:25600
v_smfmac_f32_16x16x64_bf16 v[72:75], v[44:47], a[216:223], v10
s_waitcnt lgkmcnt(6)
v_smfmac_f32_16x16x64_bf16 v[64:67], v[56:59], v[168:175], v10
ds_read_b128 v[168:171], v26 offset:26624
v_smfmac_f32_16x16x64_bf16 v[76:79], v[44:47], a[224:231], v10
ds_read_b128 v[172:175], v26 offset:27648
v_smfmac_f32_16x16x64_bf16 v[80:83], v[44:47], a[232:239], v10
s_waitcnt lgkmcnt(6)
v_smfmac_f32_16x16x64_bf16 v[68:71], v[56:59], v[176:183], v10
ds_read_b128 v[176:179], v26 offset:28672
v_smfmac_f32_16x16x64_bf16 v[84:87], v[44:47], a[240:247], v10
ds_read_b128 v[180:183], v26 offset:29696
v_smfmac_f32_16x16x64_bf16 v[88:91], v[44:47], a[248:255], v10
s_waitcnt lgkmcnt(6)
v_smfmac_f32_16x16x64_bf16 v[72:75], v[56:59], v[184:191], v10
ds_read_b128 v[184:187], v26 offset:30720
v_smfmac_f32_16x16x64_bf16 v[60:63], v[48:51], v[192:199], v10
ds_read_b128 v[188:191], v26 offset:31744
v_smfmac_f32_16x16x64_bf16 v[64:67], v[48:51], v[200:207], v10
s_waitcnt lgkmcnt(6)
v_smfmac_f32_16x16x64_bf16 v[76:79], v[56:59], v[160:167], v10
v_smfmac_f32_16x16x64_bf16 v[68:71], v[48:51], v[208:215], v10
v_smfmac_f32_16x16x64_bf16 v[72:75], v[48:51], v[216:223], v10
s_waitcnt lgkmcnt(4)
v_smfmac_f32_16x16x64_bf16 v[80:83], v[56:59], v[168:175], v10
v_smfmac_f32_16x16x64_bf16 v[76:79], v[48:51], v[224:231], v10
v_smfmac_f32_16x16x64_bf16 v[80:83], v[48:51], v[232:239], v10
s_waitcnt lgkmcnt(2)
v_smfmac_f32_16x16x64_bf16 v[84:87], v[56:59], v[176:183], v10
v_smfmac_f32_16x16x64_bf16 v[84:87], v[48:51], v[240:247], v10
v_smfmac_f32_16x16x64_bf16 v[88:91], v[48:51], v[248:255], v10
s_waitcnt lgkmcnt(0)
v_smfmac_f32_16x16x64_bf16 v[88:91], v[56:59], v[184:191], v10
s_nop 7
v_pk_add_f32 v[60:61], v[60:61], v[62:63]
v_pk_add_f32 v[64:65], v[64:65], v[66:67]
v_pk_add_f32 v[68:69], v[68:69], v[70:71]
v_pk_add_f32 v[72:73], v[72:73], v[74:75]
v_pk_add_f32 v[76:77], v[76:77], v[78:79]
v_pk_add_f32 v[80:81], v[80:81], v[82:83]
v_pk_add_f32 v[84:85], v[84:85], v[86:87]
v_pk_add_f32 v[88:89], v[88:89], v[90:91]
v_cvt_pk_bf16_f32 v124, v60, v61
v_cvt_pk_bf16_f32 v125, v64, v65
v_cvt_pk_bf16_f32 v126, v68, v69
v_cvt_pk_bf16_f32 v127, v72, v73
v_cvt_pk_bf16_f32 v132, v76, v77
v_cvt_pk_bf16_f32 v133, v80, v81
v_cvt_pk_bf16_f32 v134, v84, v85
v_cvt_pk_bf16_f32 v135, v88, v89
s_mov_b64 exec, 15
buffer_load_dword v17, v31, s[8:11], s35 offen sc1
s_nop 15
buffer_load_dword v18, v31, s[8:11], s35 offen sc1
s_nop 15
buffer_load_dword v19, v31, s[8:11], s35 offen sc1
Lfp_266:
s_waitcnt vmcnt(2)
v_cmp_gt_u32 vcc, v14, v17
s_cbranch_vccz Lfg_267
buffer_load_dword v17, v31, s[8:11], s35 offen sc1
s_waitcnt vmcnt(2)
v_cmp_gt_u32 vcc, v14, v18
s_cbranch_vccz Lfg_267
buffer_load_dword v18, v31, s[8:11], s35 offen sc1
s_waitcnt vmcnt(2)
v_cmp_gt_u32 vcc, v14, v19
s_cbranch_vccz Lfg_267
buffer_load_dword v19, v31, s[8:11], s35 offen sc1

s_sub_u32 s19, s19, 1
s_cbranch_scc0 Lfp_266
s_mov_b32 s19, 0
Lfg_267:
s_mov_b64 exec, -1
Lpp_268:
buffer_load_dwordx4 v[140:143], v21, s[8:11], s22 offen sc1
buffer_load_dwordx4 v[144:147], v21, s[8:11], s22 offen offset:1024 sc1

buffer_load_dwordx4 v[148:151], v22, s[8:11], s22 offen sc1

s_waitcnt vmcnt(2)
v_smfmac_f32_16x16x64_bf16 v[152:155], v[140:143], v[92:99], v10
v_smfmac_f32_16x16x64_bf16 v[156:159], v[140:143], v[108:115], v10
s_waitcnt vmcnt(1)
buffer_store_dword v14, v16, s[8:11], s34 offen offset:2048 sc1
v_smfmac_f32_16x16x64_bf16 v[152:155], v[144:147], v[100:107], v10
v_smfmac_f32_16x16x64_bf16 v[156:159], v[144:147], v[116:123], v10
s_waitcnt vmcnt(1)
v_smfmac_f32_16x16x64_bf16 v[152:155], v[148:151], v[124:131], v10
v_smfmac_f32_16x16x64_bf16 v[156:159], v[148:151], v[132:139], v10
s_nop 6
v_pk_add_f32 v[152:153], v[152:153], v[154:155]
v_pk_add_f32 v[156:157], v[156:157], v[158:159]
ds_write2_b32 v23, v152, v153 offset0:0 offset1:16
ds_write2_b32 v29, v156, v157 offset0:0 offset1:16
v_cmp_u_f32 vcc, v152, v153
s_cbranch_vccnz Lpr2_271
Lpa2_272:
buffer_store_dword v14, v16, s[8:11], s34 offen sc1
s_waitcnt lgkmcnt(0)
s_barrier
s_add_u32 s18, s18, 1
s_xor_b32 s20, s20, 8192
s_xor_b32 s21, s21, 8192
s_xor_b32 s22, s22, 16384
s_add_u32 s24, s24, 458752
s_add_u32 s39, s39, 458752
s_mov_b32 s27, s26
s_add_u32 s26, s26, 114688
s_lshl_b32 s28, s18, 13
s_add_u32 s28, s28, 53469184

v_cmp_gt_u32 vcc, 32, v30
s_cbranch_vccnz Lcr_274
Lco_273:
s_mov_b64 exec, 16383
buffer_load_dwordx4 v[168:171], v15, s[8:11], s34 offen sc1
s_nop 15
buffer_load_dwordx4 v[172:175], v15, s[8:11], s34 offen sc1
s_nop 15
buffer_load_dwordx4 v[176:179], v15, s[8:11], s34 offen sc1
Lfp_275:
s_waitcnt vmcnt(2)
v_min3_u32 v11, v168, v169, v170
v_min_u32 v11, v11, v171
v_cmp_gt_u32 vcc, v14, v11
s_cbranch_vccz Lfg_276
buffer_load_dwordx4 v[168:171], v15, s[8:11], s34 offen sc1
s_waitcnt vmcnt(2)
v_min3_u32 v11, v172, v173, v174
v_min_u32 v11, v11, v175
v_cmp_gt_u32 vcc, v14, v11
s_cbranch_vccz Lfg_276
buffer_load_dwordx4 v[172:175], v15, s[8:11], s34 offen sc1
s_waitcnt vmcnt(2)
v_min3_u32 v11, v176, v177, v178
v_min_u32 v11, v11, v179
v_cmp_gt_u32 vcc, v14, v11
s_cbranch_vccz Lfg_276
buffer_load_dwordx4 v[176:179], v15, s[8:11], s34 offen sc1
s_sub_u32 s19, s19, 1
s_cbranch_scc0 Lfp_275
s_mov_b32 s19, 0
Lfg_276:
s_mov_b64 exec, -1
v_add_u32 v14, 1, v14
s_cmp_lt_u32 s18, 63
s_cbranch_scc1 Ltop_258
v_mov_b32 v60, 0
v_mov_b32 v61, 0
v_mov_b32 v62, 0
v_mov_b32 v63, 0
v_mov_b32 v64, 0
v_mov_b32 v65, 0
v_mov_b32 v66, 0
v_mov_b32 v67, 0
v_mov_b32 v68, 0
v_mov_b32 v69, 0
v_mov_b32 v70, 0
v_mov_b32 v71, 0
v_mov_b32 v72, 0
v_mov_b32 v73, 0
v_mov_b32 v74, 0
v_mov_b32 v75, 0
v_mov_b32 v76, 0
v_mov_b32 v77, 0
v_mov_b32 v78, 0
v_mov_b32 v79, 0
v_mov_b32 v80, 0
v_mov_b32 v81, 0
v_mov_b32 v82, 0
v_mov_b32 v83, 0
v_mov_b32 v84, 0
v_mov_b32 v85, 0
v_mov_b32 v86, 0
v_mov_b32 v87, 0
v_mov_b32 v88, 0
v_mov_b32 v89, 0
v_mov_b32 v90, 0
v_mov_b32 v91, 0
buffer_load_dwordx4 v[32:35], v3, s[8:11], s20 offen sc1
buffer_load_dwordx4 v[36:39], v4, s[8:11], s20 offen sc1
buffer_load_dwordx4 v[40:43], v5, s[8:11], s20 offen sc1
buffer_load_dwordx4 v[44:47], v6, s[8:11], s20 offen sc1
buffer_load_dwordx4 v[48:51], v7, s[8:11], s20 offen sc1
buffer_load_dwordx4 v[52:55], v8, s[8:11], s20 offen sc1
buffer_load_dwordx4 v[56:59], v9, s[8:11], s20 offen sc1
s_barrier
buffer_store_dwordx4 v[124:127], v2, s[8:11], s27 offen sc1
s_add_u32 s30, s27, 4096
buffer_store_dwordx4 v[132:135], v2, s[8:11], s30 offen sc1
s_waitcnt vmcnt(8)
Lmp_277w:
ds_write_b128 v3, v[32:35] offset:0
v_max3_u32 v11, v32, v33, v34
v_max_u32 v11, v11, v35
s_waitcnt vmcnt(7)
ds_write_b128 v4, v[36:39] offset:0
v_max3_u32 v11, v11, v36, v37
v_max3_u32 v11, v11, v38, v39
s_waitcnt vmcnt(6)
ds_write_b128 v5, v[40:43] offset:0
v_max3_u32 v11, v11, v40, v41
v_max3_u32 v11, v11, v42, v43
s_waitcnt vmcnt(5)
ds_write_b128 v6, v[44:47] offset:0
v_max3_u32 v11, v11, v44, v45
v_max3_u32 v11, v11, v46, v47
s_waitcnt vmcnt(4)
ds_write_b128 v7, v[48:51] offset:0
v_max3_u32 v11, v11, v48, v49
v_max3_u32 v11, v11, v50, v51
s_waitcnt vmcnt(3)
ds_write_b128 v8, v[52:55] offset:0
v_max3_u32 v11, v11, v52, v53
v_max3_u32 v11, v11, v54, v55
s_waitcnt vmcnt(2)
ds_write_b128 v9, v[56:59] offset:0
v_max3_u32 v11, v11, v56, v57
v_max3_u32 v11, v11, v58, v59
v_cmp_eq_u32 vcc, -1, v11
s_cbranch_vccnz Lmr_278
Lma_279:
s_waitcnt lgkmcnt(0)
s_barrier
v_smfmac_f32_16x16x64_bf16 v[60:63], v[32:35], a[0:7], v10
ds_read_b128 v[160:163], v26 offset:0
s_cmp_eq_u32 s33, 0
s_cbranch_scc0 Lsu_280
s_mov_b32 s30, 54857856
buffer_atomic_umax v14, v28, s[8:11], s30 offen
Lsu_280:
v_smfmac_f32_16x16x64_bf16 v[64:67], v[32:35], a[8:15], v10
ds_read_b128 v[164:167], v26 offset:1024
v_smfmac_f32_16x16x64_bf16 v[68:71], v[32:35], a[16:23], v10
ds_read_b128 v[168:171], v26 offset:2048
v_smfmac_f32_16x16x64_bf16 v[72:75], v[32:35], a[24:31], v10
ds_read_b128 v[172:175], v26 offset:3072
v_smfmac_f32_16x16x64_bf16 v[76:79], v[32:35], a[32:39], v10
ds_read_b128 v[176:179], v26 offset:4096
v_smfmac_f32_16x16x64_bf16 v[80:83], v[32:35], a[40:47], v10
ds_read_b128 v[180:183], v26 offset:5120
v_smfmac_f32_16x16x64_bf16 v[84:87], v[32:35], a[48:55], v10
ds_read_b128 v[184:187], v26 offset:6144
v_smfmac_f32_16x16x64_bf16 v[88:91], v[32:35], a[56:63], v10
ds_read_b128 v[188:191], v26 offset:7168
v_smfmac_f32_16x16x64_bf16 v[60:63], v[36:39], a[64:71], v10
v_smfmac_f32_16x16x64_bf16 v[64:67], v[36:39], a[72:79], v10
s_waitcnt lgkmcnt(6)
v_smfmac_f32_16x16x64_bf16 v[60:63], v[52:55], v[160:167], v10
ds_read_b128 v[160:163], v26 offset:8192
v_smfmac_f32_16x16x64_bf16 v[68:71], v[36:39], a[80:87], v10
ds_read_b128 v[164:167], v26 offset:9216
v_smfmac_f32_16x16x64_bf16 v[72:75], v[36:39], a[88:95], v10
s_waitcnt lgkmcnt(6)
v_smfmac_f32_16x16x64_bf16 v[64:67], v[52:55], v[168:175], v10
ds_read_b128 v[168:171], v26 offset:10240
v_smfmac_f32_16x16x64_bf16 v[76:79], v[36:39], a[96:103], v10
ds_read_b128 v[172:175], v26 offset:11264
v_smfmac_f32_16x16x64_bf16 v[80:83], v[36:39], a[104:111], v10
s_waitcnt lgkmcnt(6)
v_smfmac_f32_16x16x64_bf16 v[68:71], v[52:55], v[176:183], v10
ds_read_b128 v[176:179], v26 offset:12288
v_smfmac_f32_16x16x64_bf16 v[84:87], v[36:39], a[112:119], v10
ds_read_b128 v[180:183], v26 offset:13312
v_smfmac_f32_16x16x64_bf16 v[88:91], v[36:39], a[120:127], v10
s_waitcnt lgkmcnt(6)
v_smfmac_f32_16x16x64_bf16 v[72:75], v[52:55], v[184:191], v10
ds_read_b128 v[184:187], v26 offset:14336
v_smfmac_f32_16x16x64_bf16 v[60:63], v[40:43], a[128:135], v10
ds_read_b128 v[188:191], v26 offset:15360
v_smfmac_f32_16x16x64_bf16 v[64:67], v[40:43], a[136:143], v10
s_waitcnt lgkmcnt(6)
v_smfmac_f32_16x16x64_bf16 v[76:79], v[52:55], v[160:167], v10
ds_read_b128 v[160:163], v26 offset:16384
v_smfmac_f32_16x16x64_bf16 v[68:71], v[40:43], a[144:151], v10
ds_read_b128 v[164:167], v26 offset:17408
v_smfmac_f32_16x16x64_bf16 v[72:75], v[40:43], a[152:159], v10
s_waitcnt lgkmcnt(6)
v_smfmac_f32_16x16x64_bf16 v[80:83], v[52:55], v[168:175], v10
ds_read_b128 v[168:171], v26 offset:18432
v_smfmac_f32_16x16x64_bf16 v[76:79], v[40:43], a[160:167], v10
ds_read_b128 v[172:175], v26 offset:19456
v_smfmac_f32_16x16x64_bf16 v[80:83], v[40:43], a[168:175], v10
s_waitcnt lgkmcnt(6)
v_smfmac_f32_16x16x64_bf16 v[84:87], v[52:55], v[176:183], v10
ds_read_b128 v[176:179], v26 offset:20480
v_smfmac_f32_16x16x64_bf16 v[84:87], v[40:43], a[176:183], v10
ds_read_b128 v[180:183], v26 offset:21504
v_smfmac_f32_16x16x64_bf16 v[88:91], v[40:43], a[184:191], v10
s_waitcnt lgkmcnt(6)
v_smfmac_f32_16x16x64_bf16 v[88:91], v[52:55], v[184:191], v10
ds_read_b128 v[184:187], v26 offset:22528
v_smfmac_f32_16x16x64_bf16 v[60:63], v[44:47], a[192:199], v10
ds_read_b128 v[188:191], v26 offset:23552
v_smfmac_f32_16x16x64_bf16 v[64:67], v[44:47], a[200:207], v10
s_waitcnt lgkmcnt(6)
v_smfmac_f32_16x16x64_bf16 v[60:63], v[56:59], v[160:167], v10
ds_read_b128 v[160:163], v26 offset:24576
v_smfmac_f32_16x16x64_bf16 v[68:71], v[44:47], a[208:215], v10
ds_read_b128 v[164:167], v26 offset:25600
v_smfmac_f32_16x16x64_bf16 v[72:75], v[44:47], a[216:223], v10
s_waitcnt lgkmcnt(6)
v_smfmac_f32_16x16x64_bf16 v[64:67], v[56:59], v[168:175], v10
ds_read_b128 v[168:171], v26 offset:26624
v_smfmac_f32_16x16x64_bf16 v[76:79], v[44:47], a[224:231], v10
ds_read_b128 v[172:175], v26 offset:27648
v_smfmac_f32_16x16x64_bf16 v[80:83], v[44:47], a[232:239], v10
s_waitcnt lgkmcnt(6)
v_smfmac_f32_16x16x64_bf16 v[68:71], v[56:59], v[176:183], v10
ds_read_b128 v[176:179], v26 offset:28672
v_smfmac_f32_16x16x64_bf16 v[84:87], v[44:47], a[240:247], v10
ds_read_b128 v[180:183], v26 offset:29696
v_smfmac_f32_16x16x64_bf16 v[88:91], v[44:47], a[248:255], v10
s_waitcnt lgkmcnt(6)
v_smfmac_f32_16x16x64_bf16 v[72:75], v[56:59], v[184:191], v10
ds_read_b128 v[184:187], v26 offset:30720
v_smfmac_f32_16x16x64_bf16 v[60:63], v[48:51], v[192:199], v10
ds_read_b128 v[188:191], v26 offset:31744
v_smfmac_f32_16x16x64_bf16 v[64:67], v[48:51], v[200:207], v10
s_waitcnt lgkmcnt(6)
v_smfmac_f32_16x16x64_bf16 v[76:79], v[56:59], v[160:167], v10
v_smfmac_f32_16x16x64_bf16 v[68:71], v[48:51], v[208:215], v10
v_smfmac_f32_16x16x64_bf16 v[72:75], v[48:51], v[216:223], v10
s_waitcnt lgkmcnt(4)
v_smfmac_f32_16x16x64_bf16 v[80:83], v[56:59], v[168:175], v10
v_smfmac_f32_16x16x64_bf16 v[76:79], v[48:51], v[224:231], v10
v_smfmac_f32_16x16x64_bf16 v[80:83], v[48:51], v[232:239], v10
s_waitcnt lgkmcnt(2)
v_smfmac_f32_16x16x64_bf16 v[84:87], v[56:59], v[176:183], v10
v_smfmac_f32_16x16x64_bf16 v[84:87], v[48:51], v[240:247], v10
v_smfmac_f32_16x16x64_bf16 v[88:91], v[48:51], v[248:255], v10
s_waitcnt lgkmcnt(0)
v_smfmac_f32_16x16x64_bf16 v[88:91], v[56:59], v[184:191], v10
s_nop 7
v_pk_add_f32 v[60:61], v[60:61], v[62:63]
v_pk_add_f32 v[64:65], v[64:65], v[66:67]
v_pk_add_f32 v[68:69], v[68:69], v[70:71]
v_pk_add_f32 v[72:73], v[72:73], v[74:75]
v_pk_add_f32 v[76:77], v[76:77], v[78:79]
v_pk_add_f32 v[80:81], v[80:81], v[82:83]
v_pk_add_f32 v[84:85], v[84:85], v[86:87]
v_pk_add_f32 v[88:89], v[88:89], v[90:91]
v_cvt_pk_bf16_f32 v124, v60, v61
v_cvt_pk_bf16_f32 v125, v64, v65
v_cvt_pk_bf16_f32 v126, v68, v69
v_cvt_pk_bf16_f32 v127, v72, v73
v_cvt_pk_bf16_f32 v132, v76, v77
v_cvt_pk_bf16_f32 v133, v80, v81
v_cvt_pk_bf16_f32 v134, v84, v85
v_cvt_pk_bf16_f32 v135, v88, v89
buffer_store_dwordx4 v[124:127], v2, s[8:11], s26 offen sc1
s_add_u32 s30, s26, 4096
buffer_store_dwordx4 v[132:135], v2, s[8:11], s30 offen sc1
v_mov_b32 v14, 65
s_waitcnt vmcnt(0)
buffer_store_dword v14, v16, s[8:11], s34 offen sc1
s_branch Lrec_done
Lcr_260:
buffer_load_dword v30, v13, s[8:11], s29 offen sc1
s_waitcnt vmcnt(0)
v_cmp_gt_u32 vcc, 32, v30
s_cbranch_vccz Lco_259
s_sleep 4

s_sub_u32 s19, s19, 1
s_cbranch_scc0 Lcr_260
s_mov_b32 s19, 0
s_branch Lco_259
Lmp_261:
buffer_load_dwordx4 v[32:35], v3, s[8:11], s20 offen sc1
buffer_load_dwordx4 v[36:39], v4, s[8:11], s20 offen sc1
buffer_load_dwordx4 v[40:43], v5, s[8:11], s20 offen sc1
buffer_load_dwordx4 v[44:47], v6, s[8:11], s20 offen sc1
buffer_load_dwordx4 v[48:51], v7, s[8:11], s20 offen sc1
buffer_load_dwordx4 v[52:55], v8, s[8:11], s20 offen sc1
buffer_load_dwordx4 v[56:59], v9, s[8:11], s20 offen sc1
s_waitcnt vmcnt(0)
s_branch Lmp_261w
Lmr_262:

s_sub_u32 s19, s19, 1
s_cbranch_scc0 Lmp_261
s_mov_b32 s19, 0
s_branch Lma_263
Lpr2_271:
s_sub_u32 s19, s19, 1
s_cbranch_scc1 Lpr2_271x
s_waitcnt lgkmcnt(0)

v_mov_b32 v152, 0
v_mov_b32 v153, 0
v_mov_b32 v154, 0
v_mov_b32 v155, 0
v_mov_b32 v156, 0
v_mov_b32 v157, 0
v_mov_b32 v158, 0
v_mov_b32 v159, 0
s_branch Lpp_268
Lpr2_271x:
s_mov_b32 s19, 0
s_branch Lpa2_272
Lcr_274:
buffer_load_dword v30, v13, s[8:11], s29 offen sc1
s_waitcnt vmcnt(0)
v_cmp_gt_u32 vcc, 32, v30
s_cbranch_vccz Lco_273
s_sleep 4

s_sub_u32 s19, s19, 1
s_cbranch_scc0 Lcr_274
s_mov_b32 s19, 0
s_branch Lco_273
Lmp_277:
buffer_load_dwordx4 v[32:35], v3, s[8:11], s20 offen sc1
buffer_load_dwordx4 v[36:39], v4, s[8:11], s20 offen sc1
buffer_load_dwordx4 v[40:43], v5, s[8:11], s20 offen sc1
buffer_load_dwordx4 v[44:47], v6, s[8:11], s20 offen sc1
buffer_load_dwordx4 v[48:51], v7, s[8:11], s20 offen sc1
buffer_load_dwordx4 v[52:55], v8, s[8:11], s20 offen sc1
buffer_load_dwordx4 v[56:59], v9, s[8:11], s20 offen sc1
s_waitcnt vmcnt(0)
s_branch Lmp_277w
Lmr_278:

s_sub_u32 s19, s19, 1
s_cbranch_scc0 Lmp_277
s_mov_b32 s19, 0
s_branch Lma_279
.p2align 6
Lrole_84:
v_cmp_gt_u32 vcc, 32, v30
s_cbranch_vccnz Lcr_283
Lco_282:
Ltop_281:
s_barrier
buffer_store_dwordx4 v[124:127], v2, s[8:11], s27 offen sc1
s_add_u32 s30, s27, 4096
buffer_store_dwordx4 v[132:135], v2, s[8:11], s30 offen sc1
s_cmp_lt_u32 s33, 7
s_cbranch_scc1 Lpub_284
Lpubb_285:
buffer_load_dwordx4 v[92:95], v21, s[8:11], s24 offen offset:0 sc1
v_mov_b32 v152, 0
v_mov_b32 v153, 0
v_mov_b32 v154, 0
v_mov_b32 v155, 0
v_mov_b32 v156, 0
buffer_load_dwordx4 v[96:99], v21, s[8:11], s24 offen offset:1024 sc1
v_mov_b32 v157, 0
v_mov_b32 v158, 0
v_mov_b32 v159, 0
v_mov_b32 v60, 0
v_mov_b32 v61, 0
buffer_load_dwordx4 v[100:103], v21, s[8:11], s24 offen offset:2048 sc1
v_mov_b32 v62, 0
v_mov_b32 v63, 0
v_mov_b32 v64, 0
v_mov_b32 v65, 0
v_mov_b32 v66, 0
buffer_load_dwordx4 v[104:107], v21, s[8:11], s24 offen offset:3072 sc1
v_mov_b32 v67, 0
v_mov_b32 v68, 0
v_mov_b32 v69, 0
v_mov_b32 v70, 0
v_mov_b32 v71, 0
buffer_load_dwordx4 v[108:111], v21, s[8:11], s39 offen offset:0 sc1
v_mov_b32 v72, 0
v_mov_b32 v73, 0
v_mov_b32 v74, 0
v_mov_b32 v75, 0
v_mov_b32 v76, 0
buffer_load_dwordx4 v[112:115], v21, s[8:11], s39 offen offset:1024 sc1
v_mov_b32 v77, 0
v_mov_b32 v78, 0
v_mov_b32 v79, 0
v_mov_b32 v80, 0
v_mov_b32 v81, 0
buffer_load_dwordx4 v[116:119], v21, s[8:11], s39 offen offset:2048 sc1
v_mov_b32 v82, 0
v_mov_b32 v83, 0
v_mov_b32 v84, 0
v_mov_b32 v85, 0
v_mov_b32 v86, 0
buffer_load_dwordx4 v[120:123], v21, s[8:11], s39 offen offset:3072 sc1
v_mov_b32 v87, 0
v_mov_b32 v88, 0
v_mov_b32 v89, 0
v_mov_b32 v90, 0
v_mov_b32 v91, 0
s_barrier
ds_read_b128 v[32:35], v3 offset:0
ds_read_b128 v[36:39], v4 offset:0
ds_read_b128 v[52:55], v8 offset:0
ds_read_b128 v[40:43], v5 offset:0
ds_read_b128 v[44:47], v6 offset:0
ds_read_b128 v[48:51], v7 offset:0
ds_read_b128 v[56:59], v9 offset:0
s_waitcnt lgkmcnt(6)
v_smfmac_f32_16x16x64_bf16 v[60:63], v[32:35], a[0:7], v10
ds_read_b128 v[160:163], v26 offset:0
v_smfmac_f32_16x16x64_bf16 v[64:67], v[32:35], a[8:15], v10
ds_read_b128 v[164:167], v26 offset:1024
v_smfmac_f32_16x16x64_bf16 v[68:71], v[32:35], a[16:23], v10
ds_read_b128 v[168:171], v26 offset:2048
v_smfmac_f32_16x16x64_bf16 v[72:75], v[32:35], a[24:31], v10
ds_read_b128 v[172:175], v26 offset:3072
v_smfmac_f32_16x16x64_bf16 v[76:79], v[32:35], a[32:39], v10
ds_read_b128 v[176:179], v26 offset:4096
v_smfmac_f32_16x16x64_bf16 v[80:83], v[32:35], a[40:47], v10
ds_read_b128 v[180:183], v26 offset:5120
v_smfmac_f32_16x16x64_bf16 v[84:87], v[32:35], a[48:55], v10
ds_read_b128 v[184:187], v26 offset:6144
v_smfmac_f32_16x16x64_bf16 v[88:91], v[32:35], a[56:63], v10
ds_read_b128 v[188:191], v26 offset:7168
s_waitcnt lgkmcnt(13)
v_smfmac_f32_16x16x64_bf16 v[60:63], v[36:39], a[64:71], v10
v_smfmac_f32_16x16x64_bf16 v[64:67], v[36:39], a[72:79], v10
s_waitcnt lgkmcnt(12)
s_waitcnt lgkmcnt(6)
v_smfmac_f32_16x16x64_bf16 v[60:63], v[52:55], v[160:167], v10
ds_read_b128 v[160:163], v26 offset:8192
v_smfmac_f32_16x16x64_bf16 v[68:71], v[36:39], a[80:87], v10
ds_read_b128 v[164:167], v26 offset:9216
v_smfmac_f32_16x16x64_bf16 v[72:75], v[36:39], a[88:95], v10
s_waitcnt lgkmcnt(6)
v_smfmac_f32_16x16x64_bf16 v[64:67], v[52:55], v[168:175], v10
ds_read_b128 v[168:171], v26 offset:10240
v_smfmac_f32_16x16x64_bf16 v[76:79], v[36:39], a[96:103], v10
ds_read_b128 v[172:175], v26 offset:11264
v_smfmac_f32_16x16x64_bf16 v[80:83], v[36:39], a[104:111], v10
s_waitcnt lgkmcnt(6)
v_smfmac_f32_16x16x64_bf16 v[68:71], v[52:55], v[176:183], v10
ds_read_b128 v[176:179], v26 offset:12288
v_smfmac_f32_16x16x64_bf16 v[84:87], v[36:39], a[112:119], v10
ds_read_b128 v[180:183], v26 offset:13312
v_smfmac_f32_16x16x64_bf16 v[88:91], v[36:39], a[120:127], v10
s_waitcnt lgkmcnt(6)
v_smfmac_f32_16x16x64_bf16 v[72:75], v[52:55], v[184:191], v10
ds_read_b128 v[184:187], v26 offset:14336
v_smfmac_f32_16x16x64_bf16 v[60:63], v[40:43], a[128:135], v10
ds_read_b128 v[188:191], v26 offset:15360
v_smfmac_f32_16x16x64_bf16 v[64:67], v[40:43], a[136:143], v10
s_waitcnt lgkmcnt(6)
v_smfmac_f32_16x16x64_bf16 v[76:79], v[52:55], v[160:167], v10
ds_read_b128 v[160:163], v26 offset:16384
v_smfmac_f32_16x16x64_bf16 v[68:71], v[40:43], a[144:151], v10
ds_read_b128 v[164:167], v26 offset:17408
v_smfmac_f32_16x16x64_bf16 v[72:75], v[40:43], a[152:159], v10
s_and_b32 s30, s18, 3
s_cmp_eq_u32 s30, 3
s_cbranch_scc0 Lsu_289
s_add_u32 s29, s29, 128
buffer_load_dword v30, v13, s[8:11], s29 offen sc1
Lsu_289:
s_waitcnt lgkmcnt(6)
v_smfmac_f32_16x16x64_bf16 v[80:83], v[52:55], v[168:175], v10
ds_read_b128 v[168:171], v26 offset:18432
v_smfmac_f32_16x16x64_bf16 v[76:79], v[40:43], a[160:167], v10
ds_read_b128 v[172:175], v26 offset:19456
v_smfmac_f32_16x16x64_bf16 v[80:83], v[40:43], a[168:175], v10
s_waitcnt lgkmcnt(6)
v_smfmac_f32_16x16x64_bf16 v[84:87], v[52:55], v[176:183], v10
ds_read_b128 v[176:179], v26 offset:20480
v_smfmac_f32_16x16x64_bf16 v[84:87], v[40:43], a[176:183], v10
ds_read_b128 v[180:183], v26 offset:21504
v_smfmac_f32_16x16x64_bf16 v[88:91], v[40:43], a[184:191], v10
s_waitcnt lgkmcnt(6)
v_smfmac_f32_16x16x64_bf16 v[88:91], v[52:55], v[184:191], v10
ds_read_b128 v[184:187], v26 offset:22528
v_smfmac_f32_16x16x64_bf16 v[60:63], v[44:47], a[192:199], v10
ds_read_b128 v[188:191], v26 offset:23552
v_smfmac_f32_16x16x64_bf16 v[64:67], v[44:47], a[200:207], v10
s_waitcnt lgkmcnt(6)
v_smfmac_f32_16x16x64_bf16 v[60:63], v[56:59], v[160:167], v10
ds_read_b128 v[160:163], v26 offset:24576
v_smfmac_f32_16x16x64_bf16 v[68:71], v[44:47], a[208:215], v10
ds_read_b128 v[164:167], v26 offset:25600
v_smfmac_f32_16x16x64_bf16 v[72:75], v[44:47], a[216:223], v10
s_waitcnt lgkmcnt(6)
v_smfmac_f32_16x16x64_bf16 v[64:67], v[56:59], v[168:175], v10
ds_read_b128 v[168:171], v26 offset:26624
v_smfmac_f32_16x16x64_bf16 v[76:79], v[44:47], a[224:231], v10
ds_read_b128 v[172:175], v26 offset:27648
v_smfmac_f32_16x16x64_bf16 v[80:83], v[44:47], a[232:239], v10
s_waitcnt lgkmcnt(6)
v_smfmac_f32_16x16x64_bf16 v[68:71], v[56:59], v[176:183], v10
ds_read_b128 v[176:179], v26 offset:28672
v_smfmac_f32_16x16x64_bf16 v[84:87], v[44:47], a[240:247], v10
ds_read_b128 v[180:183], v26 offset:29696
v_smfmac_f32_16x16x64_bf16 v[88:91], v[44:47], a[248:255], v10
s_waitcnt lgkmcnt(6)
v_smfmac_f32_16x16x64_bf16 v[72:75], v[56:59], v[184:191], v10
ds_read_b128 v[184:187], v26 offset:30720
v_smfmac_f32_16x16x64_bf16 v[60:63], v[48:51], v[192:199], v10
ds_read_b128 v[188:191], v26 offset:31744
v_smfmac_f32_16x16x64_bf16 v[64:67], v[48:51], v[200:207], v10
s_waitcnt lgkmcnt(6)
v_smfmac_f32_16x16x64_bf16 v[76:79], v[56:59], v[160:167], v10
v_smfmac_f32_16x16x64_bf16 v[68:71], v[48:51], v[208:215], v10
v_smfmac_f32_16x16x64_bf16 v[72:75], v[48:51], v[216:223], v10
s_waitcnt lgkmcnt(4)
v_smfmac_f32_16x16x64_bf16 v[80:83], v[56:59], v[168:175], v10
v_smfmac_f32_16x16x64_bf16 v[76:79], v[48:51], v[224:231], v10
v_smfmac_f32_16x16x64_bf16 v[80:83], v[48:51], v[232:239], v10
s_waitcnt lgkmcnt(2)
v_smfmac_f32_16x16x64_bf16 v[84:87], v[56:59], v[176:183], v10
v_smfmac_f32_16x16x64_bf16 v[84:87], v[48:51], v[240:247], v10
v_smfmac_f32_16x16x64_bf16 v[88:91], v[48:51], v[248:255], v10
s_waitcnt lgkmcnt(0)
v_smfmac_f32_16x16x64_bf16 v[88:91], v[56:59], v[184:191], v10
s_nop 7
v_pk_add_f32 v[60:61], v[60:61], v[62:63]
v_pk_add_f32 v[64:65], v[64:65], v[66:67]
v_pk_add_f32 v[68:69], v[68:69], v[70:71]
v_pk_add_f32 v[72:73], v[72:73], v[74:75]
v_pk_add_f32 v[76:77], v[76:77], v[78:79]
v_pk_add_f32 v[80:81], v[80:81], v[82:83]
v_pk_add_f32 v[84:85], v[84:85], v[86:87]
v_pk_add_f32 v[88:89], v[88:89], v[90:91]
v_cvt_pk_bf16_f32 v124, v60, v61
v_cvt_pk_bf16_f32 v125, v64, v65
v_cvt_pk_bf16_f32 v126, v68, v69
v_cvt_pk_bf16_f32 v127, v72, v73
v_cvt_pk_bf16_f32 v132, v76, v77
v_cvt_pk_bf16_f32 v133, v80, v81
v_cvt_pk_bf16_f32 v134, v84, v85
v_cvt_pk_bf16_f32 v135, v88, v89
s_mov_b64 exec, 15
buffer_load_dword v17, v31, s[8:11], s35 offen sc1
s_nop 15
buffer_load_dword v18, v31, s[8:11], s35 offen sc1
s_nop 15
buffer_load_dword v19, v31, s[8:11], s35 offen sc1
Lfp_290:
s_waitcnt vmcnt(2)
v_cmp_gt_u32 vcc, v14, v17
s_cbranch_vccz Lfg_291
buffer_load_dword v17, v31, s[8:11], s35 offen sc1
s_waitcnt vmcnt(2)
v_cmp_gt_u32 vcc, v14, v18
s_cbranch_vccz Lfg_291
buffer_load_dword v18, v31, s[8:11], s35 offen sc1
s_waitcnt vmcnt(2)
v_cmp_gt_u32 vcc, v14, v19
s_cbranch_vccz Lfg_291
buffer_load_dword v19, v31, s[8:11], s35 offen sc1

s_sub_u32 s19, s19, 1
s_cbranch_scc0 Lfp_290
s_mov_b32 s19, 0
Lfg_291:
s_mov_b64 exec, -1
Lpp_292:
buffer_load_dwordx4 v[140:143], v21, s[8:11], s22 offen sc1
buffer_load_dwordx4 v[144:147], v21, s[8:11], s22 offen offset:1024 sc1

buffer_load_dwordx4 v[148:151], v22, s[8:11], s22 offen sc1

s_waitcnt vmcnt(2)
v_smfmac_f32_16x16x64_bf16 v[152:155], v[140:143], v[92:99], v10
v_smfmac_f32_16x16x64_bf16 v[156:159], v[140:143], v[108:115], v10
s_waitcnt vmcnt(1)
buffer_store_dword v14, v16, s[8:11], s34 offen offset:2048 sc1
v_smfmac_f32_16x16x64_bf16 v[152:155], v[144:147], v[100:107], v10
v_smfmac_f32_16x16x64_bf16 v[156:159], v[144:147], v[116:123], v10
s_waitcnt vmcnt(1)
v_smfmac_f32_16x16x64_bf16 v[152:155], v[148:151], v[124:131], v10
v_smfmac_f32_16x16x64_bf16 v[156:159], v[148:151], v[132:139], v10
s_nop 6
v_pk_add_f32 v[152:153], v[152:153], v[154:155]
v_pk_add_f32 v[156:157], v[156:157], v[158:159]
ds_write2_b32 v23, v152, v153 offset0:0 offset1:16
ds_write2_b32 v29, v156, v157 offset0:0 offset1:16
v_cmp_u_f32 vcc, v152, v153
s_cbranch_vccnz Lpr2_295
Lpa2_296:
buffer_store_dword v14, v16, s[8:11], s34 offen sc1
s_waitcnt lgkmcnt(0)
s_barrier
s_add_u32 s18, s18, 1
s_xor_b32 s20, s20, 8192
s_xor_b32 s21, s21, 8192
s_xor_b32 s22, s22, 16384
s_add_u32 s24, s24, 458752
s_add_u32 s39, s39, 458752
s_mov_b32 s27, s26
s_add_u32 s26, s26, 114688
s_lshl_b32 s28, s18, 13
s_add_u32 s28, s28, 53469184

v_cmp_gt_u32 vcc, 32, v30
s_cbranch_vccnz Lcr_298
Lco_297:
v_add_u32 v14, 1, v14
s_cmp_lt_u32 s18, 63
s_cbranch_scc1 Ltop_281
v_mov_b32 v60, 0
v_mov_b32 v61, 0
v_mov_b32 v62, 0
v_mov_b32 v63, 0
v_mov_b32 v64, 0
v_mov_b32 v65, 0
v_mov_b32 v66, 0
v_mov_b32 v67, 0
v_mov_b32 v68, 0
v_mov_b32 v69, 0
v_mov_b32 v70, 0
v_mov_b32 v71, 0
v_mov_b32 v72, 0
v_mov_b32 v73, 0
v_mov_b32 v74, 0
v_mov_b32 v75, 0
v_mov_b32 v76, 0
v_mov_b32 v77, 0
v_mov_b32 v78, 0
v_mov_b32 v79, 0
v_mov_b32 v80, 0
v_mov_b32 v81, 0
v_mov_b32 v82, 0
v_mov_b32 v83, 0
v_mov_b32 v84, 0
v_mov_b32 v85, 0
v_mov_b32 v86, 0
v_mov_b32 v87, 0
v_mov_b32 v88, 0
v_mov_b32 v89, 0
v_mov_b32 v90, 0
v_mov_b32 v91, 0
s_barrier
buffer_store_dwordx4 v[124:127], v2, s[8:11], s27 offen sc1
s_add_u32 s30, s27, 4096
buffer_store_dwordx4 v[132:135], v2, s[8:11], s30 offen sc1
s_cmp_lt_u32 s33, 7
s_cbranch_scc1 Lpub_299
Lpubb_300:
s_barrier
ds_read_b128 v[32:35], v3 offset:0
ds_read_b128 v[36:39], v4 offset:0
ds_read_b128 v[52:55], v8 offset:0
ds_read_b128 v[40:43], v5 offset:0
ds_read_b128 v[44:47], v6 offset:0
ds_read_b128 v[48:51], v7 offset:0
ds_read_b128 v[56:59], v9 offset:0
s_waitcnt lgkmcnt(6)
v_smfmac_f32_16x16x64_bf16 v[60:63], v[32:35], a[0:7], v10
ds_read_b128 v[160:163], v26 offset:0
v_smfmac_f32_16x16x64_bf16 v[64:67], v[32:35], a[8:15], v10
ds_read_b128 v[164:167], v26 offset:1024
v_smfmac_f32_16x16x64_bf16 v[68:71], v[32:35], a[16:23], v10
ds_read_b128 v[168:171], v26 offset:2048
v_smfmac_f32_16x16x64_bf16 v[72:75], v[32:35], a[24:31], v10
ds_read_b128 v[172:175], v26 offset:3072
v_smfmac_f32_16x16x64_bf16 v[76:79], v[32:35], a[32:39], v10
ds_read_b128 v[176:179], v26 offset:4096
v_smfmac_f32_16x16x64_bf16 v[80:83], v[32:35], a[40:47], v10
ds_read_b128 v[180:183], v26 offset:5120
v_smfmac_f32_16x16x64_bf16 v[84:87], v[32:35], a[48:55], v10
ds_read_b128 v[184:187], v26 offset:6144
v_smfmac_f32_16x16x64_bf16 v[88:91], v[32:35], a[56:63], v10
ds_read_b128 v[188:191], v26 offset:7168
s_waitcnt lgkmcnt(13)
v_smfmac_f32_16x16x64_bf16 v[60:63], v[36:39], a[64:71], v10
v_smfmac_f32_16x16x64_bf16 v[64:67], v[36:39], a[72:79], v10
s_waitcnt lgkmcnt(12)
s_waitcnt lgkmcnt(6)
v_smfmac_f32_16x16x64_bf16 v[60:63], v[52:55], v[160:167], v10
ds_read_b128 v[160:163], v26 offset:8192
v_smfmac_f32_16x16x64_bf16 v[68:71], v[36:39], a[80:87], v10
ds_read_b128 v[164:167], v26 offset:9216
v_smfmac_f32_16x16x64_bf16 v[72:75], v[36:39], a[88:95], v10
s_waitcnt lgkmcnt(6)
v_smfmac_f32_16x16x64_bf16 v[64:67], v[52:55], v[168:175], v10
ds_read_b128 v[168:171], v26 offset:10240
v_smfmac_f32_16x16x64_bf16 v[76:79], v[36:39], a[96:103], v10
ds_read_b128 v[172:175], v26 offset:11264
v_smfmac_f32_16x16x64_bf16 v[80:83], v[36:39], a[104:111], v10
s_waitcnt lgkmcnt(6)
v_smfmac_f32_16x16x64_bf16 v[68:71], v[52:55], v[176:183], v10
ds_read_b128 v[176:179], v26 offset:12288
v_smfmac_f32_16x16x64_bf16 v[84:87], v[36:39], a[112:119], v10
ds_read_b128 v[180:183], v26 offset:13312
v_smfmac_f32_16x16x64_bf16 v[88:91], v[36:39], a[120:127], v10
s_waitcnt lgkmcnt(6)
v_smfmac_f32_16x16x64_bf16 v[72:75], v[52:55], v[184:191], v10
ds_read_b128 v[184:187], v26 offset:14336
v_smfmac_f32_16x16x64_bf16 v[60:63], v[40:43], a[128:135], v10
ds_read_b128 v[188:191], v26 offset:15360
v_smfmac_f32_16x16x64_bf16 v[64:67], v[40:43], a[136:143], v10
s_waitcnt lgkmcnt(6)
v_smfmac_f32_16x16x64_bf16 v[76:79], v[52:55], v[160:167], v10
ds_read_b128 v[160:163], v26 offset:16384
v_smfmac_f32_16x16x64_bf16 v[68:71], v[40:43], a[144:151], v10
ds_read_b128 v[164:167], v26 offset:17408
v_smfmac_f32_16x16x64_bf16 v[72:75], v[40:43], a[152:159], v10
s_waitcnt lgkmcnt(6)
v_smfmac_f32_16x16x64_bf16 v[80:83], v[52:55], v[168:175], v10
ds_read_b128 v[168:171], v26 offset:18432
v_smfmac_f32_16x16x64_bf16 v[76:79], v[40:43], a[160:167], v10
ds_read_b128 v[172:175], v26 offset:19456
v_smfmac_f32_16x16x64_bf16 v[80:83], v[40:43], a[168:175], v10
s_waitcnt lgkmcnt(6)
v_smfmac_f32_16x16x64_bf16 v[84:87], v[52:55], v[176:183], v10
ds_read_b128 v[176:179], v26 offset:20480
v_smfmac_f32_16x16x64_bf16 v[84:87], v[40:43], a[176:183], v10
ds_read_b128 v[180:183], v26 offset:21504
v_smfmac_f32_16x16x64_bf16 v[88:91], v[40:43], a[184:191], v10
s_waitcnt lgkmcnt(6)
v_smfmac_f32_16x16x64_bf16 v[88:91], v[52:55], v[184:191], v10
ds_read_b128 v[184:187], v26 offset:22528
v_smfmac_f32_16x16x64_bf16 v[60:63], v[44:47], a[192:199], v10
ds_read_b128 v[188:191], v26 offset:23552
v_smfmac_f32_16x16x64_bf16 v[64:67], v[44:47], a[200:207], v10
s_waitcnt lgkmcnt(6)
v_smfmac_f32_16x16x64_bf16 v[60:63], v[56:59], v[160:167], v10
ds_read_b128 v[160:163], v26 offset:24576
v_smfmac_f32_16x16x64_bf16 v[68:71], v[44:47], a[208:215], v10
ds_read_b128 v[164:167], v26 offset:25600
v_smfmac_f32_16x16x64_bf16 v[72:75], v[44:47], a[216:223], v10
s_waitcnt lgkmcnt(6)
v_smfmac_f32_16x16x64_bf16 v[64:67], v[56:59], v[168:175], v10
ds_read_b128 v[168:171], v26 offset:26624
v_smfmac_f32_16x16x64_bf16 v[76:79], v[44:47], a[224:231], v10
ds_read_b128 v[172:175], v26 offset:27648
v_smfmac_f32_16x16x64_bf16 v[80:83], v[44:47], a[232:239], v10
s_waitcnt lgkmcnt(6)
v_smfmac_f32_16x16x64_bf16 v[68:71], v[56:59], v[176:183], v10
ds_read_b128 v[176:179], v26 offset:28672
v_smfmac_f32_16x16x64_bf16 v[84:87], v[44:47], a[240:247], v10
ds_read_b128 v[180:183], v26 offset:29696
v_smfmac_f32_16x16x64_bf16 v[88:91], v[44:47], a[248:255], v10
s_waitcnt lgkmcnt(6)
v_smfmac_f32_16x16x64_bf16 v[72:75], v[56:59], v[184:191], v10
ds_read_b128 v[184:187], v26 offset:30720
v_smfmac_f32_16x16x64_bf16 v[60:63], v[48:51], v[192:199], v10
ds_read_b128 v[188:191], v26 offset:31744
v_smfmac_f32_16x16x64_bf16 v[64:67], v[48:51], v[200:207], v10
s_waitcnt lgkmcnt(6)
v_smfmac_f32_16x16x64_bf16 v[76:79], v[56:59], v[160:167], v10
v_smfmac_f32_16x16x64_bf16 v[68:71], v[48:51], v[208:215], v10
v_smfmac_f32_16x16x64_bf16 v[72:75], v[48:51], v[216:223], v10
s_waitcnt lgkmcnt(4)
v_smfmac_f32_16x16x64_bf16 v[80:83], v[56:59], v[168:175], v10
v_smfmac_f32_16x16x64_bf16 v[76:79], v[48:51], v[224:231], v10
v_smfmac_f32_16x16x64_bf16 v[80:83], v[48:51], v[232:239], v10
s_waitcnt lgkmcnt(2)
v_smfmac_f32_16x16x64_bf16 v[84:87], v[56:59], v[176:183], v10
v_smfmac_f32_16x16x64_bf16 v[84:87], v[48:51], v[240:247], v10
v_smfmac_f32_16x16x64_bf16 v[88:91], v[48:51], v[248:255], v10
s_waitcnt lgkmcnt(0)
v_smfmac_f32_16x16x64_bf16 v[88:91], v[56:59], v[184:191], v10
s_nop 7
v_pk_add_f32 v[60:61], v[60:61], v[62:63]
v_pk_add_f32 v[64:65], v[64:65], v[66:67]
v_pk_add_f32 v[68:69], v[68:69], v[70:71]
v_pk_add_f32 v[72:73], v[72:73], v[74:75]
v_pk_add_f32 v[76:77], v[76:77], v[78:79]
v_pk_add_f32 v[80:81], v[80:81], v[82:83]
v_pk_add_f32 v[84:85], v[84:85], v[86:87]
v_pk_add_f32 v[88:89], v[88:89], v[90:91]
v_cvt_pk_bf16_f32 v124, v60, v61
v_cvt_pk_bf16_f32 v125, v64, v65
v_cvt_pk_bf16_f32 v126, v68, v69
v_cvt_pk_bf16_f32 v127, v72, v73
v_cvt_pk_bf16_f32 v132, v76, v77
v_cvt_pk_bf16_f32 v133, v80, v81
v_cvt_pk_bf16_f32 v134, v84, v85
v_cvt_pk_bf16_f32 v135, v88, v89
buffer_store_dwordx4 v[124:127], v2, s[8:11], s26 offen sc1
s_add_u32 s30, s26, 4096
buffer_store_dwordx4 v[132:135], v2, s[8:11], s30 offen sc1
v_mov_b32 v14, 65
s_waitcnt vmcnt(0)
buffer_store_dword v14, v16, s[8:11], s34 offen sc1
s_branch Lrec_done
Lcr_283:
buffer_load_dword v30, v13, s[8:11], s29 offen sc1
s_waitcnt vmcnt(0)
v_cmp_gt_u32 vcc, 32, v30
s_cbranch_vccz Lco_282
s_sleep 4

s_sub_u32 s19, s19, 1
s_cbranch_scc0 Lcr_283
s_mov_b32 s19, 0
s_branch Lco_282
Lpub_284:
s_cmp_eq_u32 s33, 0
s_cbranch_scc0 Lpub_284_0
buffer_store_dwordx4 v[52:55], v8, s[8:11], s28 offen sc1
s_branch Lpubb_285
Lpub_284_0:
s_cmp_eq_u32 s33, 1
s_cbranch_scc0 Lpub_284_1
buffer_store_dwordx4 v[56:59], v9, s[8:11], s28 offen sc1
s_branch Lpubb_285
Lpub_284_1:
s_cmp_eq_u32 s33, 2
s_cbranch_scc0 Lpub_284_2
buffer_store_dwordx4 v[32:35], v3, s[8:11], s28 offen sc1
s_branch Lpubb_285
Lpub_284_2:
s_cmp_eq_u32 s33, 3
s_cbranch_scc0 Lpub_284_3
buffer_store_dwordx4 v[36:39], v4, s[8:11], s28 offen sc1
s_branch Lpubb_285
Lpub_284_3:
s_cmp_eq_u32 s33, 4
s_cbranch_scc0 Lpub_284_4
buffer_store_dwordx4 v[40:43], v5, s[8:11], s28 offen sc1
s_branch Lpubb_285
Lpub_284_4:
s_cmp_eq_u32 s33, 5
s_cbranch_scc0 Lpub_284_5
buffer_store_dwordx4 v[44:47], v6, s[8:11], s28 offen sc1
s_branch Lpubb_285
Lpub_284_5:
buffer_store_dwordx4 v[48:51], v7, s[8:11], s28 offen sc1
s_branch Lpubb_285
Lpub_284_6:
Lpr2_295:
s_sub_u32 s19, s19, 1
s_cbranch_scc1 Lpr2_295x
s_waitcnt lgkmcnt(0)

v_mov_b32 v152, 0
v_mov_b32 v153, 0
v_mov_b32 v154, 0
v_mov_b32 v155, 0
v_mov_b32 v156, 0
v_mov_b32 v157, 0
v_mov_b32 v158, 0
v_mov_b32 v159, 0
s_branch Lpp_292
Lpr2_295x:
s_mov_b32 s19, 0
s_branch Lpa2_296
Lcr_298:
buffer_load_dword v30, v13, s[8:11], s29 offen sc1
s_waitcnt vmcnt(0)
v_cmp_gt_u32 vcc, 32, v30
s_cbranch_vccz Lco_297
s_sleep 4

s_sub_u32 s19, s19, 1
s_cbranch_scc0 Lcr_298
s_mov_b32 s19, 0
s_branch Lco_297
Lpub_299:
s_cmp_eq_u32 s33, 0
s_cbranch_scc0 Lpub_299_0
buffer_store_dwordx4 v[52:55], v8, s[8:11], s28 offen sc1
s_branch Lpubb_300
Lpub_299_0:
s_cmp_eq_u32 s33, 1
s_cbranch_scc0 Lpub_299_1
buffer_store_dwordx4 v[56:59], v9, s[8:11], s28 offen sc1
s_branch Lpubb_300
Lpub_299_1:
s_cmp_eq_u32 s33, 2
s_cbranch_scc0 Lpub_299_2
buffer_store_dwordx4 v[32:35], v3, s[8:11], s28 offen sc1
s_branch Lpubb_300
Lpub_299_2:
s_cmp_eq_u32 s33, 3
s_cbranch_scc0 Lpub_299_3
buffer_store_dwordx4 v[36:39], v4, s[8:11], s28 offen sc1
s_branch Lpubb_300
Lpub_299_3:
s_cmp_eq_u32 s33, 4
s_cbranch_scc0 Lpub_299_4
buffer_store_dwordx4 v[40:43], v5, s[8:11], s28 offen sc1
s_branch Lpubb_300
Lpub_299_4:
s_cmp_eq_u32 s33, 5
s_cbranch_scc0 Lpub_299_5
buffer_store_dwordx4 v[44:47], v6, s[8:11], s28 offen sc1
s_branch Lpubb_300
Lpub_299_5:
buffer_store_dwordx4 v[48:51], v7, s[8:11], s28 offen sc1
s_branch Lpubb_300
Lpub_299_6:
.p2align 6
Lrole_86:
v_cmp_gt_u32 vcc, 32, v30
s_cbranch_vccnz Lcr_306
Lco_305:
Ltop_304:
s_barrier
buffer_store_dwordx4 v[124:127], v2, s[8:11], s27 offen sc1
s_add_u32 s30, s27, 4096
buffer_store_dwordx4 v[132:135], v2, s[8:11], s30 offen sc1
buffer_store_dword v20, v25, s[8:11], s21 offen sc1
buffer_load_dwordx4 v[92:95], v21, s[8:11], s24 offen offset:0 sc1
v_mov_b32 v152, 0
v_mov_b32 v153, 0
v_mov_b32 v154, 0
v_mov_b32 v155, 0
v_mov_b32 v156, 0
buffer_load_dwordx4 v[96:99], v21, s[8:11], s24 offen offset:1024 sc1
v_mov_b32 v157, 0
v_mov_b32 v158, 0
v_mov_b32 v159, 0
v_mov_b32 v60, 0
v_mov_b32 v61, 0
buffer_load_dwordx4 v[100:103], v21, s[8:11], s24 offen offset:2048 sc1
v_mov_b32 v62, 0
v_mov_b32 v63, 0
v_mov_b32 v64, 0
v_mov_b32 v65, 0
v_mov_b32 v66, 0
buffer_load_dwordx4 v[104:107], v21, s[8:11], s24 offen offset:3072 sc1
v_mov_b32 v67, 0
v_mov_b32 v68, 0
v_mov_b32 v69, 0
v_mov_b32 v70, 0
v_mov_b32 v71, 0
buffer_load_dwordx4 v[108:111], v21, s[8:11], s39 offen offset:0 sc1
v_mov_b32 v72, 0
v_mov_b32 v73, 0
v_mov_b32 v74, 0
v_mov_b32 v75, 0
v_mov_b32 v76, 0
buffer_load_dwordx4 v[112:115], v21, s[8:11], s39 offen offset:1024 sc1
v_mov_b32 v77, 0
v_mov_b32 v78, 0
v_mov_b32 v79, 0
v_mov_b32 v80, 0
v_mov_b32 v81, 0
buffer_load_dwordx4 v[116:119], v21, s[8:11], s39 offen offset:2048 sc1
v_mov_b32 v82, 0
v_mov_b32 v83, 0
v_mov_b32 v84, 0
v_mov_b32 v85, 0
v_mov_b32 v86, 0
buffer_load_dwordx4 v[120:123], v21, s[8:11], s39 offen offset:3072 sc1
v_mov_b32 v87, 0
v_mov_b32 v88, 0
v_mov_b32 v89, 0
v_mov_b32 v90, 0
v_mov_b32 v91, 0
s_barrier
ds_read_b128 v[32:35], v3 offset:0
ds_read_b128 v[36:39], v4 offset:0
ds_read_b128 v[52:55], v8 offset:0
ds_read_b128 v[40:43], v5 offset:0
ds_read_b128 v[44:47], v6 offset:0
ds_read_b128 v[48:51], v7 offset:0
ds_read_b128 v[56:59], v9 offset:0
s_waitcnt lgkmcnt(6)
v_smfmac_f32_16x16x64_bf16 v[60:63], v[32:35], a[0:7], v10
ds_read_b128 v[160:163], v26 offset:0
v_smfmac_f32_16x16x64_bf16 v[64:67], v[32:35], a[8:15], v10
ds_read_b128 v[164:167], v26 offset:1024
v_smfmac_f32_16x16x64_bf16 v[68:71], v[32:35], a[16:23], v10
ds_read_b128 v[168:171], v26 offset:2048
v_smfmac_f32_16x16x64_bf16 v[72:75], v[32:35], a[24:31], v10
ds_read_b128 v[172:175], v26 offset:3072
v_smfmac_f32_16x16x64_bf16 v[76:79], v[32:35], a[32:39], v10
ds_read_b128 v[176:179], v26 offset:4096
v_smfmac_f32_16x16x64_bf16 v[80:83], v[32:35], a[40:47], v10
ds_read_b128 v[180:183], v26 offset:5120
v_smfmac_f32_16x16x64_bf16 v[84:87], v[32:35], a[48:55], v10
ds_read_b128 v[184:187], v26 offset:6144
v_smfmac_f32_16x16x64_bf16 v[88:91], v[32:35], a[56:63], v10
ds_read_b128 v[188:191], v26 offset:7168
s_waitcnt lgkmcnt(13)
v_smfmac_f32_16x16x64_bf16 v[60:63], v[36:39], a[64:71], v10
v_smfmac_f32_16x16x64_bf16 v[64:67], v[36:39], a[72:79], v10
s_waitcnt lgkmcnt(12)
s_waitcnt lgkmcnt(6)
v_smfmac_f32_16x16x64_bf16 v[60:63], v[52:55], v[160:167], v10
ds_read_b128 v[160:163], v26 offset:8192
v_smfmac_f32_16x16x64_bf16 v[68:71], v[36:39], a[80:87], v10
ds_read_b128 v[164:167], v26 offset:9216
v_smfmac_f32_16x16x64_bf16 v[72:75], v[36:39], a[88:95], v10
s_waitcnt lgkmcnt(6)
v_smfmac_f32_16x16x64_bf16 v[64:67], v[52:55], v[168:175], v10
ds_read_b128 v[168:171], v26 offset:10240
v_smfmac_f32_16x16x64_bf16 v[76:79], v[36:39], a[96:103], v10
ds_read_b128 v[172:175], v26 offset:11264
v_smfmac_f32_16x16x64_bf16 v[80:83], v[36:39], a[104:111], v10
s_waitcnt lgkmcnt(6)
v_smfmac_f32_16x16x64_bf16 v[68:71], v[52:55], v[176:183], v10
ds_read_b128 v[176:179], v26 offset:12288
v_smfmac_f32_16x16x64_bf16 v[84:87], v[36:39], a[112:119], v10
ds_read_b128 v[180:183], v26 offset:13312
v_smfmac_f32_16x16x64_bf16 v[88:91], v[36:39], a[120:127], v10
s_waitcnt lgkmcnt(6)
v_smfmac_f32_16x16x64_bf16 v[72:75], v[52:55], v[184:191], v10
ds_read_b128 v[184:187], v26 offset:14336
v_smfmac_f32_16x16x64_bf16 v[60:63], v[40:43], a[128:135], v10
ds_read_b128 v[188:191], v26 offset:15360
v_smfmac_f32_16x16x64_bf16 v[64:67], v[40:43], a[136:143], v10
s_waitcnt lgkmcnt(6)
v_smfmac_f32_16x16x64_bf16 v[76:79], v[52:55], v[160:167], v10
ds_read_b128 v[160:163], v26 offset:16384
v_smfmac_f32_16x16x64_bf16 v[68:71], v[40:43], a[144:151], v10
ds_read_b128 v[164:167], v26 offset:17408
v_smfmac_f32_16x16x64_bf16 v[72:75], v[40:43], a[152:159], v10
s_waitcnt lgkmcnt(6)
v_smfmac_f32_16x16x64_bf16 v[80:83], v[52:55], v[168:175], v10
ds_read_b128 v[168:171], v26 offset:18432
v_smfmac_f32_16x16x64_bf16 v[76:79], v[40:43], a[160:167], v10
ds_read_b128 v[172:175], v26 offset:19456
v_smfmac_f32_16x16x64_bf16 v[80:83], v[40:43], a[168:175], v10
s_waitcnt lgkmcnt(6)
v_smfmac_f32_16x16x64_bf16 v[84:87], v[52:55], v[176:183], v10
ds_read_b128 v[176:179], v26 offset:20480
s_and_b32 s30, s18, 3
s_cmp_eq_u32 s30, 3
s_cbranch_scc0 Lsu_310
s_add_u32 s29, s29, 128
buffer_load_dword v30, v13, s[8:11], s29 offen sc1
Lsu_310:
v_smfmac_f32_16x16x64_bf16 v[84:87], v[40:43], a[176:183], v10
ds_read_b128 v[180:183], v26 offset:21504
v_smfmac_f32_16x16x64_bf16 v[88:91], v[40:43], a[184:191], v10
s_waitcnt lgkmcnt(6)
v_smfmac_f32_16x16x64_bf16 v[88:91], v[52:55], v[184:191], v10
ds_read_b128 v[184:187], v26 offset:22528
v_smfmac_f32_16x16x64_bf16 v[60:63], v[44:47], a[192:199], v10
ds_read_b128 v[188:191], v26 offset:23552
v_smfmac_f32_16x16x64_bf16 v[64:67], v[44:47], a[200:207], v10
s_waitcnt lgkmcnt(6)
v_smfmac_f32_16x16x64_bf16 v[60:63], v[56:59], v[160:167], v10
ds_read_b128 v[160:163], v26 offset:24576
v_smfmac_f32_16x16x64_bf16 v[68:71], v[44:47], a[208:215], v10
ds_read_b128 v[164:167], v26 offset:25600
v_smfmac_f32_16x16x64_bf16 v[72:75], v[44:47], a[216:223], v10
s_waitcnt lgkmcnt(6)
v_smfmac_f32_16x16x64_bf16 v[64:67], v[56:59], v[168:175], v10
ds_read_b128 v[168:171], v26 offset:26624
v_smfmac_f32_16x16x64_bf16 v[76:79], v[44:47], a[224:231], v10
ds_read_b128 v[172:175], v26 offset:27648
v_smfmac_f32_16x16x64_bf16 v[80:83], v[44:47], a[232:239], v10
s_waitcnt lgkmcnt(6)
v_smfmac_f32_16x16x64_bf16 v[68:71], v[56:59], v[176:183], v10
ds_read_b128 v[176:179], v26 offset:28672
v_smfmac_f32_16x16x64_bf16 v[84:87], v[44:47], a[240:247], v10
ds_read_b128 v[180:183], v26 offset:29696
v_smfmac_f32_16x16x64_bf16 v[88:91], v[44:47], a[248:255], v10
s_waitcnt lgkmcnt(6)
v_smfmac_f32_16x16x64_bf16 v[72:75], v[56:59], v[184:191], v10
ds_read_b128 v[184:187], v26 offset:30720
v_smfmac_f32_16x16x64_bf16 v[60:63], v[48:51], v[192:199], v10
ds_read_b128 v[188:191], v26 offset:31744
v_smfmac_f32_16x16x64_bf16 v[64:67], v[48:51], v[200:207], v10
s_waitcnt lgkmcnt(6)
v_smfmac_f32_16x16x64_bf16 v[76:79], v[56:59], v[160:167], v10
v_smfmac_f32_16x16x64_bf16 v[68:71], v[48:51], v[208:215], v10
v_smfmac_f32_16x16x64_bf16 v[72:75], v[48:51], v[216:223], v10
s_waitcnt lgkmcnt(4)
v_smfmac_f32_16x16x64_bf16 v[80:83], v[56:59], v[168:175], v10
v_smfmac_f32_16x16x64_bf16 v[76:79], v[48:51], v[224:231], v10
v_smfmac_f32_16x16x64_bf16 v[80:83], v[48:51], v[232:239], v10
s_waitcnt lgkmcnt(2)
v_smfmac_f32_16x16x64_bf16 v[84:87], v[56:59], v[176:183], v10
v_smfmac_f32_16x16x64_bf16 v[84:87], v[48:51], v[240:247], v10
v_smfmac_f32_16x16x64_bf16 v[88:91], v[48:51], v[248:255], v10
s_waitcnt lgkmcnt(0)
v_smfmac_f32_16x16x64_bf16 v[88:91], v[56:59], v[184:191], v10
s_nop 7
v_pk_add_f32 v[60:61], v[60:61], v[62:63]
v_pk_add_f32 v[64:65], v[64:65], v[66:67]
v_pk_add_f32 v[68:69], v[68:69], v[70:71]
v_pk_add_f32 v[72:73], v[72:73], v[74:75]
v_pk_add_f32 v[76:77], v[76:77], v[78:79]
v_pk_add_f32 v[80:81], v[80:81], v[82:83]
v_pk_add_f32 v[84:85], v[84:85], v[86:87]
v_pk_add_f32 v[88:89], v[88:89], v[90:91]
v_cvt_pk_bf16_f32 v124, v60, v61
v_cvt_pk_bf16_f32 v125, v64, v65
v_cvt_pk_bf16_f32 v126, v68, v69
v_cvt_pk_bf16_f32 v127, v72, v73
v_cvt_pk_bf16_f32 v132, v76, v77
v_cvt_pk_bf16_f32 v133, v80, v81
v_cvt_pk_bf16_f32 v134, v84, v85
v_cvt_pk_bf16_f32 v135, v88, v89
s_mov_b64 exec, 15
buffer_load_dword v17, v31, s[8:11], s35 offen sc1
s_nop 15
buffer_load_dword v18, v31, s[8:11], s35 offen sc1
s_nop 15
buffer_load_dword v19, v31, s[8:11], s35 offen sc1
Lfp_311:
s_waitcnt vmcnt(2)
v_cmp_gt_u32 vcc, v14, v17
s_cbranch_vccz Lfg_312
buffer_load_dword v17, v31, s[8:11], s35 offen sc1
s_waitcnt vmcnt(2)
v_cmp_gt_u32 vcc, v14, v18
s_cbranch_vccz Lfg_312
buffer_load_dword v18, v31, s[8:11], s35 offen sc1
s_waitcnt vmcnt(2)
v_cmp_gt_u32 vcc, v14, v19
s_cbranch_vccz Lfg_312
buffer_load_dword v19, v31, s[8:11], s35 offen sc1

s_sub_u32 s19, s19, 1
s_cbranch_scc0 Lfp_311
s_mov_b32 s19, 0
Lfg_312:
s_mov_b64 exec, -1
Lpp_313:
buffer_load_dwordx4 v[140:143], v21, s[8:11], s22 offen sc1
buffer_load_dwordx4 v[144:147], v21, s[8:11], s22 offen offset:1024 sc1

buffer_load_dwordx4 v[148:151], v22, s[8:11], s22 offen sc1

s_waitcnt vmcnt(2)
v_smfmac_f32_16x16x64_bf16 v[152:155], v[140:143], v[92:99], v10
v_smfmac_f32_16x16x64_bf16 v[156:159], v[140:143], v[108:115], v10
s_waitcnt vmcnt(1)
buffer_store_dword v14, v16, s[8:11], s34 offen offset:2048 sc1
v_smfmac_f32_16x16x64_bf16 v[152:155], v[144:147], v[100:107], v10
v_smfmac_f32_16x16x64_bf16 v[156:159], v[144:147], v[116:123], v10
s_waitcnt vmcnt(1)
v_smfmac_f32_16x16x64_bf16 v[152:155], v[148:151], v[124:131], v10
v_smfmac_f32_16x16x64_bf16 v[156:159], v[148:151], v[132:139], v10
s_nop 6
v_pk_add_f32 v[152:153], v[152:153], v[154:155]
v_pk_add_f32 v[156:157], v[156:157], v[158:159]
ds_write2_b32 v23, v152, v153 offset0:0 offset1:16
ds_write2_b32 v29, v156, v157 offset0:0 offset1:16
v_cmp_u_f32 vcc, v152, v153
s_cbranch_vccnz Lpr2_316
Lpa2_317:
buffer_store_dword v14, v16, s[8:11], s34 offen sc1
s_waitcnt lgkmcnt(0)
s_barrier
ds_read2st64_b64 v[160:163], v24 offset0:0 offset1:1
ds_read2st64_b64 v[164:167], v24 offset0:2 offset1:3
s_waitcnt lgkmcnt(1)
v_pk_add_f32 v[160:161], v[160:161], v[162:163]
s_waitcnt lgkmcnt(0)
v_pk_add_f32 v[164:165], v[164:165], v[166:167]
v_pk_add_f32 v[160:161], v[160:161], v[164:165]
v_cvt_pk_bf16_f32 v160, v160, v161
buffer_store_dword v160, v25, s[8:11], s21 offen sc1
s_cmp_eq_u32 s18, 62
s_mov_b32 s30, 53993472
s_cselect_b32 s30, s30, 1073741824
s_cbranch_scc0 Llast_318
buffer_store_dword v160, v25, s[8:11], s30 offen sc1
Llast_318:
s_add_u32 s18, s18, 1
s_xor_b32 s20, s20, 8192
s_xor_b32 s21, s21, 8192
s_xor_b32 s22, s22, 16384
s_add_u32 s24, s24, 458752
s_add_u32 s39, s39, 458752
s_mov_b32 s27, s26
s_add_u32 s26, s26, 114688
s_lshl_b32 s28, s18, 13
s_add_u32 s28, s28, 53469184

v_cmp_gt_u32 vcc, 32, v30
s_cbranch_vccnz Lcr_320
Lco_319:
v_add_u32 v14, 1, v14
s_cmp_lt_u32 s18, 63
s_cbranch_scc1 Ltop_304
v_mov_b32 v60, 0
v_mov_b32 v61, 0
v_mov_b32 v62, 0
v_mov_b32 v63, 0
v_mov_b32 v64, 0
v_mov_b32 v65, 0
v_mov_b32 v66, 0
v_mov_b32 v67, 0
v_mov_b32 v68, 0
v_mov_b32 v69, 0
v_mov_b32 v70, 0
v_mov_b32 v71, 0
v_mov_b32 v72, 0
v_mov_b32 v73, 0
v_mov_b32 v74, 0
v_mov_b32 v75, 0
v_mov_b32 v76, 0
v_mov_b32 v77, 0
v_mov_b32 v78, 0
v_mov_b32 v79, 0
v_mov_b32 v80, 0
v_mov_b32 v81, 0
v_mov_b32 v82, 0
v_mov_b32 v83, 0
v_mov_b32 v84, 0
v_mov_b32 v85, 0
v_mov_b32 v86, 0
v_mov_b32 v87, 0
v_mov_b32 v88, 0
v_mov_b32 v89, 0
v_mov_b32 v90, 0
v_mov_b32 v91, 0
s_barrier
buffer_store_dwordx4 v[124:127], v2, s[8:11], s27 offen sc1
s_add_u32 s30, s27, 4096
buffer_store_dwordx4 v[132:135], v2, s[8:11], s30 offen sc1
s_barrier
ds_read_b128 v[32:35], v3 offset:0
ds_read_b128 v[36:39], v4 offset:0
ds_read_b128 v[52:55], v8 offset:0
ds_read_b128 v[40:43], v5 offset:0
ds_read_b128 v[44:47], v6 offset:0
ds_read_b128 v[48:51], v7 offset:0
ds_read_b128 v[56:59], v9 offset:0
s_waitcnt lgkmcnt(6)
v_smfmac_f32_16x16x64_bf16 v[60:63], v[32:35], a[0:7], v10
ds_read_b128 v[160:163], v26 offset:0
v_smfmac_f32_16x16x64_bf16 v[64:67], v[32:35], a[8:15], v10
ds_read_b128 v[164:167], v26 offset:1024
v_smfmac_f32_16x16x64_bf16 v[68:71], v[32:35], a[16:23], v10
ds_read_b128 v[168:171], v26 offset:2048
v_smfmac_f32_16x16x64_bf16 v[72:75], v[32:35], a[24:31], v10
ds_read_b128 v[172:175], v26 offset:3072
v_smfmac_f32_16x16x64_bf16 v[76:79], v[32:35], a[32:39], v10
ds_read_b128 v[176:179], v26 offset:4096
v_smfmac_f32_16x16x64_bf16 v[80:83], v[32:35], a[40:47], v10
ds_read_b128 v[180:183], v26 offset:5120
v_smfmac_f32_16x16x64_bf16 v[84:87], v[32:35], a[48:55], v10
ds_read_b128 v[184:187], v26 offset:6144
v_smfmac_f32_16x16x64_bf16 v[88:91], v[32:35], a[56:63], v10
ds_read_b128 v[188:191], v26 offset:7168
s_waitcnt lgkmcnt(13)
v_smfmac_f32_16x16x64_bf16 v[60:63], v[36:39], a[64:71], v10
v_smfmac_f32_16x16x64_bf16 v[64:67], v[36:39], a[72:79], v10
s_waitcnt lgkmcnt(12)
s_waitcnt lgkmcnt(6)
v_smfmac_f32_16x16x64_bf16 v[60:63], v[52:55], v[160:167], v10
ds_read_b128 v[160:163], v26 offset:8192
v_smfmac_f32_16x16x64_bf16 v[68:71], v[36:39], a[80:87], v10
ds_read_b128 v[164:167], v26 offset:9216
v_smfmac_f32_16x16x64_bf16 v[72:75], v[36:39], a[88:95], v10
s_waitcnt lgkmcnt(6)
v_smfmac_f32_16x16x64_bf16 v[64:67], v[52:55], v[168:175], v10
ds_read_b128 v[168:171], v26 offset:10240
v_smfmac_f32_16x16x64_bf16 v[76:79], v[36:39], a[96:103], v10
ds_read_b128 v[172:175], v26 offset:11264
v_smfmac_f32_16x16x64_bf16 v[80:83], v[36:39], a[104:111], v10
s_waitcnt lgkmcnt(6)
v_smfmac_f32_16x16x64_bf16 v[68:71], v[52:55], v[176:183], v10
ds_read_b128 v[176:179], v26 offset:12288
v_smfmac_f32_16x16x64_bf16 v[84:87], v[36:39], a[112:119], v10
ds_read_b128 v[180:183], v26 offset:13312
v_smfmac_f32_16x16x64_bf16 v[88:91], v[36:39], a[120:127], v10
s_waitcnt lgkmcnt(6)
v_smfmac_f32_16x16x64_bf16 v[72:75], v[52:55], v[184:191], v10
ds_read_b128 v[184:187], v26 offset:14336
v_smfmac_f32_16x16x64_bf16 v[60:63], v[40:43], a[128:135], v10
ds_read_b128 v[188:191], v26 offset:15360
v_smfmac_f32_16x16x64_bf16 v[64:67], v[40:43], a[136:143], v10
s_waitcnt lgkmcnt(6)
v_smfmac_f32_16x16x64_bf16 v[76:79], v[52:55], v[160:167], v10
ds_read_b128 v[160:163], v26 offset:16384
v_smfmac_f32_16x16x64_bf16 v[68:71], v[40:43], a[144:151], v10
ds_read_b128 v[164:167], v26 offset:17408
v_smfmac_f32_16x16x64_bf16 v[72:75], v[40:43], a[152:159], v10
s_waitcnt lgkmcnt(6)
v_smfmac_f32_16x16x64_bf16 v[80:83], v[52:55], v[168:175], v10
ds_read_b128 v[168:171], v26 offset:18432
v_smfmac_f32_16x16x64_bf16 v[76:79], v[40:43], a[160:167], v10
ds_read_b128 v[172:175], v26 offset:19456
v_smfmac_f32_16x16x64_bf16 v[80:83], v[40:43], a[168:175], v10
s_waitcnt lgkmcnt(6)
v_smfmac_f32_16x16x64_bf16 v[84:87], v[52:55], v[176:183], v10
ds_read_b128 v[176:179], v26 offset:20480
v_smfmac_f32_16x16x64_bf16 v[84:87], v[40:43], a[176:183], v10
ds_read_b128 v[180:183], v26 offset:21504
v_smfmac_f32_16x16x64_bf16 v[88:91], v[40:43], a[184:191], v10
s_waitcnt lgkmcnt(6)
v_smfmac_f32_16x16x64_bf16 v[88:91], v[52:55], v[184:191], v10
ds_read_b128 v[184:187], v26 offset:22528
v_smfmac_f32_16x16x64_bf16 v[60:63], v[44:47], a[192:199], v10
ds_read_b128 v[188:191], v26 offset:23552
v_smfmac_f32_16x16x64_bf16 v[64:67], v[44:47], a[200:207], v10
s_waitcnt lgkmcnt(6)
v_smfmac_f32_16x16x64_bf16 v[60:63], v[56:59], v[160:167], v10
ds_read_b128 v[160:163], v26 offset:24576
v_smfmac_f32_16x16x64_bf16 v[68:71], v[44:47], a[208:215], v10
ds_read_b128 v[164:167], v26 offset:25600
v_smfmac_f32_16x16x64_bf16 v[72:75], v[44:47], a[216:223], v10
s_waitcnt lgkmcnt(6)
v_smfmac_f32_16x16x64_bf16 v[64:67], v[56:59], v[168:175], v10
ds_read_b128 v[168:171], v26 offset:26624
v_smfmac_f32_16x16x64_bf16 v[76:79], v[44:47], a[224:231], v10
ds_read_b128 v[172:175], v26 offset:27648
v_smfmac_f32_16x16x64_bf16 v[80:83], v[44:47], a[232:239], v10
s_waitcnt lgkmcnt(6)
v_smfmac_f32_16x16x64_bf16 v[68:71], v[56:59], v[176:183], v10
ds_read_b128 v[176:179], v26 offset:28672
v_smfmac_f32_16x16x64_bf16 v[84:87], v[44:47], a[240:247], v10
ds_read_b128 v[180:183], v26 offset:29696
v_smfmac_f32_16x16x64_bf16 v[88:91], v[44:47], a[248:255], v10
s_waitcnt lgkmcnt(6)
v_smfmac_f32_16x16x64_bf16 v[72:75], v[56:59], v[184:191], v10
ds_read_b128 v[184:187], v26 offset:30720
v_smfmac_f32_16x16x64_bf16 v[60:63], v[48:51], v[192:199], v10
ds_read_b128 v[188:191], v26 offset:31744
v_smfmac_f32_16x16x64_bf16 v[64:67], v[48:51], v[200:207], v10
s_waitcnt lgkmcnt(6)
v_smfmac_f32_16x16x64_bf16 v[76:79], v[56:59], v[160:167], v10
v_smfmac_f32_16x16x64_bf16 v[68:71], v[48:51], v[208:215], v10
v_smfmac_f32_16x16x64_bf16 v[72:75], v[48:51], v[216:223], v10
s_waitcnt lgkmcnt(4)
v_smfmac_f32_16x16x64_bf16 v[80:83], v[56:59], v[168:175], v10
v_smfmac_f32_16x16x64_bf16 v[76:79], v[48:51], v[224:231], v10
v_smfmac_f32_16x16x64_bf16 v[80:83], v[48:51], v[232:239], v10
s_waitcnt lgkmcnt(2)
v_smfmac_f32_16x16x64_bf16 v[84:87], v[56:59], v[176:183], v10
v_smfmac_f32_16x16x64_bf16 v[84:87], v[48:51], v[240:247], v10
v_smfmac_f32_16x16x64_bf16 v[88:91], v[48:51], v[248:255], v10
s_waitcnt lgkmcnt(0)
v_smfmac_f32_16x16x64_bf16 v[88:91], v[56:59], v[184:191], v10
s_nop 7
v_pk_add_f32 v[60:61], v[60:61], v[62:63]
v_pk_add_f32 v[64:65], v[64:65], v[66:67]
v_pk_add_f32 v[68:69], v[68:69], v[70:71]
v_pk_add_f32 v[72:73], v[72:73], v[74:75]
v_pk_add_f32 v[76:77], v[76:77], v[78:79]
v_pk_add_f32 v[80:81], v[80:81], v[82:83]
v_pk_add_f32 v[84:85], v[84:85], v[86:87]
v_pk_add_f32 v[88:89], v[88:89], v[90:91]
v_cvt_pk_bf16_f32 v124, v60, v61
v_cvt_pk_bf16_f32 v125, v64, v65
v_cvt_pk_bf16_f32 v126, v68, v69
v_cvt_pk_bf16_f32 v127, v72, v73
v_cvt_pk_bf16_f32 v132, v76, v77
v_cvt_pk_bf16_f32 v133, v80, v81
v_cvt_pk_bf16_f32 v134, v84, v85
v_cvt_pk_bf16_f32 v135, v88, v89
buffer_store_dwordx4 v[124:127], v2, s[8:11], s26 offen sc1
s_add_u32 s30, s26, 4096
buffer_store_dwordx4 v[132:135], v2, s[8:11], s30 offen sc1
v_mov_b32 v14, 65
s_waitcnt vmcnt(0)
buffer_store_dword v14, v16, s[8:11], s34 offen sc1
s_branch Lrec_done
Lcr_306:
buffer_load_dword v30, v13, s[8:11], s29 offen sc1
s_waitcnt vmcnt(0)
v_cmp_gt_u32 vcc, 32, v30
s_cbranch_vccz Lco_305
s_sleep 4

s_sub_u32 s19, s19, 1
s_cbranch_scc0 Lcr_306
s_mov_b32 s19, 0
s_branch Lco_305
Lpr2_316:
s_sub_u32 s19, s19, 1
s_cbranch_scc1 Lpr2_316x
s_waitcnt lgkmcnt(0)

v_mov_b32 v152, 0
v_mov_b32 v153, 0
v_mov_b32 v154, 0
v_mov_b32 v155, 0
v_mov_b32 v156, 0
v_mov_b32 v157, 0
v_mov_b32 v158, 0
v_mov_b32 v159, 0
s_branch Lpp_313
Lpr2_316x:
s_mov_b32 s19, 0
s_branch Lpa2_317
Lcr_320:
buffer_load_dword v30, v13, s[8:11], s29 offen sc1
s_waitcnt vmcnt(0)
v_cmp_gt_u32 vcc, 32, v30
s_cbranch_vccz Lco_319
s_sleep 4

s_sub_u32 s19, s19, 1
s_cbranch_scc0 Lcr_320
s_mov_b32 s19, 0
s_branch Lco_319
.p2align 6
Lrole_88:
v_cmp_gt_u32 vcc, 32, v30
s_cbranch_vccnz Lcr_326
Lco_325:
Ltop_324:
s_barrier
buffer_store_dwordx4 v[124:127], v2, s[8:11], s27 offen sc1
s_add_u32 s30, s27, 4096
buffer_store_dwordx4 v[132:135], v2, s[8:11], s30 offen sc1
buffer_store_dword v20, v25, s[8:11], s21 offen sc1
buffer_load_dwordx4 v[92:95], v21, s[8:11], s24 offen offset:0 sc1
v_mov_b32 v152, 0
v_mov_b32 v153, 0
v_mov_b32 v154, 0
v_mov_b32 v155, 0
v_mov_b32 v156, 0
buffer_load_dwordx4 v[96:99], v21, s[8:11], s24 offen offset:1024 sc1
v_mov_b32 v157, 0
v_mov_b32 v158, 0
v_mov_b32 v159, 0
v_mov_b32 v60, 0
v_mov_b32 v61, 0
buffer_load_dwordx4 v[100:103], v21, s[8:11], s24 offen offset:2048 sc1
v_mov_b32 v62, 0
v_mov_b32 v63, 0
v_mov_b32 v64, 0
v_mov_b32 v65, 0
v_mov_b32 v66, 0
buffer_load_dwordx4 v[104:107], v21, s[8:11], s24 offen offset:3072 sc1
v_mov_b32 v67, 0
v_mov_b32 v68, 0
v_mov_b32 v69, 0
v_mov_b32 v70, 0
v_mov_b32 v71, 0
buffer_load_dwordx4 v[108:111], v21, s[8:11], s39 offen offset:0 sc1
v_mov_b32 v72, 0
v_mov_b32 v73, 0
v_mov_b32 v74, 0
v_mov_b32 v75, 0
v_mov_b32 v76, 0
buffer_load_dwordx4 v[112:115], v21, s[8:11], s39 offen offset:1024 sc1
v_mov_b32 v77, 0
v_mov_b32 v78, 0
v_mov_b32 v79, 0
v_mov_b32 v80, 0
v_mov_b32 v81, 0
buffer_load_dwordx4 v[116:119], v21, s[8:11], s39 offen offset:2048 sc1
v_mov_b32 v82, 0
v_mov_b32 v83, 0
v_mov_b32 v84, 0
v_mov_b32 v85, 0
v_mov_b32 v86, 0
buffer_load_dwordx4 v[120:123], v21, s[8:11], s39 offen offset:3072 sc1
v_mov_b32 v87, 0
v_mov_b32 v88, 0
v_mov_b32 v89, 0
v_mov_b32 v90, 0
v_mov_b32 v91, 0
s_barrier
ds_read_b128 v[32:35], v3 offset:0
ds_read_b128 v[36:39], v4 offset:0
ds_read_b128 v[52:55], v8 offset:0
ds_read_b128 v[40:43], v5 offset:0
ds_read_b128 v[44:47], v6 offset:0
ds_read_b128 v[48:51], v7 offset:0
ds_read_b128 v[56:59], v9 offset:0
s_waitcnt lgkmcnt(6)
v_smfmac_f32_16x16x64_bf16 v[60:63], v[32:35], a[0:7], v10
ds_read_b128 v[160:163], v26 offset:0
v_smfmac_f32_16x16x64_bf16 v[64:67], v[32:35], a[8:15], v10
ds_read_b128 v[164:167], v26 offset:1024
v_smfmac_f32_16x16x64_bf16 v[68:71], v[32:35], a[16:23], v10
ds_read_b128 v[168:171], v26 offset:2048
v_smfmac_f32_16x16x64_bf16 v[72:75], v[32:35], a[24:31], v10
ds_read_b128 v[172:175], v26 offset:3072
v_smfmac_f32_16x16x64_bf16 v[76:79], v[32:35], a[32:39], v10
ds_read_b128 v[176:179], v26 offset:4096
v_smfmac_f32_16x16x64_bf16 v[80:83], v[32:35], a[40:47], v10
ds_read_b128 v[180:183], v26 offset:5120
v_smfmac_f32_16x16x64_bf16 v[84:87], v[32:35], a[48:55], v10
ds_read_b128 v[184:187], v26 offset:6144
v_smfmac_f32_16x16x64_bf16 v[88:91], v[32:35], a[56:63], v10
ds_read_b128 v[188:191], v26 offset:7168
s_waitcnt lgkmcnt(13)
v_smfmac_f32_16x16x64_bf16 v[60:63], v[36:39], a[64:71], v10
v_smfmac_f32_16x16x64_bf16 v[64:67], v[36:39], a[72:79], v10
s_waitcnt lgkmcnt(12)
s_waitcnt lgkmcnt(6)
v_smfmac_f32_16x16x64_bf16 v[60:63], v[52:55], v[160:167], v10
ds_read_b128 v[160:163], v26 offset:8192
v_smfmac_f32_16x16x64_bf16 v[68:71], v[36:39], a[80:87], v10
ds_read_b128 v[164:167], v26 offset:9216
v_smfmac_f32_16x16x64_bf16 v[72:75], v[36:39], a[88:95], v10
s_waitcnt lgkmcnt(6)
v_smfmac_f32_16x16x64_bf16 v[64:67], v[52:55], v[168:175], v10
ds_read_b128 v[168:171], v26 offset:10240
v_smfmac_f32_16x16x64_bf16 v[76:79], v[36:39], a[96:103], v10
ds_read_b128 v[172:175], v26 offset:11264
v_smfmac_f32_16x16x64_bf16 v[80:83], v[36:39], a[104:111], v10
s_waitcnt lgkmcnt(6)
v_smfmac_f32_16x16x64_bf16 v[68:71], v[52:55], v[176:183], v10
ds_read_b128 v[176:179], v26 offset:12288
v_smfmac_f32_16x16x64_bf16 v[84:87], v[36:39], a[112:119], v10
ds_read_b128 v[180:183], v26 offset:13312
v_smfmac_f32_16x16x64_bf16 v[88:91], v[36:39], a[120:127], v10
s_waitcnt lgkmcnt(6)
v_smfmac_f32_16x16x64_bf16 v[72:75], v[52:55], v[184:191], v10
ds_read_b128 v[184:187], v26 offset:14336
v_smfmac_f32_16x16x64_bf16 v[60:63], v[40:43], a[128:135], v10
ds_read_b128 v[188:191], v26 offset:15360
v_smfmac_f32_16x16x64_bf16 v[64:67], v[40:43], a[136:143], v10
s_waitcnt lgkmcnt(6)
v_smfmac_f32_16x16x64_bf16 v[76:79], v[52:55], v[160:167], v10
ds_read_b128 v[160:163], v26 offset:16384
v_smfmac_f32_16x16x64_bf16 v[68:71], v[40:43], a[144:151], v10
ds_read_b128 v[164:167], v26 offset:17408
v_smfmac_f32_16x16x64_bf16 v[72:75], v[40:43], a[152:159], v10
s_waitcnt lgkmcnt(6)
v_smfmac_f32_16x16x64_bf16 v[80:83], v[52:55], v[168:175], v10
ds_read_b128 v[168:171], v26 offset:18432
v_smfmac_f32_16x16x64_bf16 v[76:79], v[40:43], a[160:167], v10
ds_read_b128 v[172:175], v26 offset:19456
v_smfmac_f32_16x16x64_bf16 v[80:83], v[40:43], a[168:175], v10
s_waitcnt lgkmcnt(6)
v_smfmac_f32_16x16x64_bf16 v[84:87], v[52:55], v[176:183], v10
ds_read_b128 v[176:179], v26 offset:20480
v_smfmac_f32_16x16x64_bf16 v[84:87], v[40:43], a[176:183], v10
ds_read_b128 v[180:183], v26 offset:21504
v_smfmac_f32_16x16x64_bf16 v[88:91], v[40:43], a[184:191], v10
s_waitcnt lgkmcnt(6)
v_smfmac_f32_16x16x64_bf16 v[88:91], v[52:55], v[184:191], v10
ds_read_b128 v[184:187], v26 offset:22528
v_smfmac_f32_16x16x64_bf16 v[60:63], v[44:47], a[192:199], v10
ds_read_b128 v[188:191], v26 offset:23552
s_and_b32 s30, s18, 3
s_cmp_eq_u32 s30, 3
s_cbranch_scc0 Lsu_330
s_add_u32 s29, s29, 128
buffer_load_dword v30, v13, s[8:11], s29 offen sc1
Lsu_330:
v_smfmac_f32_16x16x64_bf16 v[64:67], v[44:47], a[200:207], v10
s_waitcnt lgkmcnt(6)
v_smfmac_f32_16x16x64_bf16 v[60:63], v[56:59], v[160:167], v10
ds_read_b128 v[160:163], v26 offset:24576
v_smfmac_f32_16x16x64_bf16 v[68:71], v[44:47], a[208:215], v10
ds_read_b128 v[164:167], v26 offset:25600
v_smfmac_f32_16x16x64_bf16 v[72:75], v[44:47], a[216:223], v10
s_waitcnt lgkmcnt(6)
v_smfmac_f32_16x16x64_bf16 v[64:67], v[56:59], v[168:175], v10
ds_read_b128 v[168:171], v26 offset:26624
v_smfmac_f32_16x16x64_bf16 v[76:79], v[44:47], a[224:231], v10
ds_read_b128 v[172:175], v26 offset:27648
v_smfmac_f32_16x16x64_bf16 v[80:83], v[44:47], a[232:239], v10
s_waitcnt lgkmcnt(6)
v_smfmac_f32_16x16x64_bf16 v[68:71], v[56:59], v[176:183], v10
ds_read_b128 v[176:179], v26 offset:28672
v_smfmac_f32_16x16x64_bf16 v[84:87], v[44:47], a[240:247], v10
ds_read_b128 v[180:183], v26 offset:29696
v_smfmac_f32_16x16x64_bf16 v[88:91], v[44:47], a[248:255], v10
s_waitcnt lgkmcnt(6)
v_smfmac_f32_16x16x64_bf16 v[72:75], v[56:59], v[184:191], v10
ds_read_b128 v[184:187], v26 offset:30720
v_smfmac_f32_16x16x64_bf16 v[60:63], v[48:51], v[192:199], v10
ds_read_b128 v[188:191], v26 offset:31744
v_smfmac_f32_16x16x64_bf16 v[64:67], v[48:51], v[200:207], v10
s_waitcnt lgkmcnt(6)
v_smfmac_f32_16x16x64_bf16 v[76:79], v[56:59], v[160:167], v10
v_smfmac_f32_16x16x64_bf16 v[68:71], v[48:51], v[208:215], v10
v_smfmac_f32_16x16x64_bf16 v[72:75], v[48:51], v[216:223], v10
s_waitcnt lgkmcnt(4)
v_smfmac_f32_16x16x64_bf16 v[80:83], v[56:59], v[168:175], v10
v_smfmac_f32_16x16x64_bf16 v[76:79], v[48:51], v[224:231], v10
v_smfmac_f32_16x16x64_bf16 v[80:83], v[48:51], v[232:239], v10
s_waitcnt lgkmcnt(2)
v_smfmac_f32_16x16x64_bf16 v[84:87], v[56:59], v[176:183], v10
v_smfmac_f32_16x16x64_bf16 v[84:87], v[48:51], v[240:247], v10
v_smfmac_f32_16x16x64_bf16 v[88:91], v[48:51], v[248:255], v10
s_waitcnt lgkmcnt(0)
v_smfmac_f32_16x16x64_bf16 v[88:91], v[56:59], v[184:191], v10
s_nop 7
v_pk_add_f32 v[60:61], v[60:61], v[62:63]
v_pk_add_f32 v[64:65], v[64:65], v[66:67]
v_pk_add_f32 v[68:69], v[68:69], v[70:71]
v_pk_add_f32 v[72:73], v[72:73], v[74:75]
v_pk_add_f32 v[76:77], v[76:77], v[78:79]
v_pk_add_f32 v[80:81], v[80:81], v[82:83]
v_pk_add_f32 v[84:85], v[84:85], v[86:87]
v_pk_add_f32 v[88:89], v[88:89], v[90:91]
v_cvt_pk_bf16_f32 v124, v60, v61
v_cvt_pk_bf16_f32 v125, v64, v65
v_cvt_pk_bf16_f32 v126, v68, v69
v_cvt_pk_bf16_f32 v127, v72, v73
v_cvt_pk_bf16_f32 v132, v76, v77
v_cvt_pk_bf16_f32 v133, v80, v81
v_cvt_pk_bf16_f32 v134, v84, v85
v_cvt_pk_bf16_f32 v135, v88, v89
s_mov_b64 exec, 15
buffer_load_dword v17, v31, s[8:11], s35 offen sc1
s_nop 15
buffer_load_dword v18, v31, s[8:11], s35 offen sc1
s_nop 15
buffer_load_dword v19, v31, s[8:11], s35 offen sc1
Lfp_331:
s_waitcnt vmcnt(2)
v_cmp_gt_u32 vcc, v14, v17
s_cbranch_vccz Lfg_332
buffer_load_dword v17, v31, s[8:11], s35 offen sc1
s_waitcnt vmcnt(2)
v_cmp_gt_u32 vcc, v14, v18
s_cbranch_vccz Lfg_332
buffer_load_dword v18, v31, s[8:11], s35 offen sc1
s_waitcnt vmcnt(2)
v_cmp_gt_u32 vcc, v14, v19
s_cbranch_vccz Lfg_332
buffer_load_dword v19, v31, s[8:11], s35 offen sc1

s_sub_u32 s19, s19, 1
s_cbranch_scc0 Lfp_331
s_mov_b32 s19, 0
Lfg_332:
s_mov_b64 exec, -1
Lpp_333:
buffer_load_dwordx4 v[140:143], v21, s[8:11], s22 offen sc1
buffer_load_dwordx4 v[144:147], v21, s[8:11], s22 offen offset:1024 sc1

buffer_load_dwordx4 v[148:151], v22, s[8:11], s22 offen sc1

s_waitcnt vmcnt(2)
v_smfmac_f32_16x16x64_bf16 v[152:155], v[140:143], v[92:99], v10
v_smfmac_f32_16x16x64_bf16 v[156:159], v[140:143], v[108:115], v10
s_waitcnt vmcnt(1)
buffer_store_dword v14, v16, s[8:11], s34 offen offset:2048 sc1
v_smfmac_f32_16x16x64_bf16 v[152:155], v[144:147], v[100:107], v10
v_smfmac_f32_16x16x64_bf16 v[156:159], v[144:147], v[116:123], v10
s_waitcnt vmcnt(1)
v_smfmac_f32_16x16x64_bf16 v[152:155], v[148:151], v[124:131], v10
v_smfmac_f32_16x16x64_bf16 v[156:159], v[148:151], v[132:139], v10
s_nop 6
v_pk_add_f32 v[152:153], v[152:153], v[154:155]
v_pk_add_f32 v[156:157], v[156:157], v[158:159]
ds_write2_b32 v23, v152, v153 offset0:0 offset1:16
ds_write2_b32 v29, v156, v157 offset0:0 offset1:16
v_cmp_u_f32 vcc, v152, v153
s_cbranch_vccnz Lpr2_336
Lpa2_337:
buffer_store_dword v14, v16, s[8:11], s34 offen sc1
s_waitcnt lgkmcnt(0)
s_barrier
ds_read2st64_b64 v[160:163], v24 offset0:0 offset1:1
ds_read2st64_b64 v[164:167], v24 offset0:2 offset1:3
s_waitcnt lgkmcnt(1)
v_pk_add_f32 v[160:161], v[160:161], v[162:163]
s_waitcnt lgkmcnt(0)
v_pk_add_f32 v[164:165], v[164:165], v[166:167]
v_pk_add_f32 v[160:161], v[160:161], v[164:165]
v_cvt_pk_bf16_f32 v160, v160, v161
buffer_store_dword v160, v25, s[8:11], s21 offen sc1
s_cmp_eq_u32 s18, 62
s_mov_b32 s30, 53993472
s_cselect_b32 s30, s30, 1073741824
s_cbranch_scc0 Llast_338
buffer_store_dword v160, v25, s[8:11], s30 offen sc1
Llast_338:
s_add_u32 s18, s18, 1
s_xor_b32 s20, s20, 8192
s_xor_b32 s21, s21, 8192
s_xor_b32 s22, s22, 16384
s_add_u32 s24, s24, 458752
s_add_u32 s39, s39, 458752
s_mov_b32 s27, s26
s_add_u32 s26, s26, 114688
s_lshl_b32 s28, s18, 13
s_add_u32 s28, s28, 53469184

v_cmp_gt_u32 vcc, 32, v30
s_cbranch_vccnz Lcr_340
Lco_339:
v_add_u32 v14, 1, v14
s_cmp_lt_u32 s18, 63
s_cbranch_scc1 Ltop_324
v_mov_b32 v60, 0
v_mov_b32 v61, 0
v_mov_b32 v62, 0
v_mov_b32 v63, 0
v_mov_b32 v64, 0
v_mov_b32 v65, 0
v_mov_b32 v66, 0
v_mov_b32 v67, 0
v_mov_b32 v68, 0
v_mov_b32 v69, 0
v_mov_b32 v70, 0
v_mov_b32 v71, 0
v_mov_b32 v72, 0
v_mov_b32 v73, 0
v_mov_b32 v74, 0
v_mov_b32 v75, 0
v_mov_b32 v76, 0
v_mov_b32 v77, 0
v_mov_b32 v78, 0
v_mov_b32 v79, 0
v_mov_b32 v80, 0
v_mov_b32 v81, 0
v_mov_b32 v82, 0
v_mov_b32 v83, 0
v_mov_b32 v84, 0
v_mov_b32 v85, 0
v_mov_b32 v86, 0
v_mov_b32 v87, 0
v_mov_b32 v88, 0
v_mov_b32 v89, 0
v_mov_b32 v90, 0
v_mov_b32 v91, 0
s_barrier
buffer_store_dwordx4 v[124:127], v2, s[8:11], s27 offen sc1
s_add_u32 s30, s27, 4096
buffer_store_dwordx4 v[132:135], v2, s[8:11], s30 offen sc1
s_barrier
ds_read_b128 v[32:35], v3 offset:0
ds_read_b128 v[36:39], v4 offset:0
ds_read_b128 v[52:55], v8 offset:0
ds_read_b128 v[40:43], v5 offset:0
ds_read_b128 v[44:47], v6 offset:0
ds_read_b128 v[48:51], v7 offset:0
ds_read_b128 v[56:59], v9 offset:0
s_waitcnt lgkmcnt(6)
v_smfmac_f32_16x16x64_bf16 v[60:63], v[32:35], a[0:7], v10
ds_read_b128 v[160:163], v26 offset:0
v_smfmac_f32_16x16x64_bf16 v[64:67], v[32:35], a[8:15], v10
ds_read_b128 v[164:167], v26 offset:1024
v_smfmac_f32_16x16x64_bf16 v[68:71], v[32:35], a[16:23], v10
ds_read_b128 v[168:171], v26 offset:2048
v_smfmac_f32_16x16x64_bf16 v[72:75], v[32:35], a[24:31], v10
ds_read_b128 v[172:175], v26 offset:3072
v_smfmac_f32_16x16x64_bf16 v[76:79], v[32:35], a[32:39], v10
ds_read_b128 v[176:179], v26 offset:4096
v_smfmac_f32_16x16x64_bf16 v[80:83], v[32:35], a[40:47], v10
ds_read_b128 v[180:183], v26 offset:5120
v_smfmac_f32_16x16x64_bf16 v[84:87], v[32:35], a[48:55], v10
ds_read_b128 v[184:187], v26 offset:6144
v_smfmac_f32_16x16x64_bf16 v[88:91], v[32:35], a[56:63], v10
ds_read_b128 v[188:191], v26 offset:7168
s_waitcnt lgkmcnt(13)
v_smfmac_f32_16x16x64_bf16 v[60:63], v[36:39], a[64:71], v10
v_smfmac_f32_16x16x64_bf16 v[64:67], v[36:39], a[72:79], v10
s_waitcnt lgkmcnt(12)
s_waitcnt lgkmcnt(6)
v_smfmac_f32_16x16x64_bf16 v[60:63], v[52:55], v[160:167], v10
ds_read_b128 v[160:163], v26 offset:8192
v_smfmac_f32_16x16x64_bf16 v[68:71], v[36:39], a[80:87], v10
ds_read_b128 v[164:167], v26 offset:9216
v_smfmac_f32_16x16x64_bf16 v[72:75], v[36:39], a[88:95], v10
s_waitcnt lgkmcnt(6)
v_smfmac_f32_16x16x64_bf16 v[64:67], v[52:55], v[168:175], v10
ds_read_b128 v[168:171], v26 offset:10240
v_smfmac_f32_16x16x64_bf16 v[76:79], v[36:39], a[96:103], v10
ds_read_b128 v[172:175], v26 offset:11264
v_smfmac_f32_16x16x64_bf16 v[80:83], v[36:39], a[104:111], v10
s_waitcnt lgkmcnt(6)
v_smfmac_f32_16x16x64_bf16 v[68:71], v[52:55], v[176:183], v10
ds_read_b128 v[176:179], v26 offset:12288
v_smfmac_f32_16x16x64_bf16 v[84:87], v[36:39], a[112:119], v10
ds_read_b128 v[180:183], v26 offset:13312
v_smfmac_f32_16x16x64_bf16 v[88:91], v[36:39], a[120:127], v10
s_waitcnt lgkmcnt(6)
v_smfmac_f32_16x16x64_bf16 v[72:75], v[52:55], v[184:191], v10
ds_read_b128 v[184:187], v26 offset:14336
v_smfmac_f32_16x16x64_bf16 v[60:63], v[40:43], a[128:135], v10
ds_read_b128 v[188:191], v26 offset:15360
v_smfmac_f32_16x16x64_bf16 v[64:67], v[40:43], a[136:143], v10
s_waitcnt lgkmcnt(6)
v_smfmac_f32_16x16x64_bf16 v[76:79], v[52:55], v[160:167], v10
ds_read_b128 v[160:163], v26 offset:16384
v_smfmac_f32_16x16x64_bf16 v[68:71], v[40:43], a[144:151], v10
ds_read_b128 v[164:167], v26 offset:17408
v_smfmac_f32_16x16x64_bf16 v[72:75], v[40:43], a[152:159], v10
s_waitcnt lgkmcnt(6)
v_smfmac_f32_16x16x64_bf16 v[80:83], v[52:55], v[168:175], v10
ds_read_b128 v[168:171], v26 offset:18432
v_smfmac_f32_16x16x64_bf16 v[76:79], v[40:43], a[160:167], v10
ds_read_b128 v[172:175], v26 offset:19456
v_smfmac_f32_16x16x64_bf16 v[80:83], v[40:43], a[168:175], v10
s_waitcnt lgkmcnt(6)
v_smfmac_f32_16x16x64_bf16 v[84:87], v[52:55], v[176:183], v10
ds_read_b128 v[176:179], v26 offset:20480
v_smfmac_f32_16x16x64_bf16 v[84:87], v[40:43], a[176:183], v10
ds_read_b128 v[180:183], v26 offset:21504
v_smfmac_f32_16x16x64_bf16 v[88:91], v[40:43], a[184:191], v10
s_waitcnt lgkmcnt(6)
v_smfmac_f32_16x16x64_bf16 v[88:91], v[52:55], v[184:191], v10
ds_read_b128 v[184:187], v26 offset:22528
v_smfmac_f32_16x16x64_bf16 v[60:63], v[44:47], a[192:199], v10
ds_read_b128 v[188:191], v26 offset:23552
v_smfmac_f32_16x16x64_bf16 v[64:67], v[44:47], a[200:207], v10
s_waitcnt lgkmcnt(6)
v_smfmac_f32_16x16x64_bf16 v[60:63], v[56:59], v[160:167], v10
ds_read_b128 v[160:163], v26 offset:24576
v_smfmac_f32_16x16x64_bf16 v[68:71], v[44:47], a[208:215], v10
ds_read_b128 v[164:167], v26 offset:25600
v_smfmac_f32_16x16x64_bf16 v[72:75], v[44:47], a[216:223], v10
s_waitcnt lgkmcnt(6)
v_smfmac_f32_16x16x64_bf16 v[64:67], v[56:59], v[168:175], v10
ds_read_b128 v[168:171], v26 offset:26624
v_smfmac_f32_16x16x64_bf16 v[76:79], v[44:47], a[224:231], v10
ds_read_b128 v[172:175], v26 offset:27648
v_smfmac_f32_16x16x64_bf16 v[80:83], v[44:47], a[232:239], v10
s_waitcnt lgkmcnt(6)
v_smfmac_f32_16x16x64_bf16 v[68:71], v[56:59], v[176:183], v10
ds_read_b128 v[176:179], v26 offset:28672
v_smfmac_f32_16x16x64_bf16 v[84:87], v[44:47], a[240:247], v10
ds_read_b128 v[180:183], v26 offset:29696
v_smfmac_f32_16x16x64_bf16 v[88:91], v[44:47], a[248:255], v10
s_waitcnt lgkmcnt(6)
v_smfmac_f32_16x16x64_bf16 v[72:75], v[56:59], v[184:191], v10
ds_read_b128 v[184:187], v26 offset:30720
v_smfmac_f32_16x16x64_bf16 v[60:63], v[48:51], v[192:199], v10
ds_read_b128 v[188:191], v26 offset:31744
v_smfmac_f32_16x16x64_bf16 v[64:67], v[48:51], v[200:207], v10
s_waitcnt lgkmcnt(6)
v_smfmac_f32_16x16x64_bf16 v[76:79], v[56:59], v[160:167], v10
v_smfmac_f32_16x16x64_bf16 v[68:71], v[48:51], v[208:215], v10
v_smfmac_f32_16x16x64_bf16 v[72:75], v[48:51], v[216:223], v10
s_waitcnt lgkmcnt(4)
v_smfmac_f32_16x16x64_bf16 v[80:83], v[56:59], v[168:175], v10
v_smfmac_f32_16x16x64_bf16 v[76:79], v[48:51], v[224:231], v10
v_smfmac_f32_16x16x64_bf16 v[80:83], v[48:51], v[232:239], v10
s_waitcnt lgkmcnt(2)
v_smfmac_f32_16x16x64_bf16 v[84:87], v[56:59], v[176:183], v10
v_smfmac_f32_16x16x64_bf16 v[84:87], v[48:51], v[240:247], v10
v_smfmac_f32_16x16x64_bf16 v[88:91], v[48:51], v[248:255], v10
s_waitcnt lgkmcnt(0)
v_smfmac_f32_16x16x64_bf16 v[88:91], v[56:59], v[184:191], v10
s_nop 7
v_pk_add_f32 v[60:61], v[60:61], v[62:63]
v_pk_add_f32 v[64:65], v[64:65], v[66:67]
v_pk_add_f32 v[68:69], v[68:69], v[70:71]
v_pk_add_f32 v[72:73], v[72:73], v[74:75]
v_pk_add_f32 v[76:77], v[76:77], v[78:79]
v_pk_add_f32 v[80:81], v[80:81], v[82:83]
v_pk_add_f32 v[84:85], v[84:85], v[86:87]
v_pk_add_f32 v[88:89], v[88:89], v[90:91]
v_cvt_pk_bf16_f32 v124, v60, v61
v_cvt_pk_bf16_f32 v125, v64, v65
v_cvt_pk_bf16_f32 v126, v68, v69
v_cvt_pk_bf16_f32 v127, v72, v73
v_cvt_pk_bf16_f32 v132, v76, v77
v_cvt_pk_bf16_f32 v133, v80, v81
v_cvt_pk_bf16_f32 v134, v84, v85
v_cvt_pk_bf16_f32 v135, v88, v89
buffer_store_dwordx4 v[124:127], v2, s[8:11], s26 offen sc1
s_add_u32 s30, s26, 4096
buffer_store_dwordx4 v[132:135], v2, s[8:11], s30 offen sc1
v_mov_b32 v14, 65
s_waitcnt vmcnt(0)
buffer_store_dword v14, v16, s[8:11], s34 offen sc1
s_branch Lrec_done
Lcr_326:
buffer_load_dword v30, v13, s[8:11], s29 offen sc1
s_waitcnt vmcnt(0)
v_cmp_gt_u32 vcc, 32, v30
s_cbranch_vccz Lco_325
s_sleep 4

s_sub_u32 s19, s19, 1
s_cbranch_scc0 Lcr_326
s_mov_b32 s19, 0
s_branch Lco_325
Lpr2_336:
s_sub_u32 s19, s19, 1
s_cbranch_scc1 Lpr2_336x
s_waitcnt lgkmcnt(0)

v_mov_b32 v152, 0
v_mov_b32 v153, 0
v_mov_b32 v154, 0
v_mov_b32 v155, 0
v_mov_b32 v156, 0
v_mov_b32 v157, 0
v_mov_b32 v158, 0
v_mov_b32 v159, 0
s_branch Lpp_333
Lpr2_336x:
s_mov_b32 s19, 0
s_branch Lpa2_337
Lcr_340:
buffer_load_dword v30, v13, s[8:11], s29 offen sc1
s_waitcnt vmcnt(0)
v_cmp_gt_u32 vcc, 32, v30
s_cbranch_vccz Lco_339
s_sleep 4

s_sub_u32 s19, s19, 1
s_cbranch_scc0 Lcr_340
s_mov_b32 s19, 0
s_branch Lco_339
Lrec_done:
Lend:
s_endpgm
.section .rodata,"a"
.p2align 6
.amdhsa_kernel recurrent_scan__memory_aug_recurrent_mem_tr__swiglu_ffn__prompt_kernel
  .amdhsa_next_free_vgpr 512
  .amdhsa_next_free_sgpr 102
  .amdhsa_accum_offset 256
  .amdhsa_group_segment_fixed_size 0
  .amdhsa_kernarg_size 112
  .amdhsa_user_sgpr_count 2
  .amdhsa_user_sgpr_kernarg_segment_ptr 1
  .amdhsa_system_sgpr_workgroup_id_x 1
  .amdhsa_float_denorm_mode_32 3
.end_amdhsa_kernel
.text
```
